```python
import torch

def _softmax(x, axis=-1):
    return torch.softmax(x, dim=axis)

def _gelu(x):
    return torch.nn.functional.gelu(x, approximate='tanh')

def _silu(x):
    return torch.nn.functional.silu(x)

def _sigmoid(x):
    return torch.sigmoid(x)

def _layernorm(x, axis=-1, eps=1e-05):
    m = x.mean(dim=axis, keepdim=True)
    v = x.var(dim=axis, keepdim=True, unbiased=False)
    return (x - m) / torch.sqrt(v + eps)

def _scatter_add(tgt, idx, src, axis=0):
    return tgt.clone().index_add_(axis, idx, src)

def _segment_sum(src, seg, n):
    out = torch.zeros((n,) + src.shape[1:], dtype=src.dtype)
    return out.index_add_(0, seg, src)

def _pad(x, pw):
    flat = tuple((v for pair in reversed(pw) for v in pair))
    return torch.nn.functional.pad(x, flat)
kernel_name = 'gated_mix__memory_aug_recurrent_mem_tr__swiglu_ffn__prompt'

def setup_inputs():

    _w = lambda a: (lambda t: t.to(torch.bfloat16) if t.is_floating_point() else t)(torch.as_tensor(a))

    def _A_setup():
        B, S, Dm = (1, 2048, 1024)
        H, Dh = (32, 128)
        M, seg = (8, 32)
        seg = min(seg, S)
        S = S // seg * seg
        return {'x': _w((lambda *s: torch.randn(*s, dtype=torch.bfloat16) * 0.05)(B, S, Dm)), 'mem0': _w((lambda *s: torch.randn(*s, dtype=torch.bfloat16) * 0.4)(B, M, Dm)), 'Wq': _w((lambda *s: torch.randn(*s, dtype=torch.bfloat16) * 6.4)(Dm, H, Dh) * Dm ** (-0.5)), 'Wk': _w((lambda *s: torch.randn(*s, dtype=torch.bfloat16) * 6.4)(Dm, H, Dh) * Dm ** (-0.5)), 'Wv': _w((lambda *s: torch.randn(*s, dtype=torch.bfloat16) * 0.4)(Dm, H, Dh) * Dm ** (-0.5)), 'Wo': _w((lambda *s: torch.randn(*s, dtype=torch.bfloat16) * 0.4)(H, Dh, Dm) * (H * Dh) ** (-0.5)), 'seg_len': seg}
    _A_in = _A_setup()

    def _B_setup():
        B, S, D, F = (1, 2048, 1024, 3584)
        return {'x': _w((lambda *s: torch.randn(*s, dtype=torch.bfloat16) * 0.05)(B, S, D)), 'w_gate': _w((lambda *s: torch.randn(*s, dtype=torch.bfloat16) * 0.05)(D, F)), 'w_up': _w((lambda *s: torch.randn(*s, dtype=torch.bfloat16) * 0.05)(D, F)), 'w_down': _w((lambda *s: torch.randn(*s, dtype=torch.bfloat16) * 0.05)(F, D))}
    _B_in = _B_setup()
    return {'A_x': _A_in['x'], 'A_mem0': _A_in['mem0'], 'A_Wq': _A_in['Wq'], 'A_Wk': _A_in['Wk'], 'A_Wv': _A_in['Wv'], 'A_Wo': _A_in['Wo'], 'A_seg_len': _A_in['seg_len'], 'B_x': _B_in['x'], 'B_w_gate': _B_in['w_gate'], 'B_w_up': _B_in['w_up'], 'B_w_down': _B_in['w_down'], 'gate_w': _w((lambda *s: torch.randn(*s, dtype=torch.bfloat16) * 0.05)(1024) * 16.0)}

def reference(A_x, A_mem0, A_Wq, A_Wk, A_Wv, A_Wo, A_seg_len, B_x, B_w_gate, B_w_up, B_w_down, gate_w):

    def _A_ref(x, mem0, Wq, Wk, Wv, Wo, seg_len):
        B, S, Dm = x.shape
        H, Dh = (Wq.shape[1], Wq.shape[2])
        M = mem0.shape[1]
        scale = Dh ** (-0.5)
        n_seg = S // seg_len
        L = M + seg_len
        idx = torch.arange(L)
        mask = (idx[:, None] < M) | (idx[:, None] >= idx[None, :])
        mem = mem0
        outs = []
        for s in range(n_seg):
            xs = x[:, s * seg_len:(s + 1) * seg_len, :].clone()
            h = torch.concatenate([mem, xs], axis=1)
            q = torch.einsum('btd,dhe->bhte', h, Wq)
            k = torch.einsum('btd,dhe->bhte', h, Wk)
            v = torch.einsum('btd,dhe->bhte', h, Wv)
            scores = torch.einsum('bhqe,bhke->bhqk', q, k) * scale
            scores = torch.where(mask[None, None], scores, -1000000000.0)
            p = _softmax(scores, axis=-1)
            o = torch.einsum('bhqk,bhke->bhqe', p, v)
            o = torch.einsum('bhte,hed->btd', o, Wo)
            mem = o[:, :M, :].clone()
            outs.append(o[:, M:, :])
        return torch.concatenate(outs, axis=1)

    def _B_ref(x, w_gate, w_up, w_down):
        g = _silu(x @ w_gate)
        u = x @ w_up
        return g * u @ w_down
    x = A_x
    g = _sigmoid((x * gate_w).sum(-1, keepdims=True))
    a = _A_ref(x, A_mem0, A_Wq, A_Wk, A_Wv, A_Wo, A_seg_len)
    b = _B_ref(x, B_w_gate, B_w_up, B_w_down)
    return g * a + (1 - g) * b
```

```asm
; @launch grid=(256,1,1) block=(256,1,1) lds=163840
.amdgcn_target "amdgcn-amd-amdhsa--gfx950"
.text
.globl gated_mix__memory_aug_recurrent_mem_tr__swiglu_ffn__prompt_kernel
.p2align 8
.type gated_mix__memory_aug_recurrent_mem_tr__swiglu_ffn__prompt_kernel,@function
gated_mix__memory_aug_recurrent_mem_tr__swiglu_ffn__prompt_kernel:
  s_cmp_ge_u32 s2, 256
  s_cbranch_scc1 .end0
  s_load_dwordx4 s[64:67], s[0:1], 0
  s_load_dwordx4 s[68:71], s[0:1], 16
  s_load_dwordx4 s[72:75], s[0:1], 32
  s_load_dwordx4 s[76:79], s[0:1], 48
  s_load_dwordx4 s[80:83], s[0:1], 64
  s_load_dwordx4 s[84:87], s[0:1], 80
  s_load_dwordx4 s[88:91], s[0:1], 96
  s_load_dwordx2 s[92:93], s[0:1], 112
  v_lshrrev_b32 v1, 6, v0
  s_nop 0
  v_readfirstlane_b32 s18, v1
  s_getreg_b32 s2, hwreg(HW_REG_XCC_ID, 0, 3)
  s_mov_b32 s20, 131072
  s_mov_b32 s3, 0
  s_mov_b32 s46, -1
  s_waitcnt lgkmcnt(0)
  s_mov_b32 s4, s92
  s_mov_b32 s5, s93
  s_mov_b32 s6, 0x10000000
  s_mov_b32 s7, 0x20000
  s_mov_b32 s8, s90
  s_mov_b32 s9, s91
  s_mov_b32 s10, 0x100
  s_mov_b32 s11, 0x20000
  s_cmp_gt_u32 s2, 1
  s_cbranch_scc1 .next
  s_cmp_lg_u32 s18, 0
  s_cbranch_scc1 .w0_1
  s_lshl_b32 s95, s2, 2
  v_mov_b32 v120, 1
  v_mov_b32 v121, 0
  s_mov_b64 exec, 1
  buffer_atomic_add v120, v121, s[8:11], s95 offen offset:0 sc0 sc1
  s_mov_b64 exec, -1
  s_waitcnt vmcnt(0)
  v_readfirstlane_b32 s94, v120
  s_nop 1
  v_mov_b32 v120, s94
  v_mov_b32 v121, 163776
  ds_write_b32 v121, v120
  s_waitcnt lgkmcnt(0)
.w0_1:
  s_barrier
  v_mov_b32 v121, 163776
  ds_read_b32 v120, v121
  s_waitcnt lgkmcnt(0)
  v_readfirstlane_b32 s94, v120
  s_barrier
  s_cmp_lt_u32 s94, 32
  s_cbranch_scc1 .chainp
.next:
  s_sub_u32 s20, s20, 32
  s_cbranch_scc1 .end
  s_cmp_lg_u32 s18, 0
  s_cbranch_scc1 .w0_2
  s_mov_b32 s94, 65535
  s_bitcmp1_b32 s3, 5
  s_cbranch_scc1 .dqo_3
  s_bitcmp1_b32 s3, 2
  s_cbranch_scc1 .dqp_7
  s_bitcmp1_b32 s3, 4
  s_cbranch_scc1 .dqs_9
  s_lshl_b32 s95, s2, 2
  v_mov_b32 v120, 1
  v_mov_b32 v121, 0
  s_mov_b64 exec, 1
  buffer_atomic_add v120, v121, s[8:11], s95 offen offset:32 sc0 sc1
  s_mov_b64 exec, -1
  s_mov_b32 s99, 0
  s_waitcnt vmcnt(0)
  v_readfirstlane_b32 s96, v120
  s_cmp_lt_u32 s96, 32
  s_cbranch_scc1 .dqt_8
  s_bitset1_b32 s3, 4
.dqs_9:
  s_bitcmp1_b32 s3, 0
  s_cbranch_scc1 .ini_11
  v_mov_b32 v121, 0
.inl_12:
  buffer_load_dword v120, v121, s[8:11], 0 offen offset:20 sc1
  s_waitcnt vmcnt(0)
  v_readfirstlane_b32 s95, v120
  s_or_b32 s3, s3, s95
  s_bitcmp1_b32 s3, 0
  s_cbranch_scc1 .ini_11
  s_sleep 2
  s_sub_u32 s20, s20, 1
  s_cbranch_scc0 .inl_12
  v_mov_b32 v120, 0xdead
  v_mov_b32 v121, 0
  buffer_store_dword v120, v121, s[8:11], 0 offen offset:28 sc1
  s_mov_b32 s20, 0
  s_mov_b32 s94, 65535
  s_branch .dqo_3
.ini_11:
  s_lshl_b32 s95, s2, 7
  s_add_u32 s95, s95, 123760640
  v_mov_b32 v120, 1
  v_mov_b32 v121, 0
  s_mov_b64 exec, 1
  buffer_atomic_add v120, v121, s[4:7], s95 offen sc0 sc1
  s_mov_b64 exec, -1
  s_mov_b32 s99, 0
  s_bitcmp1_b32 s3, 1
  s_cbranch_scc1 .dqu_10
  s_lshl_b32 s95, s2, 2
  v_mov_b32 v121, 0
  s_mov_b64 exec, 1
  buffer_load_dwordx4 v[124:127], v121, s[8:11], 0 offen offset:8 sc1
  buffer_load_dword v122, v121, s[8:11], s95 offen offset:32 sc1
  s_mov_b64 exec, -1
  s_waitcnt vmcnt(0)
  v_readfirstlane_b32 s99, v124
  v_readfirstlane_b32 s95, v127
  v_readfirstlane_b32 s94, v122
  s_or_b32 s3, s3, s95
  s_cmp_ge_u32 s94, 32
  s_cselect_b32 s94, 16, 0
  s_or_b32 s3, s3, s94
  s_and_b32 s94, s99, 65791
  s_cmp_eq_u32 s94, 65
  s_cselect_b32 s94, 2, 0
  s_or_b32 s3, s3, s94
.dqu_10:
  s_waitcnt vmcnt(0)
  v_readfirstlane_b32 s96, v120
  s_add_u32 s96, s96, 32
.dqt_8:
  s_lshr_b32 s97, s96, 5
  s_and_b32 s96, s96, 31
  s_mov_b32 s94, 65535
  s_cmp_ge_u32 s97, 128
  s_cbranch_scc1 .dqo_3
  s_lshl_b32 s98, s2, 7
  s_add_u32 s98, s98, s97
  s_lshl_b32 s98, s98, 2
  s_add_u32 s98, s98, 123748352
  s_bitcmp1_b32 s3, 2
  s_bitset0_b32 s3, 2
  s_cselect_b32 s95, 1, s96
  s_cmp_eq_u32 s95, 0
  s_cbranch_scc1 .dqlead_4
  v_mov_b32 v121, 0
.dql_6:
  s_cmp_eq_u32 s97, 0
  s_cbranch_scc1 .dq0_13
  buffer_load_dword v120, v121, s[4:7], s98 offen sc1
  s_branch .dq1_14
.dq0_13:
  s_lshl_b32 s95, s2, 2
  buffer_load_dword v120, v121, s[8:11], s95 offen offset:192 sc1
.dq1_14:
  s_waitcnt vmcnt(0)
  v_readfirstlane_b32 s94, v120
  s_sub_u32 s94, s94, 1
  s_cbranch_scc0 .dqgot_5
  s_sleep 4
  s_sub_u32 s20, s20, 1
  s_cbranch_scc0 .dql_6
  v_mov_b32 v120, 0xdead
  v_mov_b32 v121, 0
  buffer_store_dword v120, v121, s[8:11], 0 offen offset:28 sc1
  s_mov_b32 s20, 0
  s_mov_b32 s94, 65535
  s_branch .dqo_3
.dqp_7:
  s_mov_b32 s96, s36
  s_mov_b32 s99, s39
  s_sub_u32 s94, s38, 1
  s_cbranch_scc1 .dqt_8
  s_bitset0_b32 s3, 2
  s_and_b32 s96, s96, 31
  s_branch .dqgot_5
.dqlead_4:
  v_mov_b32 v120, 1
  v_mov_b32 v121, 0
  s_mov_b64 exec, 1
  buffer_atomic_add v120, v121, s[8:11], 0 offen offset:160 sc0 sc1
  s_mov_b64 exec, -1
  s_waitcnt vmcnt(0)
  v_readfirstlane_b32 s94, v120
  s_add_u32 s95, s94, 1
  v_mov_b32 v120, s95
  s_mov_b64 exec, 1
  s_cmp_eq_u32 s97, 0
  s_cbranch_scc1 .dq0_15
  buffer_store_dword v120, v121, s[4:7], s98 offen sc1
  s_mov_b64 exec, -1
  s_branch .dqgot_5
.dq0_15:
  s_lshl_b32 s95, s2, 2
  buffer_store_dword v120, v121, s[8:11], s95 offen offset:192 sc1
  s_mov_b64 exec, -1
.dqgot_5:
  s_min_u32 s94, s94, 1023
  s_lshl_b32 s94, s94, 5
  s_or_b32 s94, s94, s96
  s_bitcmp0_b32 s99, 16
  s_cbranch_scc1 .dqo_3
  s_bitcmp1_b32 s3, 1
  s_cbranch_scc1 .dqo_3
  s_cmp_lt_u32 s94, 512
  s_cbranch_scc1 .dqo_3
  s_mov_b32 s99, s94
  v_mov_b32 v120, 1
  v_mov_b32 v121, 0
  s_mov_b64 exec, 1
  buffer_atomic_add v120, v121, s[8:11], 0 offen offset:24 sc0 sc1
  s_mov_b64 exec, -1
  s_waitcnt vmcnt(0)
  v_readfirstlane_b32 s94, v120
  s_or_b32 s3, s3, 2
  s_cmp_ge_u32 s94, 64
  s_cbranch_scc1 .dqb_16
  s_lshl_b32 s94, s94, 17
  s_or_b32 s94, s94, 65536
  s_or_b32 s94, s94, s99
  s_branch .dqo_3
.dqb_16:
  s_mov_b32 s94, s99
.dqo_3:
  v_mov_b32 v120, s94
  v_mov_b32 v121, 163776
  ds_write_b32 v121, v120
  s_waitcnt lgkmcnt(0)
.w0_2:
  s_barrier
  v_mov_b32 v121, 163776
  ds_read_b32 v120, v121
  s_waitcnt lgkmcnt(0)
  v_readfirstlane_b32 s94, v120
  s_barrier
  s_and_b32 s46, s94, 65535
  s_bitcmp0_b32 s94, 16
  s_cbranch_scc1 .decode
  s_lshr_b32 s94, s94, 17
  s_branch .chainf
.special:
  s_bitcmp0_b32 s94, 16
  s_cbranch_scc1 .end
  s_and_b32 s94, s94, 63
  s_branch .chainf
.decode:
  s_lshr_b32 s94, s46, 5
  s_and_b32 s95, s46, 31
  s_mov_b32 s96, s94
  s_sub_u32 s94, s96, 0
  s_cmp_lt_u32 s96, 16
  s_cbranch_scc1 .tKV_18
  s_sub_u32 s94, s96, 8
  s_cmp_lt_u32 s96, 24
  s_cbranch_scc1 .tGU_19
  s_sub_u32 s94, s96, 23
  s_cmp_lt_u32 s96, 25
  s_cbranch_scc1 .tDN_20
  s_sub_u32 s94, s96, 25
  s_cmp_lt_u32 s96, 29
  s_cbranch_scc1 .tQ_21
  s_sub_u32 s94, s96, 29
  s_cmp_lt_u32 s96, 37
  s_cbranch_scc1 .tGU_19
  s_sub_u32 s94, s96, 37
  s_cmp_lt_u32 s96, 41
  s_cbranch_scc1 .tAT_22
  s_sub_u32 s94, s96, 37
  s_cmp_lt_u32 s96, 43
  s_cbranch_scc1 .tQ_21
  s_sub_u32 s94, s96, 43
  s_cmp_lt_u32 s96, 44
  s_cbranch_scc1 .tDN_20
  s_sub_u32 s94, s96, 44
  s_cmp_lt_u32 s96, 45
  s_cbranch_scc1 .tOP_23
  s_sub_u32 s94, s96, 39
  s_cmp_lt_u32 s96, 47
  s_cbranch_scc1 .tQ_21
  s_sub_u32 s94, s96, 43
  s_cmp_lt_u32 s96, 48
  s_cbranch_scc1 .tAT_22
  s_sub_u32 s94, s96, 48
  s_cmp_lt_u32 s96, 51
  s_cbranch_scc1 .tOPS_24
  s_sub_u32 s94, s96, 50
  s_cmp_lt_u32 s96, 52
  s_cbranch_scc1 .tOP_23
  s_sub_u32 s94, s96, 47
  s_cmp_lt_u32 s96, 54
  s_cbranch_scc1 .tAT_22
  s_sub_u32 s94, s96, 40
  s_cmp_lt_u32 s96, 56
  s_cbranch_scc1 .tAX_25
.end:
  s_waitcnt vmcnt(0)
.end0:
  s_endpgm
.tKV_18:
  s_cmp_lg_u32 s46, 0
  s_cbranch_scc1 .noz_26
  v_mbcnt_lo_u32_b32 v120, -1, 0
  v_mbcnt_hi_u32_b32 v120, -1, v120
  s_lshl_b32 s96, s18, 10
  v_lshlrev_b32 v120, 4, v120
  v_add_u32 v120, s96, v120
  v_mov_b64 v[124:125], 0
  v_mov_b64 v[126:127], 0
  s_mov_b32 s96, 123731968
  buffer_store_dwordx4 v[124:127], v120, s[4:7], s96 offen sc1
  s_mov_b32 s96, 123736064
  buffer_store_dwordx4 v[124:127], v120, s[4:7], s96 offen sc1
  s_mov_b32 s96, 123740160
  buffer_store_dwordx4 v[124:127], v120, s[4:7], s96 offen sc1
  s_mov_b32 s96, 123744256
  buffer_store_dwordx4 v[124:127], v120, s[4:7], s96 offen sc1
  s_mov_b32 s96, 123748352
  buffer_store_dwordx4 v[124:127], v120, s[4:7], s96 offen sc1
  s_mov_b32 s96, 123752448
  buffer_store_dwordx4 v[124:127], v120, s[4:7], s96 offen sc1
  s_mov_b32 s96, 123756544
  buffer_store_dwordx4 v[124:127], v120, s[4:7], s96 offen sc1
  s_mov_b32 s96, 123760640
  buffer_store_dwordx4 v[124:127], v120, s[4:7], s96 offen sc1
  s_waitcnt vmcnt(0)
  s_barrier
  s_cmp_lg_u32 s18, 0
  s_cbranch_scc1 .w0_27
  v_mov_b32 v120, 1
  v_mov_b32 v121, 0
  s_mov_b64 exec, 1
  buffer_atomic_add v120, v121, s[8:11], 0 offen offset:20 sc1
  s_mov_b64 exec, -1
.w0_27:
.noz_26:
  s_lshr_b32 s96, s95, 3
  s_and_b32 s95, s95, 7
  s_lshl_b32 s95, s95, 2
  s_add_u32 s95, s95, s96
  s_lshr_b32 s51, s94, 2
  s_lshl_b32 s51, s51, 2
  s_and_b32 s96, s95, 3
  s_add_u32 s51, s51, s96
  s_and_b32 s97, s94, 3
  s_mul_i32 s52, s97, 8
  s_lshr_b32 s96, s95, 2
  s_add_u32 s52, s52, s96
  s_mov_b32 s24, s64
  s_mov_b32 s25, s65
  s_mov_b32 s26, 0x400000
  s_mov_b32 s27, 0x20000
  s_lshl_b32 s40, s51, 18
  s_mov_b32 s60, 2048
  s_mov_b32 s44, 16
  s_mov_b32 s55, 128
  s_lshl_b32 s54, s51, 7
  s_add_u32 s54, s54, 123731968
  s_cmp_ge_u32 s52, 16
  s_cbranch_scc1 .tv_28
  s_mov_b32 s28, s70
  s_mov_b32 s29, s71
  s_mov_b32 s30, 0x800000
  s_mov_b32 s31, 0x20000
  s_mov_b32 s32, s70
  s_mov_b32 s33, s71
  s_mov_b32 s34, 0x800000
  s_mov_b32 s35, 0x20000
  s_lshl_b32 s41, s52, 9
  s_add_u32 s42, s41, 256
  s_mov_b32 s61, 8192
  s_mov_b32 s43, 524288
  s_lshl_b32 s50, s51, 20
  s_lshl_b32 s96, s52, 14
  s_add_u32 s50, s50, s96
  s_lshl_b32 s96, s18, 11
  s_add_u32 s50, s50, s96
  s_add_u32 s50, s50, 33554432
  s_mov_b32 s53, 1
  s_branch .gemm
.tv_28:
  s_sub_u32 s52, s52, 16
  s_mov_b32 s28, s72
  s_mov_b32 s29, s73
  s_mov_b32 s30, 0x800000
  s_mov_b32 s31, 0x20000
  s_mov_b32 s32, s72
  s_mov_b32 s33, s73
  s_mov_b32 s34, 0x800000
  s_mov_b32 s35, 0x20000
  s_lshl_b32 s41, s52, 9
  s_add_u32 s42, s41, 256
  s_mov_b32 s61, 8192
  s_mov_b32 s43, 524288
  s_lshl_b32 s50, s51, 20
  s_lshl_b32 s96, s52, 14
  s_add_u32 s50, s50, s96
  s_lshl_b32 s96, s18, 11
  s_add_u32 s50, s50, s96
  s_add_u32 s50, s50, 16777216
  s_and_b32 s53, s44, 0
  s_add_u32 s53, s53, 5
  s_branch .gemm
.tQ_21:
  s_lshr_b32 s51, s94, 1
  s_lshl_b32 s51, s51, 2
  s_and_b32 s96, s95, 3
  s_add_u32 s51, s51, s96
  s_and_b32 s97, s94, 1
  s_mul_i32 s52, s97, 8
  s_lshr_b32 s96, s95, 2
  s_add_u32 s52, s52, s96
  s_mov_b32 s24, s64
  s_mov_b32 s25, s65
  s_mov_b32 s26, 0x400000
  s_mov_b32 s27, 0x20000
  s_lshl_b32 s40, s51, 18
  s_mov_b32 s60, 2048
  s_mov_b32 s44, 16
  s_mov_b32 s55, 128
  s_lshl_b32 s54, s51, 7
  s_add_u32 s54, s54, 123734016
  s_mov_b32 s28, s68
  s_mov_b32 s29, s69
  s_mov_b32 s30, 0x800000
  s_mov_b32 s31, 0x20000
  s_mov_b32 s32, s68
  s_mov_b32 s33, s69
  s_mov_b32 s34, 0x800000
  s_mov_b32 s35, 0x20000
  s_lshl_b32 s41, s52, 9
  s_add_u32 s42, s41, 256
  s_mov_b32 s61, 8192
  s_mov_b32 s43, 524288
  s_lshl_b32 s50, s51, 20
  s_lshl_b32 s96, s52, 14
  s_add_u32 s50, s50, s96
  s_lshl_b32 s96, s18, 11
  s_add_u32 s50, s50, s96
  s_add_u32 s50, s50, 0
  s_mov_b32 s53, 0
  s_branch .gemm
.tGU_19:
  s_lshr_b32 s51, s94, 2
  s_lshl_b32 s51, s51, 2
  s_and_b32 s96, s95, 3
  s_add_u32 s51, s51, s96
  s_and_b32 s97, s94, 3
  s_mul_i32 s52, s97, 7
  s_lshr_b32 s96, s95, 2
  s_add_u32 s52, s52, s96
  s_cmp_ge_u32 s95, 28
  s_cbranch_scc1 .tg_29
  s_mov_b32 s24, s64
  s_mov_b32 s25, s65
  s_mov_b32 s26, 0x400000
  s_mov_b32 s27, 0x20000
  s_lshl_b32 s40, s51, 18
  s_mov_b32 s60, 2048
  s_mov_b32 s44, 16
  s_mov_b32 s55, 128
  s_lshl_b32 s54, s51, 7
  s_add_u32 s54, s54, 123736064
  s_mov_b32 s28, s80
  s_mov_b32 s29, s81
  s_mov_b32 s30, 0x700000
  s_mov_b32 s31, 0x20000
  s_mov_b32 s32, s82
  s_mov_b32 s33, s83
  s_mov_b32 s34, 0x700000
  s_mov_b32 s35, 0x20000
  s_lshl_b32 s41, s52, 8
  s_mov_b32 s42, s41
  s_mov_b32 s61, 7168
  s_mov_b32 s43, 458752
  s_mul_i32 s50, s51, 917504
  s_lshl_b32 s96, s52, 13
  s_add_u32 s50, s50, s96
  s_lshl_b32 s96, s18, 11
  s_add_u32 s50, s50, s96
  s_add_u32 s50, s50, 50331648
  s_mov_b32 s53, 2
  s_branch .gemm
.tg_29:
  s_cmp_lg_u32 s97, 0
  s_cbranch_scc1 .next
  s_lshl_b32 s54, s51, 7
  s_add_u32 s54, s54, 123738112
  v_mbcnt_lo_u32_b32 v16, -1, 0
  v_mbcnt_hi_u32_b32 v16, -1, v16
  s_mov_b32 s24, s64
  s_mov_b32 s25, s65
  s_mov_b32 s26, 0x400000
  s_mov_b32 s27, 0x20000
  s_mov_b32 s28, s86
  s_mov_b32 s29, s87
  s_mov_b32 s30, 0x800
  s_mov_b32 s31, 0x20000
  v_and_b32 v18, 31, v16
  v_lshrrev_b32 v19, 5, v16
  v_lshlrev_b32 v19, 10, v19
  v_lshl_add_u32 v18, v18, 11, v19
  s_lshl_b32 s56, s51, 2
  s_add_u32 s56, s56, s18
  s_lshl_b32 s57, s56, 16
  v_mov_b32 v24, 0
  v_mov_b32 v25, 0
  v_mov_b32 v26, 0
  v_mov_b32 v27, 0
  buffer_load_dwordx4 v[32:35], v18, s[24:27], s57 offen offset:0
  buffer_load_dwordx4 v[128:131], v19, s[28:31], 0 offen offset:0
  buffer_load_dwordx4 v[36:39], v18, s[24:27], s57 offen offset:16
  buffer_load_dwordx4 v[132:135], v19, s[28:31], 0 offen offset:16
  buffer_load_dwordx4 v[40:43], v18, s[24:27], s57 offen offset:32
  buffer_load_dwordx4 v[136:139], v19, s[28:31], 0 offen offset:32
  buffer_load_dwordx4 v[44:47], v18, s[24:27], s57 offen offset:48
  buffer_load_dwordx4 v[140:143], v19, s[28:31], 0 offen offset:48
  buffer_load_dwordx4 v[48:51], v18, s[24:27], s57 offen offset:64
  buffer_load_dwordx4 v[144:147], v19, s[28:31], 0 offen offset:64
  buffer_load_dwordx4 v[52:55], v18, s[24:27], s57 offen offset:80
  buffer_load_dwordx4 v[148:151], v19, s[28:31], 0 offen offset:80
  buffer_load_dwordx4 v[56:59], v18, s[24:27], s57 offen offset:96
  buffer_load_dwordx4 v[152:155], v19, s[28:31], 0 offen offset:96
  buffer_load_dwordx4 v[60:63], v18, s[24:27], s57 offen offset:112
  buffer_load_dwordx4 v[156:159], v19, s[28:31], 0 offen offset:112
  buffer_load_dwordx4 v[64:67], v18, s[24:27], s57 offen offset:128
  buffer_load_dwordx4 v[160:163], v19, s[28:31], 0 offen offset:128
  buffer_load_dwordx4 v[68:71], v18, s[24:27], s57 offen offset:144
  buffer_load_dwordx4 v[164:167], v19, s[28:31], 0 offen offset:144
  buffer_load_dwordx4 v[72:75], v18, s[24:27], s57 offen offset:160
  buffer_load_dwordx4 v[168:171], v19, s[28:31], 0 offen offset:160
  buffer_load_dwordx4 v[76:79], v18, s[24:27], s57 offen offset:176
  buffer_load_dwordx4 v[172:175], v19, s[28:31], 0 offen offset:176
  buffer_load_dwordx4 v[80:83], v18, s[24:27], s57 offen offset:192
  buffer_load_dwordx4 v[176:179], v19, s[28:31], 0 offen offset:192
  buffer_load_dwordx4 v[84:87], v18, s[24:27], s57 offen offset:208
  buffer_load_dwordx4 v[180:183], v19, s[28:31], 0 offen offset:208
  buffer_load_dwordx4 v[88:91], v18, s[24:27], s57 offen offset:224
  buffer_load_dwordx4 v[184:187], v19, s[28:31], 0 offen offset:224
  buffer_load_dwordx4 v[92:95], v18, s[24:27], s57 offen offset:240
  buffer_load_dwordx4 v[188:191], v19, s[28:31], 0 offen offset:240
  s_waitcnt vmcnt(30)
  v_dot2c_f32_bf16 v24, v32, v128
  v_dot2c_f32_bf16 v25, v33, v129
  v_dot2c_f32_bf16 v26, v34, v130
  v_dot2c_f32_bf16 v27, v35, v131
  s_waitcnt vmcnt(28)
  v_dot2c_f32_bf16 v24, v36, v132
  v_dot2c_f32_bf16 v25, v37, v133
  v_dot2c_f32_bf16 v26, v38, v134
  v_dot2c_f32_bf16 v27, v39, v135
  s_waitcnt vmcnt(26)
  v_dot2c_f32_bf16 v24, v40, v136
  v_dot2c_f32_bf16 v25, v41, v137
  v_dot2c_f32_bf16 v26, v42, v138
  v_dot2c_f32_bf16 v27, v43, v139
  s_waitcnt vmcnt(24)
  v_dot2c_f32_bf16 v24, v44, v140
  v_dot2c_f32_bf16 v25, v45, v141
  v_dot2c_f32_bf16 v26, v46, v142
  v_dot2c_f32_bf16 v27, v47, v143
  s_waitcnt vmcnt(22)
  v_dot2c_f32_bf16 v24, v48, v144
  v_dot2c_f32_bf16 v25, v49, v145
  v_dot2c_f32_bf16 v26, v50, v146
  v_dot2c_f32_bf16 v27, v51, v147
  s_waitcnt vmcnt(20)
  v_dot2c_f32_bf16 v24, v52, v148
  v_dot2c_f32_bf16 v25, v53, v149
  v_dot2c_f32_bf16 v26, v54, v150
  v_dot2c_f32_bf16 v27, v55, v151
  s_waitcnt vmcnt(18)
  v_dot2c_f32_bf16 v24, v56, v152
  v_dot2c_f32_bf16 v25, v57, v153
  v_dot2c_f32_bf16 v26, v58, v154
  v_dot2c_f32_bf16 v27, v59, v155
  s_waitcnt vmcnt(16)
  v_dot2c_f32_bf16 v24, v60, v156
  v_dot2c_f32_bf16 v25, v61, v157
  v_dot2c_f32_bf16 v26, v62, v158
  v_dot2c_f32_bf16 v27, v63, v159
  s_waitcnt vmcnt(14)
  v_dot2c_f32_bf16 v24, v64, v160
  v_dot2c_f32_bf16 v25, v65, v161
  v_dot2c_f32_bf16 v26, v66, v162
  v_dot2c_f32_bf16 v27, v67, v163
  s_waitcnt vmcnt(12)
  v_dot2c_f32_bf16 v24, v68, v164
  v_dot2c_f32_bf16 v25, v69, v165
  v_dot2c_f32_bf16 v26, v70, v166
  v_dot2c_f32_bf16 v27, v71, v167
  s_waitcnt vmcnt(10)
  v_dot2c_f32_bf16 v24, v72, v168
  v_dot2c_f32_bf16 v25, v73, v169
  v_dot2c_f32_bf16 v26, v74, v170
  v_dot2c_f32_bf16 v27, v75, v171
  s_waitcnt vmcnt(8)
  v_dot2c_f32_bf16 v24, v76, v172
  v_dot2c_f32_bf16 v25, v77, v173
  v_dot2c_f32_bf16 v26, v78, v174
  v_dot2c_f32_bf16 v27, v79, v175
  s_waitcnt vmcnt(6)
  v_dot2c_f32_bf16 v24, v80, v176
  v_dot2c_f32_bf16 v25, v81, v177
  v_dot2c_f32_bf16 v26, v82, v178
  v_dot2c_f32_bf16 v27, v83, v179
  s_waitcnt vmcnt(4)
  v_dot2c_f32_bf16 v24, v84, v180
  v_dot2c_f32_bf16 v25, v85, v181
  v_dot2c_f32_bf16 v26, v86, v182
  v_dot2c_f32_bf16 v27, v87, v183
  s_waitcnt vmcnt(2)
  v_dot2c_f32_bf16 v24, v88, v184
  v_dot2c_f32_bf16 v25, v89, v185
  v_dot2c_f32_bf16 v26, v90, v186
  v_dot2c_f32_bf16 v27, v91, v187
  s_waitcnt vmcnt(0)
  v_dot2c_f32_bf16 v24, v92, v188
  v_dot2c_f32_bf16 v25, v93, v189
  v_dot2c_f32_bf16 v26, v94, v190
  v_dot2c_f32_bf16 v27, v95, v191
  buffer_load_dwordx4 v[32:35], v18, s[24:27], s57 offen offset:256
  buffer_load_dwordx4 v[128:131], v19, s[28:31], 0 offen offset:256
  buffer_load_dwordx4 v[36:39], v18, s[24:27], s57 offen offset:272
  buffer_load_dwordx4 v[132:135], v19, s[28:31], 0 offen offset:272
  buffer_load_dwordx4 v[40:43], v18, s[24:27], s57 offen offset:288
  buffer_load_dwordx4 v[136:139], v19, s[28:31], 0 offen offset:288
  buffer_load_dwordx4 v[44:47], v18, s[24:27], s57 offen offset:304
  buffer_load_dwordx4 v[140:143], v19, s[28:31], 0 offen offset:304
  buffer_load_dwordx4 v[48:51], v18, s[24:27], s57 offen offset:320
  buffer_load_dwordx4 v[144:147], v19, s[28:31], 0 offen offset:320
  buffer_load_dwordx4 v[52:55], v18, s[24:27], s57 offen offset:336
  buffer_load_dwordx4 v[148:151], v19, s[28:31], 0 offen offset:336
  buffer_load_dwordx4 v[56:59], v18, s[24:27], s57 offen offset:352
  buffer_load_dwordx4 v[152:155], v19, s[28:31], 0 offen offset:352
  buffer_load_dwordx4 v[60:63], v18, s[24:27], s57 offen offset:368
  buffer_load_dwordx4 v[156:159], v19, s[28:31], 0 offen offset:368
  buffer_load_dwordx4 v[64:67], v18, s[24:27], s57 offen offset:384
  buffer_load_dwordx4 v[160:163], v19, s[28:31], 0 offen offset:384
  buffer_load_dwordx4 v[68:71], v18, s[24:27], s57 offen offset:400
  buffer_load_dwordx4 v[164:167], v19, s[28:31], 0 offen offset:400
  buffer_load_dwordx4 v[72:75], v18, s[24:27], s57 offen offset:416
  buffer_load_dwordx4 v[168:171], v19, s[28:31], 0 offen offset:416
  buffer_load_dwordx4 v[76:79], v18, s[24:27], s57 offen offset:432
  buffer_load_dwordx4 v[172:175], v19, s[28:31], 0 offen offset:432
  buffer_load_dwordx4 v[80:83], v18, s[24:27], s57 offen offset:448
  buffer_load_dwordx4 v[176:179], v19, s[28:31], 0 offen offset:448
  buffer_load_dwordx4 v[84:87], v18, s[24:27], s57 offen offset:464
  buffer_load_dwordx4 v[180:183], v19, s[28:31], 0 offen offset:464
  buffer_load_dwordx4 v[88:91], v18, s[24:27], s57 offen offset:480
  buffer_load_dwordx4 v[184:187], v19, s[28:31], 0 offen offset:480
  buffer_load_dwordx4 v[92:95], v18, s[24:27], s57 offen offset:496
  buffer_load_dwordx4 v[188:191], v19, s[28:31], 0 offen offset:496
  s_waitcnt vmcnt(30)
  v_dot2c_f32_bf16 v24, v32, v128
  v_dot2c_f32_bf16 v25, v33, v129
  v_dot2c_f32_bf16 v26, v34, v130
  v_dot2c_f32_bf16 v27, v35, v131
  s_waitcnt vmcnt(28)
  v_dot2c_f32_bf16 v24, v36, v132
  v_dot2c_f32_bf16 v25, v37, v133
  v_dot2c_f32_bf16 v26, v38, v134
  v_dot2c_f32_bf16 v27, v39, v135
  s_waitcnt vmcnt(26)
  v_dot2c_f32_bf16 v24, v40, v136
  v_dot2c_f32_bf16 v25, v41, v137
  v_dot2c_f32_bf16 v26, v42, v138
  v_dot2c_f32_bf16 v27, v43, v139
  s_waitcnt vmcnt(24)
  v_dot2c_f32_bf16 v24, v44, v140
  v_dot2c_f32_bf16 v25, v45, v141
  v_dot2c_f32_bf16 v26, v46, v142
  v_dot2c_f32_bf16 v27, v47, v143
  s_waitcnt vmcnt(22)
  v_dot2c_f32_bf16 v24, v48, v144
  v_dot2c_f32_bf16 v25, v49, v145
  v_dot2c_f32_bf16 v26, v50, v146
  v_dot2c_f32_bf16 v27, v51, v147
  s_waitcnt vmcnt(20)
  v_dot2c_f32_bf16 v24, v52, v148
  v_dot2c_f32_bf16 v25, v53, v149
  v_dot2c_f32_bf16 v26, v54, v150
  v_dot2c_f32_bf16 v27, v55, v151
  s_waitcnt vmcnt(18)
  v_dot2c_f32_bf16 v24, v56, v152
  v_dot2c_f32_bf16 v25, v57, v153
  v_dot2c_f32_bf16 v26, v58, v154
  v_dot2c_f32_bf16 v27, v59, v155
  s_waitcnt vmcnt(16)
  v_dot2c_f32_bf16 v24, v60, v156
  v_dot2c_f32_bf16 v25, v61, v157
  v_dot2c_f32_bf16 v26, v62, v158
  v_dot2c_f32_bf16 v27, v63, v159
  s_waitcnt vmcnt(14)
  v_dot2c_f32_bf16 v24, v64, v160
  v_dot2c_f32_bf16 v25, v65, v161
  v_dot2c_f32_bf16 v26, v66, v162
  v_dot2c_f32_bf16 v27, v67, v163
  s_waitcnt vmcnt(12)
  v_dot2c_f32_bf16 v24, v68, v164
  v_dot2c_f32_bf16 v25, v69, v165
  v_dot2c_f32_bf16 v26, v70, v166
  v_dot2c_f32_bf16 v27, v71, v167
  s_waitcnt vmcnt(10)
  v_dot2c_f32_bf16 v24, v72, v168
  v_dot2c_f32_bf16 v25, v73, v169
  v_dot2c_f32_bf16 v26, v74, v170
  v_dot2c_f32_bf16 v27, v75, v171
  s_waitcnt vmcnt(8)
  v_dot2c_f32_bf16 v24, v76, v172
  v_dot2c_f32_bf16 v25, v77, v173
  v_dot2c_f32_bf16 v26, v78, v174
  v_dot2c_f32_bf16 v27, v79, v175
  s_waitcnt vmcnt(6)
  v_dot2c_f32_bf16 v24, v80, v176
  v_dot2c_f32_bf16 v25, v81, v177
  v_dot2c_f32_bf16 v26, v82, v178
  v_dot2c_f32_bf16 v27, v83, v179
  s_waitcnt vmcnt(4)
  v_dot2c_f32_bf16 v24, v84, v180
  v_dot2c_f32_bf16 v25, v85, v181
  v_dot2c_f32_bf16 v26, v86, v182
  v_dot2c_f32_bf16 v27, v87, v183
  s_waitcnt vmcnt(2)
  v_dot2c_f32_bf16 v24, v88, v184
  v_dot2c_f32_bf16 v25, v89, v185
  v_dot2c_f32_bf16 v26, v90, v186
  v_dot2c_f32_bf16 v27, v91, v187
  s_waitcnt vmcnt(0)
  v_dot2c_f32_bf16 v24, v92, v188
  v_dot2c_f32_bf16 v25, v93, v189
  v_dot2c_f32_bf16 v26, v94, v190
  v_dot2c_f32_bf16 v27, v95, v191
  buffer_load_dwordx4 v[32:35], v18, s[24:27], s57 offen offset:512
  buffer_load_dwordx4 v[128:131], v19, s[28:31], 0 offen offset:512
  buffer_load_dwordx4 v[36:39], v18, s[24:27], s57 offen offset:528
  buffer_load_dwordx4 v[132:135], v19, s[28:31], 0 offen offset:528
  buffer_load_dwordx4 v[40:43], v18, s[24:27], s57 offen offset:544
  buffer_load_dwordx4 v[136:139], v19, s[28:31], 0 offen offset:544
  buffer_load_dwordx4 v[44:47], v18, s[24:27], s57 offen offset:560
  buffer_load_dwordx4 v[140:143], v19, s[28:31], 0 offen offset:560
  buffer_load_dwordx4 v[48:51], v18, s[24:27], s57 offen offset:576
  buffer_load_dwordx4 v[144:147], v19, s[28:31], 0 offen offset:576
  buffer_load_dwordx4 v[52:55], v18, s[24:27], s57 offen offset:592
  buffer_load_dwordx4 v[148:151], v19, s[28:31], 0 offen offset:592
  buffer_load_dwordx4 v[56:59], v18, s[24:27], s57 offen offset:608
  buffer_load_dwordx4 v[152:155], v19, s[28:31], 0 offen offset:608
  buffer_load_dwordx4 v[60:63], v18, s[24:27], s57 offen offset:624
  buffer_load_dwordx4 v[156:159], v19, s[28:31], 0 offen offset:624
  buffer_load_dwordx4 v[64:67], v18, s[24:27], s57 offen offset:640
  buffer_load_dwordx4 v[160:163], v19, s[28:31], 0 offen offset:640
  buffer_load_dwordx4 v[68:71], v18, s[24:27], s57 offen offset:656
  buffer_load_dwordx4 v[164:167], v19, s[28:31], 0 offen offset:656
  buffer_load_dwordx4 v[72:75], v18, s[24:27], s57 offen offset:672
  buffer_load_dwordx4 v[168:171], v19, s[28:31], 0 offen offset:672
  buffer_load_dwordx4 v[76:79], v18, s[24:27], s57 offen offset:688
  buffer_load_dwordx4 v[172:175], v19, s[28:31], 0 offen offset:688
  buffer_load_dwordx4 v[80:83], v18, s[24:27], s57 offen offset:704
  buffer_load_dwordx4 v[176:179], v19, s[28:31], 0 offen offset:704
  buffer_load_dwordx4 v[84:87], v18, s[24:27], s57 offen offset:720
  buffer_load_dwordx4 v[180:183], v19, s[28:31], 0 offen offset:720
  buffer_load_dwordx4 v[88:91], v18, s[24:27], s57 offen offset:736
  buffer_load_dwordx4 v[184:187], v19, s[28:31], 0 offen offset:736
  buffer_load_dwordx4 v[92:95], v18, s[24:27], s57 offen offset:752
  buffer_load_dwordx4 v[188:191], v19, s[28:31], 0 offen offset:752
  s_waitcnt vmcnt(30)
  v_dot2c_f32_bf16 v24, v32, v128
  v_dot2c_f32_bf16 v25, v33, v129
  v_dot2c_f32_bf16 v26, v34, v130
  v_dot2c_f32_bf16 v27, v35, v131
  s_waitcnt vmcnt(28)
  v_dot2c_f32_bf16 v24, v36, v132
  v_dot2c_f32_bf16 v25, v37, v133
  v_dot2c_f32_bf16 v26, v38, v134
  v_dot2c_f32_bf16 v27, v39, v135
  s_waitcnt vmcnt(26)
  v_dot2c_f32_bf16 v24, v40, v136
  v_dot2c_f32_bf16 v25, v41, v137
  v_dot2c_f32_bf16 v26, v42, v138
  v_dot2c_f32_bf16 v27, v43, v139
  s_waitcnt vmcnt(24)
  v_dot2c_f32_bf16 v24, v44, v140
  v_dot2c_f32_bf16 v25, v45, v141
  v_dot2c_f32_bf16 v26, v46, v142
  v_dot2c_f32_bf16 v27, v47, v143
  s_waitcnt vmcnt(22)
  v_dot2c_f32_bf16 v24, v48, v144
  v_dot2c_f32_bf16 v25, v49, v145
  v_dot2c_f32_bf16 v26, v50, v146
  v_dot2c_f32_bf16 v27, v51, v147
  s_waitcnt vmcnt(20)
  v_dot2c_f32_bf16 v24, v52, v148
  v_dot2c_f32_bf16 v25, v53, v149
  v_dot2c_f32_bf16 v26, v54, v150
  v_dot2c_f32_bf16 v27, v55, v151
  s_waitcnt vmcnt(18)
  v_dot2c_f32_bf16 v24, v56, v152
  v_dot2c_f32_bf16 v25, v57, v153
  v_dot2c_f32_bf16 v26, v58, v154
  v_dot2c_f32_bf16 v27, v59, v155
  s_waitcnt vmcnt(16)
  v_dot2c_f32_bf16 v24, v60, v156
  v_dot2c_f32_bf16 v25, v61, v157
  v_dot2c_f32_bf16 v26, v62, v158
  v_dot2c_f32_bf16 v27, v63, v159
  s_waitcnt vmcnt(14)
  v_dot2c_f32_bf16 v24, v64, v160
  v_dot2c_f32_bf16 v25, v65, v161
  v_dot2c_f32_bf16 v26, v66, v162
  v_dot2c_f32_bf16 v27, v67, v163
  s_waitcnt vmcnt(12)
  v_dot2c_f32_bf16 v24, v68, v164
  v_dot2c_f32_bf16 v25, v69, v165
  v_dot2c_f32_bf16 v26, v70, v166
  v_dot2c_f32_bf16 v27, v71, v167
  s_waitcnt vmcnt(10)
  v_dot2c_f32_bf16 v24, v72, v168
  v_dot2c_f32_bf16 v25, v73, v169
  v_dot2c_f32_bf16 v26, v74, v170
  v_dot2c_f32_bf16 v27, v75, v171
  s_waitcnt vmcnt(8)
  v_dot2c_f32_bf16 v24, v76, v172
  v_dot2c_f32_bf16 v25, v77, v173
  v_dot2c_f32_bf16 v26, v78, v174
  v_dot2c_f32_bf16 v27, v79, v175
  s_waitcnt vmcnt(6)
  v_dot2c_f32_bf16 v24, v80, v176
  v_dot2c_f32_bf16 v25, v81, v177
  v_dot2c_f32_bf16 v26, v82, v178
  v_dot2c_f32_bf16 v27, v83, v179
  s_waitcnt vmcnt(4)
  v_dot2c_f32_bf16 v24, v84, v180
  v_dot2c_f32_bf16 v25, v85, v181
  v_dot2c_f32_bf16 v26, v86, v182
  v_dot2c_f32_bf16 v27, v87, v183
  s_waitcnt vmcnt(2)
  v_dot2c_f32_bf16 v24, v88, v184
  v_dot2c_f32_bf16 v25, v89, v185
  v_dot2c_f32_bf16 v26, v90, v186
  v_dot2c_f32_bf16 v27, v91, v187
  s_waitcnt vmcnt(0)
  v_dot2c_f32_bf16 v24, v92, v188
  v_dot2c_f32_bf16 v25, v93, v189
  v_dot2c_f32_bf16 v26, v94, v190
  v_dot2c_f32_bf16 v27, v95, v191
  buffer_load_dwordx4 v[32:35], v18, s[24:27], s57 offen offset:768
  buffer_load_dwordx4 v[128:131], v19, s[28:31], 0 offen offset:768
  buffer_load_dwordx4 v[36:39], v18, s[24:27], s57 offen offset:784
  buffer_load_dwordx4 v[132:135], v19, s[28:31], 0 offen offset:784
  buffer_load_dwordx4 v[40:43], v18, s[24:27], s57 offen offset:800
  buffer_load_dwordx4 v[136:139], v19, s[28:31], 0 offen offset:800
  buffer_load_dwordx4 v[44:47], v18, s[24:27], s57 offen offset:816
  buffer_load_dwordx4 v[140:143], v19, s[28:31], 0 offen offset:816
  buffer_load_dwordx4 v[48:51], v18, s[24:27], s57 offen offset:832
  buffer_load_dwordx4 v[144:147], v19, s[28:31], 0 offen offset:832
  buffer_load_dwordx4 v[52:55], v18, s[24:27], s57 offen offset:848
  buffer_load_dwordx4 v[148:151], v19, s[28:31], 0 offen offset:848
  buffer_load_dwordx4 v[56:59], v18, s[24:27], s57 offen offset:864
  buffer_load_dwordx4 v[152:155], v19, s[28:31], 0 offen offset:864
  buffer_load_dwordx4 v[60:63], v18, s[24:27], s57 offen offset:880
  buffer_load_dwordx4 v[156:159], v19, s[28:31], 0 offen offset:880
  buffer_load_dwordx4 v[64:67], v18, s[24:27], s57 offen offset:896
  buffer_load_dwordx4 v[160:163], v19, s[28:31], 0 offen offset:896
  buffer_load_dwordx4 v[68:71], v18, s[24:27], s57 offen offset:912
  buffer_load_dwordx4 v[164:167], v19, s[28:31], 0 offen offset:912
  buffer_load_dwordx4 v[72:75], v18, s[24:27], s57 offen offset:928
  buffer_load_dwordx4 v[168:171], v19, s[28:31], 0 offen offset:928
  buffer_load_dwordx4 v[76:79], v18, s[24:27], s57 offen offset:944
  buffer_load_dwordx4 v[172:175], v19, s[28:31], 0 offen offset:944
  buffer_load_dwordx4 v[80:83], v18, s[24:27], s57 offen offset:960
  buffer_load_dwordx4 v[176:179], v19, s[28:31], 0 offen offset:960
  buffer_load_dwordx4 v[84:87], v18, s[24:27], s57 offen offset:976
  buffer_load_dwordx4 v[180:183], v19, s[28:31], 0 offen offset:976
  buffer_load_dwordx4 v[88:91], v18, s[24:27], s57 offen offset:992
  buffer_load_dwordx4 v[184:187], v19, s[28:31], 0 offen offset:992
  buffer_load_dwordx4 v[92:95], v18, s[24:27], s57 offen offset:1008
  buffer_load_dwordx4 v[188:191], v19, s[28:31], 0 offen offset:1008
  s_waitcnt vmcnt(30)
  v_dot2c_f32_bf16 v24, v32, v128
  v_dot2c_f32_bf16 v25, v33, v129
  v_dot2c_f32_bf16 v26, v34, v130
  v_dot2c_f32_bf16 v27, v35, v131
  s_waitcnt vmcnt(28)
  v_dot2c_f32_bf16 v24, v36, v132
  v_dot2c_f32_bf16 v25, v37, v133
  v_dot2c_f32_bf16 v26, v38, v134
  v_dot2c_f32_bf16 v27, v39, v135
  s_waitcnt vmcnt(26)
  v_dot2c_f32_bf16 v24, v40, v136
  v_dot2c_f32_bf16 v25, v41, v137
  v_dot2c_f32_bf16 v26, v42, v138
  v_dot2c_f32_bf16 v27, v43, v139
  s_waitcnt vmcnt(24)
  v_dot2c_f32_bf16 v24, v44, v140
  v_dot2c_f32_bf16 v25, v45, v141
  v_dot2c_f32_bf16 v26, v46, v142
  v_dot2c_f32_bf16 v27, v47, v143
  s_waitcnt vmcnt(22)
  v_dot2c_f32_bf16 v24, v48, v144
  v_dot2c_f32_bf16 v25, v49, v145
  v_dot2c_f32_bf16 v26, v50, v146
  v_dot2c_f32_bf16 v27, v51, v147
  s_waitcnt vmcnt(20)
  v_dot2c_f32_bf16 v24, v52, v148
  v_dot2c_f32_bf16 v25, v53, v149
  v_dot2c_f32_bf16 v26, v54, v150
  v_dot2c_f32_bf16 v27, v55, v151
  s_waitcnt vmcnt(18)
  v_dot2c_f32_bf16 v24, v56, v152
  v_dot2c_f32_bf16 v25, v57, v153
  v_dot2c_f32_bf16 v26, v58, v154
  v_dot2c_f32_bf16 v27, v59, v155
  s_waitcnt vmcnt(16)
  v_dot2c_f32_bf16 v24, v60, v156
  v_dot2c_f32_bf16 v25, v61, v157
  v_dot2c_f32_bf16 v26, v62, v158
  v_dot2c_f32_bf16 v27, v63, v159
  s_waitcnt vmcnt(14)
  v_dot2c_f32_bf16 v24, v64, v160
  v_dot2c_f32_bf16 v25, v65, v161
  v_dot2c_f32_bf16 v26, v66, v162
  v_dot2c_f32_bf16 v27, v67, v163
  s_waitcnt vmcnt(12)
  v_dot2c_f32_bf16 v24, v68, v164
  v_dot2c_f32_bf16 v25, v69, v165
  v_dot2c_f32_bf16 v26, v70, v166
  v_dot2c_f32_bf16 v27, v71, v167
  s_waitcnt vmcnt(10)
  v_dot2c_f32_bf16 v24, v72, v168
  v_dot2c_f32_bf16 v25, v73, v169
  v_dot2c_f32_bf16 v26, v74, v170
  v_dot2c_f32_bf16 v27, v75, v171
  s_waitcnt vmcnt(8)
  v_dot2c_f32_bf16 v24, v76, v172
  v_dot2c_f32_bf16 v25, v77, v173
  v_dot2c_f32_bf16 v26, v78, v174
  v_dot2c_f32_bf16 v27, v79, v175
  s_waitcnt vmcnt(6)
  v_dot2c_f32_bf16 v24, v80, v176
  v_dot2c_f32_bf16 v25, v81, v177
  v_dot2c_f32_bf16 v26, v82, v178
  v_dot2c_f32_bf16 v27, v83, v179
  s_waitcnt vmcnt(4)
  v_dot2c_f32_bf16 v24, v84, v180
  v_dot2c_f32_bf16 v25, v85, v181
  v_dot2c_f32_bf16 v26, v86, v182
  v_dot2c_f32_bf16 v27, v87, v183
  s_waitcnt vmcnt(2)
  v_dot2c_f32_bf16 v24, v88, v184
  v_dot2c_f32_bf16 v25, v89, v185
  v_dot2c_f32_bf16 v26, v90, v186
  v_dot2c_f32_bf16 v27, v91, v187
  s_waitcnt vmcnt(0)
  v_dot2c_f32_bf16 v24, v92, v188
  v_dot2c_f32_bf16 v25, v93, v189
  v_dot2c_f32_bf16 v26, v94, v190
  v_dot2c_f32_bf16 v27, v95, v191
  s_nop 0
  v_add_f32 v24, v24, v25
  s_nop 0
  v_add_f32 v26, v26, v27
  v_add_f32 v24, v24, v26
  v_mov_b32 v25, v24
  s_nop 1
  v_permlane32_swap_b32 v24, v25
  v_add_f32 v24, v24, v25
  v_mul_f32 v24, 0xbfb8aa3b, v24
  v_exp_f32 v24, v24
  s_nop 0
  v_add_f32 v24, 1.0, v24
  v_rcp_f32 v24, v24
  v_lshlrev_b32 v18, 2, v16
  s_lshl_b32 s56, s56, 7
  s_add_u32 s56, s56, 92274688
  s_mov_b64 exec, 0xffffffff
  buffer_store_dword v24, v18, s[4:7], s56 offen sc1
  s_mov_b64 exec, -1
  s_branch .done
.tDN_20:
  s_lshl_b32 s51, s94, 3
  s_and_b32 s96, s95, 7
  s_add_u32 s51, s51, s96
  s_lshr_b32 s52, s95, 3
  s_cmp_lg_u32 s18, 0
  s_cbranch_scc1 .w0_30
  s_bitcmp1_b32 s3, 0
  s_cbranch_scc1 .ini_34
  v_mov_b32 v121, 0
.inl_35:
  buffer_load_dword v120, v121, s[8:11], 0 offen offset:20 sc1
  s_waitcnt vmcnt(0)
  v_readfirstlane_b32 s95, v120
  s_or_b32 s3, s3, s95
  s_bitcmp1_b32 s3, 0
  s_cbranch_scc1 .ini_34
  s_sleep 2
  s_sub_u32 s20, s20, 1
  s_cbranch_scc0 .inl_35
  v_mov_b32 v120, 0xdead
  v_mov_b32 v121, 0
  buffer_store_dword v120, v121, s[8:11], 0 offen offset:28 sc1
  s_mov_b32 s20, 0
  s_mov_b32 s94, 65535
  s_branch .dwo_31
.ini_34:
  s_lshl_b32 s96, s51, 7
  s_add_u32 s96, s96, 123736064
  v_mov_b32 v122, s96
  v_mov_b32 v123, 28
  v_mov_b32 v126, 0
.dwl_32:
  buffer_load_dword v124, v122, s[4:7], 0 offen sc1
  s_bitcmp1_b32 s3, 1
  s_cbranch_scc1 .dwn_36
  buffer_load_dword v125, v126, s[8:11], 0 offen offset:8 sc1
.dwn_36:
  s_waitcnt vmcnt(0)
  s_mov_b32 s94, 0
  v_cmp_lt_u32 vcc, v124, v123
  s_cbranch_vccz .dwo_31
  s_bitcmp1_b32 s3, 1
  s_cbranch_scc1 .dws_33
  v_readfirstlane_b32 s95, v125
  s_and_b32 s94, s95, 65791
  s_cmp_eq_u32 s94, 65
  s_cselect_b32 s94, 2, 0
  s_or_b32 s3, s3, s94
  s_bitcmp0_b32 s95, 16
  s_cbranch_scc1 .dws_33
  v_mov_b32 v120, 1
  v_mov_b32 v121, 0
  s_mov_b64 exec, 1
  buffer_atomic_add v120, v121, s[8:11], 0 offen offset:24 sc0 sc1
  s_mov_b64 exec, -1
  s_waitcnt vmcnt(0)
  v_readfirstlane_b32 s94, v120
  s_or_b32 s3, s3, 2
  s_cmp_ge_u32 s94, 64
  s_cbranch_scc1 .dws_33
  s_or_b32 s94, s94, 65536
  s_branch .dwo_31
.dws_33:
  s_sleep 4
  s_sub_u32 s20, s20, 1
  s_cbranch_scc0 .dwl_32
  v_mov_b32 v120, 0xdead
  v_mov_b32 v121, 0
  buffer_store_dword v120, v121, s[8:11], 0 offen offset:28 sc1
  s_mov_b32 s20, 0
  s_mov_b32 s94, 65535
  s_branch .dwo_31
.dwo_31:
  v_mov_b32 v120, s94
  v_mov_b32 v121, 163776
  ds_write_b32 v121, v120
  s_waitcnt lgkmcnt(0)
.w0_30:
  s_barrier
  v_mov_b32 v121, 163776
  ds_read_b32 v120, v121
  s_waitcnt lgkmcnt(0)
  v_readfirstlane_b32 s94, v120
  s_barrier
  s_cmp_lg_u32 s94, 0
  s_cbranch_scc1 .special
  s_lshl_b32 s54, s51, 7
  s_add_u32 s54, s54, 123738112
  s_mov_b32 s24, s92
  s_mov_b32 s25, s93
  s_mov_b32 s26, 0x10000000
  s_mov_b32 s27, 0x20000
  s_mul_i32 s40, s51, 917504
  s_add_u32 s40, s40, 50331648
  s_mov_b32 s60, 229376
  s_mov_b32 s44, 56
  s_mov_b32 s55, 4096
  s_mov_b32 s28, s84
  s_mov_b32 s29, s85
  s_mov_b32 s30, 0x700000
  s_mov_b32 s31, 0x20000
  s_mov_b32 s32, s84
  s_mov_b32 s33, s85
  s_mov_b32 s34, 0x700000
  s_mov_b32 s35, 0x20000
  s_lshl_b32 s41, s52, 9
  s_add_u32 s42, s41, 256
  s_mov_b32 s61, 2048
  s_mov_b32 s43, 131072
  s_lshl_b32 s50, s51, 2
  s_add_u32 s50, s50, s52
  s_lshl_b32 s50, s50, 2
  s_add_u32 s50, s50, s18
  s_lshl_b32 s50, s50, 14
  s_add_u32 s50, s50, 83886080
  s_mov_b32 s53, 3
  s_branch .gemm
.tAT_22:
  s_lshl_b32 s51, s94, 3
  s_lshr_b32 s96, s95, 2
  s_add_u32 s51, s51, s96
  s_and_b32 s52, s95, 3
  s_cmp_ge_u32 s51, 56
  s_cbranch_scc1 .next
  s_lshl_b32 s54, s51, 7
  s_add_u32 s54, s54, 123740160
  s_cmp_lg_u32 s18, 0
  s_cbranch_scc1 .w0_37
  s_bitcmp1_b32 s3, 0
  s_cbranch_scc1 .ini_41
  v_mov_b32 v121, 0
.inl_42:
  buffer_load_dword v120, v121, s[8:11], 0 offen offset:20 sc1
  s_waitcnt vmcnt(0)
  v_readfirstlane_b32 s95, v120
  s_or_b32 s3, s3, s95
  s_bitcmp1_b32 s3, 0
  s_cbranch_scc1 .ini_41
  s_sleep 2
  s_sub_u32 s20, s20, 1
  s_cbranch_scc0 .inl_42
  v_mov_b32 v120, 0xdead
  v_mov_b32 v121, 0
  buffer_store_dword v120, v121, s[8:11], 0 offen offset:28 sc1
  s_mov_b32 s20, 0
  s_mov_b32 s94, 65535
  s_branch .dwo_38
.ini_41:
  s_lshr_b32 s96, s51, 2
  s_lshl_b32 s96, s96, 7
  s_add_u32 s96, s96, 123731968
  v_mbcnt_lo_u32_b32 v123, -1, 0
  v_mbcnt_hi_u32_b32 v123, -1, v123
  v_and_b32 v123, 1, v123
  v_lshlrev_b32 v122, 11, v123
  v_add_u32 v122, s96, v122
  v_lshlrev_b32 v123, 4, v123
  v_sub_u32 v123, 32, v123
  v_mov_b32 v126, 0
.dwl_39:
  buffer_load_dword v124, v122, s[4:7], 0 offen sc1
  s_bitcmp1_b32 s3, 1
  s_cbranch_scc1 .dwn_43
  buffer_load_dword v125, v126, s[8:11], 0 offen offset:8 sc1
.dwn_43:
  s_waitcnt vmcnt(0)
  s_mov_b32 s94, 0
  v_cmp_lt_u32 vcc, v124, v123
  s_cbranch_vccz .dwo_38
  s_bitcmp1_b32 s3, 1
  s_cbranch_scc1 .dws_40
  v_readfirstlane_b32 s95, v125
  s_and_b32 s94, s95, 65791
  s_cmp_eq_u32 s94, 65
  s_cselect_b32 s94, 2, 0
  s_or_b32 s3, s3, s94
  s_bitcmp0_b32 s95, 16
  s_cbranch_scc1 .dws_40
  v_mov_b32 v120, 1
  v_mov_b32 v121, 0
  s_mov_b64 exec, 1
  buffer_atomic_add v120, v121, s[8:11], 0 offen offset:24 sc0 sc1
  s_mov_b64 exec, -1
  s_waitcnt vmcnt(0)
  v_readfirstlane_b32 s94, v120
  s_or_b32 s3, s3, 2
  s_cmp_ge_u32 s94, 64
  s_cbranch_scc1 .dws_40
  s_or_b32 s94, s94, 65536
  s_branch .dwo_38
.dws_40:
  s_sleep 4
  s_sub_u32 s20, s20, 1
  s_cbranch_scc0 .dwl_39
  v_mov_b32 v120, 0xdead
  v_mov_b32 v121, 0
  buffer_store_dword v120, v121, s[8:11], 0 offen offset:28 sc1
  s_mov_b32 s20, 0
  s_mov_b32 s94, 65535
  s_branch .dwo_38
.dwo_38:
  v_mov_b32 v120, s94
  v_mov_b32 v121, 163776
  ds_write_b32 v121, v120
  s_waitcnt lgkmcnt(0)
.w0_37:
  s_barrier
  v_mov_b32 v121, 163776
  ds_read_b32 v120, v121
  s_waitcnt lgkmcnt(0)
  v_readfirstlane_b32 s94, v120
  s_barrier
  s_cmp_lg_u32 s94, 0
  s_cbranch_scc1 .special
  v_mbcnt_lo_u32_b32 v16, -1, 0
  v_mbcnt_hi_u32_b32 v16, -1, v16
  v_and_b32 v18, 31, v16
  v_lshrrev_b32 v19, 5, v16
  v_lshlrev_b32 v21, 4, v16
  v_lshlrev_b32 v26, 3, v19
  v_sub_u32 v26, v18, v26
  v_and_b32 v20, 7, v16
  v_lshlrev_b32 v20, 4, v20
  v_lshl_add_u32 v25, v19, 7, v20
  v_lshrrev_b32 v20, 3, v18
  v_lshl_add_u32 v23, v20, 9, v25
  v_bfe_u32 v20, v16, 3, 1
  v_lshl_add_u32 v22, v20, 10, v25
  v_bfe_u32 v20, v16, 4, 1
  v_lshl_add_u32 v22, v20, 9, v22
  v_lshlrev_b32 v24, 8, v20
  v_lshl_add_u32 v24, v19, 7, v24
  v_and_b32 v20, 15, v16
  v_lshl_add_u32 v24, v20, 3, v24
  v_bfe_u32 v20, v16, 3, 1
  v_lshl_add_u32 v25, v20, 9, v25
  s_lshl_b32 s56, s51, 2
  s_add_u32 s56, s56, s52
  s_lshl_b32 s56, s56, 2
  s_add_u32 s56, s56, s18
  s_lshl_b32 s56, s56, 14
  s_add_u32 s40, s56, 0
  s_add_u32 s16, s56, 67108864
  s_add_u32 s41, s56, 33554432
  s_add_u32 s42, s56, 16777216
  s_add_u32 s43, s56, 100663296
  s_add_u32 s56, s41, 0
  s_add_u32 s57, s40, 0
  buffer_load_dwordx4 a[32:35], v22, s[4:7], s56 offen offset:0 sc1
  buffer_load_dwordx4 a[0:3], v21, s[4:7], s57 offen offset:0 sc1
  buffer_load_dwordx4 a[36:39], v22, s[4:7], s56 offen offset:256 sc1
  buffer_load_dwordx4 a[4:7], v21, s[4:7], s57 offen offset:1024 sc1
  buffer_load_dwordx4 a[40:43], v22, s[4:7], s56 offen offset:2048 sc1
  buffer_load_dwordx4 a[8:11], v21, s[4:7], s57 offen offset:2048 sc1
  buffer_load_dwordx4 a[44:47], v22, s[4:7], s56 offen offset:2304 sc1
  buffer_load_dwordx4 a[12:15], v21, s[4:7], s57 offen offset:3072 sc1
  s_add_u32 s56, s41, 4096
  s_add_u32 s57, s40, 4096
  buffer_load_dwordx4 a[48:51], v22, s[4:7], s56 offen offset:0 sc1
  buffer_load_dwordx4 a[16:19], v21, s[4:7], s57 offen offset:0 sc1
  buffer_load_dwordx4 a[52:55], v22, s[4:7], s56 offen offset:256 sc1
  buffer_load_dwordx4 a[20:23], v21, s[4:7], s57 offen offset:1024 sc1
  buffer_load_dwordx4 a[56:59], v22, s[4:7], s56 offen offset:2048 sc1
  buffer_load_dwordx4 a[24:27], v21, s[4:7], s57 offen offset:2048 sc1
  buffer_load_dwordx4 a[60:63], v22, s[4:7], s56 offen offset:2304 sc1
  buffer_load_dwordx4 a[28:31], v21, s[4:7], s57 offen offset:3072 sc1
  s_add_u32 s56, s41, 8192
  s_add_u32 s57, s40, 8192
  buffer_load_dwordx4 a[128:131], v22, s[4:7], s56 offen offset:0 sc1
  buffer_load_dwordx4 a[96:99], v21, s[4:7], s57 offen offset:0 sc1
  buffer_load_dwordx4 a[132:135], v22, s[4:7], s56 offen offset:256 sc1
  buffer_load_dwordx4 a[100:103], v21, s[4:7], s57 offen offset:1024 sc1
  buffer_load_dwordx4 a[136:139], v22, s[4:7], s56 offen offset:2048 sc1
  buffer_load_dwordx4 a[104:107], v21, s[4:7], s57 offen offset:2048 sc1
  buffer_load_dwordx4 a[140:143], v22, s[4:7], s56 offen offset:2304 sc1
  buffer_load_dwordx4 a[108:111], v21, s[4:7], s57 offen offset:3072 sc1
  s_add_u32 s56, s41, 12288
  s_add_u32 s57, s40, 12288
  buffer_load_dwordx4 a[144:147], v22, s[4:7], s56 offen offset:0 sc1
  buffer_load_dwordx4 a[112:115], v21, s[4:7], s57 offen offset:0 sc1
  buffer_load_dwordx4 a[148:151], v22, s[4:7], s56 offen offset:256 sc1
  buffer_load_dwordx4 a[116:119], v21, s[4:7], s57 offen offset:1024 sc1
  buffer_load_dwordx4 a[152:155], v22, s[4:7], s56 offen offset:2048 sc1
  buffer_load_dwordx4 a[120:123], v21, s[4:7], s57 offen offset:2048 sc1
  buffer_load_dwordx4 a[156:159], v22, s[4:7], s56 offen offset:2304 sc1
  buffer_load_dwordx4 a[124:127], v21, s[4:7], s57 offen offset:3072 sc1
  s_add_u32 s56, s42, 0
  buffer_load_dwordx4 a[64:67], v23, s[4:7], s56 offen offset:0 sc1
  buffer_load_dwordx4 a[68:71], v23, s[4:7], s56 offen offset:256 sc1
  buffer_load_dwordx4 a[72:75], v23, s[4:7], s56 offen offset:2048 sc1
  buffer_load_dwordx4 a[76:79], v23, s[4:7], s56 offen offset:2304 sc1
  s_add_u32 s56, s42, 4096
  buffer_load_dwordx4 a[80:83], v23, s[4:7], s56 offen offset:0 sc1
  buffer_load_dwordx4 a[84:87], v23, s[4:7], s56 offen offset:256 sc1
  buffer_load_dwordx4 a[88:91], v23, s[4:7], s56 offen offset:2048 sc1
  buffer_load_dwordx4 a[92:95], v23, s[4:7], s56 offen offset:2304 sc1
  s_add_u32 s56, s42, 8192
  buffer_load_dwordx4 a[160:163], v23, s[4:7], s56 offen offset:0 sc1
  buffer_load_dwordx4 a[164:167], v23, s[4:7], s56 offen offset:256 sc1
  buffer_load_dwordx4 a[168:171], v23, s[4:7], s56 offen offset:2048 sc1
  buffer_load_dwordx4 a[172:175], v23, s[4:7], s56 offen offset:2304 sc1
  s_add_u32 s56, s42, 12288
  buffer_load_dwordx4 a[176:179], v23, s[4:7], s56 offen offset:0 sc1
  buffer_load_dwordx4 a[180:183], v23, s[4:7], s56 offen offset:256 sc1
  buffer_load_dwordx4 a[184:187], v23, s[4:7], s56 offen offset:2048 sc1
  buffer_load_dwordx4 a[188:191], v23, s[4:7], s56 offen offset:2304 sc1
  v_mov_b32 v18, 0xd028965f
  s_waitcnt vmcnt(46)
  v_mfma_f32_32x32x16_bf16 v[32:47], a[32:35], a[0:3], 0
  s_waitcnt vmcnt(44)
  v_mfma_f32_32x32x16_bf16 v[32:47], a[36:39], a[4:7], v[32:47]
  s_waitcnt vmcnt(42)
  v_mfma_f32_32x32x16_bf16 v[32:47], a[40:43], a[8:11], v[32:47]
  s_waitcnt vmcnt(40)
  v_mfma_f32_32x32x16_bf16 v[32:47], a[44:47], a[12:15], v[32:47]
  s_waitcnt vmcnt(38)
  v_mfma_f32_32x32x16_bf16 v[32:47], a[48:51], a[16:19], v[32:47]
  s_waitcnt vmcnt(36)
  v_mfma_f32_32x32x16_bf16 v[32:47], a[52:55], a[20:23], v[32:47]
  s_waitcnt vmcnt(34)
  v_mfma_f32_32x32x16_bf16 v[32:47], a[56:59], a[24:27], v[32:47]
  s_waitcnt vmcnt(32)
  v_mfma_f32_32x32x16_bf16 v[32:47], a[60:63], a[28:31], v[32:47]
  s_waitcnt vmcnt(30)
  v_mfma_f32_32x32x16_bf16 v[48:63], a[128:131], a[96:99], 0
  s_waitcnt vmcnt(28)
  v_mfma_f32_32x32x16_bf16 v[48:63], a[132:135], a[100:103], v[48:63]
  s_waitcnt vmcnt(26)
  v_mfma_f32_32x32x16_bf16 v[48:63], a[136:139], a[104:107], v[48:63]
  s_waitcnt vmcnt(24)
  v_mfma_f32_32x32x16_bf16 v[48:63], a[140:143], a[108:111], v[48:63]
  s_waitcnt vmcnt(22)
  v_mfma_f32_32x32x16_bf16 v[48:63], a[144:147], a[112:115], v[48:63]
  s_waitcnt vmcnt(20)
  v_mfma_f32_32x32x16_bf16 v[48:63], a[148:151], a[116:119], v[48:63]
  s_waitcnt vmcnt(18)
  v_mfma_f32_32x32x16_bf16 v[48:63], a[152:155], a[120:123], v[48:63]
  s_waitcnt vmcnt(16)
  v_mfma_f32_32x32x16_bf16 v[48:63], a[156:159], a[124:127], v[48:63]
  v_cmp_le_i32 vcc, 0, v26
  s_nop 1
  v_cndmask_b32 v32, v18, v32, vcc
  v_cmp_le_i32 vcc, 1, v26
  s_nop 1
  v_cndmask_b32 v33, v18, v33, vcc
  v_cmp_le_i32 vcc, 2, v26
  s_nop 1
  v_cndmask_b32 v34, v18, v34, vcc
  v_cmp_le_i32 vcc, 3, v26
  s_nop 1
  v_cndmask_b32 v35, v18, v35, vcc
  v_cmp_le_i32 vcc, 4, v26
  s_nop 1
  v_cndmask_b32 v36, v18, v36, vcc
  v_cmp_le_i32 vcc, 5, v26
  s_nop 1
  v_cndmask_b32 v37, v18, v37, vcc
  v_cmp_le_i32 vcc, 6, v26
  s_nop 1
  v_cndmask_b32 v38, v18, v38, vcc
  v_cmp_le_i32 vcc, 7, v26
  s_nop 1
  v_cndmask_b32 v39, v18, v39, vcc
  v_cmp_le_i32 vcc, 16, v26
  s_nop 1
  v_cndmask_b32 v40, v18, v40, vcc
  v_cmp_le_i32 vcc, 17, v26
  s_nop 1
  v_cndmask_b32 v41, v18, v41, vcc
  v_cmp_le_i32 vcc, 18, v26
  s_nop 1
  v_cndmask_b32 v42, v18, v42, vcc
  v_cmp_le_i32 vcc, 19, v26
  s_nop 1
  v_cndmask_b32 v43, v18, v43, vcc
  v_cmp_le_i32 vcc, 20, v26
  s_nop 1
  v_cndmask_b32 v44, v18, v44, vcc
  v_cmp_le_i32 vcc, 21, v26
  s_nop 1
  v_cndmask_b32 v45, v18, v45, vcc
  v_cmp_le_i32 vcc, 22, v26
  s_nop 1
  v_cndmask_b32 v46, v18, v46, vcc
  v_cmp_le_i32 vcc, 23, v26
  s_nop 1
  v_cndmask_b32 v47, v18, v47, vcc
  v_cmp_le_i32 vcc, 0, v26
  s_nop 1
  v_cndmask_b32 v48, v18, v48, vcc
  v_cmp_le_i32 vcc, 1, v26
  s_nop 1
  v_cndmask_b32 v49, v18, v49, vcc
  v_cmp_le_i32 vcc, 2, v26
  s_nop 1
  v_cndmask_b32 v50, v18, v50, vcc
  v_cmp_le_i32 vcc, 3, v26
  s_nop 1
  v_cndmask_b32 v51, v18, v51, vcc
  v_cmp_le_i32 vcc, 4, v26
  s_nop 1
  v_cndmask_b32 v52, v18, v52, vcc
  v_cmp_le_i32 vcc, 5, v26
  s_nop 1
  v_cndmask_b32 v53, v18, v53, vcc
  v_cmp_le_i32 vcc, 6, v26
  s_nop 1
  v_cndmask_b32 v54, v18, v54, vcc
  v_cmp_le_i32 vcc, 7, v26
  s_nop 1
  v_cndmask_b32 v55, v18, v55, vcc
  v_cmp_le_i32 vcc, 16, v26
  s_nop 1
  v_cndmask_b32 v56, v18, v56, vcc
  v_cmp_le_i32 vcc, 17, v26
  s_nop 1
  v_cndmask_b32 v57, v18, v57, vcc
  v_cmp_le_i32 vcc, 18, v26
  s_nop 1
  v_cndmask_b32 v58, v18, v58, vcc
  v_cmp_le_i32 vcc, 19, v26
  s_nop 1
  v_cndmask_b32 v59, v18, v59, vcc
  v_cmp_le_i32 vcc, 20, v26
  s_nop 1
  v_cndmask_b32 v60, v18, v60, vcc
  v_cmp_le_i32 vcc, 21, v26
  s_nop 1
  v_cndmask_b32 v61, v18, v61, vcc
  v_cmp_le_i32 vcc, 22, v26
  s_nop 1
  v_cndmask_b32 v62, v18, v62, vcc
  v_cmp_le_i32 vcc, 23, v26
  s_nop 1
  v_cndmask_b32 v63, v18, v63, vcc
  s_cmp_lg_u32 s18, 0
  s_cbranch_scc1 .w0_44
  s_bitcmp1_b32 s3, 0
  s_cbranch_scc1 .ini_48
  v_mov_b32 v121, 0
.inl_49:
  buffer_load_dword v120, v121, s[8:11], 0 offen offset:20 sc1
  s_waitcnt vmcnt(0)
  v_readfirstlane_b32 s95, v120
  s_or_b32 s3, s3, s95
  s_bitcmp1_b32 s3, 0
  s_cbranch_scc1 .ini_48
  s_sleep 2
  s_sub_u32 s20, s20, 1
  s_cbranch_scc0 .inl_49
  v_mov_b32 v120, 0xdead
  v_mov_b32 v121, 0
  buffer_store_dword v120, v121, s[8:11], 0 offen offset:28 sc1
  s_mov_b32 s20, 0
  s_mov_b32 s94, 65535
  s_branch .dwo_45
.ini_48:
  v_mbcnt_lo_u32_b32 v123, -1, 0
  v_mbcnt_hi_u32_b32 v123, -1, v123
  v_and_b32 v122, 1, v123
  v_lshlrev_b32 v122, 12, v122
  v_bfe_u32 v123, v123, 1, 3
  v_lshl_add_u32 v122, v123, 7, v122
  s_lshl_b32 s96, s52, 10
  s_add_u32 s96, s96, 123752448
  v_add_u32 v122, s96, v122
  s_add_u32 s96, s51, 1
  v_mov_b32 v123, s96
  v_mov_b32 v126, 0
.dwl_46:
  buffer_load_dword v124, v122, s[4:7], 0 offen sc1
  s_bitcmp1_b32 s3, 1
  s_cbranch_scc1 .dwn_50
  buffer_load_dword v125, v126, s[8:11], 0 offen offset:8 sc1
.dwn_50:
  s_waitcnt vmcnt(0)
  s_mov_b32 s94, 0
  v_cmp_lt_u32 vcc, v124, v123
  s_cbranch_vccz .dwo_45
  s_bitcmp1_b32 s3, 1
  s_cbranch_scc1 .dws_47
  v_readfirstlane_b32 s95, v125
  s_and_b32 s94, s95, 65791
  s_cmp_eq_u32 s94, 65
  s_cselect_b32 s94, 2, 0
  s_or_b32 s3, s3, s94
  s_bitcmp0_b32 s95, 16
  s_cbranch_scc1 .dws_47
  v_mov_b32 v120, 1
  v_mov_b32 v121, 0
  s_mov_b64 exec, 1
  buffer_atomic_add v120, v121, s[8:11], 0 offen offset:24 sc0 sc1
  s_mov_b64 exec, -1
  s_waitcnt vmcnt(0)
  v_readfirstlane_b32 s94, v120
  s_or_b32 s3, s3, 2
  s_cmp_ge_u32 s94, 64
  s_cbranch_scc1 .dws_47
  s_or_b32 s94, s94, 65536
  s_branch .dwo_45
.dws_47:
  s_sleep 4
  s_sub_u32 s20, s20, 1
  s_cbranch_scc0 .dwl_46
  v_mov_b32 v120, 0xdead
  v_mov_b32 v121, 0
  buffer_store_dword v120, v121, s[8:11], 0 offen offset:28 sc1
  s_mov_b32 s20, 0
  s_mov_b32 s94, 65535
  s_branch .dwo_45
.dwo_45:
  v_mov_b32 v120, s94
  v_mov_b32 v121, 163776
  ds_write_b32 v121, v120
  s_waitcnt lgkmcnt(0)
.w0_44:
  s_barrier
  v_mov_b32 v121, 163776
  ds_read_b32 v120, v121
  s_waitcnt lgkmcnt(0)
  v_readfirstlane_b32 s94, v120
  s_barrier
  s_cmp_lg_u32 s94, 0
  s_cbranch_scc1 .special
  s_add_u32 s56, s43, 0
  buffer_load_dwordx4 v[128:131], v25, s[4:7], s56 offen offset:0 sc1
  buffer_load_dwordx4 v[132:135], v25, s[4:7], s56 offen offset:256 sc1
  buffer_load_dwordx4 v[136:139], v25, s[4:7], s56 offen offset:2048 sc1
  buffer_load_dwordx4 v[140:143], v25, s[4:7], s56 offen offset:2304 sc1
  s_add_u32 s56, s43, 4096
  buffer_load_dwordx4 v[144:147], v25, s[4:7], s56 offen offset:0 sc1
  buffer_load_dwordx4 v[148:151], v25, s[4:7], s56 offen offset:256 sc1
  buffer_load_dwordx4 v[152:155], v25, s[4:7], s56 offen offset:2048 sc1
  buffer_load_dwordx4 v[156:159], v25, s[4:7], s56 offen offset:2304 sc1
  s_add_u32 s56, s43, 8192
  buffer_load_dwordx4 v[160:163], v25, s[4:7], s56 offen offset:0 sc1
  buffer_load_dwordx4 v[164:167], v25, s[4:7], s56 offen offset:256 sc1
  buffer_load_dwordx4 v[168:171], v25, s[4:7], s56 offen offset:2048 sc1
  buffer_load_dwordx4 v[172:175], v25, s[4:7], s56 offen offset:2304 sc1
  s_add_u32 s56, s43, 12288
  buffer_load_dwordx4 v[176:179], v25, s[4:7], s56 offen offset:0 sc1
  buffer_load_dwordx4 v[180:183], v25, s[4:7], s56 offen offset:256 sc1
  buffer_load_dwordx4 v[184:187], v25, s[4:7], s56 offen offset:2048 sc1
  buffer_load_dwordx4 v[188:191], v25, s[4:7], s56 offen offset:2304 sc1
  s_add_u32 s56, s43, 0
  buffer_load_dwordx2 a[192:193], v24, s[4:7], s56 offen offset:1024 sc1
  buffer_load_dwordx2 a[194:195], v24, s[4:7], s56 offen offset:1536 sc1
  buffer_load_dwordx2 a[196:197], v24, s[4:7], s56 offen offset:3072 sc1
  buffer_load_dwordx2 a[198:199], v24, s[4:7], s56 offen offset:3584 sc1
  s_add_u32 s56, s43, 4096
  buffer_load_dwordx2 a[200:201], v24, s[4:7], s56 offen offset:1024 sc1
  buffer_load_dwordx2 a[202:203], v24, s[4:7], s56 offen offset:1536 sc1
  buffer_load_dwordx2 a[204:205], v24, s[4:7], s56 offen offset:3072 sc1
  buffer_load_dwordx2 a[206:207], v24, s[4:7], s56 offen offset:3584 sc1
  s_add_u32 s56, s43, 8192
  buffer_load_dwordx2 a[208:209], v24, s[4:7], s56 offen offset:1024 sc1
  buffer_load_dwordx2 a[210:211], v24, s[4:7], s56 offen offset:1536 sc1
  buffer_load_dwordx2 a[212:213], v24, s[4:7], s56 offen offset:3072 sc1
  buffer_load_dwordx2 a[214:215], v24, s[4:7], s56 offen offset:3584 sc1
  s_add_u32 s56, s43, 12288
  buffer_load_dwordx2 a[216:217], v24, s[4:7], s56 offen offset:1024 sc1
  buffer_load_dwordx2 a[218:219], v24, s[4:7], s56 offen offset:1536 sc1
  buffer_load_dwordx2 a[220:221], v24, s[4:7], s56 offen offset:3072 sc1
  buffer_load_dwordx2 a[222:223], v24, s[4:7], s56 offen offset:3584 sc1
  s_mov_b32 s58, 0x3e0293ee
  s_mov_b32 s59, 0x3e0293ee
  s_waitcnt vmcnt(31)
  v_mfma_f32_32x32x16_bf16 v[64:79], v[128:131], a[0:3], 0
  s_waitcnt vmcnt(30)
  v_mfma_f32_32x32x16_bf16 v[64:79], v[132:135], a[4:7], v[64:79]
  s_waitcnt vmcnt(29)
  v_mfma_f32_32x32x16_bf16 v[64:79], v[136:139], a[8:11], v[64:79]
  s_waitcnt vmcnt(28)
  v_mfma_f32_32x32x16_bf16 v[64:79], v[140:143], a[12:15], v[64:79]
  s_waitcnt vmcnt(27)
  v_mfma_f32_32x32x16_bf16 v[64:79], v[144:147], a[16:19], v[64:79]
  s_waitcnt vmcnt(26)
  v_mfma_f32_32x32x16_bf16 v[64:79], v[148:151], a[20:23], v[64:79]
  s_waitcnt vmcnt(25)
  v_mfma_f32_32x32x16_bf16 v[64:79], v[152:155], a[24:27], v[64:79]
  s_waitcnt vmcnt(24)
  v_mfma_f32_32x32x16_bf16 v[64:79], v[156:159], a[28:31], v[64:79]
  s_waitcnt vmcnt(23)
  v_mfma_f32_32x32x16_bf16 v[80:95], v[160:163], a[96:99], 0
  s_waitcnt vmcnt(22)
  v_mfma_f32_32x32x16_bf16 v[80:95], v[164:167], a[100:103], v[80:95]
  s_waitcnt vmcnt(21)
  v_mfma_f32_32x32x16_bf16 v[80:95], v[168:171], a[104:107], v[80:95]
  s_waitcnt vmcnt(20)
  v_mfma_f32_32x32x16_bf16 v[80:95], v[172:175], a[108:111], v[80:95]
  s_waitcnt vmcnt(19)
  v_mfma_f32_32x32x16_bf16 v[80:95], v[176:179], a[112:115], v[80:95]
  s_waitcnt vmcnt(18)
  v_mfma_f32_32x32x16_bf16 v[80:95], v[180:183], a[116:119], v[80:95]
  s_waitcnt vmcnt(17)
  v_mfma_f32_32x32x16_bf16 v[80:95], v[184:187], a[120:123], v[80:95]
  s_waitcnt vmcnt(16)
  v_mfma_f32_32x32x16_bf16 v[80:95], v[188:191], a[124:127], v[80:95]
  v_pk_add_f32 v[64:65], v[64:65], v[68:69]
  v_pk_add_f32 v[66:67], v[66:67], v[70:71]
  v_max3_f32 v112, v32, v33, v34
  v_max3_f32 v112, v112, v35, v36
  v_max3_f32 v112, v112, v37, v38
  v_max3_f32 v112, v112, v39, v40
  v_max3_f32 v112, v112, v41, v42
  v_max3_f32 v112, v112, v43, v44
  v_max3_f32 v112, v112, v45, v46
  v_max3_f32 v112, v112, v47, v64
  v_max3_f32 v112, v112, v65, v66
  v_max_f32 v112, v112, v67
  v_mov_b32 v113, v112
  s_nop 1
  v_permlane32_swap_b32 v112, v113
  v_max_f32 v112, v112, v113
  v_mul_f32 v112, s58, v112
  v_pk_fma_f32 v[32:33], v[32:33], s[58:59], v[112:113] op_sel_hi:[1,1,0] neg_lo:[0,0,1] neg_hi:[0,0,1]
  v_pk_fma_f32 v[34:35], v[34:35], s[58:59], v[112:113] op_sel_hi:[1,1,0] neg_lo:[0,0,1] neg_hi:[0,0,1]
  v_pk_fma_f32 v[36:37], v[36:37], s[58:59], v[112:113] op_sel_hi:[1,1,0] neg_lo:[0,0,1] neg_hi:[0,0,1]
  v_pk_fma_f32 v[38:39], v[38:39], s[58:59], v[112:113] op_sel_hi:[1,1,0] neg_lo:[0,0,1] neg_hi:[0,0,1]
  v_pk_fma_f32 v[40:41], v[40:41], s[58:59], v[112:113] op_sel_hi:[1,1,0] neg_lo:[0,0,1] neg_hi:[0,0,1]
  v_pk_fma_f32 v[42:43], v[42:43], s[58:59], v[112:113] op_sel_hi:[1,1,0] neg_lo:[0,0,1] neg_hi:[0,0,1]
  v_pk_fma_f32 v[44:45], v[44:45], s[58:59], v[112:113] op_sel_hi:[1,1,0] neg_lo:[0,0,1] neg_hi:[0,0,1]
  v_pk_fma_f32 v[46:47], v[46:47], s[58:59], v[112:113] op_sel_hi:[1,1,0] neg_lo:[0,0,1] neg_hi:[0,0,1]
  v_pk_fma_f32 v[64:65], v[64:65], s[58:59], v[112:113] op_sel_hi:[1,1,0] neg_lo:[0,0,1] neg_hi:[0,0,1]
  v_pk_fma_f32 v[66:67], v[66:67], s[58:59], v[112:113] op_sel_hi:[1,1,0] neg_lo:[0,0,1] neg_hi:[0,0,1]
  s_waitcnt vmcnt(0)
  v_exp_f32 v32, v32
  v_exp_f32 v33, v33
  v_exp_f32 v34, v34
  v_exp_f32 v35, v35
  v_exp_f32 v36, v36
  v_exp_f32 v37, v37
  v_exp_f32 v38, v38
  v_exp_f32 v39, v39
  v_exp_f32 v40, v40
  v_exp_f32 v41, v41
  v_exp_f32 v42, v42
  v_exp_f32 v43, v43
  v_exp_f32 v44, v44
  v_exp_f32 v45, v45
  v_exp_f32 v46, v46
  v_exp_f32 v47, v47
  v_exp_f32 v64, v64
  v_exp_f32 v65, v65
  v_exp_f32 v66, v66
  v_exp_f32 v67, v67
  v_cvt_pk_bf16_f32 v116, v32, v33
  v_cvt_pk_bf16_f32 v117, v34, v35
  v_cvt_pk_bf16_f32 v118, v36, v37
  v_cvt_pk_bf16_f32 v119, v38, v39
  v_cvt_pk_bf16_f32 v120, v40, v41
  v_cvt_pk_bf16_f32 v121, v42, v43
  v_cvt_pk_bf16_f32 v122, v44, v45
  v_cvt_pk_bf16_f32 v123, v46, v47
  v_cvt_pk_bf16_f32 v124, v64, v65
  v_cvt_pk_bf16_f32 v125, v66, v67
  v_mov_b64 v[126:127], v[124:125]
  v_mfma_f32_32x32x16_bf16 v[128:143], a[64:67], v[116:119], 0
  v_mfma_f32_32x32x16_bf16 v[128:143], a[68:71], v[120:123], v[128:143]
  v_mfma_f32_32x32x16_bf16 v[128:143], a[192:195], v[124:127], v[128:143]
  v_mfma_f32_32x32x16_bf16 v[144:159], a[72:75], v[116:119], 0
  v_mfma_f32_32x32x16_bf16 v[144:159], a[76:79], v[120:123], v[144:159]
  v_mfma_f32_32x32x16_bf16 v[144:159], a[196:199], v[124:127], v[144:159]
  v_mfma_f32_32x32x16_bf16 v[160:175], a[80:83], v[116:119], 0
  v_mfma_f32_32x32x16_bf16 v[160:175], a[84:87], v[120:123], v[160:175]
  v_mfma_f32_32x32x16_bf16 v[160:175], a[200:203], v[124:127], v[160:175]
  v_mfma_f32_32x32x16_bf16 v[176:191], a[88:91], v[116:119], 0
  v_mfma_f32_32x32x16_bf16 v[176:191], a[92:95], v[120:123], v[176:191]
  v_mfma_f32_32x32x16_bf16 v[176:191], a[204:207], v[124:127], v[176:191]
  v_pk_add_f32 v[32:33], v[32:33], v[34:35]
  v_pk_add_f32 v[32:33], v[32:33], v[36:37]
  v_pk_add_f32 v[32:33], v[32:33], v[38:39]
  v_pk_add_f32 v[32:33], v[32:33], v[40:41]
  v_pk_add_f32 v[32:33], v[32:33], v[42:43]
  v_pk_add_f32 v[32:33], v[32:33], v[44:45]
  v_pk_add_f32 v[32:33], v[32:33], v[46:47]
  v_pk_add_f32 v[32:33], v[32:33], v[64:65]
  v_pk_add_f32 v[32:33], v[32:33], v[66:67]
  v_add_f32 v114, v32, v33
  v_mov_b32 v113, v114
  s_nop 1
  v_permlane32_swap_b32 v114, v113
  v_add_f32 v114, v114, v113
  v_rcp_f32 v114, v114
  v_pk_add_f32 v[80:81], v[80:81], v[84:85]
  v_pk_add_f32 v[82:83], v[82:83], v[86:87]
  v_max3_f32 v112, v48, v49, v50
  v_max3_f32 v112, v112, v51, v52
  v_max3_f32 v112, v112, v53, v54
  v_max3_f32 v112, v112, v55, v56
  v_max3_f32 v112, v112, v57, v58
  v_max3_f32 v112, v112, v59, v60
  v_max3_f32 v112, v112, v61, v62
  v_max3_f32 v112, v112, v63, v80
  v_max3_f32 v112, v112, v81, v82
  v_max_f32 v112, v112, v83
  v_mov_b32 v113, v112
  s_nop 1
  v_permlane32_swap_b32 v112, v113
  v_max_f32 v112, v112, v113
  v_mul_f32 v112, s58, v112
  v_pk_fma_f32 v[48:49], v[48:49], s[58:59], v[112:113] op_sel_hi:[1,1,0] neg_lo:[0,0,1] neg_hi:[0,0,1]
  v_pk_fma_f32 v[50:51], v[50:51], s[58:59], v[112:113] op_sel_hi:[1,1,0] neg_lo:[0,0,1] neg_hi:[0,0,1]
  v_pk_fma_f32 v[52:53], v[52:53], s[58:59], v[112:113] op_sel_hi:[1,1,0] neg_lo:[0,0,1] neg_hi:[0,0,1]
  v_pk_fma_f32 v[54:55], v[54:55], s[58:59], v[112:113] op_sel_hi:[1,1,0] neg_lo:[0,0,1] neg_hi:[0,0,1]
  v_pk_fma_f32 v[56:57], v[56:57], s[58:59], v[112:113] op_sel_hi:[1,1,0] neg_lo:[0,0,1] neg_hi:[0,0,1]
  v_pk_fma_f32 v[58:59], v[58:59], s[58:59], v[112:113] op_sel_hi:[1,1,0] neg_lo:[0,0,1] neg_hi:[0,0,1]
  v_pk_fma_f32 v[60:61], v[60:61], s[58:59], v[112:113] op_sel_hi:[1,1,0] neg_lo:[0,0,1] neg_hi:[0,0,1]
  v_pk_fma_f32 v[62:63], v[62:63], s[58:59], v[112:113] op_sel_hi:[1,1,0] neg_lo:[0,0,1] neg_hi:[0,0,1]
  v_pk_fma_f32 v[80:81], v[80:81], s[58:59], v[112:113] op_sel_hi:[1,1,0] neg_lo:[0,0,1] neg_hi:[0,0,1]
  v_pk_fma_f32 v[82:83], v[82:83], s[58:59], v[112:113] op_sel_hi:[1,1,0] neg_lo:[0,0,1] neg_hi:[0,0,1]
  v_exp_f32 v48, v48
  v_exp_f32 v49, v49
  v_exp_f32 v50, v50
  v_exp_f32 v51, v51
  v_exp_f32 v52, v52
  v_exp_f32 v53, v53
  v_exp_f32 v54, v54
  v_exp_f32 v55, v55
  v_exp_f32 v56, v56
  v_exp_f32 v57, v57
  v_exp_f32 v58, v58
  v_exp_f32 v59, v59
  v_exp_f32 v60, v60
  v_exp_f32 v61, v61
  v_exp_f32 v62, v62
  v_exp_f32 v63, v63
  v_exp_f32 v80, v80
  v_exp_f32 v81, v81
  v_exp_f32 v82, v82
  v_exp_f32 v83, v83
  v_cvt_pk_bf16_f32 v116, v48, v49
  v_cvt_pk_bf16_f32 v117, v50, v51
  v_cvt_pk_bf16_f32 v118, v52, v53
  v_cvt_pk_bf16_f32 v119, v54, v55
  v_cvt_pk_bf16_f32 v120, v56, v57
  v_cvt_pk_bf16_f32 v121, v58, v59
  v_cvt_pk_bf16_f32 v122, v60, v61
  v_cvt_pk_bf16_f32 v123, v62, v63
  v_cvt_pk_bf16_f32 v124, v80, v81
  v_cvt_pk_bf16_f32 v125, v82, v83
  v_mov_b64 v[126:127], v[124:125]
  v_mfma_f32_32x32x16_bf16 v[192:207], a[160:163], v[116:119], 0
  v_mfma_f32_32x32x16_bf16 v[192:207], a[164:167], v[120:123], v[192:207]
  v_mfma_f32_32x32x16_bf16 v[192:207], a[208:211], v[124:127], v[192:207]
  v_mfma_f32_32x32x16_bf16 v[208:223], a[168:171], v[116:119], 0
  v_mfma_f32_32x32x16_bf16 v[208:223], a[172:175], v[120:123], v[208:223]
  v_mfma_f32_32x32x16_bf16 v[208:223], a[212:215], v[124:127], v[208:223]
  v_mfma_f32_32x32x16_bf16 v[224:239], a[176:179], v[116:119], 0
  v_mfma_f32_32x32x16_bf16 v[224:239], a[180:183], v[120:123], v[224:239]
  v_mfma_f32_32x32x16_bf16 v[224:239], a[216:219], v[124:127], v[224:239]
  v_mfma_f32_32x32x16_bf16 v[240:255], a[184:187], v[116:119], 0
  v_mfma_f32_32x32x16_bf16 v[240:255], a[188:191], v[120:123], v[240:255]
  v_mfma_f32_32x32x16_bf16 v[240:255], a[220:223], v[124:127], v[240:255]
  v_pk_add_f32 v[48:49], v[48:49], v[50:51]
  v_pk_add_f32 v[48:49], v[48:49], v[52:53]
  v_pk_add_f32 v[48:49], v[48:49], v[54:55]
  v_pk_add_f32 v[48:49], v[48:49], v[56:57]
  v_pk_add_f32 v[48:49], v[48:49], v[58:59]
  v_pk_add_f32 v[48:49], v[48:49], v[60:61]
  v_pk_add_f32 v[48:49], v[48:49], v[62:63]
  v_pk_add_f32 v[48:49], v[48:49], v[80:81]
  v_pk_add_f32 v[48:49], v[48:49], v[82:83]
  v_add_f32 v115, v48, v49
  v_mov_b32 v113, v115
  s_nop 1
  v_permlane32_swap_b32 v115, v113
  v_add_f32 v115, v115, v113
  v_rcp_f32 v115, v115
  v_lshlrev_b32 v17, 4, v16
  v_pk_mul_f32 v[128:129], v[128:129], v[114:115] op_sel_hi:[1,0]
  v_pk_mul_f32 v[130:131], v[130:131], v[114:115] op_sel_hi:[1,0]
  v_pk_mul_f32 v[132:133], v[132:133], v[114:115] op_sel_hi:[1,0]
  v_pk_mul_f32 v[134:135], v[134:135], v[114:115] op_sel_hi:[1,0]
  v_pk_mul_f32 v[136:137], v[136:137], v[114:115] op_sel_hi:[1,0]
  v_pk_mul_f32 v[138:139], v[138:139], v[114:115] op_sel_hi:[1,0]
  v_pk_mul_f32 v[140:141], v[140:141], v[114:115] op_sel_hi:[1,0]
  v_pk_mul_f32 v[142:143], v[142:143], v[114:115] op_sel_hi:[1,0]
  v_cvt_pk_bf16_f32 v128, v128, v129
  v_cvt_pk_bf16_f32 v129, v130, v131
  v_cvt_pk_bf16_f32 v130, v132, v133
  v_cvt_pk_bf16_f32 v131, v134, v135
  v_cvt_pk_bf16_f32 v132, v136, v137
  v_cvt_pk_bf16_f32 v133, v138, v139
  v_cvt_pk_bf16_f32 v134, v140, v141
  v_cvt_pk_bf16_f32 v135, v142, v143
  v_pk_mul_f32 v[144:145], v[144:145], v[114:115] op_sel_hi:[1,0]
  v_pk_mul_f32 v[146:147], v[146:147], v[114:115] op_sel_hi:[1,0]
  v_pk_mul_f32 v[148:149], v[148:149], v[114:115] op_sel_hi:[1,0]
  v_pk_mul_f32 v[150:151], v[150:151], v[114:115] op_sel_hi:[1,0]
  v_pk_mul_f32 v[152:153], v[152:153], v[114:115] op_sel_hi:[1,0]
  v_pk_mul_f32 v[154:155], v[154:155], v[114:115] op_sel_hi:[1,0]
  v_pk_mul_f32 v[156:157], v[156:157], v[114:115] op_sel_hi:[1,0]
  v_pk_mul_f32 v[158:159], v[158:159], v[114:115] op_sel_hi:[1,0]
  v_cvt_pk_bf16_f32 v144, v144, v145
  v_cvt_pk_bf16_f32 v145, v146, v147
  v_cvt_pk_bf16_f32 v146, v148, v149
  v_cvt_pk_bf16_f32 v147, v150, v151
  v_cvt_pk_bf16_f32 v148, v152, v153
  v_cvt_pk_bf16_f32 v149, v154, v155
  v_cvt_pk_bf16_f32 v150, v156, v157
  v_cvt_pk_bf16_f32 v151, v158, v159
  v_permlane32_swap_b32 v128, v130
  v_permlane32_swap_b32 v129, v131
  v_permlane32_swap_b32 v132, v134
  v_permlane32_swap_b32 v133, v135
  s_add_u32 s56, s16, 0x0
  buffer_store_dwordx4 v[128:131], v17, s[4:7], s56 offen offset:0 sc1
  buffer_store_dwordx4 v[132:135], v17, s[4:7], s56 offen offset:1024 sc1
  v_pk_mul_f32 v[160:161], v[160:161], v[114:115] op_sel_hi:[1,0]
  v_pk_mul_f32 v[162:163], v[162:163], v[114:115] op_sel_hi:[1,0]
  v_pk_mul_f32 v[164:165], v[164:165], v[114:115] op_sel_hi:[1,0]
  v_pk_mul_f32 v[166:167], v[166:167], v[114:115] op_sel_hi:[1,0]
  v_pk_mul_f32 v[168:169], v[168:169], v[114:115] op_sel_hi:[1,0]
  v_pk_mul_f32 v[170:171], v[170:171], v[114:115] op_sel_hi:[1,0]
  v_pk_mul_f32 v[172:173], v[172:173], v[114:115] op_sel_hi:[1,0]
  v_pk_mul_f32 v[174:175], v[174:175], v[114:115] op_sel_hi:[1,0]
  v_cvt_pk_bf16_f32 v160, v160, v161
  v_cvt_pk_bf16_f32 v161, v162, v163
  v_cvt_pk_bf16_f32 v162, v164, v165
  v_cvt_pk_bf16_f32 v163, v166, v167
  v_cvt_pk_bf16_f32 v164, v168, v169
  v_cvt_pk_bf16_f32 v165, v170, v171
  v_cvt_pk_bf16_f32 v166, v172, v173
  v_cvt_pk_bf16_f32 v167, v174, v175
  v_permlane32_swap_b32 v144, v146
  v_permlane32_swap_b32 v145, v147
  v_permlane32_swap_b32 v148, v150
  v_permlane32_swap_b32 v149, v151
  s_add_u32 s56, s16, 0x800
  buffer_store_dwordx4 v[144:147], v17, s[4:7], s56 offen offset:0 sc1
  buffer_store_dwordx4 v[148:151], v17, s[4:7], s56 offen offset:1024 sc1
  v_pk_mul_f32 v[176:177], v[176:177], v[114:115] op_sel_hi:[1,0]
  v_pk_mul_f32 v[178:179], v[178:179], v[114:115] op_sel_hi:[1,0]
  v_pk_mul_f32 v[180:181], v[180:181], v[114:115] op_sel_hi:[1,0]
  v_pk_mul_f32 v[182:183], v[182:183], v[114:115] op_sel_hi:[1,0]
  v_pk_mul_f32 v[184:185], v[184:185], v[114:115] op_sel_hi:[1,0]
  v_pk_mul_f32 v[186:187], v[186:187], v[114:115] op_sel_hi:[1,0]
  v_pk_mul_f32 v[188:189], v[188:189], v[114:115] op_sel_hi:[1,0]
  v_pk_mul_f32 v[190:191], v[190:191], v[114:115] op_sel_hi:[1,0]
  v_cvt_pk_bf16_f32 v176, v176, v177
  v_cvt_pk_bf16_f32 v177, v178, v179
  v_cvt_pk_bf16_f32 v178, v180, v181
  v_cvt_pk_bf16_f32 v179, v182, v183
  v_cvt_pk_bf16_f32 v180, v184, v185
  v_cvt_pk_bf16_f32 v181, v186, v187
  v_cvt_pk_bf16_f32 v182, v188, v189
  v_cvt_pk_bf16_f32 v183, v190, v191
  v_permlane32_swap_b32 v160, v162
  v_permlane32_swap_b32 v161, v163
  v_permlane32_swap_b32 v164, v166
  v_permlane32_swap_b32 v165, v167
  s_add_u32 s56, s16, 0x1000
  buffer_store_dwordx4 v[160:163], v17, s[4:7], s56 offen offset:0 sc1
  buffer_store_dwordx4 v[164:167], v17, s[4:7], s56 offen offset:1024 sc1
  v_pk_mul_f32 v[192:193], v[192:193], v[114:115] op_sel:[0,1] op_sel_hi:[1,1]
  v_pk_mul_f32 v[194:195], v[194:195], v[114:115] op_sel:[0,1] op_sel_hi:[1,1]
  v_pk_mul_f32 v[196:197], v[196:197], v[114:115] op_sel:[0,1] op_sel_hi:[1,1]
  v_pk_mul_f32 v[198:199], v[198:199], v[114:115] op_sel:[0,1] op_sel_hi:[1,1]
  v_pk_mul_f32 v[200:201], v[200:201], v[114:115] op_sel:[0,1] op_sel_hi:[1,1]
  v_pk_mul_f32 v[202:203], v[202:203], v[114:115] op_sel:[0,1] op_sel_hi:[1,1]
  v_pk_mul_f32 v[204:205], v[204:205], v[114:115] op_sel:[0,1] op_sel_hi:[1,1]
  v_pk_mul_f32 v[206:207], v[206:207], v[114:115] op_sel:[0,1] op_sel_hi:[1,1]
  v_cvt_pk_bf16_f32 v192, v192, v193
  v_cvt_pk_bf16_f32 v193, v194, v195
  v_cvt_pk_bf16_f32 v194, v196, v197
  v_cvt_pk_bf16_f32 v195, v198, v199
  v_cvt_pk_bf16_f32 v196, v200, v201
  v_cvt_pk_bf16_f32 v197, v202, v203
  v_cvt_pk_bf16_f32 v198, v204, v205
  v_cvt_pk_bf16_f32 v199, v206, v207
  v_permlane32_swap_b32 v176, v178
  v_permlane32_swap_b32 v177, v179
  v_permlane32_swap_b32 v180, v182
  v_permlane32_swap_b32 v181, v183
  s_add_u32 s56, s16, 0x1800
  buffer_store_dwordx4 v[176:179], v17, s[4:7], s56 offen offset:0 sc1
  buffer_store_dwordx4 v[180:183], v17, s[4:7], s56 offen offset:1024 sc1
  v_pk_mul_f32 v[208:209], v[208:209], v[114:115] op_sel:[0,1] op_sel_hi:[1,1]
  v_pk_mul_f32 v[210:211], v[210:211], v[114:115] op_sel:[0,1] op_sel_hi:[1,1]
  v_pk_mul_f32 v[212:213], v[212:213], v[114:115] op_sel:[0,1] op_sel_hi:[1,1]
  v_pk_mul_f32 v[214:215], v[214:215], v[114:115] op_sel:[0,1] op_sel_hi:[1,1]
  v_pk_mul_f32 v[216:217], v[216:217], v[114:115] op_sel:[0,1] op_sel_hi:[1,1]
  v_pk_mul_f32 v[218:219], v[218:219], v[114:115] op_sel:[0,1] op_sel_hi:[1,1]
  v_pk_mul_f32 v[220:221], v[220:221], v[114:115] op_sel:[0,1] op_sel_hi:[1,1]
  v_pk_mul_f32 v[222:223], v[222:223], v[114:115] op_sel:[0,1] op_sel_hi:[1,1]
  v_cvt_pk_bf16_f32 v208, v208, v209
  v_cvt_pk_bf16_f32 v209, v210, v211
  v_cvt_pk_bf16_f32 v210, v212, v213
  v_cvt_pk_bf16_f32 v211, v214, v215
  v_cvt_pk_bf16_f32 v212, v216, v217
  v_cvt_pk_bf16_f32 v213, v218, v219
  v_cvt_pk_bf16_f32 v214, v220, v221
  v_cvt_pk_bf16_f32 v215, v222, v223
  v_permlane32_swap_b32 v192, v194
  v_permlane32_swap_b32 v193, v195
  v_permlane32_swap_b32 v196, v198
  v_permlane32_swap_b32 v197, v199
  s_add_u32 s56, s16, 0x2000
  buffer_store_dwordx4 v[192:195], v17, s[4:7], s56 offen offset:0 sc1
  buffer_store_dwordx4 v[196:199], v17, s[4:7], s56 offen offset:1024 sc1
  v_pk_mul_f32 v[224:225], v[224:225], v[114:115] op_sel:[0,1] op_sel_hi:[1,1]
  v_pk_mul_f32 v[226:227], v[226:227], v[114:115] op_sel:[0,1] op_sel_hi:[1,1]
  v_pk_mul_f32 v[228:229], v[228:229], v[114:115] op_sel:[0,1] op_sel_hi:[1,1]
  v_pk_mul_f32 v[230:231], v[230:231], v[114:115] op_sel:[0,1] op_sel_hi:[1,1]
  v_pk_mul_f32 v[232:233], v[232:233], v[114:115] op_sel:[0,1] op_sel_hi:[1,1]
  v_pk_mul_f32 v[234:235], v[234:235], v[114:115] op_sel:[0,1] op_sel_hi:[1,1]
  v_pk_mul_f32 v[236:237], v[236:237], v[114:115] op_sel:[0,1] op_sel_hi:[1,1]
  v_pk_mul_f32 v[238:239], v[238:239], v[114:115] op_sel:[0,1] op_sel_hi:[1,1]
  v_cvt_pk_bf16_f32 v224, v224, v225
  v_cvt_pk_bf16_f32 v225, v226, v227
  v_cvt_pk_bf16_f32 v226, v228, v229
  v_cvt_pk_bf16_f32 v227, v230, v231
  v_cvt_pk_bf16_f32 v228, v232, v233
  v_cvt_pk_bf16_f32 v229, v234, v235
  v_cvt_pk_bf16_f32 v230, v236, v237
  v_cvt_pk_bf16_f32 v231, v238, v239
  v_permlane32_swap_b32 v208, v210
  v_permlane32_swap_b32 v209, v211
  v_permlane32_swap_b32 v212, v214
  v_permlane32_swap_b32 v213, v215
  s_add_u32 s56, s16, 0x2800
  buffer_store_dwordx4 v[208:211], v17, s[4:7], s56 offen offset:0 sc1
  buffer_store_dwordx4 v[212:215], v17, s[4:7], s56 offen offset:1024 sc1
  v_pk_mul_f32 v[240:241], v[240:241], v[114:115] op_sel:[0,1] op_sel_hi:[1,1]
  v_pk_mul_f32 v[242:243], v[242:243], v[114:115] op_sel:[0,1] op_sel_hi:[1,1]
  v_pk_mul_f32 v[244:245], v[244:245], v[114:115] op_sel:[0,1] op_sel_hi:[1,1]
  v_pk_mul_f32 v[246:247], v[246:247], v[114:115] op_sel:[0,1] op_sel_hi:[1,1]
  v_pk_mul_f32 v[248:249], v[248:249], v[114:115] op_sel:[0,1] op_sel_hi:[1,1]
  v_pk_mul_f32 v[250:251], v[250:251], v[114:115] op_sel:[0,1] op_sel_hi:[1,1]
  v_pk_mul_f32 v[252:253], v[252:253], v[114:115] op_sel:[0,1] op_sel_hi:[1,1]
  v_pk_mul_f32 v[254:255], v[254:255], v[114:115] op_sel:[0,1] op_sel_hi:[1,1]
  v_cvt_pk_bf16_f32 v240, v240, v241
  v_cvt_pk_bf16_f32 v241, v242, v243
  v_cvt_pk_bf16_f32 v242, v244, v245
  v_cvt_pk_bf16_f32 v243, v246, v247
  v_cvt_pk_bf16_f32 v244, v248, v249
  v_cvt_pk_bf16_f32 v245, v250, v251
  v_cvt_pk_bf16_f32 v246, v252, v253
  v_cvt_pk_bf16_f32 v247, v254, v255
  v_permlane32_swap_b32 v224, v226
  v_permlane32_swap_b32 v225, v227
  v_permlane32_swap_b32 v228, v230
  v_permlane32_swap_b32 v229, v231
  s_add_u32 s56, s16, 0x3000
  buffer_store_dwordx4 v[224:227], v17, s[4:7], s56 offen offset:0 sc1
  buffer_store_dwordx4 v[228:231], v17, s[4:7], s56 offen offset:1024 sc1
  v_permlane32_swap_b32 v240, v242
  v_permlane32_swap_b32 v241, v243
  v_permlane32_swap_b32 v244, v246
  v_permlane32_swap_b32 v245, v247
  s_add_u32 s56, s16, 0x3800
  buffer_store_dwordx4 v[240:243], v17, s[4:7], s56 offen offset:0 sc1
  buffer_store_dwordx4 v[244:247], v17, s[4:7], s56 offen offset:1024 sc1
  s_branch .done
.tAX_25:
  s_lshr_b32 s51, s95, 3
  s_lshl2_add_u32 s51, s94, s51
  s_and_b32 s52, s95, 7
  s_cmp_lt_u32 s51, 56
  s_cbranch_scc1 .next
  s_lshl_b32 s54, s51, 7
  s_add_u32 s54, s54, 123740160
  s_cmp_lg_u32 s18, 0
  s_cbranch_scc1 .w0_51
  s_bitcmp1_b32 s3, 0
  s_cbranch_scc1 .ini_55
  v_mov_b32 v121, 0
.inl_56:
  buffer_load_dword v120, v121, s[8:11], 0 offen offset:20 sc1
  s_waitcnt vmcnt(0)
  v_readfirstlane_b32 s95, v120
  s_or_b32 s3, s3, s95
  s_bitcmp1_b32 s3, 0
  s_cbranch_scc1 .ini_55
  s_sleep 2
  s_sub_u32 s20, s20, 1
  s_cbranch_scc0 .inl_56
  v_mov_b32 v120, 0xdead
  v_mov_b32 v121, 0
  buffer_store_dword v120, v121, s[8:11], 0 offen offset:28 sc1
  s_mov_b32 s20, 0
  s_mov_b32 s94, 65535
  s_branch .dwo_52
.ini_55:
  s_lshr_b32 s96, s51, 2
  s_lshl_b32 s96, s96, 7
  s_add_u32 s96, s96, 123731968
  v_mbcnt_lo_u32_b32 v123, -1, 0
  v_mbcnt_hi_u32_b32 v123, -1, v123
  v_and_b32 v123, 1, v123
  v_lshlrev_b32 v122, 11, v123
  v_add_u32 v122, s96, v122
  v_lshlrev_b32 v123, 4, v123
  v_sub_u32 v123, 32, v123
  v_mov_b32 v126, 0
.dwl_53:
  buffer_load_dword v124, v122, s[4:7], 0 offen sc1
  s_bitcmp1_b32 s3, 1
  s_cbranch_scc1 .dwn_57
  buffer_load_dword v125, v126, s[8:11], 0 offen offset:8 sc1
.dwn_57:
  s_waitcnt vmcnt(0)
  s_mov_b32 s94, 0
  v_cmp_lt_u32 vcc, v124, v123
  s_cbranch_vccz .dwo_52
  s_bitcmp1_b32 s3, 1
  s_cbranch_scc1 .dws_54
  v_readfirstlane_b32 s95, v125
  s_and_b32 s94, s95, 65791
  s_cmp_eq_u32 s94, 65
  s_cselect_b32 s94, 2, 0
  s_or_b32 s3, s3, s94
  s_bitcmp0_b32 s95, 16
  s_cbranch_scc1 .dws_54
  v_mov_b32 v120, 1
  v_mov_b32 v121, 0
  s_mov_b64 exec, 1
  buffer_atomic_add v120, v121, s[8:11], 0 offen offset:24 sc0 sc1
  s_mov_b64 exec, -1
  s_waitcnt vmcnt(0)
  v_readfirstlane_b32 s94, v120
  s_or_b32 s3, s3, 2
  s_cmp_ge_u32 s94, 64
  s_cbranch_scc1 .dws_54
  s_or_b32 s94, s94, 65536
  s_branch .dwo_52
.dws_54:
  s_sleep 4
  s_sub_u32 s20, s20, 1
  s_cbranch_scc0 .dwl_53
  v_mov_b32 v120, 0xdead
  v_mov_b32 v121, 0
  buffer_store_dword v120, v121, s[8:11], 0 offen offset:28 sc1
  s_mov_b32 s20, 0
  s_mov_b32 s94, 65535
  s_branch .dwo_52
.dwo_52:
  v_mov_b32 v120, s94
  v_mov_b32 v121, 163776
  ds_write_b32 v121, v120
  s_waitcnt lgkmcnt(0)
.w0_51:
  s_barrier
  v_mov_b32 v121, 163776
  ds_read_b32 v120, v121
  s_waitcnt lgkmcnt(0)
  v_readfirstlane_b32 s94, v120
  s_barrier
  s_cmp_lg_u32 s94, 0
  s_cbranch_scc1 .special
  v_mbcnt_lo_u32_b32 v16, -1, 0
  v_mbcnt_hi_u32_b32 v16, -1, v16
  v_and_b32 v18, 31, v16
  v_lshrrev_b32 v19, 5, v16
  v_lshlrev_b32 v21, 4, v16
  v_lshlrev_b32 v26, 3, v19
  v_sub_u32 v26, v18, v26
  v_and_b32 v20, 7, v16
  v_lshlrev_b32 v20, 4, v20
  v_lshl_add_u32 v25, v19, 7, v20
  v_lshrrev_b32 v20, 3, v18
  v_lshl_add_u32 v23, v20, 9, v25
  v_bfe_u32 v20, v16, 3, 1
  v_lshl_add_u32 v22, v20, 10, v25
  v_bfe_u32 v20, v16, 4, 1
  v_lshl_add_u32 v22, v20, 9, v22
  v_lshlrev_b32 v24, 8, v20
  v_lshl_add_u32 v24, v19, 7, v24
  v_and_b32 v20, 15, v16
  v_lshl_add_u32 v24, v20, 3, v24
  v_bfe_u32 v20, v16, 3, 1
  v_lshl_add_u32 v25, v20, 9, v25
  s_lshl_b32 s56, s51, 3
  s_add_u32 s56, s56, s52
  s_lshl_b32 s56, s56, 2
  s_add_u32 s56, s56, s18
  s_lshl_b32 s56, s56, 13
  s_add_u32 s40, s56, 0
  s_add_u32 s16, s56, 67108864
  s_add_u32 s41, s56, 33554432
  s_add_u32 s42, s56, 16777216
  s_add_u32 s43, s56, 100663296
  s_add_u32 s56, s41, 0
  s_add_u32 s57, s40, 0
  buffer_load_dwordx4 a[32:35], v22, s[4:7], s56 offen offset:0 sc1
  buffer_load_dwordx4 a[0:3], v21, s[4:7], s57 offen offset:0 sc1
  buffer_load_dwordx4 a[36:39], v22, s[4:7], s56 offen offset:256 sc1
  buffer_load_dwordx4 a[4:7], v21, s[4:7], s57 offen offset:1024 sc1
  buffer_load_dwordx4 a[40:43], v22, s[4:7], s56 offen offset:2048 sc1
  buffer_load_dwordx4 a[8:11], v21, s[4:7], s57 offen offset:2048 sc1
  buffer_load_dwordx4 a[44:47], v22, s[4:7], s56 offen offset:2304 sc1
  buffer_load_dwordx4 a[12:15], v21, s[4:7], s57 offen offset:3072 sc1
  s_add_u32 s56, s41, 4096
  s_add_u32 s57, s40, 4096
  buffer_load_dwordx4 a[48:51], v22, s[4:7], s56 offen offset:0 sc1
  buffer_load_dwordx4 a[16:19], v21, s[4:7], s57 offen offset:0 sc1
  buffer_load_dwordx4 a[52:55], v22, s[4:7], s56 offen offset:256 sc1
  buffer_load_dwordx4 a[20:23], v21, s[4:7], s57 offen offset:1024 sc1
  buffer_load_dwordx4 a[56:59], v22, s[4:7], s56 offen offset:2048 sc1
  buffer_load_dwordx4 a[24:27], v21, s[4:7], s57 offen offset:2048 sc1
  buffer_load_dwordx4 a[60:63], v22, s[4:7], s56 offen offset:2304 sc1
  buffer_load_dwordx4 a[28:31], v21, s[4:7], s57 offen offset:3072 sc1
  s_add_u32 s56, s42, 0
  buffer_load_dwordx4 a[64:67], v23, s[4:7], s56 offen offset:0 sc1
  buffer_load_dwordx4 a[68:71], v23, s[4:7], s56 offen offset:256 sc1
  buffer_load_dwordx4 a[72:75], v23, s[4:7], s56 offen offset:2048 sc1
  buffer_load_dwordx4 a[76:79], v23, s[4:7], s56 offen offset:2304 sc1
  s_add_u32 s56, s42, 4096
  buffer_load_dwordx4 a[80:83], v23, s[4:7], s56 offen offset:0 sc1
  buffer_load_dwordx4 a[84:87], v23, s[4:7], s56 offen offset:256 sc1
  buffer_load_dwordx4 a[88:91], v23, s[4:7], s56 offen offset:2048 sc1
  buffer_load_dwordx4 a[92:95], v23, s[4:7], s56 offen offset:2304 sc1
.aag_58:
  v_mov_b32 v18, 0xd028965f
  s_waitcnt vmcnt(22)
  v_mfma_f32_32x32x16_bf16 v[32:47], a[32:35], a[0:3], 0
  s_waitcnt vmcnt(20)
  v_mfma_f32_32x32x16_bf16 v[32:47], a[36:39], a[4:7], v[32:47]
  s_waitcnt vmcnt(18)
  v_mfma_f32_32x32x16_bf16 v[32:47], a[40:43], a[8:11], v[32:47]
  s_waitcnt vmcnt(16)
  v_mfma_f32_32x32x16_bf16 v[32:47], a[44:47], a[12:15], v[32:47]
  s_waitcnt vmcnt(14)
  v_mfma_f32_32x32x16_bf16 v[32:47], a[48:51], a[16:19], v[32:47]
  s_waitcnt vmcnt(12)
  v_mfma_f32_32x32x16_bf16 v[32:47], a[52:55], a[20:23], v[32:47]
  s_waitcnt vmcnt(10)
  v_mfma_f32_32x32x16_bf16 v[32:47], a[56:59], a[24:27], v[32:47]
  s_waitcnt vmcnt(8)
  v_mfma_f32_32x32x16_bf16 v[32:47], a[60:63], a[28:31], v[32:47]
  v_cmp_le_i32 vcc, 0, v26
  s_nop 10
  v_cndmask_b32 v32, v18, v32, vcc
  v_cmp_le_i32 vcc, 1, v26
  s_nop 1
  v_cndmask_b32 v33, v18, v33, vcc
  v_cmp_le_i32 vcc, 2, v26
  s_nop 1
  v_cndmask_b32 v34, v18, v34, vcc
  v_cmp_le_i32 vcc, 3, v26
  s_nop 1
  v_cndmask_b32 v35, v18, v35, vcc
  v_cmp_le_i32 vcc, 4, v26
  s_nop 1
  v_cndmask_b32 v36, v18, v36, vcc
  v_cmp_le_i32 vcc, 5, v26
  s_nop 1
  v_cndmask_b32 v37, v18, v37, vcc
  v_cmp_le_i32 vcc, 6, v26
  s_nop 1
  v_cndmask_b32 v38, v18, v38, vcc
  v_cmp_le_i32 vcc, 7, v26
  s_nop 1
  v_cndmask_b32 v39, v18, v39, vcc
  v_cmp_le_i32 vcc, 16, v26
  s_nop 1
  v_cndmask_b32 v40, v18, v40, vcc
  v_cmp_le_i32 vcc, 17, v26
  s_nop 1
  v_cndmask_b32 v41, v18, v41, vcc
  v_cmp_le_i32 vcc, 18, v26
  s_nop 1
  v_cndmask_b32 v42, v18, v42, vcc
  v_cmp_le_i32 vcc, 19, v26
  s_nop 1
  v_cndmask_b32 v43, v18, v43, vcc
  v_cmp_le_i32 vcc, 20, v26
  s_nop 1
  v_cndmask_b32 v44, v18, v44, vcc
  v_cmp_le_i32 vcc, 21, v26
  s_nop 1
  v_cndmask_b32 v45, v18, v45, vcc
  v_cmp_le_i32 vcc, 22, v26
  s_nop 1
  v_cndmask_b32 v46, v18, v46, vcc
  v_cmp_le_i32 vcc, 23, v26
  s_nop 1
  v_cndmask_b32 v47, v18, v47, vcc
  s_bitcmp1_b32 s3, 7
  s_cbranch_scc1 .apr_59
  s_cmp_lg_u32 s18, 0
  s_cbranch_scc1 .w0_61
  s_bitcmp1_b32 s3, 0
  s_cbranch_scc1 .ini_65
  v_mov_b32 v121, 0
.inl_66:
  buffer_load_dword v120, v121, s[8:11], 0 offen offset:20 sc1
  s_waitcnt vmcnt(0)
  v_readfirstlane_b32 s95, v120
  s_or_b32 s3, s3, s95
  s_bitcmp1_b32 s3, 0
  s_cbranch_scc1 .ini_65
  s_sleep 2
  s_sub_u32 s20, s20, 1
  s_cbranch_scc0 .inl_66
  v_mov_b32 v120, 0xdead
  v_mov_b32 v121, 0
  buffer_store_dword v120, v121, s[8:11], 0 offen offset:28 sc1
  s_mov_b32 s20, 0
  s_mov_b32 s94, 65535
  s_branch .dwo_62
.ini_65:
  v_mbcnt_lo_u32_b32 v123, -1, 0
  v_mbcnt_hi_u32_b32 v123, -1, v123
  v_and_b32 v122, 1, v123
  v_lshlrev_b32 v122, 12, v122
  v_bfe_u32 v123, v123, 1, 2
  v_lshl_add_u32 v122, v123, 7, v122
  s_lshl_b32 s96, s52, 9
  s_add_u32 s96, s96, 123752448
  v_add_u32 v122, s96, v122
  s_add_u32 s96, s51, -1
  v_mov_b32 v123, s96
  v_mov_b32 v126, 0
.dwl_63:
  buffer_load_dword v124, v122, s[4:7], 0 offen sc1
  s_bitcmp1_b32 s3, 1
  s_cbranch_scc1 .dwn_67
  buffer_load_dword v125, v126, s[8:11], 0 offen offset:8 sc1
.dwn_67:
  s_waitcnt vmcnt(0)
  s_mov_b32 s94, 0
  v_cmp_lt_u32 vcc, v124, v123
  s_cbranch_vccz .dwo_62
  s_bitcmp1_b32 s3, 1
  s_cbranch_scc1 .dws_64
  v_readfirstlane_b32 s95, v125
  s_and_b32 s94, s95, 65791
  s_cmp_eq_u32 s94, 65
  s_cselect_b32 s94, 2, 0
  s_or_b32 s3, s3, s94
  s_bitcmp0_b32 s95, 16
  s_cbranch_scc1 .dws_64
  v_mov_b32 v120, 1
  v_mov_b32 v121, 0
  s_mov_b64 exec, 1
  buffer_atomic_add v120, v121, s[8:11], 0 offen offset:24 sc0 sc1
  s_mov_b64 exec, -1
  s_waitcnt vmcnt(0)
  v_readfirstlane_b32 s94, v120
  s_or_b32 s3, s3, 2
  s_cmp_ge_u32 s94, 64
  s_cbranch_scc1 .dws_64
  s_or_b32 s94, s94, 65536
  s_branch .dwo_62
.dws_64:
  s_sleep 4
  s_sub_u32 s20, s20, 1
  s_cbranch_scc0 .dwl_63
  v_mov_b32 v120, 0xdead
  v_mov_b32 v121, 0
  buffer_store_dword v120, v121, s[8:11], 0 offen offset:28 sc1
  s_mov_b32 s20, 0
  s_mov_b32 s94, 65535
  s_branch .dwo_62
.dwo_62:
  v_mov_b32 v120, s94
  v_mov_b32 v121, 163776
  ds_write_b32 v121, v120
  s_waitcnt lgkmcnt(0)
.w0_61:
  s_barrier
  v_mov_b32 v121, 163776
  ds_read_b32 v120, v121
  s_waitcnt lgkmcnt(0)
  v_readfirstlane_b32 s94, v120
  s_barrier
  s_cmp_lg_u32 s94, 0
  s_cbranch_scc1 .special
  v_lshlrev_b32 v17, 4, v16
  v_mov_b32 v120, -1
  v_mov_b32 v121, -1
  v_mov_b32 v122, -1
  v_mov_b32 v123, -1
  s_add_u32 s56, s16, 0
  buffer_store_dwordx4 v[120:123], v17, s[4:7], s56 offen offset:0 sc1
  buffer_store_dwordx4 v[120:123], v17, s[4:7], s56 offen offset:1024 sc1
  buffer_store_dwordx4 v[120:123], v17, s[4:7], s56 offen offset:2048 sc1
  buffer_store_dwordx4 v[120:123], v17, s[4:7], s56 offen offset:3072 sc1
  s_add_u32 s56, s16, 4096
  buffer_store_dwordx4 v[120:123], v17, s[4:7], s56 offen offset:0 sc1
  buffer_store_dwordx4 v[120:123], v17, s[4:7], s56 offen offset:1024 sc1
  buffer_store_dwordx4 v[120:123], v17, s[4:7], s56 offen offset:2048 sc1
  buffer_store_dwordx4 v[120:123], v17, s[4:7], s56 offen offset:3072 sc1
  s_waitcnt vmcnt(0)
  s_barrier
  s_cmp_lg_u32 s18, 0
  s_cbranch_scc1 .w0_68
  v_mov_b32 v120, 16
  v_mov_b32 v121, 0
  s_mov_b64 exec, 1
  buffer_atomic_add v120, v121, s[4:7], s54 offen sc1
  s_mov_b64 exec, -1
.w0_68:
  s_bitset1_b32 s3, 6
.apr_59:
  v_and_b32 v122, 15, v16
  v_lshlrev_b32 v122, 9, v122
  s_add_u32 s96, s43, 496
  v_add_u32 v122, s96, v122
  v_and_b32 v123, 1, v16
  v_lshlrev_b32 v123, 12, v123
  s_lshl_b32 s96, s52, 9
  s_lshl_b32 s97, s18, 7
  s_add_u32 s96, s96, s97
  s_add_u32 s96, s96, 123752448
  v_add_u32 v123, s96, v123
  v_cmp_lt_u32 vcc, 31, v16
  s_nop 1
  v_cndmask_b32 v122, v122, v123, vcc
  buffer_load_dword v124, v122, s[4:7], 0 offen sc1
.prl_69:
  buffer_load_dword v125, v122, s[4:7], 0 offen sc1
  s_waitcnt vmcnt(1)
  v_cmp_ge_u32 vcc, s51, v124
  s_cmp_eq_u32 vcc_hi, 0
  s_cbranch_scc1 .pra_70
  s_bitcmp0_b32 s3, 6
  s_cbranch_scc1 .prr_71
  v_cmp_eq_u32 vcc, -1, v124
  s_cmp_eq_u32 vcc_lo, 0
  s_cbranch_scc1 .apo_60
.prr_71:
  buffer_load_dword v124, v122, s[4:7], 0 offen sc1
  s_waitcnt vmcnt(1)
  v_cmp_ge_u32 vcc, s51, v125
  s_cmp_eq_u32 vcc_hi, 0
  s_cbranch_scc1 .pra_70
  s_bitcmp0_b32 s3, 6
  s_cbranch_scc1 .prr_72
  v_cmp_eq_u32 vcc, -1, v125
  s_cmp_eq_u32 vcc_lo, 0
  s_cbranch_scc1 .apo_60
.prr_72:
  s_sub_u32 s20, s20, 1
  s_cbranch_scc0 .prl_69
  s_branch .end
.pra_70:
  s_bitset0_b32 s3, 6
.apo_60:
  s_add_u32 s56, s43, 0
  buffer_load_dwordx4 v[128:131], v25, s[4:7], s56 offen offset:0 sc1
  buffer_load_dwordx4 v[132:135], v25, s[4:7], s56 offen offset:256 sc1
  buffer_load_dwordx4 v[136:139], v25, s[4:7], s56 offen offset:2048 sc1
  buffer_load_dwordx4 v[140:143], v25, s[4:7], s56 offen offset:2304 sc1
  s_add_u32 s56, s43, 4096
  buffer_load_dwordx4 v[144:147], v25, s[4:7], s56 offen offset:0 sc1
  buffer_load_dwordx4 v[148:151], v25, s[4:7], s56 offen offset:256 sc1
  buffer_load_dwordx4 v[152:155], v25, s[4:7], s56 offen offset:2048 sc1
  buffer_load_dwordx4 v[156:159], v25, s[4:7], s56 offen offset:2304 sc1
  s_add_u32 s56, s43, 0
  buffer_load_dwordx2 a[192:193], v24, s[4:7], s56 offen offset:1024 sc1
  buffer_load_dwordx2 a[194:195], v24, s[4:7], s56 offen offset:1536 sc1
  buffer_load_dwordx2 a[196:197], v24, s[4:7], s56 offen offset:3072 sc1
  buffer_load_dwordx2 a[198:199], v24, s[4:7], s56 offen offset:3584 sc1
  s_add_u32 s56, s43, 4096
  buffer_load_dwordx2 a[200:201], v24, s[4:7], s56 offen offset:1024 sc1
  buffer_load_dwordx2 a[202:203], v24, s[4:7], s56 offen offset:1536 sc1
  buffer_load_dwordx2 a[204:205], v24, s[4:7], s56 offen offset:3072 sc1
  buffer_load_dwordx2 a[206:207], v24, s[4:7], s56 offen offset:3584 sc1
  s_mov_b32 s58, 0x3e0293ee
  s_mov_b32 s59, 0x3e0293ee
  s_waitcnt vmcnt(15)
  v_mfma_f32_32x32x16_bf16 v[64:79], v[128:131], a[0:3], 0
  s_waitcnt vmcnt(14)
  v_mfma_f32_32x32x16_bf16 v[64:79], v[132:135], a[4:7], v[64:79]
  s_waitcnt vmcnt(13)
  v_mfma_f32_32x32x16_bf16 v[64:79], v[136:139], a[8:11], v[64:79]
  s_waitcnt vmcnt(12)
  v_mfma_f32_32x32x16_bf16 v[64:79], v[140:143], a[12:15], v[64:79]
  s_waitcnt vmcnt(11)
  v_mfma_f32_32x32x16_bf16 v[64:79], v[144:147], a[16:19], v[64:79]
  s_waitcnt vmcnt(10)
  v_mfma_f32_32x32x16_bf16 v[64:79], v[148:151], a[20:23], v[64:79]
  s_waitcnt vmcnt(9)
  v_mfma_f32_32x32x16_bf16 v[64:79], v[152:155], a[24:27], v[64:79]
  s_waitcnt vmcnt(8)
  v_mfma_f32_32x32x16_bf16 v[64:79], v[156:159], a[28:31], v[64:79]
  s_nop 11
  v_pk_add_f32 v[64:65], v[64:65], v[68:69]
  v_pk_add_f32 v[66:67], v[66:67], v[70:71]
  v_max3_f32 v112, v32, v33, v34
  v_max3_f32 v112, v112, v35, v36
  v_max3_f32 v112, v112, v37, v38
  v_max3_f32 v112, v112, v39, v40
  v_max3_f32 v112, v112, v41, v42
  v_max3_f32 v112, v112, v43, v44
  v_max3_f32 v112, v112, v45, v46
  v_max3_f32 v112, v112, v47, v64
  v_max3_f32 v112, v112, v65, v66
  v_max_f32 v112, v112, v67
  v_mov_b32 v113, v112
  s_nop 1
  v_permlane32_swap_b32 v112, v113
  v_max_f32 v112, v112, v113
  v_mul_f32 v112, s58, v112
  v_pk_fma_f32 v[32:33], v[32:33], s[58:59], v[112:113] op_sel_hi:[1,1,0] neg_lo:[0,0,1] neg_hi:[0,0,1]
  v_pk_fma_f32 v[34:35], v[34:35], s[58:59], v[112:113] op_sel_hi:[1,1,0] neg_lo:[0,0,1] neg_hi:[0,0,1]
  v_pk_fma_f32 v[36:37], v[36:37], s[58:59], v[112:113] op_sel_hi:[1,1,0] neg_lo:[0,0,1] neg_hi:[0,0,1]
  v_pk_fma_f32 v[38:39], v[38:39], s[58:59], v[112:113] op_sel_hi:[1,1,0] neg_lo:[0,0,1] neg_hi:[0,0,1]
  v_pk_fma_f32 v[40:41], v[40:41], s[58:59], v[112:113] op_sel_hi:[1,1,0] neg_lo:[0,0,1] neg_hi:[0,0,1]
  v_pk_fma_f32 v[42:43], v[42:43], s[58:59], v[112:113] op_sel_hi:[1,1,0] neg_lo:[0,0,1] neg_hi:[0,0,1]
  v_pk_fma_f32 v[44:45], v[44:45], s[58:59], v[112:113] op_sel_hi:[1,1,0] neg_lo:[0,0,1] neg_hi:[0,0,1]
  v_pk_fma_f32 v[46:47], v[46:47], s[58:59], v[112:113] op_sel_hi:[1,1,0] neg_lo:[0,0,1] neg_hi:[0,0,1]
  v_pk_fma_f32 v[64:65], v[64:65], s[58:59], v[112:113] op_sel_hi:[1,1,0] neg_lo:[0,0,1] neg_hi:[0,0,1]
  v_pk_fma_f32 v[66:67], v[66:67], s[58:59], v[112:113] op_sel_hi:[1,1,0] neg_lo:[0,0,1] neg_hi:[0,0,1]
  s_waitcnt vmcnt(0)
  v_exp_f32 v32, v32
  v_exp_f32 v33, v33
  v_mfma_f32_16x16x32_bf16 v[96:99], a[192:195], a[0:3], 0
  v_exp_f32 v34, v34
  v_exp_f32 v35, v35
  v_mfma_f32_16x16x32_bf16 v[96:99], a[196:199], a[0:3], v[96:99]
  v_exp_f32 v36, v36
  v_exp_f32 v37, v37
  v_mfma_f32_16x16x32_bf16 v[96:99], a[200:203], a[0:3], v[96:99]
  v_exp_f32 v38, v38
  v_exp_f32 v39, v39
  v_mfma_f32_16x16x32_bf16 v[96:99], a[204:207], a[0:3], v[96:99]
  v_exp_f32 v40, v40
  v_exp_f32 v41, v41
  v_exp_f32 v42, v42
  v_exp_f32 v43, v43
  v_exp_f32 v44, v44
  v_exp_f32 v45, v45
  v_exp_f32 v46, v46
  v_exp_f32 v47, v47
  v_exp_f32 v64, v64
  v_exp_f32 v65, v65
  v_exp_f32 v66, v66
  v_exp_f32 v67, v67
  v_cvt_pk_bf16_f32 v116, v32, v33
  v_cvt_pk_bf16_f32 v117, v34, v35
  v_cvt_pk_bf16_f32 v118, v36, v37
  v_cvt_pk_bf16_f32 v119, v38, v39
  v_cvt_pk_bf16_f32 v120, v40, v41
  v_cvt_pk_bf16_f32 v121, v42, v43
  v_cvt_pk_bf16_f32 v122, v44, v45
  v_cvt_pk_bf16_f32 v123, v46, v47
  v_cvt_pk_bf16_f32 v124, v64, v65
  v_cvt_pk_bf16_f32 v125, v66, v67
  v_mov_b64 v[126:127], v[124:125]
  v_mfma_f32_32x32x16_bf16 v[128:143], a[64:67], v[116:119], 0
  v_mfma_f32_32x32x16_bf16 v[128:143], a[68:71], v[120:123], v[128:143]
  v_mfma_f32_32x32x16_bf16 v[128:143], a[192:195], v[124:127], v[128:143]
  v_mfma_f32_32x32x16_bf16 v[144:159], a[72:75], v[116:119], 0
  v_mfma_f32_32x32x16_bf16 v[144:159], a[76:79], v[120:123], v[144:159]
  v_mfma_f32_32x32x16_bf16 v[144:159], a[196:199], v[124:127], v[144:159]
  v_mfma_f32_32x32x16_bf16 v[160:175], a[80:83], v[116:119], 0
  v_mfma_f32_32x32x16_bf16 v[160:175], a[84:87], v[120:123], v[160:175]
  v_mfma_f32_32x32x16_bf16 v[160:175], a[200:203], v[124:127], v[160:175]
  v_mfma_f32_32x32x16_bf16 v[176:191], a[88:91], v[116:119], 0
  v_mfma_f32_32x32x16_bf16 v[176:191], a[92:95], v[120:123], v[176:191]
  v_mfma_f32_32x32x16_bf16 v[176:191], a[204:207], v[124:127], v[176:191]
  v_pk_add_f32 v[32:33], v[32:33], v[34:35]
  v_pk_add_f32 v[32:33], v[32:33], v[36:37]
  v_pk_add_f32 v[32:33], v[32:33], v[38:39]
  v_pk_add_f32 v[32:33], v[32:33], v[40:41]
  v_pk_add_f32 v[32:33], v[32:33], v[42:43]
  v_pk_add_f32 v[32:33], v[32:33], v[44:45]
  v_pk_add_f32 v[32:33], v[32:33], v[46:47]
  v_pk_add_f32 v[32:33], v[32:33], v[64:65]
  v_pk_add_f32 v[32:33], v[32:33], v[66:67]
  v_add_f32 v114, v32, v33
  v_mov_b32 v113, v114
  s_nop 1
  v_permlane32_swap_b32 v114, v113
  v_add_f32 v114, v114, v113
  v_rcp_f32 v114, v114
  s_bitcmp0_b32 s3, 6
  s_cbranch_scc1 .aok_73
  v_add_f32 v96, v96, v114
  v_pk_add_f32 v[96:97], v[96:97], v[98:99]
  v_cmp_u_f32 vcc, v96, v97
  s_cbranch_vccz .aok_73
  s_bitset0_b32 s3, 6
  s_bitset1_b32 s3, 7
  s_branch .aag_58
.aok_73:
  s_and_b32 s3, s3, 63
.adr_74:
  v_lshlrev_b32 v17, 4, v16
  v_pk_mul_f32 v[128:129], v[128:129], v[114:115] op_sel_hi:[1,0]
  v_pk_mul_f32 v[130:131], v[130:131], v[114:115] op_sel_hi:[1,0]
  v_pk_mul_f32 v[132:133], v[132:133], v[114:115] op_sel_hi:[1,0]
  v_pk_mul_f32 v[134:135], v[134:135], v[114:115] op_sel_hi:[1,0]
  v_pk_mul_f32 v[136:137], v[136:137], v[114:115] op_sel_hi:[1,0]
  v_pk_mul_f32 v[138:139], v[138:139], v[114:115] op_sel_hi:[1,0]
  v_pk_mul_f32 v[140:141], v[140:141], v[114:115] op_sel_hi:[1,0]
  v_pk_mul_f32 v[142:143], v[142:143], v[114:115] op_sel_hi:[1,0]
  v_cvt_pk_bf16_f32 v128, v128, v129
  v_cvt_pk_bf16_f32 v129, v130, v131
  v_cvt_pk_bf16_f32 v130, v132, v133
  v_cvt_pk_bf16_f32 v131, v134, v135
  v_cvt_pk_bf16_f32 v132, v136, v137
  v_cvt_pk_bf16_f32 v133, v138, v139
  v_cvt_pk_bf16_f32 v134, v140, v141
  v_cvt_pk_bf16_f32 v135, v142, v143
  v_pk_mul_f32 v[144:145], v[144:145], v[114:115] op_sel_hi:[1,0]
  v_pk_mul_f32 v[146:147], v[146:147], v[114:115] op_sel_hi:[1,0]
  v_pk_mul_f32 v[148:149], v[148:149], v[114:115] op_sel_hi:[1,0]
  v_pk_mul_f32 v[150:151], v[150:151], v[114:115] op_sel_hi:[1,0]
  v_pk_mul_f32 v[152:153], v[152:153], v[114:115] op_sel_hi:[1,0]
  v_pk_mul_f32 v[154:155], v[154:155], v[114:115] op_sel_hi:[1,0]
  v_pk_mul_f32 v[156:157], v[156:157], v[114:115] op_sel_hi:[1,0]
  v_pk_mul_f32 v[158:159], v[158:159], v[114:115] op_sel_hi:[1,0]
  v_cvt_pk_bf16_f32 v144, v144, v145
  v_cvt_pk_bf16_f32 v145, v146, v147
  v_cvt_pk_bf16_f32 v146, v148, v149
  v_cvt_pk_bf16_f32 v147, v150, v151
  v_cvt_pk_bf16_f32 v148, v152, v153
  v_cvt_pk_bf16_f32 v149, v154, v155
  v_cvt_pk_bf16_f32 v150, v156, v157
  v_cvt_pk_bf16_f32 v151, v158, v159
  v_permlane32_swap_b32 v128, v130
  v_permlane32_swap_b32 v129, v131
  v_permlane32_swap_b32 v132, v134
  v_permlane32_swap_b32 v133, v135
  s_add_u32 s56, s16, 0x0
  buffer_store_dwordx4 v[128:131], v17, s[4:7], s56 offen offset:0 sc1
  buffer_store_dwordx4 v[132:135], v17, s[4:7], s56 offen offset:1024 sc1
  v_pk_mul_f32 v[160:161], v[160:161], v[114:115] op_sel_hi:[1,0]
  v_pk_mul_f32 v[162:163], v[162:163], v[114:115] op_sel_hi:[1,0]
  v_pk_mul_f32 v[164:165], v[164:165], v[114:115] op_sel_hi:[1,0]
  v_pk_mul_f32 v[166:167], v[166:167], v[114:115] op_sel_hi:[1,0]
  v_pk_mul_f32 v[168:169], v[168:169], v[114:115] op_sel_hi:[1,0]
  v_pk_mul_f32 v[170:171], v[170:171], v[114:115] op_sel_hi:[1,0]
  v_pk_mul_f32 v[172:173], v[172:173], v[114:115] op_sel_hi:[1,0]
  v_pk_mul_f32 v[174:175], v[174:175], v[114:115] op_sel_hi:[1,0]
  v_cvt_pk_bf16_f32 v160, v160, v161
  v_cvt_pk_bf16_f32 v161, v162, v163
  v_cvt_pk_bf16_f32 v162, v164, v165
  v_cvt_pk_bf16_f32 v163, v166, v167
  v_cvt_pk_bf16_f32 v164, v168, v169
  v_cvt_pk_bf16_f32 v165, v170, v171
  v_cvt_pk_bf16_f32 v166, v172, v173
  v_cvt_pk_bf16_f32 v167, v174, v175
  v_permlane32_swap_b32 v144, v146
  v_permlane32_swap_b32 v145, v147
  v_permlane32_swap_b32 v148, v150
  v_permlane32_swap_b32 v149, v151
  s_add_u32 s56, s16, 0x800
  buffer_store_dwordx4 v[144:147], v17, s[4:7], s56 offen offset:0 sc1
  buffer_store_dwordx4 v[148:151], v17, s[4:7], s56 offen offset:1024 sc1
  v_pk_mul_f32 v[176:177], v[176:177], v[114:115] op_sel_hi:[1,0]
  v_pk_mul_f32 v[178:179], v[178:179], v[114:115] op_sel_hi:[1,0]
  v_pk_mul_f32 v[180:181], v[180:181], v[114:115] op_sel_hi:[1,0]
  v_pk_mul_f32 v[182:183], v[182:183], v[114:115] op_sel_hi:[1,0]
  v_pk_mul_f32 v[184:185], v[184:185], v[114:115] op_sel_hi:[1,0]
  v_pk_mul_f32 v[186:187], v[186:187], v[114:115] op_sel_hi:[1,0]
  v_pk_mul_f32 v[188:189], v[188:189], v[114:115] op_sel_hi:[1,0]
  v_pk_mul_f32 v[190:191], v[190:191], v[114:115] op_sel_hi:[1,0]
  v_cvt_pk_bf16_f32 v176, v176, v177
  v_cvt_pk_bf16_f32 v177, v178, v179
  v_cvt_pk_bf16_f32 v178, v180, v181
  v_cvt_pk_bf16_f32 v179, v182, v183
  v_cvt_pk_bf16_f32 v180, v184, v185
  v_cvt_pk_bf16_f32 v181, v186, v187
  v_cvt_pk_bf16_f32 v182, v188, v189
  v_cvt_pk_bf16_f32 v183, v190, v191
  v_permlane32_swap_b32 v160, v162
  v_permlane32_swap_b32 v161, v163
  v_permlane32_swap_b32 v164, v166
  v_permlane32_swap_b32 v165, v167
  s_add_u32 s56, s16, 0x1000
  buffer_store_dwordx4 v[160:163], v17, s[4:7], s56 offen offset:0 sc1
  buffer_store_dwordx4 v[164:167], v17, s[4:7], s56 offen offset:1024 sc1
  v_permlane32_swap_b32 v176, v178
  v_permlane32_swap_b32 v177, v179
  v_permlane32_swap_b32 v180, v182
  v_permlane32_swap_b32 v181, v183
  s_add_u32 s56, s16, 0x1800
  buffer_store_dwordx4 v[176:179], v17, s[4:7], s56 offen offset:0 sc1
  buffer_store_dwordx4 v[180:183], v17, s[4:7], s56 offen offset:1024 sc1
  s_branch .done
.tOPS_24:
  s_mov_b32 s52, s95
  s_add_u32 s51, s94, 40
  v_mbcnt_lo_u32_b32 v16, -1, 0
  v_mbcnt_hi_u32_b32 v16, -1, v16
  s_mov_b32 s28, s74
  s_mov_b32 s29, s75
  s_mov_b32 s30, 0x800000
  s_mov_b32 s31, 0x20000
  v_lshrrev_b32 v18, 2, v16
  v_and_b32 v19, 3, v16
  v_lshlrev_b32 v21, 11, v18
  v_lshl_add_u32 v21, v19, 4, v21
  v_and_b32 v18, 3, v18
  v_lshlrev_b32 v22, 6, v18
  v_lshl_add_u32 v22, v19, 3, v22
  v_lshrrev_b32 v18, 5, v16
  v_lshl_add_u32 v22, v18, 9, v22
  v_bfe_u32 v18, v16, 4, 1
  v_lshl_add_u32 v22, v18, 5, v22
  s_lshl_b32 s45, s18, 15
  v_add_u32 v22, s45, v22
  s_lshl_b32 s41, s18, 21
  s_lshl_b32 s56, s52, 6
  s_add_u32 s41, s41, s56
  s_add_u32 m0, s45, 0
  s_nop 0
  buffer_load_dwordx4 v21, s[28:31], s41 offen lds
  s_add_u32 s41, s41, 32768
  s_add_u32 m0, s45, 1024
  s_nop 0
  buffer_load_dwordx4 v21, s[28:31], s41 offen lds
  s_add_u32 s41, s41, 32768
  s_add_u32 m0, s45, 2048
  s_nop 0
  buffer_load_dwordx4 v21, s[28:31], s41 offen lds
  s_add_u32 s41, s41, 32768
  s_add_u32 m0, s45, 3072
  s_nop 0
  buffer_load_dwordx4 v21, s[28:31], s41 offen lds
  s_add_u32 s41, s41, 32768
  s_add_u32 m0, s45, 4096
  s_nop 0
  buffer_load_dwordx4 v21, s[28:31], s41 offen lds
  s_add_u32 s41, s41, 32768
  s_add_u32 m0, s45, 5120
  s_nop 0
  buffer_load_dwordx4 v21, s[28:31], s41 offen lds
  s_add_u32 s41, s41, 32768
  s_add_u32 m0, s45, 6144
  s_nop 0
  buffer_load_dwordx4 v21, s[28:31], s41 offen lds
  s_add_u32 s41, s41, 32768
  s_add_u32 m0, s45, 7168
  s_nop 0
  buffer_load_dwordx4 v21, s[28:31], s41 offen lds
  s_add_u32 s41, s41, 32768
  s_add_u32 m0, s45, 8192
  s_nop 0
  buffer_load_dwordx4 v21, s[28:31], s41 offen lds
  s_add_u32 s41, s41, 32768
  s_add_u32 m0, s45, 9216
  s_nop 0
  buffer_load_dwordx4 v21, s[28:31], s41 offen lds
  s_add_u32 s41, s41, 32768
  s_add_u32 m0, s45, 10240
  s_nop 0
  buffer_load_dwordx4 v21, s[28:31], s41 offen lds
  s_add_u32 s41, s41, 32768
  s_add_u32 m0, s45, 11264
  s_nop 0
  buffer_load_dwordx4 v21, s[28:31], s41 offen lds
  s_add_u32 s41, s41, 32768
  s_add_u32 m0, s45, 12288
  s_nop 0
  buffer_load_dwordx4 v21, s[28:31], s41 offen lds
  s_add_u32 s41, s41, 32768
  s_add_u32 m0, s45, 13312
  s_nop 0
  buffer_load_dwordx4 v21, s[28:31], s41 offen lds
  s_add_u32 s41, s41, 32768
  s_add_u32 m0, s45, 14336
  s_nop 0
  buffer_load_dwordx4 v21, s[28:31], s41 offen lds
  s_add_u32 s41, s41, 32768
  s_add_u32 m0, s45, 15360
  s_nop 0
  buffer_load_dwordx4 v21, s[28:31], s41 offen lds
  s_add_u32 s41, s41, 32768
  s_add_u32 m0, s45, 16384
  s_nop 0
  buffer_load_dwordx4 v21, s[28:31], s41 offen lds
  s_add_u32 s41, s41, 32768
  s_add_u32 m0, s45, 17408
  s_nop 0
  buffer_load_dwordx4 v21, s[28:31], s41 offen lds
  s_add_u32 s41, s41, 32768
  s_add_u32 m0, s45, 18432
  s_nop 0
  buffer_load_dwordx4 v21, s[28:31], s41 offen lds
  s_add_u32 s41, s41, 32768
  s_add_u32 m0, s45, 19456
  s_nop 0
  buffer_load_dwordx4 v21, s[28:31], s41 offen lds
  s_add_u32 s41, s41, 32768
  s_add_u32 m0, s45, 20480
  s_nop 0
  buffer_load_dwordx4 v21, s[28:31], s41 offen lds
  s_add_u32 s41, s41, 32768
  s_add_u32 m0, s45, 21504
  s_nop 0
  buffer_load_dwordx4 v21, s[28:31], s41 offen lds
  s_add_u32 s41, s41, 32768
  s_add_u32 m0, s45, 22528
  s_nop 0
  buffer_load_dwordx4 v21, s[28:31], s41 offen lds
  s_add_u32 s41, s41, 32768
  s_add_u32 m0, s45, 23552
  s_nop 0
  buffer_load_dwordx4 v21, s[28:31], s41 offen lds
  s_add_u32 s41, s41, 32768
  s_add_u32 m0, s45, 24576
  s_nop 0
  buffer_load_dwordx4 v21, s[28:31], s41 offen lds
  s_add_u32 s41, s41, 32768
  s_add_u32 m0, s45, 25600
  s_nop 0
  buffer_load_dwordx4 v21, s[28:31], s41 offen lds
  s_add_u32 s41, s41, 32768
  s_add_u32 m0, s45, 26624
  s_nop 0
  buffer_load_dwordx4 v21, s[28:31], s41 offen lds
  s_add_u32 s41, s41, 32768
  s_add_u32 m0, s45, 27648
  s_nop 0
  buffer_load_dwordx4 v21, s[28:31], s41 offen lds
  s_add_u32 s41, s41, 32768
  s_add_u32 m0, s45, 28672
  s_nop 0
  buffer_load_dwordx4 v21, s[28:31], s41 offen lds
  s_add_u32 s41, s41, 32768
  s_add_u32 m0, s45, 29696
  s_nop 0
  buffer_load_dwordx4 v21, s[28:31], s41 offen lds
  s_add_u32 s41, s41, 32768
  s_add_u32 m0, s45, 30720
  s_nop 0
  buffer_load_dwordx4 v21, s[28:31], s41 offen lds
  s_add_u32 s41, s41, 32768
  s_add_u32 m0, s45, 31744
  s_nop 0
  buffer_load_dwordx4 v21, s[28:31], s41 offen lds
  s_add_u32 s41, s41, 32768
  s_waitcnt vmcnt(24)
  ds_read_b64_tr_b16 a[0:1], v22 offset:0
  ds_read_b64_tr_b16 a[2:3], v22 offset:256
  ds_read_b64_tr_b16 a[4:5], v22 offset:1024
  ds_read_b64_tr_b16 a[6:7], v22 offset:1280
  ds_read_b64_tr_b16 a[8:9], v22 offset:2048
  ds_read_b64_tr_b16 a[10:11], v22 offset:2304
  ds_read_b64_tr_b16 a[12:13], v22 offset:3072
  ds_read_b64_tr_b16 a[14:15], v22 offset:3328
  s_waitcnt lgkmcnt(8)
  ds_read_b64_tr_b16 a[16:17], v22 offset:4096
  ds_read_b64_tr_b16 a[18:19], v22 offset:4352
  ds_read_b64_tr_b16 a[20:21], v22 offset:5120
  ds_read_b64_tr_b16 a[22:23], v22 offset:5376
  ds_read_b64_tr_b16 a[24:25], v22 offset:6144
  ds_read_b64_tr_b16 a[26:27], v22 offset:6400
  ds_read_b64_tr_b16 a[28:29], v22 offset:7168
  ds_read_b64_tr_b16 a[30:31], v22 offset:7424
  s_waitcnt lgkmcnt(0)
  s_add_u32 m0, s45, 0
  s_nop 0
  buffer_load_dwordx4 v21, s[28:31], s41 offen lds
  s_add_u32 s41, s41, 32768
  s_add_u32 m0, s45, 1024
  s_nop 0
  buffer_load_dwordx4 v21, s[28:31], s41 offen lds
  s_add_u32 s41, s41, 32768
  s_add_u32 m0, s45, 2048
  s_nop 0
  buffer_load_dwordx4 v21, s[28:31], s41 offen lds
  s_add_u32 s41, s41, 32768
  s_add_u32 m0, s45, 3072
  s_nop 0
  buffer_load_dwordx4 v21, s[28:31], s41 offen lds
  s_add_u32 s41, s41, 32768
  s_add_u32 m0, s45, 4096
  s_nop 0
  buffer_load_dwordx4 v21, s[28:31], s41 offen lds
  s_add_u32 s41, s41, 32768
  s_add_u32 m0, s45, 5120
  s_nop 0
  buffer_load_dwordx4 v21, s[28:31], s41 offen lds
  s_add_u32 s41, s41, 32768
  s_add_u32 m0, s45, 6144
  s_nop 0
  buffer_load_dwordx4 v21, s[28:31], s41 offen lds
  s_add_u32 s41, s41, 32768
  s_add_u32 m0, s45, 7168
  s_nop 0
  buffer_load_dwordx4 v21, s[28:31], s41 offen lds
  s_add_u32 s41, s41, 32768
  s_waitcnt vmcnt(24)
  ds_read_b64_tr_b16 a[32:33], v22 offset:8192
  ds_read_b64_tr_b16 a[34:35], v22 offset:8448
  ds_read_b64_tr_b16 a[36:37], v22 offset:9216
  ds_read_b64_tr_b16 a[38:39], v22 offset:9472
  ds_read_b64_tr_b16 a[40:41], v22 offset:10240
  ds_read_b64_tr_b16 a[42:43], v22 offset:10496
  ds_read_b64_tr_b16 a[44:45], v22 offset:11264
  ds_read_b64_tr_b16 a[46:47], v22 offset:11520
  s_waitcnt lgkmcnt(8)
  ds_read_b64_tr_b16 a[48:49], v22 offset:12288
  ds_read_b64_tr_b16 a[50:51], v22 offset:12544
  ds_read_b64_tr_b16 a[52:53], v22 offset:13312
  ds_read_b64_tr_b16 a[54:55], v22 offset:13568
  ds_read_b64_tr_b16 a[56:57], v22 offset:14336
  ds_read_b64_tr_b16 a[58:59], v22 offset:14592
  ds_read_b64_tr_b16 a[60:61], v22 offset:15360
  ds_read_b64_tr_b16 a[62:63], v22 offset:15616
  s_waitcnt lgkmcnt(0)
  s_add_u32 m0, s45, 8192
  s_nop 0
  buffer_load_dwordx4 v21, s[28:31], s41 offen lds
  s_add_u32 s41, s41, 32768
  s_add_u32 m0, s45, 9216
  s_nop 0
  buffer_load_dwordx4 v21, s[28:31], s41 offen lds
  s_add_u32 s41, s41, 32768
  s_add_u32 m0, s45, 10240
  s_nop 0
  buffer_load_dwordx4 v21, s[28:31], s41 offen lds
  s_add_u32 s41, s41, 32768
  s_add_u32 m0, s45, 11264
  s_nop 0
  buffer_load_dwordx4 v21, s[28:31], s41 offen lds
  s_add_u32 s41, s41, 32768
  s_add_u32 m0, s45, 12288
  s_nop 0
  buffer_load_dwordx4 v21, s[28:31], s41 offen lds
  s_add_u32 s41, s41, 32768
  s_add_u32 m0, s45, 13312
  s_nop 0
  buffer_load_dwordx4 v21, s[28:31], s41 offen lds
  s_add_u32 s41, s41, 32768
  s_add_u32 m0, s45, 14336
  s_nop 0
  buffer_load_dwordx4 v21, s[28:31], s41 offen lds
  s_add_u32 s41, s41, 32768
  s_add_u32 m0, s45, 15360
  s_nop 0
  buffer_load_dwordx4 v21, s[28:31], s41 offen lds
  s_add_u32 s41, s41, 32768
  s_waitcnt vmcnt(24)
  ds_read_b64_tr_b16 a[64:65], v22 offset:16384
  ds_read_b64_tr_b16 a[66:67], v22 offset:16640
  ds_read_b64_tr_b16 a[68:69], v22 offset:17408
  ds_read_b64_tr_b16 a[70:71], v22 offset:17664
  ds_read_b64_tr_b16 a[72:73], v22 offset:18432
  ds_read_b64_tr_b16 a[74:75], v22 offset:18688
  ds_read_b64_tr_b16 a[76:77], v22 offset:19456
  ds_read_b64_tr_b16 a[78:79], v22 offset:19712
  s_waitcnt lgkmcnt(8)
  ds_read_b64_tr_b16 a[80:81], v22 offset:20480
  ds_read_b64_tr_b16 a[82:83], v22 offset:20736
  ds_read_b64_tr_b16 a[84:85], v22 offset:21504
  ds_read_b64_tr_b16 a[86:87], v22 offset:21760
  ds_read_b64_tr_b16 a[88:89], v22 offset:22528
  ds_read_b64_tr_b16 a[90:91], v22 offset:22784
  ds_read_b64_tr_b16 a[92:93], v22 offset:23552
  ds_read_b64_tr_b16 a[94:95], v22 offset:23808
  s_waitcnt lgkmcnt(0)
  s_add_u32 m0, s45, 16384
  s_nop 0
  buffer_load_dwordx4 v21, s[28:31], s41 offen lds
  s_add_u32 s41, s41, 32768
  s_add_u32 m0, s45, 17408
  s_nop 0
  buffer_load_dwordx4 v21, s[28:31], s41 offen lds
  s_add_u32 s41, s41, 32768
  s_add_u32 m0, s45, 18432
  s_nop 0
  buffer_load_dwordx4 v21, s[28:31], s41 offen lds
  s_add_u32 s41, s41, 32768
  s_add_u32 m0, s45, 19456
  s_nop 0
  buffer_load_dwordx4 v21, s[28:31], s41 offen lds
  s_add_u32 s41, s41, 32768
  s_add_u32 m0, s45, 20480
  s_nop 0
  buffer_load_dwordx4 v21, s[28:31], s41 offen lds
  s_add_u32 s41, s41, 32768
  s_add_u32 m0, s45, 21504
  s_nop 0
  buffer_load_dwordx4 v21, s[28:31], s41 offen lds
  s_add_u32 s41, s41, 32768
  s_add_u32 m0, s45, 22528
  s_nop 0
  buffer_load_dwordx4 v21, s[28:31], s41 offen lds
  s_add_u32 s41, s41, 32768
  s_add_u32 m0, s45, 23552
  s_nop 0
  buffer_load_dwordx4 v21, s[28:31], s41 offen lds
  s_add_u32 s41, s41, 32768
  s_waitcnt vmcnt(24)
  ds_read_b64_tr_b16 a[96:97], v22 offset:24576
  ds_read_b64_tr_b16 a[98:99], v22 offset:24832
  ds_read_b64_tr_b16 a[100:101], v22 offset:25600
  ds_read_b64_tr_b16 a[102:103], v22 offset:25856
  ds_read_b64_tr_b16 a[104:105], v22 offset:26624
  ds_read_b64_tr_b16 a[106:107], v22 offset:26880
  ds_read_b64_tr_b16 a[108:109], v22 offset:27648
  ds_read_b64_tr_b16 a[110:111], v22 offset:27904
  s_waitcnt lgkmcnt(8)
  ds_read_b64_tr_b16 a[112:113], v22 offset:28672
  ds_read_b64_tr_b16 a[114:115], v22 offset:28928
  ds_read_b64_tr_b16 a[116:117], v22 offset:29696
  ds_read_b64_tr_b16 a[118:119], v22 offset:29952
  ds_read_b64_tr_b16 a[120:121], v22 offset:30720
  ds_read_b64_tr_b16 a[122:123], v22 offset:30976
  ds_read_b64_tr_b16 a[124:125], v22 offset:31744
  ds_read_b64_tr_b16 a[126:127], v22 offset:32000
  s_waitcnt lgkmcnt(0)
  s_add_u32 m0, s45, 24576
  s_nop 0
  buffer_load_dwordx4 v21, s[28:31], s41 offen lds
  s_add_u32 s41, s41, 32768
  s_add_u32 m0, s45, 25600
  s_nop 0
  buffer_load_dwordx4 v21, s[28:31], s41 offen lds
  s_add_u32 s41, s41, 32768
  s_add_u32 m0, s45, 26624
  s_nop 0
  buffer_load_dwordx4 v21, s[28:31], s41 offen lds
  s_add_u32 s41, s41, 32768
  s_add_u32 m0, s45, 27648
  s_nop 0
  buffer_load_dwordx4 v21, s[28:31], s41 offen lds
  s_add_u32 s41, s41, 32768
  s_add_u32 m0, s45, 28672
  s_nop 0
  buffer_load_dwordx4 v21, s[28:31], s41 offen lds
  s_add_u32 s41, s41, 32768
  s_add_u32 m0, s45, 29696
  s_nop 0
  buffer_load_dwordx4 v21, s[28:31], s41 offen lds
  s_add_u32 s41, s41, 32768
  s_add_u32 m0, s45, 30720
  s_nop 0
  buffer_load_dwordx4 v21, s[28:31], s41 offen lds
  s_add_u32 s41, s41, 32768
  s_add_u32 m0, s45, 31744
  s_nop 0
  buffer_load_dwordx4 v21, s[28:31], s41 offen lds
  s_add_u32 s41, s41, 32768
  s_waitcnt vmcnt(24)
  ds_read_b64_tr_b16 a[128:129], v22 offset:0
  ds_read_b64_tr_b16 a[130:131], v22 offset:256
  ds_read_b64_tr_b16 a[132:133], v22 offset:1024
  ds_read_b64_tr_b16 a[134:135], v22 offset:1280
  ds_read_b64_tr_b16 a[136:137], v22 offset:2048
  ds_read_b64_tr_b16 a[138:139], v22 offset:2304
  ds_read_b64_tr_b16 a[140:141], v22 offset:3072
  ds_read_b64_tr_b16 a[142:143], v22 offset:3328
  s_waitcnt lgkmcnt(8)
  ds_read_b64_tr_b16 a[144:145], v22 offset:4096
  ds_read_b64_tr_b16 a[146:147], v22 offset:4352
  ds_read_b64_tr_b16 a[148:149], v22 offset:5120
  ds_read_b64_tr_b16 a[150:151], v22 offset:5376
  ds_read_b64_tr_b16 a[152:153], v22 offset:6144
  ds_read_b64_tr_b16 a[154:155], v22 offset:6400
  ds_read_b64_tr_b16 a[156:157], v22 offset:7168
  ds_read_b64_tr_b16 a[158:159], v22 offset:7424
  s_waitcnt lgkmcnt(0)
  s_waitcnt vmcnt(16)
  ds_read_b64_tr_b16 a[160:161], v22 offset:8192
  ds_read_b64_tr_b16 a[162:163], v22 offset:8448
  ds_read_b64_tr_b16 a[164:165], v22 offset:9216
  ds_read_b64_tr_b16 a[166:167], v22 offset:9472
  ds_read_b64_tr_b16 a[168:169], v22 offset:10240
  ds_read_b64_tr_b16 a[170:171], v22 offset:10496
  ds_read_b64_tr_b16 a[172:173], v22 offset:11264
  ds_read_b64_tr_b16 a[174:175], v22 offset:11520
  s_waitcnt lgkmcnt(8)
  ds_read_b64_tr_b16 a[176:177], v22 offset:12288
  ds_read_b64_tr_b16 a[178:179], v22 offset:12544
  ds_read_b64_tr_b16 a[180:181], v22 offset:13312
  ds_read_b64_tr_b16 a[182:183], v22 offset:13568
  ds_read_b64_tr_b16 a[184:185], v22 offset:14336
  ds_read_b64_tr_b16 a[186:187], v22 offset:14592
  ds_read_b64_tr_b16 a[188:189], v22 offset:15360
  ds_read_b64_tr_b16 a[190:191], v22 offset:15616
  s_waitcnt lgkmcnt(0)
  s_waitcnt vmcnt(8)
  ds_read_b64_tr_b16 a[192:193], v22 offset:16384
  ds_read_b64_tr_b16 a[194:195], v22 offset:16640
  ds_read_b64_tr_b16 a[196:197], v22 offset:17408
  ds_read_b64_tr_b16 a[198:199], v22 offset:17664
  ds_read_b64_tr_b16 a[200:201], v22 offset:18432
  ds_read_b64_tr_b16 a[202:203], v22 offset:18688
  ds_read_b64_tr_b16 a[204:205], v22 offset:19456
  ds_read_b64_tr_b16 a[206:207], v22 offset:19712
  s_waitcnt lgkmcnt(8)
  ds_read_b64_tr_b16 a[208:209], v22 offset:20480
  ds_read_b64_tr_b16 a[210:211], v22 offset:20736
  ds_read_b64_tr_b16 a[212:213], v22 offset:21504
  ds_read_b64_tr_b16 a[214:215], v22 offset:21760
  ds_read_b64_tr_b16 a[216:217], v22 offset:22528
  ds_read_b64_tr_b16 a[218:219], v22 offset:22784
  ds_read_b64_tr_b16 a[220:221], v22 offset:23552
  ds_read_b64_tr_b16 a[222:223], v22 offset:23808
  s_waitcnt lgkmcnt(0)
  s_waitcnt vmcnt(0)
  ds_read_b64_tr_b16 a[224:225], v22 offset:24576
  ds_read_b64_tr_b16 a[226:227], v22 offset:24832
  ds_read_b64_tr_b16 a[228:229], v22 offset:25600
  ds_read_b64_tr_b16 a[230:231], v22 offset:25856
  ds_read_b64_tr_b16 a[232:233], v22 offset:26624
  ds_read_b64_tr_b16 a[234:235], v22 offset:26880
  ds_read_b64_tr_b16 a[236:237], v22 offset:27648
  ds_read_b64_tr_b16 a[238:239], v22 offset:27904
  s_waitcnt lgkmcnt(8)
  ds_read_b64_tr_b16 a[240:241], v22 offset:28672
  ds_read_b64_tr_b16 a[242:243], v22 offset:28928
  ds_read_b64_tr_b16 a[244:245], v22 offset:29696
  ds_read_b64_tr_b16 a[246:247], v22 offset:29952
  ds_read_b64_tr_b16 a[248:249], v22 offset:30720
  ds_read_b64_tr_b16 a[250:251], v22 offset:30976
  ds_read_b64_tr_b16 a[252:253], v22 offset:31744
  ds_read_b64_tr_b16 a[254:255], v22 offset:32000
  s_waitcnt lgkmcnt(0)
.opsl_75:
  s_cmp_lg_u32 s18, 0
  s_cbranch_scc1 .w0_76
  s_bitcmp1_b32 s3, 0
  s_cbranch_scc1 .ini_80
  v_mov_b32 v121, 0
.inl_81:
  buffer_load_dword v120, v121, s[8:11], 0 offen offset:20 sc1
  s_waitcnt vmcnt(0)
  v_readfirstlane_b32 s95, v120
  s_or_b32 s3, s3, s95
  s_bitcmp1_b32 s3, 0
  s_cbranch_scc1 .ini_80
  s_sleep 2
  s_sub_u32 s20, s20, 1
  s_cbranch_scc0 .inl_81
  v_mov_b32 v120, 0xdead
  v_mov_b32 v121, 0
  buffer_store_dword v120, v121, s[8:11], 0 offen offset:28 sc1
  s_mov_b32 s20, 0
  s_mov_b32 s94, 65535
  s_branch .dwo_77
.ini_80:
  v_mbcnt_lo_u32_b32 v123, -1, 0
  v_mbcnt_hi_u32_b32 v123, -1, v123
  v_and_b32 v123, 1, v123
  s_lshl_b32 s96, s51, 7
  s_add_u32 s96, s96, 123740160
  s_lshr_b32 s97, s51, 2
  s_lshl_b32 s97, s97, 7
  s_add_u32 s97, s97, 123738112
  s_sub_u32 s97, s96, s97
  v_mul_u32_u24 v122, s97, v123
  v_sub_u32 v122, s96, v122
  v_add_u32 v123, 4, v123
  s_cmp_ge_u32 s51, 56
  s_cselect_b32 s97, 128, 4
  v_writelane_b32 v123, s97, 0
  v_mov_b32 v126, 0
.dwl_78:
  buffer_load_dword v124, v122, s[4:7], 0 offen sc1
  s_bitcmp1_b32 s3, 1
  s_cbranch_scc1 .dwn_82
  buffer_load_dword v125, v126, s[8:11], 0 offen offset:8 sc1
.dwn_82:
  s_waitcnt vmcnt(0)
  s_mov_b32 s94, 0
  v_cmp_lt_u32 vcc, v124, v123
  s_cbranch_vccz .dwo_77
  s_bitcmp1_b32 s3, 1
  s_cbranch_scc1 .dws_79
  v_readfirstlane_b32 s95, v125
  s_and_b32 s94, s95, 65791
  s_cmp_eq_u32 s94, 65
  s_cselect_b32 s94, 2, 0
  s_or_b32 s3, s3, s94
  s_bitcmp0_b32 s95, 16
  s_cbranch_scc1 .dws_79
  v_mov_b32 v120, 1
  v_mov_b32 v121, 0
  s_mov_b64 exec, 1
  buffer_atomic_add v120, v121, s[8:11], 0 offen offset:24 sc0 sc1
  s_mov_b64 exec, -1
  s_waitcnt vmcnt(0)
  v_readfirstlane_b32 s94, v120
  s_or_b32 s3, s3, 2
  s_cmp_ge_u32 s94, 64
  s_cbranch_scc1 .dws_79
  s_or_b32 s94, s94, 65536
  s_branch .dwo_77
.dws_79:
  s_sleep 4
  s_sub_u32 s20, s20, 1
  s_cbranch_scc0 .dwl_78
  v_mov_b32 v120, 0xdead
  v_mov_b32 v121, 0
  buffer_store_dword v120, v121, s[8:11], 0 offen offset:28 sc1
  s_mov_b32 s20, 0
  s_mov_b32 s94, 65535
  s_branch .dwo_77
.dwo_77:
  v_mov_b32 v120, s94
  v_mov_b32 v121, 163776
  ds_write_b32 v121, v120
  s_waitcnt lgkmcnt(0)
.w0_76:
  s_barrier
  v_mov_b32 v121, 163776
  ds_read_b32 v120, v121
  s_waitcnt lgkmcnt(0)
  v_readfirstlane_b32 s94, v120
  s_barrier
  s_cmp_lg_u32 s94, 0
  s_cbranch_scc1 .special
  s_cmp_lt_u32 s51, 56
  s_cbranch_scc1 .ogo_84
  s_bitset1_b32 s3, 6
.opr_83:
  v_and_b32 v122, 7, v16
  v_lshlrev_b32 v122, 13, v122
  v_mov_b32 v123, 0
  s_lshl_b32 s96, s51, 2
  s_add_u32 s96, s96, s18
  s_lshl_b32 s96, s96, 16
  s_add_u32 s96, s96, 67117040
  s_lshl_b32 s97, s51, 7
  s_add_u32 s97, s97, 123740160
  v_add_u32 v122, s96, v122
  v_mov_b32 v123, s97
  v_cmp_lt_u32 vcc, 31, v16
  s_nop 1
  v_cndmask_b32 v122, v122, v123, vcc
  buffer_load_dword v124, v122, s[4:7], 0 offen sc1
.prl_85:
  buffer_load_dword v125, v122, s[4:7], 0 offen sc1
  s_waitcnt vmcnt(1)
  v_readlane_b32 s94, v124, 32
  s_cmp_ge_u32 s94, 136
  s_cbranch_scc1 .pra_86
  s_bitcmp0_b32 s3, 6
  s_cbranch_scc1 .prr_87
  v_cmp_eq_u32 vcc, -1, v124
  s_cmp_lt_u32 s94, 128
  s_cmov_b32 vcc_lo, 1
  s_cmp_eq_u32 vcc_lo, 0
  s_cbranch_scc1 .ogo_84
.prr_87:
  buffer_load_dword v124, v122, s[4:7], 0 offen sc1
  s_waitcnt vmcnt(1)
  v_readlane_b32 s94, v125, 32
  s_cmp_ge_u32 s94, 136
  s_cbranch_scc1 .pra_86
  s_bitcmp0_b32 s3, 6
  s_cbranch_scc1 .prr_88
  v_cmp_eq_u32 vcc, -1, v125
  s_cmp_lt_u32 s94, 128
  s_cmov_b32 vcc_lo, 1
  s_cmp_eq_u32 vcc_lo, 0
  s_cbranch_scc1 .ogo_84
.prr_88:
  s_sub_u32 s20, s20, 1
  s_cbranch_scc0 .prl_85
  s_branch .end
.pra_86:
  s_bitset0_b32 s3, 6
.ogo_84:
  s_cmp_eq_u32 s51, 63
  s_cbranch_scc1 .opsh_90
  v_mbcnt_lo_u32_b32 v16, -1, 0
  v_mbcnt_hi_u32_b32 v16, -1, v16
  v_lshlrev_b32 v21, 4, v16
  s_lshl_b32 s40, s51, 2
  s_add_u32 s40, s40, s18
  s_lshl_b32 s40, s40, 16
  s_add_u32 s40, s40, 67108864
  buffer_load_dwordx4 v[32:35], v21, s[4:7], s40 offen offset:0 sc1
  buffer_load_dwordx4 v[36:39], v21, s[4:7], s40 offen offset:1024 sc1
  buffer_load_dwordx4 v[40:43], v21, s[4:7], s40 offen offset:2048 sc1
  buffer_load_dwordx4 v[44:47], v21, s[4:7], s40 offen offset:3072 sc1
  s_add_u32 s40, s40, 4096
  buffer_load_dwordx4 v[48:51], v21, s[4:7], s40 offen offset:0 sc1
  buffer_load_dwordx4 v[52:55], v21, s[4:7], s40 offen offset:1024 sc1
  buffer_load_dwordx4 v[56:59], v21, s[4:7], s40 offen offset:2048 sc1
  buffer_load_dwordx4 v[60:63], v21, s[4:7], s40 offen offset:3072 sc1
  s_add_u32 s40, s40, 4096
  buffer_load_dwordx4 v[64:67], v21, s[4:7], s40 offen offset:0 sc1
  buffer_load_dwordx4 v[68:71], v21, s[4:7], s40 offen offset:1024 sc1
  buffer_load_dwordx4 v[72:75], v21, s[4:7], s40 offen offset:2048 sc1
  buffer_load_dwordx4 v[76:79], v21, s[4:7], s40 offen offset:3072 sc1
  s_add_u32 s40, s40, 4096
  buffer_load_dwordx4 v[80:83], v21, s[4:7], s40 offen offset:0 sc1
  buffer_load_dwordx4 v[84:87], v21, s[4:7], s40 offen offset:1024 sc1
  buffer_load_dwordx4 v[88:91], v21, s[4:7], s40 offen offset:2048 sc1
  buffer_load_dwordx4 v[92:95], v21, s[4:7], s40 offen offset:3072 sc1
  s_add_u32 s40, s40, 4096
  buffer_load_dwordx4 v[96:99], v21, s[4:7], s40 offen offset:0 sc1
  buffer_load_dwordx4 v[100:103], v21, s[4:7], s40 offen offset:1024 sc1
  buffer_load_dwordx4 v[104:107], v21, s[4:7], s40 offen offset:2048 sc1
  buffer_load_dwordx4 v[108:111], v21, s[4:7], s40 offen offset:3072 sc1
  s_add_u32 s40, s40, 4096
  buffer_load_dwordx4 v[112:115], v21, s[4:7], s40 offen offset:0 sc1
  buffer_load_dwordx4 v[116:119], v21, s[4:7], s40 offen offset:1024 sc1
  buffer_load_dwordx4 v[120:123], v21, s[4:7], s40 offen offset:2048 sc1
  buffer_load_dwordx4 v[124:127], v21, s[4:7], s40 offen offset:3072 sc1
  s_add_u32 s40, s40, 4096
  buffer_load_dwordx4 v[128:131], v21, s[4:7], s40 offen offset:0 sc1
  buffer_load_dwordx4 v[132:135], v21, s[4:7], s40 offen offset:1024 sc1
  buffer_load_dwordx4 v[136:139], v21, s[4:7], s40 offen offset:2048 sc1
  buffer_load_dwordx4 v[140:143], v21, s[4:7], s40 offen offset:3072 sc1
  s_add_u32 s40, s40, 4096
  buffer_load_dwordx4 v[144:147], v21, s[4:7], s40 offen offset:0 sc1
  buffer_load_dwordx4 v[148:151], v21, s[4:7], s40 offen offset:1024 sc1
  buffer_load_dwordx4 v[152:155], v21, s[4:7], s40 offen offset:2048 sc1
  buffer_load_dwordx4 v[156:159], v21, s[4:7], s40 offen offset:3072 sc1
  s_add_u32 s40, s40, 4096
  buffer_load_dwordx4 v[160:163], v21, s[4:7], s40 offen offset:0 sc1
  buffer_load_dwordx4 v[164:167], v21, s[4:7], s40 offen offset:1024 sc1
  buffer_load_dwordx4 v[168:171], v21, s[4:7], s40 offen offset:2048 sc1
  buffer_load_dwordx4 v[172:175], v21, s[4:7], s40 offen offset:3072 sc1
  s_add_u32 s40, s40, 4096
  buffer_load_dwordx4 v[176:179], v21, s[4:7], s40 offen offset:0 sc1
  buffer_load_dwordx4 v[180:183], v21, s[4:7], s40 offen offset:1024 sc1
  buffer_load_dwordx4 v[184:187], v21, s[4:7], s40 offen offset:2048 sc1
  buffer_load_dwordx4 v[188:191], v21, s[4:7], s40 offen offset:3072 sc1
  s_add_u32 s40, s40, 4096
  buffer_load_dwordx4 v[192:195], v21, s[4:7], s40 offen offset:0 sc1
  buffer_load_dwordx4 v[196:199], v21, s[4:7], s40 offen offset:1024 sc1
  buffer_load_dwordx4 v[200:203], v21, s[4:7], s40 offen offset:2048 sc1
  buffer_load_dwordx4 v[204:207], v21, s[4:7], s40 offen offset:3072 sc1
  s_add_u32 s40, s40, 4096
  buffer_load_dwordx4 v[208:211], v21, s[4:7], s40 offen offset:0 sc1
  buffer_load_dwordx4 v[212:215], v21, s[4:7], s40 offen offset:1024 sc1
  buffer_load_dwordx4 v[216:219], v21, s[4:7], s40 offen offset:2048 sc1
  buffer_load_dwordx4 v[220:223], v21, s[4:7], s40 offen offset:3072 sc1
  s_add_u32 s40, s40, 4096
  s_lshr_b32 s56, s51, 2
  s_lshl_b32 s56, s56, 2
  s_lshr_b32 s57, s52, 3
  s_add_u32 s56, s56, s57
  s_lshl_b32 s56, s56, 2
  s_and_b32 s57, s52, 3
  s_add_u32 s56, s56, s57
  s_lshl_b32 s56, s56, 2
  s_and_b32 s57, s51, 3
  s_add_u32 s56, s56, s57
  s_lshl_b32 s56, s56, 1
  s_bfe_u32 s57, s52, 65538
  s_add_u32 s56, s56, s57
  s_lshl_b32 s56, s56, 1
  s_lshr_b32 s57, s18, 1
  s_add_u32 s56, s56, s57
  s_lshl_b32 s56, s56, 10
  s_and_b32 s57, s18, 1
  s_lshl_b32 s57, s57, 3
  s_add_u32 s56, s56, s57
  s_add_u32 s56, s56, 83886080
  v_and_b32 v18, 31, v16
  v_lshlrev_b32 v23, 2, v18
  s_lshl_b32 s57, s51, 7
  s_add_u32 s57, s57, 92274688
  v_lshrrev_b32 v19, 5, v16
  v_lshlrev_b32 v19, 3, v19
  v_lshl_add_u32 v24, v18, 11, v19
  s_lshl_b32 s50, s51, 16
  s_lshl_b32 s58, s52, 6
  s_add_u32 s50, s50, s58
  s_lshl_b32 s58, s18, 4
  s_add_u32 s50, s50, s58
  s_mov_b32 s36, s88
  s_mov_b32 s37, s89
  s_mov_b32 s38, 0x400000
  s_mov_b32 s39, 0x20000
  s_lshl_b32 s58, s18, 12
  v_add_u32 v22, s58, v21
  s_lshl_b32 s58, s18, 10
  v_add_u32 v19, s58, v21
  s_waitcnt vmcnt(47)
  v_mfma_f32_32x32x16_bf16 v[224:239], a[0:3], v[32:35], 0
  buffer_load_dwordx4 v[32:35], v21, s[4:7], s40 offen offset:0 sc1
  s_waitcnt vmcnt(47)
  v_mfma_f32_32x32x16_bf16 v[240:255], a[4:7], v[36:39], 0
  buffer_load_dwordx4 v[36:39], v21, s[4:7], s40 offen offset:1024 sc1
  s_waitcnt vmcnt(47)
  v_mfma_f32_32x32x16_bf16 v[224:239], a[8:11], v[40:43], v[224:239]
  buffer_load_dwordx4 v[40:43], v21, s[4:7], s40 offen offset:2048 sc1
  s_waitcnt vmcnt(47)
  v_mfma_f32_32x32x16_bf16 v[240:255], a[12:15], v[44:47], v[240:255]
  buffer_load_dwordx4 v[44:47], v21, s[4:7], s40 offen offset:3072 sc1
  s_add_u32 s40, s40, 4096
  s_waitcnt vmcnt(47)
  v_mfma_f32_32x32x16_bf16 v[224:239], a[16:19], v[48:51], v[224:239]
  buffer_load_dwordx4 v[48:51], v21, s[4:7], s40 offen offset:0 sc1
  s_waitcnt vmcnt(47)
  v_mfma_f32_32x32x16_bf16 v[240:255], a[20:23], v[52:55], v[240:255]
  buffer_load_dwordx4 v[52:55], v21, s[4:7], s40 offen offset:1024 sc1
  s_waitcnt vmcnt(47)
  v_mfma_f32_32x32x16_bf16 v[224:239], a[24:27], v[56:59], v[224:239]
  buffer_load_dwordx4 v[56:59], v21, s[4:7], s40 offen offset:2048 sc1
  s_waitcnt vmcnt(47)
  v_mfma_f32_32x32x16_bf16 v[240:255], a[28:31], v[60:63], v[240:255]
  buffer_load_dwordx4 v[60:63], v21, s[4:7], s40 offen offset:3072 sc1
  s_add_u32 s40, s40, 4096
  s_waitcnt vmcnt(47)
  v_mfma_f32_32x32x16_bf16 v[224:239], a[32:35], v[64:67], v[224:239]
  buffer_load_dwordx4 v[64:67], v21, s[4:7], s40 offen offset:0 sc1
  s_waitcnt vmcnt(47)
  v_mfma_f32_32x32x16_bf16 v[240:255], a[36:39], v[68:71], v[240:255]
  buffer_load_dwordx4 v[68:71], v21, s[4:7], s40 offen offset:1024 sc1
  s_waitcnt vmcnt(47)
  v_mfma_f32_32x32x16_bf16 v[224:239], a[40:43], v[72:75], v[224:239]
  buffer_load_dwordx4 v[72:75], v21, s[4:7], s40 offen offset:2048 sc1
  s_waitcnt vmcnt(47)
  v_mfma_f32_32x32x16_bf16 v[240:255], a[44:47], v[76:79], v[240:255]
  buffer_load_dwordx4 v[76:79], v21, s[4:7], s40 offen offset:3072 sc1
  s_add_u32 s40, s40, 4096
  s_waitcnt vmcnt(47)
  v_mfma_f32_32x32x16_bf16 v[224:239], a[48:51], v[80:83], v[224:239]
  buffer_load_dwordx4 v[80:83], v21, s[4:7], s40 offen offset:0 sc1
  s_waitcnt vmcnt(47)
  v_mfma_f32_32x32x16_bf16 v[240:255], a[52:55], v[84:87], v[240:255]
  buffer_load_dwordx4 v[84:87], v21, s[4:7], s40 offen offset:1024 sc1
  s_waitcnt vmcnt(47)
  v_mfma_f32_32x32x16_bf16 v[224:239], a[56:59], v[88:91], v[224:239]
  buffer_load_dwordx4 v[88:91], v21, s[4:7], s40 offen offset:2048 sc1
  s_waitcnt vmcnt(47)
  v_mfma_f32_32x32x16_bf16 v[240:255], a[60:63], v[92:95], v[240:255]
  buffer_load_dwordx4 v[92:95], v21, s[4:7], s40 offen offset:3072 sc1
  s_add_u32 s40, s40, 4096
  buffer_load_dwordx2 v[26:27], v21, s[4:7], s56 offen sc1
  buffer_load_dword v28, v23, s[4:7], s57 offen sc1
  s_waitcnt vmcnt(49)
  v_mfma_f32_32x32x16_bf16 v[224:239], a[64:67], v[96:99], v[224:239]
  s_waitcnt vmcnt(48)
  v_mfma_f32_32x32x16_bf16 v[240:255], a[68:71], v[100:103], v[240:255]
  s_waitcnt vmcnt(47)
  v_mfma_f32_32x32x16_bf16 v[224:239], a[72:75], v[104:107], v[224:239]
  s_waitcnt vmcnt(46)
  v_mfma_f32_32x32x16_bf16 v[240:255], a[76:79], v[108:111], v[240:255]
  s_waitcnt vmcnt(45)
  v_mfma_f32_32x32x16_bf16 v[224:239], a[80:83], v[112:115], v[224:239]
  s_waitcnt vmcnt(44)
  v_mfma_f32_32x32x16_bf16 v[240:255], a[84:87], v[116:119], v[240:255]
  s_waitcnt vmcnt(43)
  v_mfma_f32_32x32x16_bf16 v[224:239], a[88:91], v[120:123], v[224:239]
  s_waitcnt vmcnt(42)
  v_mfma_f32_32x32x16_bf16 v[240:255], a[92:95], v[124:127], v[240:255]
  s_waitcnt vmcnt(41)
  v_mfma_f32_32x32x16_bf16 v[224:239], a[96:99], v[128:131], v[224:239]
  s_waitcnt vmcnt(40)
  v_mfma_f32_32x32x16_bf16 v[240:255], a[100:103], v[132:135], v[240:255]
  s_waitcnt vmcnt(39)
  v_mfma_f32_32x32x16_bf16 v[224:239], a[104:107], v[136:139], v[224:239]
  s_waitcnt vmcnt(38)
  v_mfma_f32_32x32x16_bf16 v[240:255], a[108:111], v[140:143], v[240:255]
  s_waitcnt vmcnt(37)
  v_mfma_f32_32x32x16_bf16 v[224:239], a[112:115], v[144:147], v[224:239]
  s_waitcnt vmcnt(36)
  v_mfma_f32_32x32x16_bf16 v[240:255], a[116:119], v[148:151], v[240:255]
  s_waitcnt vmcnt(35)
  v_mfma_f32_32x32x16_bf16 v[224:239], a[120:123], v[152:155], v[224:239]
  s_waitcnt vmcnt(34)
  v_mfma_f32_32x32x16_bf16 v[240:255], a[124:127], v[156:159], v[240:255]
  s_waitcnt vmcnt(33)
  v_mfma_f32_32x32x16_bf16 v[224:239], a[128:131], v[160:163], v[224:239]
  s_waitcnt vmcnt(32)
  v_mfma_f32_32x32x16_bf16 v[240:255], a[132:135], v[164:167], v[240:255]
  s_waitcnt vmcnt(31)
  v_mfma_f32_32x32x16_bf16 v[224:239], a[136:139], v[168:171], v[224:239]
  s_waitcnt vmcnt(30)
  v_mfma_f32_32x32x16_bf16 v[240:255], a[140:143], v[172:175], v[240:255]
  s_waitcnt vmcnt(29)
  v_mfma_f32_32x32x16_bf16 v[224:239], a[144:147], v[176:179], v[224:239]
  s_waitcnt vmcnt(28)
  v_mfma_f32_32x32x16_bf16 v[240:255], a[148:151], v[180:183], v[240:255]
  s_waitcnt vmcnt(27)
  v_mfma_f32_32x32x16_bf16 v[224:239], a[152:155], v[184:187], v[224:239]
  s_waitcnt vmcnt(26)
  v_mfma_f32_32x32x16_bf16 v[240:255], a[156:159], v[188:191], v[240:255]
  s_waitcnt vmcnt(25)
  v_mfma_f32_32x32x16_bf16 v[224:239], a[160:163], v[192:195], v[224:239]
  s_waitcnt vmcnt(24)
  v_mfma_f32_32x32x16_bf16 v[240:255], a[164:167], v[196:199], v[240:255]
  s_waitcnt vmcnt(23)
  v_mfma_f32_32x32x16_bf16 v[224:239], a[168:171], v[200:203], v[224:239]
  s_waitcnt vmcnt(22)
  v_mfma_f32_32x32x16_bf16 v[240:255], a[172:175], v[204:207], v[240:255]
  s_waitcnt vmcnt(21)
  v_mfma_f32_32x32x16_bf16 v[224:239], a[176:179], v[208:211], v[224:239]
  s_waitcnt vmcnt(20)
  v_mfma_f32_32x32x16_bf16 v[240:255], a[180:183], v[212:215], v[240:255]
  s_waitcnt vmcnt(19)
  v_mfma_f32_32x32x16_bf16 v[224:239], a[184:187], v[216:219], v[224:239]
  s_waitcnt vmcnt(18)
  v_mfma_f32_32x32x16_bf16 v[240:255], a[188:191], v[220:223], v[240:255]
  s_waitcnt vmcnt(17)
  v_mfma_f32_32x32x16_bf16 v[224:239], a[192:195], v[32:35], v[224:239]
  s_waitcnt vmcnt(16)
  v_mfma_f32_32x32x16_bf16 v[240:255], a[196:199], v[36:39], v[240:255]
  s_waitcnt vmcnt(15)
  v_mfma_f32_32x32x16_bf16 v[224:239], a[200:203], v[40:43], v[224:239]
  s_waitcnt vmcnt(14)
  v_mfma_f32_32x32x16_bf16 v[240:255], a[204:207], v[44:47], v[240:255]
  s_waitcnt vmcnt(13)
  v_mfma_f32_32x32x16_bf16 v[224:239], a[208:211], v[48:51], v[224:239]
  s_waitcnt vmcnt(12)
  v_mfma_f32_32x32x16_bf16 v[240:255], a[212:215], v[52:55], v[240:255]
  s_waitcnt vmcnt(11)
  v_mfma_f32_32x32x16_bf16 v[224:239], a[216:219], v[56:59], v[224:239]
  s_waitcnt vmcnt(10)
  v_mfma_f32_32x32x16_bf16 v[240:255], a[220:223], v[60:63], v[240:255]
  s_waitcnt vmcnt(9)
  v_mfma_f32_32x32x16_bf16 v[224:239], a[224:227], v[64:67], v[224:239]
  s_waitcnt vmcnt(8)
  v_mfma_f32_32x32x16_bf16 v[240:255], a[228:231], v[68:71], v[240:255]
  s_waitcnt vmcnt(7)
  v_mfma_f32_32x32x16_bf16 v[224:239], a[232:235], v[72:75], v[224:239]
  s_waitcnt vmcnt(6)
  v_mfma_f32_32x32x16_bf16 v[240:255], a[236:239], v[76:79], v[240:255]
  s_waitcnt vmcnt(5)
  v_mfma_f32_32x32x16_bf16 v[224:239], a[240:243], v[80:83], v[224:239]
  s_waitcnt vmcnt(4)
  v_mfma_f32_32x32x16_bf16 v[240:255], a[244:247], v[84:87], v[240:255]
  s_waitcnt vmcnt(3)
  v_mfma_f32_32x32x16_bf16 v[224:239], a[248:251], v[88:91], v[224:239]
  s_waitcnt vmcnt(2)
  v_mfma_f32_32x32x16_bf16 v[240:255], a[252:255], v[92:95], v[240:255]
  s_nop 11
  v_pk_add_f32 v[224:225], v[224:225], v[240:241]
  v_pk_add_f32 v[226:227], v[226:227], v[242:243]
  v_pk_add_f32 v[228:229], v[228:229], v[244:245]
  v_pk_add_f32 v[230:231], v[230:231], v[246:247]
  v_pk_add_f32 v[232:233], v[232:233], v[248:249]
  v_pk_add_f32 v[234:235], v[234:235], v[250:251]
  v_pk_add_f32 v[236:237], v[236:237], v[252:253]
  v_pk_add_f32 v[238:239], v[238:239], v[254:255]
  s_bitcmp0_b32 s3, 6
  s_cbranch_scc1 .ook_92
  s_bitset0_b32 s3, 6
  v_cmp_u_f32 vcc, v224, v224
  s_cbranch_vccnz .opr_83
.ook_92:
  ds_write_b128 v22, v[224:227] offset:0
  ds_write_b128 v22, v[228:231] offset:1024
  ds_write_b128 v22, v[232:235] offset:2048
  ds_write_b128 v22, v[236:239] offset:3072
  s_waitcnt lgkmcnt(0)
  s_barrier
  ds_read_b128 v[32:35], v19 offset:0
  ds_read_b128 v[36:39], v19 offset:4096
  ds_read_b128 v[40:43], v19 offset:8192
  ds_read_b128 v[44:47], v19 offset:12288
  s_waitcnt vmcnt(0)
  v_lshlrev_b32 v48, 16, v26
  v_and_b32 v49, 0xffff0000, v26
  v_lshlrev_b32 v50, 16, v27
  v_and_b32 v51, 0xffff0000, v27
  s_waitcnt lgkmcnt(2)
  v_pk_add_f32 v[32:33], v[32:33], v[36:37]
  v_pk_add_f32 v[34:35], v[34:35], v[38:39]
  s_waitcnt lgkmcnt(0)
  v_pk_add_f32 v[40:41], v[40:41], v[44:45]
  v_pk_add_f32 v[42:43], v[42:43], v[46:47]
  v_pk_add_f32 v[32:33], v[32:33], v[40:41]
  v_pk_add_f32 v[34:35], v[34:35], v[42:43]
  v_pk_add_f32 v[32:33], v[32:33], v[48:49] neg_lo:[0,1] neg_hi:[0,1]
  v_pk_add_f32 v[34:35], v[34:35], v[50:51] neg_lo:[0,1] neg_hi:[0,1]
  v_pk_fma_f32 v[32:33], v[32:33], v[28:29], v[48:49] op_sel_hi:[1,0,1]
  v_pk_fma_f32 v[34:35], v[34:35], v[28:29], v[50:51] op_sel_hi:[1,0,1]
  v_cvt_pk_bf16_f32 v32, v32, v33
  v_cvt_pk_bf16_f32 v33, v34, v35
  buffer_store_dwordx2 v[32:33], v24, s[36:39], s50 offen
.opsx_91:
  s_add_u32 s51, s51, 3
  s_cmp_lt_u32 s51, 61
  s_cbranch_scc1 .opsl_75
  s_cmp_ge_u32 s51, 65
  s_cbranch_scc1 .opse_89
  s_cmp_lg_u32 s51, 64
  s_cbranch_scc1 .opsn_93
  s_mov_b32 s51, 63
  s_or_b32 s3, s3, 192
  s_barrier
  s_branch .opr_83
.opsn_93:
  s_cmp_lg_u32 s18, 0
  s_cbranch_scc1 .opsl_75
  s_bitcmp0_b32 s3, 4
  s_cbranch_scc1 .opsl_75
  v_mov_b32 v121, 0
  buffer_load_dword v120, v121, s[8:11], 0 offen offset:160 sc1
  s_waitcnt vmcnt(0)
  v_readfirstlane_b32 s94, v120
  s_cmp_lt_u32 s94, 56
  s_cbranch_scc1 .opsl_75
  s_lshl_b32 s95, s2, 7
  s_add_u32 s95, s95, 123760640
  buffer_load_dword v120, v121, s[4:7], s95 offen sc1
  s_waitcnt vmcnt(0)
  v_readfirstlane_b32 s96, v120
  s_and_b32 s94, s96, 31
  s_cbranch_scc0 .opy_94
  s_lshr_b32 s97, s96, 5
  s_add_u32 s97, s97, 1
  s_cmp_ge_u32 s97, 128
  s_cbranch_scc1 .opy_94
  s_lshl_b32 s98, s2, 7
  s_add_u32 s98, s98, s97
  s_lshl_b32 s98, s98, 2
  s_add_u32 s98, s98, 123748352
  buffer_load_dword v120, v121, s[4:7], s98 offen sc1
  s_waitcnt vmcnt(0)
  v_readfirstlane_b32 s94, v120
  s_cmp_le_u32 s94, 56
  s_cbranch_scc1 .opsl_75
.opy_94:
  s_bitset1_b32 s3, 5
  s_branch .opsl_75
.opsh_90:
  s_bitcmp1_b32 s3, 7
  s_cselect_b32 s59, 8, 0
  v_mbcnt_lo_u32_b32 v16, -1, 0
  v_mbcnt_hi_u32_b32 v16, -1, v16
  v_bfe_u32 v19, v16, 4, 1
  v_and_b32 v18, 8, v16
  v_and_b32 v16, 39, v16
  v_lshl_add_u32 v16, v18, 1, v16
  v_add_u32 v16, s59, v16
  v_lshlrev_b32 v21, 4, v16
  v_lshl_add_u32 v25, v19, 10, v21
  s_lshl_b32 s40, s51, 2
  s_add_u32 s40, s40, s18
  s_lshl_b32 s40, s40, 16
  s_add_u32 s40, s40, 67108864
  buffer_load_dwordx4 v[32:35], v25, s[4:7], s40 offen offset:0 sc1
  buffer_load_dwordx4 v[36:39], v25, s[4:7], s40 offen offset:2048 sc1
  s_add_u32 s40, s40, 4096
  buffer_load_dwordx4 v[40:43], v25, s[4:7], s40 offen offset:0 sc1
  buffer_load_dwordx4 v[44:47], v25, s[4:7], s40 offen offset:2048 sc1
  s_add_u32 s40, s40, 4096
  buffer_load_dwordx4 v[48:51], v25, s[4:7], s40 offen offset:0 sc1
  buffer_load_dwordx4 v[52:55], v25, s[4:7], s40 offen offset:2048 sc1
  s_add_u32 s40, s40, 4096
  buffer_load_dwordx4 v[56:59], v25, s[4:7], s40 offen offset:0 sc1
  buffer_load_dwordx4 v[60:63], v25, s[4:7], s40 offen offset:2048 sc1
  s_add_u32 s40, s40, 4096
  buffer_load_dwordx4 v[64:67], v25, s[4:7], s40 offen offset:0 sc1
  buffer_load_dwordx4 v[68:71], v25, s[4:7], s40 offen offset:2048 sc1
  s_add_u32 s40, s40, 4096
  buffer_load_dwordx4 v[72:75], v25, s[4:7], s40 offen offset:0 sc1
  buffer_load_dwordx4 v[76:79], v25, s[4:7], s40 offen offset:2048 sc1
  s_add_u32 s40, s40, 4096
  buffer_load_dwordx4 v[80:83], v25, s[4:7], s40 offen offset:0 sc1
  buffer_load_dwordx4 v[84:87], v25, s[4:7], s40 offen offset:2048 sc1
  s_add_u32 s40, s40, 4096
  buffer_load_dwordx4 v[88:91], v25, s[4:7], s40 offen offset:0 sc1
  buffer_load_dwordx4 v[92:95], v25, s[4:7], s40 offen offset:2048 sc1
  s_add_u32 s40, s40, 4096
  buffer_load_dwordx4 v[96:99], v25, s[4:7], s40 offen offset:0 sc1
  buffer_load_dwordx4 v[100:103], v25, s[4:7], s40 offen offset:2048 sc1
  s_add_u32 s40, s40, 4096
  buffer_load_dwordx4 v[104:107], v25, s[4:7], s40 offen offset:0 sc1
  buffer_load_dwordx4 v[108:111], v25, s[4:7], s40 offen offset:2048 sc1
  s_add_u32 s40, s40, 4096
  buffer_load_dwordx4 v[112:115], v25, s[4:7], s40 offen offset:0 sc1
  buffer_load_dwordx4 v[116:119], v25, s[4:7], s40 offen offset:2048 sc1
  s_add_u32 s40, s40, 4096
  buffer_load_dwordx4 v[120:123], v25, s[4:7], s40 offen offset:0 sc1
  buffer_load_dwordx4 v[124:127], v25, s[4:7], s40 offen offset:2048 sc1
  s_add_u32 s40, s40, 4096
  buffer_load_dwordx4 v[128:131], v25, s[4:7], s40 offen offset:0 sc1
  buffer_load_dwordx4 v[132:135], v25, s[4:7], s40 offen offset:2048 sc1
  s_add_u32 s40, s40, 4096
  buffer_load_dwordx4 v[136:139], v25, s[4:7], s40 offen offset:0 sc1
  buffer_load_dwordx4 v[140:143], v25, s[4:7], s40 offen offset:2048 sc1
  s_add_u32 s40, s40, 4096
  buffer_load_dwordx4 v[144:147], v25, s[4:7], s40 offen offset:0 sc1
  buffer_load_dwordx4 v[148:151], v25, s[4:7], s40 offen offset:2048 sc1
  s_add_u32 s40, s40, 4096
  buffer_load_dwordx4 v[152:155], v25, s[4:7], s40 offen offset:0 sc1
  buffer_load_dwordx4 v[156:159], v25, s[4:7], s40 offen offset:2048 sc1
  s_add_u32 s40, s40, 4096
  s_lshr_b32 s56, s51, 2
  s_lshl_b32 s56, s56, 2
  s_lshr_b32 s57, s52, 3
  s_add_u32 s56, s56, s57
  s_lshl_b32 s56, s56, 2
  s_and_b32 s57, s52, 3
  s_add_u32 s56, s56, s57
  s_lshl_b32 s56, s56, 2
  s_and_b32 s57, s51, 3
  s_add_u32 s56, s56, s57
  s_lshl_b32 s56, s56, 1
  s_bfe_u32 s57, s52, 65538
  s_add_u32 s56, s56, s57
  s_lshl_b32 s56, s56, 1
  s_lshr_b32 s57, s18, 1
  s_add_u32 s56, s56, s57
  s_lshl_b32 s56, s56, 10
  s_and_b32 s57, s18, 1
  s_lshl_b32 s57, s57, 3
  s_add_u32 s56, s56, s57
  s_add_u32 s56, s56, 83886080
  v_and_b32 v18, 31, v16
  v_lshlrev_b32 v23, 2, v18
  s_lshl_b32 s57, s51, 7
  s_add_u32 s57, s57, 92274688
  v_lshrrev_b32 v19, 5, v16
  v_lshlrev_b32 v19, 3, v19
  v_lshl_add_u32 v24, v18, 11, v19
  s_lshl_b32 s50, s51, 16
  s_lshl_b32 s58, s52, 6
  s_add_u32 s50, s50, s58
  s_lshl_b32 s58, s18, 4
  s_add_u32 s50, s50, s58
  s_mov_b32 s36, s88
  s_mov_b32 s37, s89
  s_mov_b32 s38, 0x400000
  s_mov_b32 s39, 0x20000
  buffer_load_dwordx2 v[26:27], v21, s[4:7], s56 offen sc1
  buffer_load_dword v28, v23, s[4:7], s57 offen sc1
  v_mbcnt_lo_u32_b32 v16, -1, 0
  v_mbcnt_hi_u32_b32 v16, -1, v16
  v_lshlrev_b32 v21, 4, v16
  s_lshl_b32 s58, s18, 12
  v_add_u32 v22, s58, v21
  s_lshl_b32 s58, s18, 10
  v_add_u32 v19, s58, v21
  s_waitcnt vmcnt(33)
  v_mfma_f32_32x32x16_bf16 v[224:239], a[0:3], v[32:35], 0
  v_mfma_f32_32x32x16_bf16 v[240:255], a[4:7], v[32:35], 0
  s_waitcnt vmcnt(32)
  v_mfma_f32_32x32x16_bf16 v[224:239], a[8:11], v[36:39], v[224:239]
  v_mfma_f32_32x32x16_bf16 v[240:255], a[12:15], v[36:39], v[240:255]
  s_waitcnt vmcnt(31)
  v_mfma_f32_32x32x16_bf16 v[224:239], a[16:19], v[40:43], v[224:239]
  v_mfma_f32_32x32x16_bf16 v[240:255], a[20:23], v[40:43], v[240:255]
  s_waitcnt vmcnt(30)
  v_mfma_f32_32x32x16_bf16 v[224:239], a[24:27], v[44:47], v[224:239]
  v_mfma_f32_32x32x16_bf16 v[240:255], a[28:31], v[44:47], v[240:255]
  s_waitcnt vmcnt(29)
  v_mfma_f32_32x32x16_bf16 v[224:239], a[32:35], v[48:51], v[224:239]
  v_mfma_f32_32x32x16_bf16 v[240:255], a[36:39], v[48:51], v[240:255]
  s_waitcnt vmcnt(28)
  v_mfma_f32_32x32x16_bf16 v[224:239], a[40:43], v[52:55], v[224:239]
  v_mfma_f32_32x32x16_bf16 v[240:255], a[44:47], v[52:55], v[240:255]
  s_waitcnt vmcnt(27)
  v_mfma_f32_32x32x16_bf16 v[224:239], a[48:51], v[56:59], v[224:239]
  v_mfma_f32_32x32x16_bf16 v[240:255], a[52:55], v[56:59], v[240:255]
  s_waitcnt vmcnt(26)
  v_mfma_f32_32x32x16_bf16 v[224:239], a[56:59], v[60:63], v[224:239]
  v_mfma_f32_32x32x16_bf16 v[240:255], a[60:63], v[60:63], v[240:255]
  s_waitcnt vmcnt(25)
  v_mfma_f32_32x32x16_bf16 v[224:239], a[64:67], v[64:67], v[224:239]
  v_mfma_f32_32x32x16_bf16 v[240:255], a[68:71], v[64:67], v[240:255]
  s_waitcnt vmcnt(24)
  v_mfma_f32_32x32x16_bf16 v[224:239], a[72:75], v[68:71], v[224:239]
  v_mfma_f32_32x32x16_bf16 v[240:255], a[76:79], v[68:71], v[240:255]
  s_waitcnt vmcnt(23)
  v_mfma_f32_32x32x16_bf16 v[224:239], a[80:83], v[72:75], v[224:239]
  v_mfma_f32_32x32x16_bf16 v[240:255], a[84:87], v[72:75], v[240:255]
  s_waitcnt vmcnt(22)
  v_mfma_f32_32x32x16_bf16 v[224:239], a[88:91], v[76:79], v[224:239]
  v_mfma_f32_32x32x16_bf16 v[240:255], a[92:95], v[76:79], v[240:255]
  s_waitcnt vmcnt(21)
  v_mfma_f32_32x32x16_bf16 v[224:239], a[96:99], v[80:83], v[224:239]
  v_mfma_f32_32x32x16_bf16 v[240:255], a[100:103], v[80:83], v[240:255]
  s_waitcnt vmcnt(20)
  v_mfma_f32_32x32x16_bf16 v[224:239], a[104:107], v[84:87], v[224:239]
  v_mfma_f32_32x32x16_bf16 v[240:255], a[108:111], v[84:87], v[240:255]
  s_waitcnt vmcnt(19)
  v_mfma_f32_32x32x16_bf16 v[224:239], a[112:115], v[88:91], v[224:239]
  v_mfma_f32_32x32x16_bf16 v[240:255], a[116:119], v[88:91], v[240:255]
  s_waitcnt vmcnt(18)
  v_mfma_f32_32x32x16_bf16 v[224:239], a[120:123], v[92:95], v[224:239]
  v_mfma_f32_32x32x16_bf16 v[240:255], a[124:127], v[92:95], v[240:255]
  s_waitcnt vmcnt(17)
  v_mfma_f32_32x32x16_bf16 v[224:239], a[128:131], v[96:99], v[224:239]
  v_mfma_f32_32x32x16_bf16 v[240:255], a[132:135], v[96:99], v[240:255]
  s_waitcnt vmcnt(16)
  v_mfma_f32_32x32x16_bf16 v[224:239], a[136:139], v[100:103], v[224:239]
  v_mfma_f32_32x32x16_bf16 v[240:255], a[140:143], v[100:103], v[240:255]
  s_waitcnt vmcnt(15)
  v_mfma_f32_32x32x16_bf16 v[224:239], a[144:147], v[104:107], v[224:239]
  v_mfma_f32_32x32x16_bf16 v[240:255], a[148:151], v[104:107], v[240:255]
  s_waitcnt vmcnt(14)
  v_mfma_f32_32x32x16_bf16 v[224:239], a[152:155], v[108:111], v[224:239]
  v_mfma_f32_32x32x16_bf16 v[240:255], a[156:159], v[108:111], v[240:255]
  s_waitcnt vmcnt(13)
  v_mfma_f32_32x32x16_bf16 v[224:239], a[160:163], v[112:115], v[224:239]
  v_mfma_f32_32x32x16_bf16 v[240:255], a[164:167], v[112:115], v[240:255]
  s_waitcnt vmcnt(12)
  v_mfma_f32_32x32x16_bf16 v[224:239], a[168:171], v[116:119], v[224:239]
  v_mfma_f32_32x32x16_bf16 v[240:255], a[172:175], v[116:119], v[240:255]
  s_waitcnt vmcnt(11)
  v_mfma_f32_32x32x16_bf16 v[224:239], a[176:179], v[120:123], v[224:239]
  v_mfma_f32_32x32x16_bf16 v[240:255], a[180:183], v[120:123], v[240:255]
  s_waitcnt vmcnt(10)
  v_mfma_f32_32x32x16_bf16 v[224:239], a[184:187], v[124:127], v[224:239]
  v_mfma_f32_32x32x16_bf16 v[240:255], a[188:191], v[124:127], v[240:255]
  s_waitcnt vmcnt(9)
  v_mfma_f32_32x32x16_bf16 v[224:239], a[192:195], v[128:131], v[224:239]
  v_mfma_f32_32x32x16_bf16 v[240:255], a[196:199], v[128:131], v[240:255]
  s_waitcnt vmcnt(8)
  v_mfma_f32_32x32x16_bf16 v[224:239], a[200:203], v[132:135], v[224:239]
  v_mfma_f32_32x32x16_bf16 v[240:255], a[204:207], v[132:135], v[240:255]
  s_waitcnt vmcnt(7)
  v_mfma_f32_32x32x16_bf16 v[224:239], a[208:211], v[136:139], v[224:239]
  v_mfma_f32_32x32x16_bf16 v[240:255], a[212:215], v[136:139], v[240:255]
  s_waitcnt vmcnt(6)
  v_mfma_f32_32x32x16_bf16 v[224:239], a[216:219], v[140:143], v[224:239]
  v_mfma_f32_32x32x16_bf16 v[240:255], a[220:223], v[140:143], v[240:255]
  s_waitcnt vmcnt(5)
  v_mfma_f32_32x32x16_bf16 v[224:239], a[224:227], v[144:147], v[224:239]
  v_mfma_f32_32x32x16_bf16 v[240:255], a[228:231], v[144:147], v[240:255]
  s_waitcnt vmcnt(4)
  v_mfma_f32_32x32x16_bf16 v[224:239], a[232:235], v[148:151], v[224:239]
  v_mfma_f32_32x32x16_bf16 v[240:255], a[236:239], v[148:151], v[240:255]
  s_waitcnt vmcnt(3)
  v_mfma_f32_32x32x16_bf16 v[224:239], a[240:243], v[152:155], v[224:239]
  v_mfma_f32_32x32x16_bf16 v[240:255], a[244:247], v[152:155], v[240:255]
  s_waitcnt vmcnt(2)
  v_mfma_f32_32x32x16_bf16 v[224:239], a[248:251], v[156:159], v[224:239]
  v_mfma_f32_32x32x16_bf16 v[240:255], a[252:255], v[156:159], v[240:255]
  s_bitcmp0_b32 s3, 6
  s_cbranch_scc1 .ook_95
  s_bitset0_b32 s3, 6
  s_nop 8
  v_cmp_u_f32 vcc, v224, v240
  s_cbranch_vccnz .opr_83
.ook_95:
  s_nop 9
  v_permlane16_swap_b32 v240, v32
  v_permlane16_swap_b32 v241, v33
  v_permlane16_swap_b32 v242, v34
  v_permlane16_swap_b32 v243, v35
  v_permlane16_swap_b32 v244, v36
  v_permlane16_swap_b32 v245, v37
  v_permlane16_swap_b32 v246, v38
  v_permlane16_swap_b32 v247, v39
  v_permlane16_swap_b32 v248, v40
  v_permlane16_swap_b32 v249, v41
  v_permlane16_swap_b32 v250, v42
  v_permlane16_swap_b32 v251, v43
  v_permlane16_swap_b32 v252, v44
  v_permlane16_swap_b32 v253, v45
  v_permlane16_swap_b32 v254, v46
  v_permlane16_swap_b32 v255, v47
  v_pk_add_f32 v[224:225], v[224:225], v[32:33]
  v_pk_add_f32 v[226:227], v[226:227], v[34:35]
  v_pk_add_f32 v[228:229], v[228:229], v[36:37]
  v_pk_add_f32 v[230:231], v[230:231], v[38:39]
  v_pk_add_f32 v[232:233], v[232:233], v[40:41]
  v_pk_add_f32 v[234:235], v[234:235], v[42:43]
  v_pk_add_f32 v[236:237], v[236:237], v[44:45]
  v_pk_add_f32 v[238:239], v[238:239], v[46:47]
  ds_write_b128 v22, v[224:227] offset:0
  ds_write_b128 v22, v[228:231] offset:1024
  ds_write_b128 v22, v[232:235] offset:2048
  ds_write_b128 v22, v[236:239] offset:3072
  s_waitcnt lgkmcnt(0)
  s_barrier
  ds_read_b128 v[32:35], v19 offset:0
  ds_read_b128 v[36:39], v19 offset:4096
  ds_read_b128 v[40:43], v19 offset:8192
  ds_read_b128 v[44:47], v19 offset:12288
  s_waitcnt vmcnt(0)
  v_lshlrev_b32 v48, 16, v26
  v_and_b32 v49, 0xffff0000, v26
  v_lshlrev_b32 v50, 16, v27
  v_and_b32 v51, 0xffff0000, v27
  s_waitcnt lgkmcnt(2)
  v_pk_add_f32 v[32:33], v[32:33], v[36:37]
  v_pk_add_f32 v[34:35], v[34:35], v[38:39]
  s_waitcnt lgkmcnt(0)
  v_pk_add_f32 v[40:41], v[40:41], v[44:45]
  v_pk_add_f32 v[42:43], v[42:43], v[46:47]
  v_pk_add_f32 v[32:33], v[32:33], v[40:41]
  v_pk_add_f32 v[34:35], v[34:35], v[42:43]
  v_pk_add_f32 v[32:33], v[32:33], v[48:49] neg_lo:[0,1] neg_hi:[0,1]
  v_pk_add_f32 v[34:35], v[34:35], v[50:51] neg_lo:[0,1] neg_hi:[0,1]
  v_pk_fma_f32 v[32:33], v[32:33], v[28:29], v[48:49] op_sel_hi:[1,0,1]
  v_pk_fma_f32 v[34:35], v[34:35], v[28:29], v[50:51] op_sel_hi:[1,0,1]
  v_cvt_pk_bf16_f32 v32, v32, v33
  v_cvt_pk_bf16_f32 v33, v34, v35
  s_mov_b32 exec_lo, 0xffff
  s_mov_b32 exec_hi, 0xffff
  buffer_store_dwordx2 v[32:33], v24, s[36:39], s50 offen
  s_mov_b64 exec, -1
  s_xor_b32 s3, s3, 128
  s_bitset0_b32 s3, 7
.opse_89:
  s_branch .next
.tOP_23:
  s_lshl_b32 s51, s94, 3
  s_lshr_b32 s96, s95, 2
  s_add_u32 s51, s51, s96
  s_and_b32 s52, s95, 3
  s_cmp_ge_u32 s51, 10
  s_cbranch_scc1 .next
  s_cmp_lg_u32 s18, 0
  s_cbranch_scc1 .w0_96
  s_bitcmp1_b32 s3, 0
  s_cbranch_scc1 .ini_100
  v_mov_b32 v121, 0
.inl_101:
  buffer_load_dword v120, v121, s[8:11], 0 offen offset:20 sc1
  s_waitcnt vmcnt(0)
  v_readfirstlane_b32 s95, v120
  s_or_b32 s3, s3, s95
  s_bitcmp1_b32 s3, 0
  s_cbranch_scc1 .ini_100
  s_sleep 2
  s_sub_u32 s20, s20, 1
  s_cbranch_scc0 .inl_101
  v_mov_b32 v120, 0xdead
  v_mov_b32 v121, 0
  buffer_store_dword v120, v121, s[8:11], 0 offen offset:28 sc1
  s_mov_b32 s20, 0
  s_mov_b32 s94, 65535
  s_branch .dwo_97
.ini_100:
  v_mbcnt_lo_u32_b32 v123, -1, 0
  v_mbcnt_hi_u32_b32 v123, -1, v123
  v_and_b32 v123, 3, v123
  s_lshl_b32 s96, s51, 9
  s_add_u32 s96, s96, 123740160
  v_lshlrev_b32 v122, 7, v123
  v_add_u32 v122, s96, v122
  v_mov_b32 v123, 4
  v_mov_b32 v126, 0
.dwl_98:
  buffer_load_dword v124, v122, s[4:7], 0 offen sc1
  s_bitcmp1_b32 s3, 1
  s_cbranch_scc1 .dwn_102
  buffer_load_dword v125, v126, s[8:11], 0 offen offset:8 sc1
.dwn_102:
  s_waitcnt vmcnt(0)
  s_mov_b32 s94, 0
  v_cmp_lt_u32 vcc, v124, v123
  s_cbranch_vccz .dwo_97
  s_bitcmp1_b32 s3, 1
  s_cbranch_scc1 .dws_99
  v_readfirstlane_b32 s95, v125
  s_and_b32 s94, s95, 65791
  s_cmp_eq_u32 s94, 65
  s_cselect_b32 s94, 2, 0
  s_or_b32 s3, s3, s94
  s_bitcmp0_b32 s95, 16
  s_cbranch_scc1 .dws_99
  v_mov_b32 v120, 1
  v_mov_b32 v121, 0
  s_mov_b64 exec, 1
  buffer_atomic_add v120, v121, s[8:11], 0 offen offset:24 sc0 sc1
  s_mov_b64 exec, -1
  s_waitcnt vmcnt(0)
  v_readfirstlane_b32 s94, v120
  s_or_b32 s3, s3, 2
  s_cmp_ge_u32 s94, 64
  s_cbranch_scc1 .dws_99
  s_or_b32 s94, s94, 65536
  s_branch .dwo_97
.dws_99:
  s_sleep 4
  s_sub_u32 s20, s20, 1
  s_cbranch_scc0 .dwl_98
  v_mov_b32 v120, 0xdead
  v_mov_b32 v121, 0
  buffer_store_dword v120, v121, s[8:11], 0 offen offset:28 sc1
  s_mov_b32 s20, 0
  s_mov_b32 s94, 65535
  s_branch .dwo_97
.dwo_97:
  v_mov_b32 v120, s94
  v_mov_b32 v121, 163776
  ds_write_b32 v121, v120
  s_waitcnt lgkmcnt(0)
.w0_96:
  s_barrier
  v_mov_b32 v121, 163776
  ds_read_b32 v120, v121
  s_waitcnt lgkmcnt(0)
  v_readfirstlane_b32 s94, v120
  s_barrier
  s_cmp_lg_u32 s94, 0
  s_cbranch_scc1 .special
  s_mov_b32 s24, s92
  s_mov_b32 s25, s93
  s_mov_b32 s26, 0x10000000
  s_mov_b32 s27, 0x20000
  s_lshl_b32 s40, s51, 20
  s_add_u32 s40, s40, 67108864
  s_mov_b32 s60, 262144
  s_mov_b32 s44, 64
  s_mov_b32 s55, 4096
  s_mov_b32 s28, s74
  s_mov_b32 s29, s75
  s_mov_b32 s30, 0x800000
  s_mov_b32 s31, 0x20000
  s_mov_b32 s32, s74
  s_mov_b32 s33, s75
  s_mov_b32 s34, 0x800000
  s_mov_b32 s35, 0x20000
  s_lshl_b32 s41, s52, 9
  s_add_u32 s42, s41, 256
  s_mov_b32 s61, 2048
  s_mov_b32 s43, 131072
  s_lshl_b32 s50, s51, 18
  s_lshl_b32 s96, s52, 9
  s_add_u32 s50, s50, s96
  s_lshl_b32 s96, s18, 6
  s_add_u32 s50, s50, s96
  s_mov_b32 s53, 4
.gemm:
  v_mbcnt_lo_u32_b32 v16, -1, 0
  v_mbcnt_hi_u32_b32 v16, -1, v16
  v_lshrrev_b32 v18, 3, v16
  s_lshl_b32 s56, s18, 5
  v_add_u32 v18, s56, v18
  v_mul_u32_u24 v18, s60, v18
  v_lshrrev_b32 v19, 4, v16
  v_and_b32 v20, 7, v16
  v_xor_b32 v20, v20, v19
  s_lshl_b32 s57, s60, 3
  s_sub_u32 s57, s57, 1024
  v_lshl_add_u32 v80, v20, 4, v18
  v_xor_b32 v20, 4, v20
  v_lshl_add_u32 v81, v20, 4, v18
  v_add_u32 v81, s57, v81
  s_lshl_b32 s57, s57, 1
  v_add_u32 v82, s57, v80
  v_add_u32 v83, s57, v81
  s_lshl_b32 s56, s18, 4
  v_add_u32 v18, s56, v19
  v_mul_u32_u24 v18, s61, v18
  v_and_b32 v20, 15, v16
  v_lshlrev_b32 v21, 2, v19
  v_xor_b32 v20, v20, v21
  v_lshl_add_u32 v84, v20, 4, v18
  s_lshl_b32 s57, s61, 2
  s_sub_u32 s57, s57, 1024
  v_add_u32 v85, s57, v84
  v_add_u32 v86, s57, v85
  v_add_u32 v87, s57, v86
  v_and_b32 v18, 31, v16
  v_bfe_u32 v20, v16, 1, 3
  v_lshrrev_b32 v21, 5, v16
  v_xor_b32 v20, v20, v21
  v_lshlrev_b32 v18, 7, v18
  v_lshl_add_u32 v88, v20, 4, v18
  v_xor_b32 v89, 32, v88
  v_xor_b32 v90, 64, v88
  v_xor_b32 v91, 96, v88
  v_bfe_u32 v18, v16, 2, 2
  v_lshl_add_u32 v20, v21, 3, v18
  v_lshlrev_b32 v20, 8, v20
  v_xor_b32 v18, s18, v18
  v_lshl_add_u32 v20, v18, 6, v20
  v_and_b32 v18, 1, v19
  v_lshl_add_u32 v20, v18, 5, v20
  v_and_b32 v18, 3, v16
  v_lshl_add_u32 v20, v18, 3, v20
  v_add_u32 v92, 16384, v20
  s_cmp_eq_u32 s55, 128
  s_cbranch_scc1 .rm_104
  s_mul_i32 s56, s60, s18
  v_lshlrev_b32 v88, 4, v16
  v_add_u32 v80, s56, v88
  v_add_u32 v81, s56, v88
  v_add_u32 v82, s56, v88
  v_add_u32 v83, s56, v88
  v_add_u32 v89, 1024, v88
  v_add_u32 v90, 2048, v88
  v_add_u32 v91, 3072, v88
.rm_104:
  s_or_b32 s62, s44, -1
  s_cmp_lg_u32 s18, 0
  s_cbranch_scc1 .nh_105
  s_cmp_lg_u32 s44, 16
  s_cbranch_scc1 .nh_105
  s_mov_b32 s62, 14
  s_and_b32 s37, s44, 0
  s_and_b32 s94, s3, 17
  s_cmp_eq_u32 s94, 17
  s_cbranch_scc1 .nh_105
  s_lshl_b32 s95, s2, 2
  v_mov_b32 v121, 0
  s_mov_b64 exec, 1
  buffer_load_dwordx4 v[124:127], v121, s[8:11], 0 offen offset:8 sc1
  buffer_load_dword v122, v121, s[8:11], s95 offen offset:32 sc1
  s_mov_b64 exec, -1
.nh_105:
  s_lshl_b32 s45, s18, 12
  s_mov_b32 s49, s44
  s_mov_b32 s48, 0
  s_add_u32 m0, s45, 0
  s_nop 0
  buffer_load_dwordx4 v80, s[24:27], s40 offen offset:0 sc1 lds
  buffer_load_dwordx4 v81, s[24:27], s40 offen offset:1024 sc1 lds
  buffer_load_dwordx4 v82, s[24:27], s40 offen offset:2048 sc1 lds
  buffer_load_dwordx4 v83, s[24:27], s40 offen offset:3072 sc1 lds
  s_add_u32 m0, s45, 16384
  s_nop 0
  buffer_load_dwordx4 v84, s[28:31], s41 offen offset:0 lds
  buffer_load_dwordx4 v85, s[28:31], s41 offen offset:1024 lds
  buffer_load_dwordx4 v86, s[28:31], s41 offen offset:2048 lds
  buffer_load_dwordx4 v87, s[28:31], s41 offen offset:3072 lds
  s_add_u32 m0, s45, 32768
  s_nop 0
  buffer_load_dwordx4 v84, s[32:35], s42 offen offset:0 lds
  buffer_load_dwordx4 v85, s[32:35], s42 offen offset:1024 lds
  buffer_load_dwordx4 v86, s[32:35], s42 offen offset:2048 lds
  buffer_load_dwordx4 v87, s[32:35], s42 offen offset:3072 lds
  s_add_u32 s40, s40, s55
  s_add_u32 s41, s41, s43
  s_add_u32 s42, s42, s43
  s_add_u32 s45, s45, 49152
  s_cmp_ge_u32 s45, 147456
  s_cselect_b32 s56, 147456, 0
  s_sub_u32 s45, s45, s56
  s_sub_u32 s49, s49, 1
  s_cmp_gt_i32 s49, 0
  s_cselect_b32 s26, s26, 0
  s_cselect_b32 s30, s30, 0
  s_cselect_b32 s34, s34, 0
  s_bitcmp1_b32 s3, 3
  s_cbranch_scc1 .epi
  s_mov_b32 s19, 0
  s_add_u32 m0, s45, 0
  s_nop 0
  buffer_load_dwordx4 v80, s[24:27], s40 offen offset:0 sc1 lds
  buffer_load_dwordx4 v81, s[24:27], s40 offen offset:1024 sc1 lds
  buffer_load_dwordx4 v82, s[24:27], s40 offen offset:2048 sc1 lds
  buffer_load_dwordx4 v83, s[24:27], s40 offen offset:3072 sc1 lds
  s_add_u32 m0, s45, 16384
  s_nop 0
  buffer_load_dwordx4 v84, s[28:31], s41 offen offset:0 lds
  buffer_load_dwordx4 v85, s[28:31], s41 offen offset:1024 lds
  buffer_load_dwordx4 v86, s[28:31], s41 offen offset:2048 lds
  buffer_load_dwordx4 v87, s[28:31], s41 offen offset:3072 lds
  s_add_u32 m0, s45, 32768
  s_nop 0
  buffer_load_dwordx4 v84, s[32:35], s42 offen offset:0 lds
  buffer_load_dwordx4 v85, s[32:35], s42 offen offset:1024 lds
  buffer_load_dwordx4 v86, s[32:35], s42 offen offset:2048 lds
  buffer_load_dwordx4 v87, s[32:35], s42 offen offset:3072 lds
  s_add_u32 s40, s40, s55
  s_add_u32 s41, s41, s43
  s_add_u32 s42, s42, s43
  s_add_u32 s45, s45, 49152
  s_cmp_ge_u32 s45, 147456
  s_cselect_b32 s56, 147456, 0
  s_sub_u32 s45, s45, s56
  s_sub_u32 s49, s49, 1
  s_cmp_gt_i32 s49, 0
  s_cselect_b32 s26, s26, 0
  s_cselect_b32 s30, s30, 0
  s_cselect_b32 s34, s34, 0
  s_add_u32 m0, s45, 0
  s_nop 0
  buffer_load_dwordx4 v80, s[24:27], s40 offen offset:0 sc1 lds
  buffer_load_dwordx4 v81, s[24:27], s40 offen offset:1024 sc1 lds
  buffer_load_dwordx4 v82, s[24:27], s40 offen offset:2048 sc1 lds
  v_mov_b64 v[128:129], 0
  v_mov_b64 v[130:131], 0
  v_mov_b64 v[132:133], 0
  v_mov_b64 v[134:135], 0
  v_mov_b64 v[136:137], 0
  v_mov_b64 v[138:139], 0
  v_mov_b64 v[140:141], 0
  v_mov_b64 v[142:143], 0
  v_mov_b64 v[144:145], 0
  v_mov_b64 v[146:147], 0
  v_mov_b64 v[148:149], 0
  v_mov_b64 v[150:151], 0
  v_mov_b64 v[152:153], 0
  v_mov_b64 v[154:155], 0
  v_mov_b64 v[156:157], 0
  v_mov_b64 v[158:159], 0
  v_mov_b64 v[160:161], 0
  v_mov_b64 v[162:163], 0
  v_mov_b64 v[164:165], 0
  v_mov_b64 v[166:167], 0
  v_mov_b64 v[168:169], 0
  v_mov_b64 v[170:171], 0
  v_mov_b64 v[172:173], 0
  v_mov_b64 v[174:175], 0
  v_mov_b64 v[176:177], 0
  v_mov_b64 v[178:179], 0
  v_mov_b64 v[180:181], 0
  v_mov_b64 v[182:183], 0
  v_mov_b64 v[184:185], 0
  v_mov_b64 v[186:187], 0
  v_mov_b64 v[188:189], 0
  v_mov_b64 v[190:191], 0
  v_mov_b64 v[192:193], 0
  v_mov_b64 v[194:195], 0
  v_mov_b64 v[196:197], 0
  v_mov_b64 v[198:199], 0
  v_mov_b64 v[200:201], 0
  v_mov_b64 v[202:203], 0
  v_mov_b64 v[204:205], 0
  v_mov_b64 v[206:207], 0
  v_mov_b64 v[208:209], 0
  v_mov_b64 v[210:211], 0
  v_mov_b64 v[212:213], 0
  v_mov_b64 v[214:215], 0
  v_mov_b64 v[216:217], 0
  v_mov_b64 v[218:219], 0
  v_mov_b64 v[220:221], 0
  v_mov_b64 v[222:223], 0
  v_mov_b64 v[224:225], 0
  v_mov_b64 v[226:227], 0
  v_mov_b64 v[228:229], 0
  v_mov_b64 v[230:231], 0
  v_mov_b64 v[232:233], 0
  v_mov_b64 v[234:235], 0
  v_mov_b64 v[236:237], 0
  v_mov_b64 v[238:239], 0
  v_mov_b64 v[240:241], 0
  v_mov_b64 v[242:243], 0
  v_mov_b64 v[244:245], 0
  v_mov_b64 v[246:247], 0
  v_mov_b64 v[248:249], 0
  v_mov_b64 v[250:251], 0
  v_mov_b64 v[252:253], 0
  v_mov_b64 v[254:255], 0
  s_waitcnt vmcnt(15)
.go_103:
  s_barrier
  s_cmp_eq_u32 s53, 5
  s_cbranch_scc1 .gemmv
  ds_read_b128 v[32:35], v88 offset:0
  ds_read_b64_tr_b16 v[48:49], v92 offset:0
  ds_read_b64_tr_b16 v[50:51], v92 offset:1024
  ds_read_b128 v[36:39], v88 offset:4096
  ds_read_b64_tr_b16 v[52:53], v92 offset:16384
  ds_read_b64_tr_b16 v[54:55], v92 offset:17408
  ds_read_b128 v[40:43], v88 offset:8192
  ds_read_b128 v[44:47], v88 offset:12288
.gl_106:
  s_waitcnt lgkmcnt(5)
  v_mfma_f32_32x32x16_bf16 v[128:143], v[48:51], v[32:35], v[128:143]
  ds_read_b128 v[56:59], v89 offset:0
  ds_read_b64_tr_b16 v[72:73], v92 offset:4096
  ds_read_b64_tr_b16 v[74:75], v92 offset:5120
  s_waitcnt lgkmcnt(7)
  v_mfma_f32_32x32x16_bf16 v[160:175], v[48:51], v[36:39], v[160:175]
  ds_read_b128 v[60:63], v89 offset:4096
  ds_read_b64_tr_b16 v[76:77], v92 offset:20480
  ds_read_b64_tr_b16 v[78:79], v92 offset:21504
  s_waitcnt lgkmcnt(8)
  v_mfma_f32_32x32x16_bf16 v[144:159], v[52:55], v[32:35], v[144:159]
  ds_read_b128 v[64:67], v89 offset:8192
  ds_read_b128 v[68:71], v89 offset:12288
  v_mfma_f32_32x32x16_bf16 v[176:191], v[52:55], v[36:39], v[176:191]
  buffer_load_dwordx4 v83, s[24:27], s40 offen offset:3072 sc1 lds
  s_waitcnt lgkmcnt(9)
  v_mfma_f32_32x32x16_bf16 v[192:207], v[48:51], v[40:43], v[192:207]
  v_mfma_f32_32x32x16_bf16 v[208:223], v[52:55], v[40:43], v[208:223]
  s_add_u32 m0, s45, 16384
  s_nop 0
  buffer_load_dwordx4 v84, s[28:31], s41 offen offset:0 lds
  s_waitcnt lgkmcnt(8)
  v_mfma_f32_32x32x16_bf16 v[224:239], v[48:51], v[44:47], v[224:239]
  v_mfma_f32_32x32x16_bf16 v[240:255], v[52:55], v[44:47], v[240:255]
  buffer_load_dwordx4 v85, s[28:31], s41 offen offset:1024 lds
  s_waitcnt lgkmcnt(5)
  v_mfma_f32_32x32x16_bf16 v[128:143], v[72:75], v[56:59], v[128:143]
  ds_read_b128 v[32:35], v90 offset:0
  ds_read_b64_tr_b16 v[48:49], v92 offset:8192
  ds_read_b64_tr_b16 v[50:51], v92 offset:9216
  s_waitcnt lgkmcnt(7)
  v_mfma_f32_32x32x16_bf16 v[160:175], v[72:75], v[60:63], v[160:175]
  ds_read_b128 v[36:39], v90 offset:4096
  ds_read_b64_tr_b16 v[52:53], v92 offset:24576
  ds_read_b64_tr_b16 v[54:55], v92 offset:25600
  s_waitcnt lgkmcnt(8)
  v_mfma_f32_32x32x16_bf16 v[144:159], v[76:79], v[56:59], v[144:159]
  ds_read_b128 v[40:43], v90 offset:8192
  ds_read_b128 v[44:47], v90 offset:12288
  v_mfma_f32_32x32x16_bf16 v[176:191], v[76:79], v[60:63], v[176:191]
  buffer_load_dwordx4 v86, s[28:31], s41 offen offset:2048 lds
  s_waitcnt lgkmcnt(9)
  v_mfma_f32_32x32x16_bf16 v[192:207], v[72:75], v[64:67], v[192:207]
  v_mfma_f32_32x32x16_bf16 v[208:223], v[76:79], v[64:67], v[208:223]
  buffer_load_dwordx4 v87, s[28:31], s41 offen offset:3072 lds
  s_waitcnt lgkmcnt(8)
  v_mfma_f32_32x32x16_bf16 v[224:239], v[72:75], v[68:71], v[224:239]
  v_mfma_f32_32x32x16_bf16 v[240:255], v[76:79], v[68:71], v[240:255]
  s_add_u32 m0, s45, 32768
  s_nop 0
  buffer_load_dwordx4 v84, s[32:35], s42 offen offset:0 lds
  s_waitcnt lgkmcnt(5)
  v_mfma_f32_32x32x16_bf16 v[128:143], v[48:51], v[32:35], v[128:143]
  ds_read_b128 v[56:59], v91 offset:0
  ds_read_b64_tr_b16 v[72:73], v92 offset:12288
  ds_read_b64_tr_b16 v[74:75], v92 offset:13312
  s_waitcnt lgkmcnt(7)
  v_mfma_f32_32x32x16_bf16 v[160:175], v[48:51], v[36:39], v[160:175]
  ds_read_b128 v[60:63], v91 offset:4096
  ds_read_b64_tr_b16 v[76:77], v92 offset:28672
  ds_read_b64_tr_b16 v[78:79], v92 offset:29696
  s_waitcnt lgkmcnt(8)
  v_mfma_f32_32x32x16_bf16 v[144:159], v[52:55], v[32:35], v[144:159]
  ds_read_b128 v[64:67], v91 offset:8192
  ds_read_b128 v[68:71], v91 offset:12288
  v_mfma_f32_32x32x16_bf16 v[176:191], v[52:55], v[36:39], v[176:191]
  buffer_load_dwordx4 v85, s[32:35], s42 offen offset:1024 lds
  s_waitcnt lgkmcnt(9)
  v_mfma_f32_32x32x16_bf16 v[192:207], v[48:51], v[40:43], v[192:207]
  v_mfma_f32_32x32x16_bf16 v[208:223], v[52:55], v[40:43], v[208:223]
  buffer_load_dwordx4 v86, s[32:35], s42 offen offset:2048 lds
  s_waitcnt lgkmcnt(8)
  v_mfma_f32_32x32x16_bf16 v[224:239], v[48:51], v[44:47], v[224:239]
  v_mfma_f32_32x32x16_bf16 v[240:255], v[52:55], v[44:47], v[240:255]
  buffer_load_dwordx4 v87, s[32:35], s42 offen offset:3072 lds
  s_waitcnt lgkmcnt(5)
  v_mfma_f32_32x32x16_bf16 v[128:143], v[72:75], v[56:59], v[128:143]
  s_add_u32 s40, s40, s55
  s_add_u32 s41, s41, s43
  s_add_u32 s42, s42, s43
  s_add_u32 s45, s45, 49152
  s_cmp_ge_u32 s45, 147456
  s_cselect_b32 s56, 147456, 0
  s_sub_u32 s45, s45, s56
  s_sub_u32 s49, s49, 1
  s_cmp_gt_i32 s49, 0
  s_cselect_b32 s26, s26, 0
  s_cselect_b32 s30, s30, 0
  s_cselect_b32 s34, s34, 0
  s_add_u32 s48, s48, 1
  s_cmp_eq_u32 s48, 3
  s_mov_b32 s47, 49152
  s_cmov_b32 s47, -98304
  s_cmov_b32 s48, 0
  s_waitcnt lgkmcnt(4)
  v_mfma_f32_32x32x16_bf16 v[160:175], v[72:75], v[60:63], v[160:175]
  s_waitcnt lgkmcnt(0)
  s_waitcnt vmcnt(12)
  s_barrier
  v_add_u32 v88, s47, v88
  v_add_u32 v92, s47, v92
  v_mfma_f32_32x32x16_bf16 v[144:159], v[76:79], v[56:59], v[144:159]
  ds_read_b128 v[32:35], v88 offset:0
  ds_read_b64_tr_b16 v[48:49], v92 offset:0
  ds_read_b64_tr_b16 v[50:51], v92 offset:1024
  v_mfma_f32_32x32x16_bf16 v[176:191], v[76:79], v[60:63], v[176:191]
  ds_read_b128 v[36:39], v88 offset:4096
  ds_read_b64_tr_b16 v[52:53], v92 offset:16384
  ds_read_b64_tr_b16 v[54:55], v92 offset:17408
  v_mfma_f32_32x32x16_bf16 v[192:207], v[72:75], v[64:67], v[192:207]
  ds_read_b128 v[40:43], v88 offset:8192
  ds_read_b128 v[44:47], v88 offset:12288
  v_add_u32 v89, s47, v89
  v_add_u32 v90, s47, v90
  v_add_u32 v91, s47, v91
  v_mfma_f32_32x32x16_bf16 v[208:223], v[76:79], v[64:67], v[208:223]
  s_add_u32 m0, s45, 0
  s_nop 0
  buffer_load_dwordx4 v80, s[24:27], s40 offen offset:0 sc1 lds
  v_mfma_f32_32x32x16_bf16 v[224:239], v[72:75], v[68:71], v[224:239]
  buffer_load_dwordx4 v81, s[24:27], s40 offen offset:1024 sc1 lds
  v_mfma_f32_32x32x16_bf16 v[240:255], v[76:79], v[68:71], v[240:255]
  buffer_load_dwordx4 v82, s[24:27], s40 offen offset:2048 sc1 lds
  s_sub_u32 s44, s44, 1
  s_cmp_eq_u32 s44, s62
  s_cbranch_scc1 .hook
.hret:
  s_cmp_lg_u32 s44, 0
  s_cbranch_scc1 .gl_106
  s_waitcnt lgkmcnt(0)
.lend:
  s_mov_b32 s16, s50
  s_mov_b32 s17, s53
  s_mov_b32 s19, s54
  s_cmp_lg_u32 s55, 128
  s_cbranch_scc1 .epi
  s_cmp_lg_u32 s18, 0
  s_cbranch_scc1 .w0_107
  s_mov_b32 s94, -1
  s_cmp_lg_u32 s62, -2
  s_cbranch_scc1 .slow_108
  v_readfirstlane_b32 s38, v120
  s_bitcmp1_b32 s3, 1
  s_cbranch_scc1 .np_109
  v_readfirstlane_b32 s99, v124
  v_readfirstlane_b32 s95, v127
  v_readfirstlane_b32 s94, v122
  s_or_b32 s3, s3, s95
  s_cmp_ge_u32 s94, 32
  s_cselect_b32 s94, 16, 0
  s_or_b32 s3, s3, s94
  s_and_b32 s94, s99, 65791
  s_cmp_eq_u32 s94, 65
  s_cselect_b32 s94, 2, 0
  s_or_b32 s3, s3, s94
  s_mov_b32 s39, s99
  s_mov_b32 s94, -1
  s_bitcmp1_b32 s39, 16
  s_cbranch_scc1 .slow_108
.np_109:
  s_cmp_eq_u32 s54, 123731968
  s_cbranch_scc1 .slow_108
  s_sub_u32 s95, s38, 1
  s_cmp_ge_u32 s95, 64
  s_cbranch_scc1 .slow_108
  s_and_b32 s96, s36, 31
  s_cmp_ge_u32 s96, 28
  s_mov_b32 s98, 0xfeffffff
  s_cmov_b32 s98, 0x1e00ffff
  s_mov_b32 s99, 0x661f
  s_cmov_b32 s99, 0x6600
  s_bitcmp0_b64 s[98:99], s95
  s_cbranch_scc1 .slow_108
  s_lshl_b32 s94, s95, 5
  s_or_b32 s94, s94, s96
  s_bitset0_b32 s3, 2
.slow_108:
  v_mov_b32 v120, s94
  v_mov_b32 v121, 163776
  ds_write_b32 v121, v120
  s_waitcnt lgkmcnt(0)
.w0_107:
  s_barrier
  v_mov_b32 v121, 163776
  ds_read_b32 v120, v121
  s_waitcnt lgkmcnt(0)
  v_readfirstlane_b32 s94, v120
  s_cmp_eq_u32 s94, -1
  s_cbranch_scc1 .epi
  s_mov_b32 s46, s94
  s_bitset1_b32 s3, 3
  s_branch .decode
.gemmv:
  ds_read_b128 v[32:35], v88 offset:0
  ds_read_b64_tr_b16 v[48:49], v92 offset:0
  ds_read_b64_tr_b16 v[50:51], v92 offset:1024
  ds_read_b128 v[36:39], v88 offset:4096
  ds_read_b64_tr_b16 v[52:53], v92 offset:16384
  ds_read_b64_tr_b16 v[54:55], v92 offset:17408
  ds_read_b128 v[40:43], v88 offset:8192
  ds_read_b128 v[44:47], v88 offset:12288
.gl_110:
  s_waitcnt lgkmcnt(5)
  v_mfma_f32_32x32x16_bf16 v[128:143], v[32:35], v[48:51], v[128:143]
  ds_read_b128 v[56:59], v89 offset:0
  ds_read_b64_tr_b16 v[72:73], v92 offset:4096
  ds_read_b64_tr_b16 v[74:75], v92 offset:5120
  s_waitcnt lgkmcnt(7)
  v_mfma_f32_32x32x16_bf16 v[160:175], v[36:39], v[48:51], v[160:175]
  ds_read_b128 v[60:63], v89 offset:4096
  ds_read_b64_tr_b16 v[76:77], v92 offset:20480
  ds_read_b64_tr_b16 v[78:79], v92 offset:21504
  s_waitcnt lgkmcnt(8)
  v_mfma_f32_32x32x16_bf16 v[144:159], v[32:35], v[52:55], v[144:159]
  ds_read_b128 v[64:67], v89 offset:8192
  ds_read_b128 v[68:71], v89 offset:12288
  v_mfma_f32_32x32x16_bf16 v[176:191], v[36:39], v[52:55], v[176:191]
  buffer_load_dwordx4 v83, s[24:27], s40 offen offset:3072 sc1 lds
  s_waitcnt lgkmcnt(9)
  v_mfma_f32_32x32x16_bf16 v[192:207], v[40:43], v[48:51], v[192:207]
  v_mfma_f32_32x32x16_bf16 v[208:223], v[40:43], v[52:55], v[208:223]
  s_add_u32 m0, s45, 16384
  s_nop 0
  buffer_load_dwordx4 v84, s[28:31], s41 offen offset:0 lds
  s_waitcnt lgkmcnt(8)
  v_mfma_f32_32x32x16_bf16 v[224:239], v[44:47], v[48:51], v[224:239]
  v_mfma_f32_32x32x16_bf16 v[240:255], v[44:47], v[52:55], v[240:255]
  buffer_load_dwordx4 v85, s[28:31], s41 offen offset:1024 lds
  s_waitcnt lgkmcnt(5)
  v_mfma_f32_32x32x16_bf16 v[128:143], v[56:59], v[72:75], v[128:143]
  ds_read_b128 v[32:35], v90 offset:0
  ds_read_b64_tr_b16 v[48:49], v92 offset:8192
  ds_read_b64_tr_b16 v[50:51], v92 offset:9216
  s_waitcnt lgkmcnt(7)
  v_mfma_f32_32x32x16_bf16 v[160:175], v[60:63], v[72:75], v[160:175]
  ds_read_b128 v[36:39], v90 offset:4096
  ds_read_b64_tr_b16 v[52:53], v92 offset:24576
  ds_read_b64_tr_b16 v[54:55], v92 offset:25600
  s_waitcnt lgkmcnt(8)
  v_mfma_f32_32x32x16_bf16 v[144:159], v[56:59], v[76:79], v[144:159]
  ds_read_b128 v[40:43], v90 offset:8192
  ds_read_b128 v[44:47], v90 offset:12288
  v_mfma_f32_32x32x16_bf16 v[176:191], v[60:63], v[76:79], v[176:191]
  buffer_load_dwordx4 v86, s[28:31], s41 offen offset:2048 lds
  s_waitcnt lgkmcnt(9)
  v_mfma_f32_32x32x16_bf16 v[192:207], v[64:67], v[72:75], v[192:207]
  v_mfma_f32_32x32x16_bf16 v[208:223], v[64:67], v[76:79], v[208:223]
  buffer_load_dwordx4 v87, s[28:31], s41 offen offset:3072 lds
  s_waitcnt lgkmcnt(8)
  v_mfma_f32_32x32x16_bf16 v[224:239], v[68:71], v[72:75], v[224:239]
  v_mfma_f32_32x32x16_bf16 v[240:255], v[68:71], v[76:79], v[240:255]
  s_add_u32 m0, s45, 32768
  s_nop 0
  buffer_load_dwordx4 v84, s[32:35], s42 offen offset:0 lds
  s_waitcnt lgkmcnt(5)
  v_mfma_f32_32x32x16_bf16 v[128:143], v[32:35], v[48:51], v[128:143]
  ds_read_b128 v[56:59], v91 offset:0
  ds_read_b64_tr_b16 v[72:73], v92 offset:12288
  ds_read_b64_tr_b16 v[74:75], v92 offset:13312
  s_waitcnt lgkmcnt(7)
  v_mfma_f32_32x32x16_bf16 v[160:175], v[36:39], v[48:51], v[160:175]
  ds_read_b128 v[60:63], v91 offset:4096
  ds_read_b64_tr_b16 v[76:77], v92 offset:28672
  ds_read_b64_tr_b16 v[78:79], v92 offset:29696
  s_waitcnt lgkmcnt(8)
  v_mfma_f32_32x32x16_bf16 v[144:159], v[32:35], v[52:55], v[144:159]
  ds_read_b128 v[64:67], v91 offset:8192
  ds_read_b128 v[68:71], v91 offset:12288
  v_mfma_f32_32x32x16_bf16 v[176:191], v[36:39], v[52:55], v[176:191]
  buffer_load_dwordx4 v85, s[32:35], s42 offen offset:1024 lds
  s_waitcnt lgkmcnt(9)
  v_mfma_f32_32x32x16_bf16 v[192:207], v[40:43], v[48:51], v[192:207]
  v_mfma_f32_32x32x16_bf16 v[208:223], v[40:43], v[52:55], v[208:223]
  buffer_load_dwordx4 v86, s[32:35], s42 offen offset:2048 lds
  s_waitcnt lgkmcnt(8)
  v_mfma_f32_32x32x16_bf16 v[224:239], v[44:47], v[48:51], v[224:239]
  v_mfma_f32_32x32x16_bf16 v[240:255], v[44:47], v[52:55], v[240:255]
  buffer_load_dwordx4 v87, s[32:35], s42 offen offset:3072 lds
  s_waitcnt lgkmcnt(5)
  v_mfma_f32_32x32x16_bf16 v[128:143], v[56:59], v[72:75], v[128:143]
  s_add_u32 s40, s40, s55
  s_add_u32 s41, s41, s43
  s_add_u32 s42, s42, s43
  s_add_u32 s45, s45, 49152
  s_cmp_ge_u32 s45, 147456
  s_cselect_b32 s56, 147456, 0
  s_sub_u32 s45, s45, s56
  s_sub_u32 s49, s49, 1
  s_cmp_gt_i32 s49, 0
  s_cselect_b32 s26, s26, 0
  s_cselect_b32 s30, s30, 0
  s_cselect_b32 s34, s34, 0
  s_add_u32 s48, s48, 1
  s_cmp_eq_u32 s48, 3
  s_mov_b32 s47, 49152
  s_cmov_b32 s47, -98304
  s_cmov_b32 s48, 0
  s_waitcnt lgkmcnt(4)
  v_mfma_f32_32x32x16_bf16 v[160:175], v[60:63], v[72:75], v[160:175]
  s_waitcnt lgkmcnt(0)
  s_waitcnt vmcnt(12)
  s_barrier
  v_add_u32 v88, s47, v88
  v_add_u32 v92, s47, v92
  v_mfma_f32_32x32x16_bf16 v[144:159], v[56:59], v[76:79], v[144:159]
  ds_read_b128 v[32:35], v88 offset:0
  ds_read_b64_tr_b16 v[48:49], v92 offset:0
  ds_read_b64_tr_b16 v[50:51], v92 offset:1024
  v_mfma_f32_32x32x16_bf16 v[176:191], v[60:63], v[76:79], v[176:191]
  ds_read_b128 v[36:39], v88 offset:4096
  ds_read_b64_tr_b16 v[52:53], v92 offset:16384
  ds_read_b64_tr_b16 v[54:55], v92 offset:17408
  v_mfma_f32_32x32x16_bf16 v[192:207], v[64:67], v[72:75], v[192:207]
  ds_read_b128 v[40:43], v88 offset:8192
  ds_read_b128 v[44:47], v88 offset:12288
  v_add_u32 v89, s47, v89
  v_add_u32 v90, s47, v90
  v_add_u32 v91, s47, v91
  v_mfma_f32_32x32x16_bf16 v[208:223], v[64:67], v[76:79], v[208:223]
  s_add_u32 m0, s45, 0
  s_nop 0
  buffer_load_dwordx4 v80, s[24:27], s40 offen offset:0 sc1 lds
  v_mfma_f32_32x32x16_bf16 v[224:239], v[68:71], v[72:75], v[224:239]
  buffer_load_dwordx4 v81, s[24:27], s40 offen offset:1024 sc1 lds
  v_mfma_f32_32x32x16_bf16 v[240:255], v[68:71], v[76:79], v[240:255]
  buffer_load_dwordx4 v82, s[24:27], s40 offen offset:2048 sc1 lds
  s_sub_u32 s44, s44, 1
  s_cmp_eq_u32 s44, s62
  s_cbranch_scc1 .hook
.hretv:
  s_cmp_lg_u32 s44, 0
  s_cbranch_scc1 .gl_110
  s_waitcnt lgkmcnt(0)
  s_branch .lend
.hook:
  s_cmp_eq_u32 s37, 1
  s_cbranch_scc1 .ha_111
  s_cmp_eq_u32 s37, 2
  s_cbranch_scc1 .hb_112
  s_cmp_eq_u32 s37, 3
  s_cbranch_scc1 .hc_113
  s_cmp_eq_u32 s19, 0
  s_cbranch_scc1 .hn_116
  v_mov_b32 v120, 1
  v_mov_b32 v121, 0
  s_mov_b64 exec, 1
  buffer_atomic_add v120, v121, s[4:7], s19 offen sc1
  s_mov_b64 exec, -1
  s_mov_b32 s19, 0
.hn_116:
  s_and_b32 s94, s3, 17
  s_cmp_eq_u32 s94, 17
  s_cbranch_scc1 .hk_118
  v_readfirstlane_b32 s99, v124
  v_readfirstlane_b32 s95, v127
  v_readfirstlane_b32 s94, v122
  s_or_b32 s3, s3, s95
  s_cmp_ge_u32 s94, 32
  s_cselect_b32 s94, 16, 0
  s_or_b32 s3, s3, s94
  s_and_b32 s94, s99, 65791
  s_cmp_eq_u32 s94, 65
  s_cselect_b32 s94, 2, 0
  s_or_b32 s3, s3, s94
  s_and_b32 s94, s3, 17
  s_cmp_eq_u32 s94, 17
  s_cbranch_scc1 .hk_118
  s_cmp_le_u32 s62, 8
  s_cbranch_scc1 .hoff_117
  s_lshl_b32 s95, s2, 2
  v_mov_b32 v121, 0
  s_mov_b64 exec, 1
  buffer_load_dwordx4 v[124:127], v121, s[8:11], 0 offen offset:8 sc1
  buffer_load_dword v122, v121, s[8:11], s95 offen offset:32 sc1
  s_mov_b64 exec, -1
  s_branch .hm_119
.hk_118:
  s_lshl_b32 s95, s2, 7
  s_add_u32 s95, s95, 123760640
  v_mov_b32 v120, 1
  v_mov_b32 v121, 0
  s_mov_b64 exec, 1
  buffer_atomic_add v120, v121, s[4:7], s95 offen sc0 sc1
  s_mov_b64 exec, -1
  s_mov_b32 s37, 1
  s_branch .hm_119
.ha_111:
  v_readfirstlane_b32 s36, v120
  s_add_u32 s36, s36, 32
  s_bitset1_b32 s3, 2
  s_mov_b32 s38, 0
  s_mov_b32 s39, 0
  s_cmp_ge_u32 s36, 4096
  s_cbranch_scc1 .hoff_117
  s_mov_b32 s37, 3
  s_mov_b32 s94, s62
  s_mov_b32 s62, 3
  s_and_b32 s96, s36, 31
  s_cbranch_scc1 .hx_115
  v_mov_b32 v120, 1
  v_mov_b32 v121, 0
  s_mov_b64 exec, 1
  buffer_atomic_add v120, v121, s[8:11], 0 offen offset:160 sc0 sc1
  s_mov_b64 exec, -1
  s_mov_b32 s37, 2
  s_sub_u32 s62, s94, 2
  s_branch .hx_115
.hb_112:
  s_lshr_b32 s97, s36, 5
  s_lshl_b32 s98, s2, 7
  s_add_u32 s98, s98, s97
  s_lshl_b32 s98, s98, 2
  s_add_u32 s98, s98, 123748352
  v_add_u32 v120, 1, v120
  v_mov_b32 v121, 0
  s_mov_b64 exec, 1
  buffer_store_dword v120, v121, s[4:7], s98 offen sc1
  s_branch .hd_114
.hc_113:
  s_lshr_b32 s97, s36, 5
  s_lshl_b32 s98, s2, 7
  s_add_u32 s98, s98, s97
  s_lshl_b32 s98, s98, 2
  s_add_u32 s98, s98, 123748352
  v_mov_b32 v121, 0
  s_mov_b64 exec, 1
  buffer_load_dword v120, v121, s[4:7], s98 offen sc1
.hd_114:
  s_mov_b64 exec, -1
  s_mov_b32 s62, -2
  s_bitcmp1_b32 s3, 1
  s_cbranch_scc1 .hx_115
  s_lshl_b32 s95, s2, 2
  v_mov_b32 v121, 0
  s_mov_b64 exec, 1
  buffer_load_dwordx4 v[124:127], v121, s[8:11], 0 offen offset:8 sc1
  buffer_load_dword v122, v121, s[8:11], s95 offen offset:32 sc1
  s_mov_b64 exec, -1
  s_branch .hx_115
.hm_119:
  s_sub_u32 s62, s62, 2
  s_branch .hx_115
.hoff_117:
  s_mov_b32 s62, -1
.hx_115:
  s_cmp_eq_u32 s53, 5
  s_cbranch_scc1 .hretv
  s_branch .hret
.epiret:
  s_bitcmp0_b32 s3, 3
  s_cbranch_scc1 .done
  s_bitset0_b32 s3, 3
  s_add_u32 m0, s45, 0
  s_nop 0
  buffer_load_dwordx4 v80, s[24:27], s40 offen offset:0 sc1 lds
  buffer_load_dwordx4 v81, s[24:27], s40 offen offset:1024 sc1 lds
  buffer_load_dwordx4 v82, s[24:27], s40 offen offset:2048 sc1 lds
  buffer_load_dwordx4 v83, s[24:27], s40 offen offset:3072 sc1 lds
  s_add_u32 m0, s45, 16384
  s_nop 0
  buffer_load_dwordx4 v84, s[28:31], s41 offen offset:0 lds
  buffer_load_dwordx4 v85, s[28:31], s41 offen offset:1024 lds
  buffer_load_dwordx4 v86, s[28:31], s41 offen offset:2048 lds
  buffer_load_dwordx4 v87, s[28:31], s41 offen offset:3072 lds
  s_add_u32 m0, s45, 32768
  s_nop 0
  buffer_load_dwordx4 v84, s[32:35], s42 offen offset:0 lds
  buffer_load_dwordx4 v85, s[32:35], s42 offen offset:1024 lds
  buffer_load_dwordx4 v86, s[32:35], s42 offen offset:2048 lds
  buffer_load_dwordx4 v87, s[32:35], s42 offen offset:3072 lds
  s_add_u32 s40, s40, s55
  s_add_u32 s41, s41, s43
  s_add_u32 s42, s42, s43
  s_add_u32 s45, s45, 49152
  s_cmp_ge_u32 s45, 147456
  s_cselect_b32 s56, 147456, 0
  s_sub_u32 s45, s45, s56
  s_sub_u32 s49, s49, 1
  s_cmp_gt_i32 s49, 0
  s_cselect_b32 s26, s26, 0
  s_cselect_b32 s30, s30, 0
  s_cselect_b32 s34, s34, 0
  s_add_u32 m0, s45, 0
  s_nop 0
  buffer_load_dwordx4 v80, s[24:27], s40 offen offset:0 sc1 lds
  buffer_load_dwordx4 v81, s[24:27], s40 offen offset:1024 sc1 lds
  buffer_load_dwordx4 v82, s[24:27], s40 offen offset:2048 sc1 lds
  v_mov_b64 v[128:129], 0
  v_mov_b64 v[130:131], 0
  v_mov_b64 v[132:133], 0
  v_mov_b64 v[134:135], 0
  v_mov_b64 v[136:137], 0
  v_mov_b64 v[138:139], 0
  v_mov_b64 v[140:141], 0
  v_mov_b64 v[142:143], 0
  v_mov_b64 v[144:145], 0
  v_mov_b64 v[146:147], 0
  v_mov_b64 v[148:149], 0
  v_mov_b64 v[150:151], 0
  v_mov_b64 v[152:153], 0
  v_mov_b64 v[154:155], 0
  v_mov_b64 v[156:157], 0
  v_mov_b64 v[158:159], 0
  v_mov_b64 v[160:161], 0
  v_mov_b64 v[162:163], 0
  v_mov_b64 v[164:165], 0
  v_mov_b64 v[166:167], 0
  v_mov_b64 v[168:169], 0
  v_mov_b64 v[170:171], 0
  v_mov_b64 v[172:173], 0
  v_mov_b64 v[174:175], 0
  v_mov_b64 v[176:177], 0
  v_mov_b64 v[178:179], 0
  v_mov_b64 v[180:181], 0
  v_mov_b64 v[182:183], 0
  v_mov_b64 v[184:185], 0
  v_mov_b64 v[186:187], 0
  v_mov_b64 v[188:189], 0
  v_mov_b64 v[190:191], 0
  v_mov_b64 v[192:193], 0
  v_mov_b64 v[194:195], 0
  v_mov_b64 v[196:197], 0
  v_mov_b64 v[198:199], 0
  v_mov_b64 v[200:201], 0
  v_mov_b64 v[202:203], 0
  v_mov_b64 v[204:205], 0
  v_mov_b64 v[206:207], 0
  v_mov_b64 v[208:209], 0
  v_mov_b64 v[210:211], 0
  v_mov_b64 v[212:213], 0
  v_mov_b64 v[214:215], 0
  v_mov_b64 v[216:217], 0
  v_mov_b64 v[218:219], 0
  v_mov_b64 v[220:221], 0
  v_mov_b64 v[222:223], 0
  v_mov_b64 v[224:225], 0
  v_mov_b64 v[226:227], 0
  v_mov_b64 v[228:229], 0
  v_mov_b64 v[230:231], 0
  v_mov_b64 v[232:233], 0
  v_mov_b64 v[234:235], 0
  v_mov_b64 v[236:237], 0
  v_mov_b64 v[238:239], 0
  v_mov_b64 v[240:241], 0
  v_mov_b64 v[242:243], 0
  v_mov_b64 v[244:245], 0
  v_mov_b64 v[246:247], 0
  v_mov_b64 v[248:249], 0
  v_mov_b64 v[250:251], 0
  v_mov_b64 v[252:253], 0
  v_mov_b64 v[254:255], 0
  s_waitcnt vmcnt(23)
  s_branch .go_103
.epi:
  s_cmp_eq_u32 s17, 1
  s_cbranch_scc1 .ek_123
  s_cmp_eq_u32 s17, 2
  s_cbranch_scc1 .egu_120
  s_cmp_eq_u32 s17, 3
  s_cbranch_scc1 .edn_121
  s_cmp_eq_u32 s17, 4
  s_cbranch_scc1 .eop_122
  s_cmp_eq_u32 s17, 5
  s_cbranch_scc1 .ev_124
  v_lshlrev_b32 v17, 4, v16
  v_cvt_pk_bf16_f32 v128, v128, v129
  v_cvt_pk_bf16_f32 v129, v130, v131
  v_cvt_pk_bf16_f32 v130, v132, v133
  v_cvt_pk_bf16_f32 v131, v134, v135
  v_cvt_pk_bf16_f32 v132, v136, v137
  v_cvt_pk_bf16_f32 v133, v138, v139
  v_cvt_pk_bf16_f32 v134, v140, v141
  v_cvt_pk_bf16_f32 v135, v142, v143
  v_cvt_pk_bf16_f32 v144, v144, v145
  v_cvt_pk_bf16_f32 v145, v146, v147
  v_cvt_pk_bf16_f32 v146, v148, v149
  v_cvt_pk_bf16_f32 v147, v150, v151
  v_cvt_pk_bf16_f32 v148, v152, v153
  v_cvt_pk_bf16_f32 v149, v154, v155
  v_cvt_pk_bf16_f32 v150, v156, v157
  v_cvt_pk_bf16_f32 v151, v158, v159
  v_permlane32_swap_b32 v128, v130
  v_permlane32_swap_b32 v129, v131
  v_permlane32_swap_b32 v132, v134
  v_permlane32_swap_b32 v133, v135
  s_add_u32 s56, s16, 0x0
  buffer_store_dwordx4 v[128:131], v17, s[4:7], s56 offen offset:0 sc1
  buffer_store_dwordx4 v[132:135], v17, s[4:7], s56 offen offset:1024 sc1
  v_cvt_pk_bf16_f32 v160, v160, v161
  v_cvt_pk_bf16_f32 v161, v162, v163
  v_cvt_pk_bf16_f32 v162, v164, v165
  v_cvt_pk_bf16_f32 v163, v166, v167
  v_cvt_pk_bf16_f32 v164, v168, v169
  v_cvt_pk_bf16_f32 v165, v170, v171
  v_cvt_pk_bf16_f32 v166, v172, v173
  v_cvt_pk_bf16_f32 v167, v174, v175
  v_permlane32_swap_b32 v144, v146
  v_permlane32_swap_b32 v145, v147
  v_permlane32_swap_b32 v148, v150
  v_permlane32_swap_b32 v149, v151
  s_add_u32 s56, s16, 0x2000
  buffer_store_dwordx4 v[144:147], v17, s[4:7], s56 offen offset:0 sc1
  buffer_store_dwordx4 v[148:151], v17, s[4:7], s56 offen offset:1024 sc1
  v_cvt_pk_bf16_f32 v176, v176, v177
  v_cvt_pk_bf16_f32 v177, v178, v179
  v_cvt_pk_bf16_f32 v178, v180, v181
  v_cvt_pk_bf16_f32 v179, v182, v183
  v_cvt_pk_bf16_f32 v180, v184, v185
  v_cvt_pk_bf16_f32 v181, v186, v187
  v_cvt_pk_bf16_f32 v182, v188, v189
  v_cvt_pk_bf16_f32 v183, v190, v191
  v_permlane32_swap_b32 v160, v162
  v_permlane32_swap_b32 v161, v163
  v_permlane32_swap_b32 v164, v166
  v_permlane32_swap_b32 v165, v167
  s_add_u32 s56, s16, 0x40000
  buffer_store_dwordx4 v[160:163], v17, s[4:7], s56 offen offset:0 sc1
  buffer_store_dwordx4 v[164:167], v17, s[4:7], s56 offen offset:1024 sc1
  v_cvt_pk_bf16_f32 v192, v192, v193
  v_cvt_pk_bf16_f32 v193, v194, v195
  v_cvt_pk_bf16_f32 v194, v196, v197
  v_cvt_pk_bf16_f32 v195, v198, v199
  v_cvt_pk_bf16_f32 v196, v200, v201
  v_cvt_pk_bf16_f32 v197, v202, v203
  v_cvt_pk_bf16_f32 v198, v204, v205
  v_cvt_pk_bf16_f32 v199, v206, v207
  v_permlane32_swap_b32 v176, v178
  v_permlane32_swap_b32 v177, v179
  v_permlane32_swap_b32 v180, v182
  v_permlane32_swap_b32 v181, v183
  s_add_u32 s56, s16, 0x42000
  buffer_store_dwordx4 v[176:179], v17, s[4:7], s56 offen offset:0 sc1
  buffer_store_dwordx4 v[180:183], v17, s[4:7], s56 offen offset:1024 sc1
  v_cvt_pk_bf16_f32 v208, v208, v209
  v_cvt_pk_bf16_f32 v209, v210, v211
  v_cvt_pk_bf16_f32 v210, v212, v213
  v_cvt_pk_bf16_f32 v211, v214, v215
  v_cvt_pk_bf16_f32 v212, v216, v217
  v_cvt_pk_bf16_f32 v213, v218, v219
  v_cvt_pk_bf16_f32 v214, v220, v221
  v_cvt_pk_bf16_f32 v215, v222, v223
  v_permlane32_swap_b32 v192, v194
  v_permlane32_swap_b32 v193, v195
  v_permlane32_swap_b32 v196, v198
  v_permlane32_swap_b32 v197, v199
  s_add_u32 s56, s16, 0x80000
  buffer_store_dwordx4 v[192:195], v17, s[4:7], s56 offen offset:0 sc1
  buffer_store_dwordx4 v[196:199], v17, s[4:7], s56 offen offset:1024 sc1
  v_cvt_pk_bf16_f32 v224, v224, v225
  v_cvt_pk_bf16_f32 v225, v226, v227
  v_cvt_pk_bf16_f32 v226, v228, v229
  v_cvt_pk_bf16_f32 v227, v230, v231
  v_cvt_pk_bf16_f32 v228, v232, v233
  v_cvt_pk_bf16_f32 v229, v234, v235
  v_cvt_pk_bf16_f32 v230, v236, v237
  v_cvt_pk_bf16_f32 v231, v238, v239
  v_permlane32_swap_b32 v208, v210
  v_permlane32_swap_b32 v209, v211
  v_permlane32_swap_b32 v212, v214
  v_permlane32_swap_b32 v213, v215
  s_add_u32 s56, s16, 0x82000
  buffer_store_dwordx4 v[208:211], v17, s[4:7], s56 offen offset:0 sc1
  buffer_store_dwordx4 v[212:215], v17, s[4:7], s56 offen offset:1024 sc1
  v_cvt_pk_bf16_f32 v240, v240, v241
  v_cvt_pk_bf16_f32 v241, v242, v243
  v_cvt_pk_bf16_f32 v242, v244, v245
  v_cvt_pk_bf16_f32 v243, v246, v247
  v_cvt_pk_bf16_f32 v244, v248, v249
  v_cvt_pk_bf16_f32 v245, v250, v251
  v_cvt_pk_bf16_f32 v246, v252, v253
  v_cvt_pk_bf16_f32 v247, v254, v255
  v_permlane32_swap_b32 v224, v226
  v_permlane32_swap_b32 v225, v227
  v_permlane32_swap_b32 v228, v230
  v_permlane32_swap_b32 v229, v231
  s_add_u32 s56, s16, 0xc0000
  buffer_store_dwordx4 v[224:227], v17, s[4:7], s56 offen offset:0 sc1
  buffer_store_dwordx4 v[228:231], v17, s[4:7], s56 offen offset:1024 sc1
  v_permlane32_swap_b32 v240, v242
  v_permlane32_swap_b32 v241, v243
  v_permlane32_swap_b32 v244, v246
  v_permlane32_swap_b32 v245, v247
  s_add_u32 s56, s16, 0xc2000
  buffer_store_dwordx4 v[240:243], v17, s[4:7], s56 offen offset:0 sc1
  buffer_store_dwordx4 v[244:247], v17, s[4:7], s56 offen offset:1024 sc1
  s_branch .epiret
.ek_123:
  v_bfe_u32 v18, v16, 4, 1
  v_lshlrev_b32 v18, 8, v18
  v_lshrrev_b32 v19, 5, v16
  v_lshl_add_u32 v18, v19, 7, v18
  v_bfe_u32 v19, v16, 2, 1
  v_lshl_add_u32 v18, v19, 10, v18
  v_bfe_u32 v19, v16, 3, 1
  v_lshl_add_u32 v18, v19, 6, v18
  v_and_b32 v19, 3, v16
  v_lshl_add_u32 v17, v19, 4, v18
  v_cvt_pk_bf16_f32 v128, v128, v129
  v_cvt_pk_bf16_f32 v129, v130, v131
  v_cvt_pk_bf16_f32 v130, v132, v133
  v_cvt_pk_bf16_f32 v131, v134, v135
  v_cvt_pk_bf16_f32 v132, v136, v137
  v_cvt_pk_bf16_f32 v133, v138, v139
  v_cvt_pk_bf16_f32 v134, v140, v141
  v_cvt_pk_bf16_f32 v135, v142, v143
  v_cvt_pk_bf16_f32 v144, v144, v145
  v_cvt_pk_bf16_f32 v145, v146, v147
  v_cvt_pk_bf16_f32 v146, v148, v149
  v_cvt_pk_bf16_f32 v147, v150, v151
  v_cvt_pk_bf16_f32 v148, v152, v153
  v_cvt_pk_bf16_f32 v149, v154, v155
  v_cvt_pk_bf16_f32 v150, v156, v157
  v_cvt_pk_bf16_f32 v151, v158, v159
  v_permlane32_swap_b32 v128, v130
  v_permlane32_swap_b32 v129, v131
  v_permlane32_swap_b32 v132, v134
  v_permlane32_swap_b32 v133, v135
  v_cvt_pk_bf16_f32 v160, v160, v161
  v_cvt_pk_bf16_f32 v161, v162, v163
  v_cvt_pk_bf16_f32 v162, v164, v165
  v_cvt_pk_bf16_f32 v163, v166, v167
  v_cvt_pk_bf16_f32 v164, v168, v169
  v_cvt_pk_bf16_f32 v165, v170, v171
  v_cvt_pk_bf16_f32 v166, v172, v173
  v_cvt_pk_bf16_f32 v167, v174, v175
  v_permlane16_swap_b32 v128, v132
  v_permlane16_swap_b32 v129, v133
  v_permlane16_swap_b32 v130, v134
  v_permlane16_swap_b32 v131, v135
  v_permlane32_swap_b32 v144, v146
  v_permlane32_swap_b32 v145, v147
  v_permlane32_swap_b32 v148, v150
  v_permlane32_swap_b32 v149, v151
  s_add_u32 s56, s16, 0x0
  s_add_u32 s57, s16, 0x200
  buffer_store_dwordx4 v[128:131], v17, s[4:7], s56 offen sc1
  buffer_store_dwordx4 v[132:135], v17, s[4:7], s57 offen sc1
  v_cvt_pk_bf16_f32 v176, v176, v177
  v_cvt_pk_bf16_f32 v177, v178, v179
  v_cvt_pk_bf16_f32 v178, v180, v181
  v_cvt_pk_bf16_f32 v179, v182, v183
  v_cvt_pk_bf16_f32 v180, v184, v185
  v_cvt_pk_bf16_f32 v181, v186, v187
  v_cvt_pk_bf16_f32 v182, v188, v189
  v_cvt_pk_bf16_f32 v183, v190, v191
  v_permlane16_swap_b32 v144, v148
  v_permlane16_swap_b32 v145, v149
  v_permlane16_swap_b32 v146, v150
  v_permlane16_swap_b32 v147, v151
  v_permlane32_swap_b32 v160, v162
  v_permlane32_swap_b32 v161, v163
  v_permlane32_swap_b32 v164, v166
  v_permlane32_swap_b32 v165, v167
  s_add_u32 s56, s16, 0x2000
  s_add_u32 s57, s16, 0x2200
  buffer_store_dwordx4 v[144:147], v17, s[4:7], s56 offen sc1
  buffer_store_dwordx4 v[148:151], v17, s[4:7], s57 offen sc1
  v_cvt_pk_bf16_f32 v192, v192, v193
  v_cvt_pk_bf16_f32 v193, v194, v195
  v_cvt_pk_bf16_f32 v194, v196, v197
  v_cvt_pk_bf16_f32 v195, v198, v199
  v_cvt_pk_bf16_f32 v196, v200, v201
  v_cvt_pk_bf16_f32 v197, v202, v203
  v_cvt_pk_bf16_f32 v198, v204, v205
  v_cvt_pk_bf16_f32 v199, v206, v207
  v_permlane16_swap_b32 v160, v164
  v_permlane16_swap_b32 v161, v165
  v_permlane16_swap_b32 v162, v166
  v_permlane16_swap_b32 v163, v167
  v_permlane32_swap_b32 v176, v178
  v_permlane32_swap_b32 v177, v179
  v_permlane32_swap_b32 v180, v182
  v_permlane32_swap_b32 v181, v183
  s_add_u32 s56, s16, 0x40000
  s_add_u32 s57, s16, 0x40200
  buffer_store_dwordx4 v[160:163], v17, s[4:7], s56 offen sc1
  buffer_store_dwordx4 v[164:167], v17, s[4:7], s57 offen sc1
  v_cvt_pk_bf16_f32 v208, v208, v209
  v_cvt_pk_bf16_f32 v209, v210, v211
  v_cvt_pk_bf16_f32 v210, v212, v213
  v_cvt_pk_bf16_f32 v211, v214, v215
  v_cvt_pk_bf16_f32 v212, v216, v217
  v_cvt_pk_bf16_f32 v213, v218, v219
  v_cvt_pk_bf16_f32 v214, v220, v221
  v_cvt_pk_bf16_f32 v215, v222, v223
  v_permlane16_swap_b32 v176, v180
  v_permlane16_swap_b32 v177, v181
  v_permlane16_swap_b32 v178, v182
  v_permlane16_swap_b32 v179, v183
  v_permlane32_swap_b32 v192, v194
  v_permlane32_swap_b32 v193, v195
  v_permlane32_swap_b32 v196, v198
  v_permlane32_swap_b32 v197, v199
  s_add_u32 s56, s16, 0x42000
  s_add_u32 s57, s16, 0x42200
  buffer_store_dwordx4 v[176:179], v17, s[4:7], s56 offen sc1
  buffer_store_dwordx4 v[180:183], v17, s[4:7], s57 offen sc1
  v_cvt_pk_bf16_f32 v224, v224, v225
  v_cvt_pk_bf16_f32 v225, v226, v227
  v_cvt_pk_bf16_f32 v226, v228, v229
  v_cvt_pk_bf16_f32 v227, v230, v231
  v_cvt_pk_bf16_f32 v228, v232, v233
  v_cvt_pk_bf16_f32 v229, v234, v235
  v_cvt_pk_bf16_f32 v230, v236, v237
  v_cvt_pk_bf16_f32 v231, v238, v239
  v_permlane16_swap_b32 v192, v196
  v_permlane16_swap_b32 v193, v197
  v_permlane16_swap_b32 v194, v198
  v_permlane16_swap_b32 v195, v199
  v_permlane32_swap_b32 v208, v210
  v_permlane32_swap_b32 v209, v211
  v_permlane32_swap_b32 v212, v214
  v_permlane32_swap_b32 v213, v215
  s_add_u32 s56, s16, 0x80000
  s_add_u32 s57, s16, 0x80200
  buffer_store_dwordx4 v[192:195], v17, s[4:7], s56 offen sc1
  buffer_store_dwordx4 v[196:199], v17, s[4:7], s57 offen sc1
  v_cvt_pk_bf16_f32 v240, v240, v241
  v_cvt_pk_bf16_f32 v241, v242, v243
  v_cvt_pk_bf16_f32 v242, v244, v245
  v_cvt_pk_bf16_f32 v243, v246, v247
  v_cvt_pk_bf16_f32 v244, v248, v249
  v_cvt_pk_bf16_f32 v245, v250, v251
  v_cvt_pk_bf16_f32 v246, v252, v253
  v_cvt_pk_bf16_f32 v247, v254, v255
  v_permlane16_swap_b32 v208, v212
  v_permlane16_swap_b32 v209, v213
  v_permlane16_swap_b32 v210, v214
  v_permlane16_swap_b32 v211, v215
  v_permlane32_swap_b32 v224, v226
  v_permlane32_swap_b32 v225, v227
  v_permlane32_swap_b32 v228, v230
  v_permlane32_swap_b32 v229, v231
  s_add_u32 s56, s16, 0x82000
  s_add_u32 s57, s16, 0x82200
  buffer_store_dwordx4 v[208:211], v17, s[4:7], s56 offen sc1
  buffer_store_dwordx4 v[212:215], v17, s[4:7], s57 offen sc1
  v_permlane16_swap_b32 v224, v228
  v_permlane16_swap_b32 v225, v229
  v_permlane16_swap_b32 v226, v230
  v_permlane16_swap_b32 v227, v231
  v_permlane32_swap_b32 v240, v242
  v_permlane32_swap_b32 v241, v243
  v_permlane32_swap_b32 v244, v246
  v_permlane32_swap_b32 v245, v247
  s_add_u32 s56, s16, 0xc0000
  s_add_u32 s57, s16, 0xc0200
  buffer_store_dwordx4 v[224:227], v17, s[4:7], s56 offen sc1
  buffer_store_dwordx4 v[228:231], v17, s[4:7], s57 offen sc1
  v_permlane16_swap_b32 v240, v244
  v_permlane16_swap_b32 v241, v245
  v_permlane16_swap_b32 v242, v246
  v_permlane16_swap_b32 v243, v247
  s_add_u32 s56, s16, 0xc2000
  s_add_u32 s57, s16, 0xc2200
  buffer_store_dwordx4 v[240:243], v17, s[4:7], s56 offen sc1
  buffer_store_dwordx4 v[244:247], v17, s[4:7], s57 offen sc1
  s_branch .epiret
.ev_124:
  v_bfe_u32 v18, v16, 4, 1
  v_lshlrev_b32 v18, 8, v18
  v_lshrrev_b32 v19, 5, v16
  v_lshl_add_u32 v18, v19, 7, v18
  v_bfe_u32 v19, v16, 3, 1
  v_lshl_add_u32 v18, v19, 9, v18
  v_and_b32 v19, 7, v16
  v_lshl_add_u32 v17, v19, 4, v18
  v_cvt_pk_bf16_f32 v128, v128, v129
  v_cvt_pk_bf16_f32 v129, v130, v131
  v_cvt_pk_bf16_f32 v130, v132, v133
  v_cvt_pk_bf16_f32 v131, v134, v135
  v_cvt_pk_bf16_f32 v132, v136, v137
  v_cvt_pk_bf16_f32 v133, v138, v139
  v_cvt_pk_bf16_f32 v134, v140, v141
  v_cvt_pk_bf16_f32 v135, v142, v143
  v_cvt_pk_bf16_f32 v144, v144, v145
  v_cvt_pk_bf16_f32 v145, v146, v147
  v_cvt_pk_bf16_f32 v146, v148, v149
  v_cvt_pk_bf16_f32 v147, v150, v151
  v_cvt_pk_bf16_f32 v148, v152, v153
  v_cvt_pk_bf16_f32 v149, v154, v155
  v_cvt_pk_bf16_f32 v150, v156, v157
  v_cvt_pk_bf16_f32 v151, v158, v159
  v_permlane32_swap_b32 v128, v130
  v_permlane32_swap_b32 v129, v131
  v_permlane32_swap_b32 v132, v134
  v_permlane32_swap_b32 v133, v135
  v_cvt_pk_bf16_f32 v160, v160, v161
  v_cvt_pk_bf16_f32 v161, v162, v163
  v_cvt_pk_bf16_f32 v162, v164, v165
  v_cvt_pk_bf16_f32 v163, v166, v167
  v_cvt_pk_bf16_f32 v164, v168, v169
  v_cvt_pk_bf16_f32 v165, v170, v171
  v_cvt_pk_bf16_f32 v166, v172, v173
  v_cvt_pk_bf16_f32 v167, v174, v175
  v_permlane16_swap_b32 v128, v132
  v_permlane16_swap_b32 v129, v133
  v_permlane16_swap_b32 v130, v134
  v_permlane16_swap_b32 v131, v135
  v_permlane32_swap_b32 v144, v146
  v_permlane32_swap_b32 v145, v147
  v_permlane32_swap_b32 v148, v150
  v_permlane32_swap_b32 v149, v151
  s_add_u32 s56, s16, 0x0
  s_add_u32 s57, s16, 0x400
  buffer_store_dwordx4 v[128:131], v17, s[4:7], s56 offen sc1
  buffer_store_dwordx4 v[132:135], v17, s[4:7], s57 offen sc1
  v_cvt_pk_bf16_f32 v176, v176, v177
  v_cvt_pk_bf16_f32 v177, v178, v179
  v_cvt_pk_bf16_f32 v178, v180, v181
  v_cvt_pk_bf16_f32 v179, v182, v183
  v_cvt_pk_bf16_f32 v180, v184, v185
  v_cvt_pk_bf16_f32 v181, v186, v187
  v_cvt_pk_bf16_f32 v182, v188, v189
  v_cvt_pk_bf16_f32 v183, v190, v191
  v_permlane16_swap_b32 v144, v148
  v_permlane16_swap_b32 v145, v149
  v_permlane16_swap_b32 v146, v150
  v_permlane16_swap_b32 v147, v151
  v_permlane32_swap_b32 v160, v162
  v_permlane32_swap_b32 v161, v163
  v_permlane32_swap_b32 v164, v166
  v_permlane32_swap_b32 v165, v167
  s_add_u32 s56, s16, 0x2000
  s_add_u32 s57, s16, 0x2400
  buffer_store_dwordx4 v[144:147], v17, s[4:7], s56 offen sc1
  buffer_store_dwordx4 v[148:151], v17, s[4:7], s57 offen sc1
  v_cvt_pk_bf16_f32 v192, v192, v193
  v_cvt_pk_bf16_f32 v193, v194, v195
  v_cvt_pk_bf16_f32 v194, v196, v197
  v_cvt_pk_bf16_f32 v195, v198, v199
  v_cvt_pk_bf16_f32 v196, v200, v201
  v_cvt_pk_bf16_f32 v197, v202, v203
  v_cvt_pk_bf16_f32 v198, v204, v205
  v_cvt_pk_bf16_f32 v199, v206, v207
  v_permlane16_swap_b32 v160, v164
  v_permlane16_swap_b32 v161, v165
  v_permlane16_swap_b32 v162, v166
  v_permlane16_swap_b32 v163, v167
  v_permlane32_swap_b32 v176, v178
  v_permlane32_swap_b32 v177, v179
  v_permlane32_swap_b32 v180, v182
  v_permlane32_swap_b32 v181, v183
  s_add_u32 s56, s16, 0x40000
  s_add_u32 s57, s16, 0x40400
  buffer_store_dwordx4 v[160:163], v17, s[4:7], s56 offen sc1
  buffer_store_dwordx4 v[164:167], v17, s[4:7], s57 offen sc1
  v_cvt_pk_bf16_f32 v208, v208, v209
  v_cvt_pk_bf16_f32 v209, v210, v211
  v_cvt_pk_bf16_f32 v210, v212, v213
  v_cvt_pk_bf16_f32 v211, v214, v215
  v_cvt_pk_bf16_f32 v212, v216, v217
  v_cvt_pk_bf16_f32 v213, v218, v219
  v_cvt_pk_bf16_f32 v214, v220, v221
  v_cvt_pk_bf16_f32 v215, v222, v223
  v_permlane16_swap_b32 v176, v180
  v_permlane16_swap_b32 v177, v181
  v_permlane16_swap_b32 v178, v182
  v_permlane16_swap_b32 v179, v183
  v_permlane32_swap_b32 v192, v194
  v_permlane32_swap_b32 v193, v195
  v_permlane32_swap_b32 v196, v198
  v_permlane32_swap_b32 v197, v199
  s_add_u32 s56, s16, 0x42000
  s_add_u32 s57, s16, 0x42400
  buffer_store_dwordx4 v[176:179], v17, s[4:7], s56 offen sc1
  buffer_store_dwordx4 v[180:183], v17, s[4:7], s57 offen sc1
  v_cvt_pk_bf16_f32 v224, v224, v225
  v_cvt_pk_bf16_f32 v225, v226, v227
  v_cvt_pk_bf16_f32 v226, v228, v229
  v_cvt_pk_bf16_f32 v227, v230, v231
  v_cvt_pk_bf16_f32 v228, v232, v233
  v_cvt_pk_bf16_f32 v229, v234, v235
  v_cvt_pk_bf16_f32 v230, v236, v237
  v_cvt_pk_bf16_f32 v231, v238, v239
  v_permlane16_swap_b32 v192, v196
  v_permlane16_swap_b32 v193, v197
  v_permlane16_swap_b32 v194, v198
  v_permlane16_swap_b32 v195, v199
  v_permlane32_swap_b32 v208, v210
  v_permlane32_swap_b32 v209, v211
  v_permlane32_swap_b32 v212, v214
  v_permlane32_swap_b32 v213, v215
  s_add_u32 s56, s16, 0x80000
  s_add_u32 s57, s16, 0x80400
  buffer_store_dwordx4 v[192:195], v17, s[4:7], s56 offen sc1
  buffer_store_dwordx4 v[196:199], v17, s[4:7], s57 offen sc1
  v_cvt_pk_bf16_f32 v240, v240, v241
  v_cvt_pk_bf16_f32 v241, v242, v243
  v_cvt_pk_bf16_f32 v242, v244, v245
  v_cvt_pk_bf16_f32 v243, v246, v247
  v_cvt_pk_bf16_f32 v244, v248, v249
  v_cvt_pk_bf16_f32 v245, v250, v251
  v_cvt_pk_bf16_f32 v246, v252, v253
  v_cvt_pk_bf16_f32 v247, v254, v255
  v_permlane16_swap_b32 v208, v212
  v_permlane16_swap_b32 v209, v213
  v_permlane16_swap_b32 v210, v214
  v_permlane16_swap_b32 v211, v215
  v_permlane32_swap_b32 v224, v226
  v_permlane32_swap_b32 v225, v227
  v_permlane32_swap_b32 v228, v230
  v_permlane32_swap_b32 v229, v231
  s_add_u32 s56, s16, 0x82000
  s_add_u32 s57, s16, 0x82400
  buffer_store_dwordx4 v[208:211], v17, s[4:7], s56 offen sc1
  buffer_store_dwordx4 v[212:215], v17, s[4:7], s57 offen sc1
  v_permlane16_swap_b32 v224, v228
  v_permlane16_swap_b32 v225, v229
  v_permlane16_swap_b32 v226, v230
  v_permlane16_swap_b32 v227, v231
  v_permlane32_swap_b32 v240, v242
  v_permlane32_swap_b32 v241, v243
  v_permlane32_swap_b32 v244, v246
  v_permlane32_swap_b32 v245, v247
  s_add_u32 s56, s16, 0xc0000
  s_add_u32 s57, s16, 0xc0400
  buffer_store_dwordx4 v[224:227], v17, s[4:7], s56 offen sc1
  buffer_store_dwordx4 v[228:231], v17, s[4:7], s57 offen sc1
  v_permlane16_swap_b32 v240, v244
  v_permlane16_swap_b32 v241, v245
  v_permlane16_swap_b32 v242, v246
  v_permlane16_swap_b32 v243, v247
  s_add_u32 s56, s16, 0xc2000
  s_add_u32 s57, s16, 0xc2400
  buffer_store_dwordx4 v[240:243], v17, s[4:7], s56 offen sc1
  buffer_store_dwordx4 v[244:247], v17, s[4:7], s57 offen sc1
  s_branch .epiret
.egu_120:
  s_mov_b32 s58, 0xbfb8aa3b
  s_mov_b32 s59, 0xbfb8aa3b
  v_lshlrev_b32 v17, 4, v16
  v_pk_mul_f32 v[32:33], v[128:129], s[58:59]
  v_pk_mul_f32 v[34:35], v[130:131], s[58:59]
  v_pk_mul_f32 v[36:37], v[132:133], s[58:59]
  v_pk_mul_f32 v[38:39], v[134:135], s[58:59]
  v_pk_mul_f32 v[40:41], v[136:137], s[58:59]
  v_pk_mul_f32 v[42:43], v[138:139], s[58:59]
  v_pk_mul_f32 v[44:45], v[140:141], s[58:59]
  v_pk_mul_f32 v[46:47], v[142:143], s[58:59]
  v_exp_f32 v32, v32
  v_exp_f32 v33, v33
  v_exp_f32 v34, v34
  v_exp_f32 v35, v35
  v_exp_f32 v36, v36
  v_exp_f32 v37, v37
  v_exp_f32 v38, v38
  v_exp_f32 v39, v39
  v_exp_f32 v40, v40
  v_exp_f32 v41, v41
  v_exp_f32 v42, v42
  v_exp_f32 v43, v43
  v_exp_f32 v44, v44
  v_exp_f32 v45, v45
  v_exp_f32 v46, v46
  v_exp_f32 v47, v47
  v_pk_mul_f32 v[128:129], v[128:129], v[144:145]
  v_pk_mul_f32 v[130:131], v[130:131], v[146:147]
  v_pk_mul_f32 v[132:133], v[132:133], v[148:149]
  v_pk_mul_f32 v[134:135], v[134:135], v[150:151]
  v_pk_mul_f32 v[136:137], v[136:137], v[152:153]
  v_pk_mul_f32 v[138:139], v[138:139], v[154:155]
  v_pk_mul_f32 v[140:141], v[140:141], v[156:157]
  v_pk_mul_f32 v[142:143], v[142:143], v[158:159]
  v_pk_add_f32 v[32:33], v[32:33], 1.0 op_sel_hi:[1,0]
  v_pk_add_f32 v[34:35], v[34:35], 1.0 op_sel_hi:[1,0]
  v_pk_add_f32 v[36:37], v[36:37], 1.0 op_sel_hi:[1,0]
  v_pk_add_f32 v[38:39], v[38:39], 1.0 op_sel_hi:[1,0]
  v_pk_add_f32 v[40:41], v[40:41], 1.0 op_sel_hi:[1,0]
  v_pk_add_f32 v[42:43], v[42:43], 1.0 op_sel_hi:[1,0]
  v_pk_add_f32 v[44:45], v[44:45], 1.0 op_sel_hi:[1,0]
  v_pk_add_f32 v[46:47], v[46:47], 1.0 op_sel_hi:[1,0]
  v_rcp_f32 v32, v32
  v_rcp_f32 v33, v33
  v_rcp_f32 v34, v34
  v_rcp_f32 v35, v35
  v_rcp_f32 v36, v36
  v_rcp_f32 v37, v37
  v_rcp_f32 v38, v38
  v_rcp_f32 v39, v39
  v_rcp_f32 v40, v40
  v_rcp_f32 v41, v41
  v_rcp_f32 v42, v42
  v_rcp_f32 v43, v43
  v_rcp_f32 v44, v44
  v_rcp_f32 v45, v45
  v_rcp_f32 v46, v46
  v_rcp_f32 v47, v47
  v_pk_mul_f32 v[128:129], v[128:129], v[32:33]
  v_pk_mul_f32 v[130:131], v[130:131], v[34:35]
  v_pk_mul_f32 v[132:133], v[132:133], v[36:37]
  v_pk_mul_f32 v[134:135], v[134:135], v[38:39]
  v_pk_mul_f32 v[136:137], v[136:137], v[40:41]
  v_pk_mul_f32 v[138:139], v[138:139], v[42:43]
  v_pk_mul_f32 v[140:141], v[140:141], v[44:45]
  v_pk_mul_f32 v[142:143], v[142:143], v[46:47]
  v_cvt_pk_bf16_f32 v128, v128, v129
  v_cvt_pk_bf16_f32 v129, v130, v131
  v_cvt_pk_bf16_f32 v130, v132, v133
  v_cvt_pk_bf16_f32 v131, v134, v135
  v_cvt_pk_bf16_f32 v132, v136, v137
  v_cvt_pk_bf16_f32 v133, v138, v139
  v_cvt_pk_bf16_f32 v134, v140, v141
  v_cvt_pk_bf16_f32 v135, v142, v143
  v_pk_mul_f32 v[32:33], v[160:161], s[58:59]
  v_pk_mul_f32 v[34:35], v[162:163], s[58:59]
  v_pk_mul_f32 v[36:37], v[164:165], s[58:59]
  v_pk_mul_f32 v[38:39], v[166:167], s[58:59]
  v_pk_mul_f32 v[40:41], v[168:169], s[58:59]
  v_pk_mul_f32 v[42:43], v[170:171], s[58:59]
  v_pk_mul_f32 v[44:45], v[172:173], s[58:59]
  v_pk_mul_f32 v[46:47], v[174:175], s[58:59]
  v_exp_f32 v32, v32
  v_exp_f32 v33, v33
  v_exp_f32 v34, v34
  v_exp_f32 v35, v35
  v_exp_f32 v36, v36
  v_exp_f32 v37, v37
  v_exp_f32 v38, v38
  v_exp_f32 v39, v39
  v_exp_f32 v40, v40
  v_exp_f32 v41, v41
  v_exp_f32 v42, v42
  v_exp_f32 v43, v43
  v_exp_f32 v44, v44
  v_exp_f32 v45, v45
  v_exp_f32 v46, v46
  v_exp_f32 v47, v47
  v_pk_mul_f32 v[160:161], v[160:161], v[176:177]
  v_pk_mul_f32 v[162:163], v[162:163], v[178:179]
  v_pk_mul_f32 v[164:165], v[164:165], v[180:181]
  v_pk_mul_f32 v[166:167], v[166:167], v[182:183]
  v_pk_mul_f32 v[168:169], v[168:169], v[184:185]
  v_pk_mul_f32 v[170:171], v[170:171], v[186:187]
  v_pk_mul_f32 v[172:173], v[172:173], v[188:189]
  v_pk_mul_f32 v[174:175], v[174:175], v[190:191]
  v_pk_add_f32 v[32:33], v[32:33], 1.0 op_sel_hi:[1,0]
  v_pk_add_f32 v[34:35], v[34:35], 1.0 op_sel_hi:[1,0]
  v_pk_add_f32 v[36:37], v[36:37], 1.0 op_sel_hi:[1,0]
  v_pk_add_f32 v[38:39], v[38:39], 1.0 op_sel_hi:[1,0]
  v_pk_add_f32 v[40:41], v[40:41], 1.0 op_sel_hi:[1,0]
  v_pk_add_f32 v[42:43], v[42:43], 1.0 op_sel_hi:[1,0]
  v_pk_add_f32 v[44:45], v[44:45], 1.0 op_sel_hi:[1,0]
  v_pk_add_f32 v[46:47], v[46:47], 1.0 op_sel_hi:[1,0]
  v_rcp_f32 v32, v32
  v_rcp_f32 v33, v33
  v_rcp_f32 v34, v34
  v_rcp_f32 v35, v35
  v_rcp_f32 v36, v36
  v_rcp_f32 v37, v37
  v_rcp_f32 v38, v38
  v_rcp_f32 v39, v39
  v_rcp_f32 v40, v40
  v_rcp_f32 v41, v41
  v_rcp_f32 v42, v42
  v_rcp_f32 v43, v43
  v_rcp_f32 v44, v44
  v_rcp_f32 v45, v45
  v_rcp_f32 v46, v46
  v_rcp_f32 v47, v47
  v_pk_mul_f32 v[160:161], v[160:161], v[32:33]
  v_pk_mul_f32 v[162:163], v[162:163], v[34:35]
  v_pk_mul_f32 v[164:165], v[164:165], v[36:37]
  v_pk_mul_f32 v[166:167], v[166:167], v[38:39]
  v_pk_mul_f32 v[168:169], v[168:169], v[40:41]
  v_pk_mul_f32 v[170:171], v[170:171], v[42:43]
  v_pk_mul_f32 v[172:173], v[172:173], v[44:45]
  v_pk_mul_f32 v[174:175], v[174:175], v[46:47]
  v_cvt_pk_bf16_f32 v160, v160, v161
  v_cvt_pk_bf16_f32 v161, v162, v163
  v_cvt_pk_bf16_f32 v162, v164, v165
  v_cvt_pk_bf16_f32 v163, v166, v167
  v_cvt_pk_bf16_f32 v164, v168, v169
  v_cvt_pk_bf16_f32 v165, v170, v171
  v_cvt_pk_bf16_f32 v166, v172, v173
  v_cvt_pk_bf16_f32 v167, v174, v175
  v_permlane32_swap_b32 v128, v130
  v_permlane32_swap_b32 v129, v131
  v_permlane32_swap_b32 v132, v134
  v_permlane32_swap_b32 v133, v135
  s_add_u32 s56, s16, 0x0
  buffer_store_dwordx4 v[128:131], v17, s[4:7], s56 offen offset:0 sc1
  buffer_store_dwordx4 v[132:135], v17, s[4:7], s56 offen offset:1024 sc1
  v_pk_mul_f32 v[32:33], v[192:193], s[58:59]
  v_pk_mul_f32 v[34:35], v[194:195], s[58:59]
  v_pk_mul_f32 v[36:37], v[196:197], s[58:59]
  v_pk_mul_f32 v[38:39], v[198:199], s[58:59]
  v_pk_mul_f32 v[40:41], v[200:201], s[58:59]
  v_pk_mul_f32 v[42:43], v[202:203], s[58:59]
  v_pk_mul_f32 v[44:45], v[204:205], s[58:59]
  v_pk_mul_f32 v[46:47], v[206:207], s[58:59]
  v_exp_f32 v32, v32
  v_exp_f32 v33, v33
  v_exp_f32 v34, v34
  v_exp_f32 v35, v35
  v_exp_f32 v36, v36
  v_exp_f32 v37, v37
  v_exp_f32 v38, v38
  v_exp_f32 v39, v39
  v_exp_f32 v40, v40
  v_exp_f32 v41, v41
  v_exp_f32 v42, v42
  v_exp_f32 v43, v43
  v_exp_f32 v44, v44
  v_exp_f32 v45, v45
  v_exp_f32 v46, v46
  v_exp_f32 v47, v47
  v_pk_mul_f32 v[192:193], v[192:193], v[208:209]
  v_pk_mul_f32 v[194:195], v[194:195], v[210:211]
  v_pk_mul_f32 v[196:197], v[196:197], v[212:213]
  v_pk_mul_f32 v[198:199], v[198:199], v[214:215]
  v_pk_mul_f32 v[200:201], v[200:201], v[216:217]
  v_pk_mul_f32 v[202:203], v[202:203], v[218:219]
  v_pk_mul_f32 v[204:205], v[204:205], v[220:221]
  v_pk_mul_f32 v[206:207], v[206:207], v[222:223]
  v_pk_add_f32 v[32:33], v[32:33], 1.0 op_sel_hi:[1,0]
  v_pk_add_f32 v[34:35], v[34:35], 1.0 op_sel_hi:[1,0]
  v_pk_add_f32 v[36:37], v[36:37], 1.0 op_sel_hi:[1,0]
  v_pk_add_f32 v[38:39], v[38:39], 1.0 op_sel_hi:[1,0]
  v_pk_add_f32 v[40:41], v[40:41], 1.0 op_sel_hi:[1,0]
  v_pk_add_f32 v[42:43], v[42:43], 1.0 op_sel_hi:[1,0]
  v_pk_add_f32 v[44:45], v[44:45], 1.0 op_sel_hi:[1,0]
  v_pk_add_f32 v[46:47], v[46:47], 1.0 op_sel_hi:[1,0]
  v_rcp_f32 v32, v32
  v_rcp_f32 v33, v33
  v_rcp_f32 v34, v34
  v_rcp_f32 v35, v35
  v_rcp_f32 v36, v36
  v_rcp_f32 v37, v37
  v_rcp_f32 v38, v38
  v_rcp_f32 v39, v39
  v_rcp_f32 v40, v40
  v_rcp_f32 v41, v41
  v_rcp_f32 v42, v42
  v_rcp_f32 v43, v43
  v_rcp_f32 v44, v44
  v_rcp_f32 v45, v45
  v_rcp_f32 v46, v46
  v_rcp_f32 v47, v47
  v_pk_mul_f32 v[192:193], v[192:193], v[32:33]
  v_pk_mul_f32 v[194:195], v[194:195], v[34:35]
  v_pk_mul_f32 v[196:197], v[196:197], v[36:37]
  v_pk_mul_f32 v[198:199], v[198:199], v[38:39]
  v_pk_mul_f32 v[200:201], v[200:201], v[40:41]
  v_pk_mul_f32 v[202:203], v[202:203], v[42:43]
  v_pk_mul_f32 v[204:205], v[204:205], v[44:45]
  v_pk_mul_f32 v[206:207], v[206:207], v[46:47]
  v_cvt_pk_bf16_f32 v192, v192, v193
  v_cvt_pk_bf16_f32 v193, v194, v195
  v_cvt_pk_bf16_f32 v194, v196, v197
  v_cvt_pk_bf16_f32 v195, v198, v199
  v_cvt_pk_bf16_f32 v196, v200, v201
  v_cvt_pk_bf16_f32 v197, v202, v203
  v_cvt_pk_bf16_f32 v198, v204, v205
  v_cvt_pk_bf16_f32 v199, v206, v207
  v_permlane32_swap_b32 v160, v162
  v_permlane32_swap_b32 v161, v163
  v_permlane32_swap_b32 v164, v166
  v_permlane32_swap_b32 v165, v167
  s_add_u32 s56, s16, 0x38000
  buffer_store_dwordx4 v[160:163], v17, s[4:7], s56 offen offset:0 sc1
  buffer_store_dwordx4 v[164:167], v17, s[4:7], s56 offen offset:1024 sc1
  v_pk_mul_f32 v[32:33], v[224:225], s[58:59]
  v_pk_mul_f32 v[34:35], v[226:227], s[58:59]
  v_pk_mul_f32 v[36:37], v[228:229], s[58:59]
  v_pk_mul_f32 v[38:39], v[230:231], s[58:59]
  v_pk_mul_f32 v[40:41], v[232:233], s[58:59]
  v_pk_mul_f32 v[42:43], v[234:235], s[58:59]
  v_pk_mul_f32 v[44:45], v[236:237], s[58:59]
  v_pk_mul_f32 v[46:47], v[238:239], s[58:59]
  v_exp_f32 v32, v32
  v_exp_f32 v33, v33
  v_exp_f32 v34, v34
  v_exp_f32 v35, v35
  v_exp_f32 v36, v36
  v_exp_f32 v37, v37
  v_exp_f32 v38, v38
  v_exp_f32 v39, v39
  v_exp_f32 v40, v40
  v_exp_f32 v41, v41
  v_exp_f32 v42, v42
  v_exp_f32 v43, v43
  v_exp_f32 v44, v44
  v_exp_f32 v45, v45
  v_exp_f32 v46, v46
  v_exp_f32 v47, v47
  v_pk_mul_f32 v[224:225], v[224:225], v[240:241]
  v_pk_mul_f32 v[226:227], v[226:227], v[242:243]
  v_pk_mul_f32 v[228:229], v[228:229], v[244:245]
  v_pk_mul_f32 v[230:231], v[230:231], v[246:247]
  v_pk_mul_f32 v[232:233], v[232:233], v[248:249]
  v_pk_mul_f32 v[234:235], v[234:235], v[250:251]
  v_pk_mul_f32 v[236:237], v[236:237], v[252:253]
  v_pk_mul_f32 v[238:239], v[238:239], v[254:255]
  v_pk_add_f32 v[32:33], v[32:33], 1.0 op_sel_hi:[1,0]
  v_pk_add_f32 v[34:35], v[34:35], 1.0 op_sel_hi:[1,0]
  v_pk_add_f32 v[36:37], v[36:37], 1.0 op_sel_hi:[1,0]
  v_pk_add_f32 v[38:39], v[38:39], 1.0 op_sel_hi:[1,0]
  v_pk_add_f32 v[40:41], v[40:41], 1.0 op_sel_hi:[1,0]
  v_pk_add_f32 v[42:43], v[42:43], 1.0 op_sel_hi:[1,0]
  v_pk_add_f32 v[44:45], v[44:45], 1.0 op_sel_hi:[1,0]
  v_pk_add_f32 v[46:47], v[46:47], 1.0 op_sel_hi:[1,0]
  v_rcp_f32 v32, v32
  v_rcp_f32 v33, v33
  v_rcp_f32 v34, v34
  v_rcp_f32 v35, v35
  v_rcp_f32 v36, v36
  v_rcp_f32 v37, v37
  v_rcp_f32 v38, v38
  v_rcp_f32 v39, v39
  v_rcp_f32 v40, v40
  v_rcp_f32 v41, v41
  v_rcp_f32 v42, v42
  v_rcp_f32 v43, v43
  v_rcp_f32 v44, v44
  v_rcp_f32 v45, v45
  v_rcp_f32 v46, v46
  v_rcp_f32 v47, v47
  v_pk_mul_f32 v[224:225], v[224:225], v[32:33]
  v_pk_mul_f32 v[226:227], v[226:227], v[34:35]
  v_pk_mul_f32 v[228:229], v[228:229], v[36:37]
  v_pk_mul_f32 v[230:231], v[230:231], v[38:39]
  v_pk_mul_f32 v[232:233], v[232:233], v[40:41]
  v_pk_mul_f32 v[234:235], v[234:235], v[42:43]
  v_pk_mul_f32 v[236:237], v[236:237], v[44:45]
  v_pk_mul_f32 v[238:239], v[238:239], v[46:47]
  v_cvt_pk_bf16_f32 v224, v224, v225
  v_cvt_pk_bf16_f32 v225, v226, v227
  v_cvt_pk_bf16_f32 v226, v228, v229
  v_cvt_pk_bf16_f32 v227, v230, v231
  v_cvt_pk_bf16_f32 v228, v232, v233
  v_cvt_pk_bf16_f32 v229, v234, v235
  v_cvt_pk_bf16_f32 v230, v236, v237
  v_cvt_pk_bf16_f32 v231, v238, v239
  v_permlane32_swap_b32 v192, v194
  v_permlane32_swap_b32 v193, v195
  v_permlane32_swap_b32 v196, v198
  v_permlane32_swap_b32 v197, v199
  s_add_u32 s56, s16, 0x70000
  buffer_store_dwordx4 v[192:195], v17, s[4:7], s56 offen offset:0 sc1
  buffer_store_dwordx4 v[196:199], v17, s[4:7], s56 offen offset:1024 sc1
  v_permlane32_swap_b32 v224, v226
  v_permlane32_swap_b32 v225, v227
  v_permlane32_swap_b32 v228, v230
  v_permlane32_swap_b32 v229, v231
  s_add_u32 s56, s16, 0xa8000
  buffer_store_dwordx4 v[224:227], v17, s[4:7], s56 offen offset:0 sc1
  buffer_store_dwordx4 v[228:231], v17, s[4:7], s56 offen offset:1024 sc1
  s_branch .epiret
.edn_121:
  v_lshlrev_b32 v17, 4, v16
  v_cvt_pk_bf16_f32 v128, v128, v129
  v_cvt_pk_bf16_f32 v129, v130, v131
  v_cvt_pk_bf16_f32 v130, v132, v133
  v_cvt_pk_bf16_f32 v131, v134, v135
  v_cvt_pk_bf16_f32 v132, v136, v137
  v_cvt_pk_bf16_f32 v133, v138, v139
  v_cvt_pk_bf16_f32 v134, v140, v141
  v_cvt_pk_bf16_f32 v135, v142, v143
  s_add_u32 s56, s16, 0
  buffer_store_dwordx4 v[128:131], v17, s[4:7], s56 offen offset:0 sc1
  buffer_store_dwordx4 v[132:135], v17, s[4:7], s56 offen offset:1024 sc1
  v_cvt_pk_bf16_f32 v144, v144, v145
  v_cvt_pk_bf16_f32 v145, v146, v147
  v_cvt_pk_bf16_f32 v146, v148, v149
  v_cvt_pk_bf16_f32 v147, v150, v151
  v_cvt_pk_bf16_f32 v148, v152, v153
  v_cvt_pk_bf16_f32 v149, v154, v155
  v_cvt_pk_bf16_f32 v150, v156, v157
  v_cvt_pk_bf16_f32 v151, v158, v159
  buffer_store_dwordx4 v[144:147], v17, s[4:7], s56 offen offset:2048 sc1
  buffer_store_dwordx4 v[148:151], v17, s[4:7], s56 offen offset:3072 sc1
  v_cvt_pk_bf16_f32 v160, v160, v161
  v_cvt_pk_bf16_f32 v161, v162, v163
  v_cvt_pk_bf16_f32 v162, v164, v165
  v_cvt_pk_bf16_f32 v163, v166, v167
  v_cvt_pk_bf16_f32 v164, v168, v169
  v_cvt_pk_bf16_f32 v165, v170, v171
  v_cvt_pk_bf16_f32 v166, v172, v173
  v_cvt_pk_bf16_f32 v167, v174, v175
  s_add_u32 s56, s16, 4096
  buffer_store_dwordx4 v[160:163], v17, s[4:7], s56 offen offset:0 sc1
  buffer_store_dwordx4 v[164:167], v17, s[4:7], s56 offen offset:1024 sc1
  v_cvt_pk_bf16_f32 v176, v176, v177
  v_cvt_pk_bf16_f32 v177, v178, v179
  v_cvt_pk_bf16_f32 v178, v180, v181
  v_cvt_pk_bf16_f32 v179, v182, v183
  v_cvt_pk_bf16_f32 v180, v184, v185
  v_cvt_pk_bf16_f32 v181, v186, v187
  v_cvt_pk_bf16_f32 v182, v188, v189
  v_cvt_pk_bf16_f32 v183, v190, v191
  buffer_store_dwordx4 v[176:179], v17, s[4:7], s56 offen offset:2048 sc1
  buffer_store_dwordx4 v[180:183], v17, s[4:7], s56 offen offset:3072 sc1
  v_cvt_pk_bf16_f32 v192, v192, v193
  v_cvt_pk_bf16_f32 v193, v194, v195
  v_cvt_pk_bf16_f32 v194, v196, v197
  v_cvt_pk_bf16_f32 v195, v198, v199
  v_cvt_pk_bf16_f32 v196, v200, v201
  v_cvt_pk_bf16_f32 v197, v202, v203
  v_cvt_pk_bf16_f32 v198, v204, v205
  v_cvt_pk_bf16_f32 v199, v206, v207
  s_add_u32 s56, s16, 8192
  buffer_store_dwordx4 v[192:195], v17, s[4:7], s56 offen offset:0 sc1
  buffer_store_dwordx4 v[196:199], v17, s[4:7], s56 offen offset:1024 sc1
  v_cvt_pk_bf16_f32 v208, v208, v209
  v_cvt_pk_bf16_f32 v209, v210, v211
  v_cvt_pk_bf16_f32 v210, v212, v213
  v_cvt_pk_bf16_f32 v211, v214, v215
  v_cvt_pk_bf16_f32 v212, v216, v217
  v_cvt_pk_bf16_f32 v213, v218, v219
  v_cvt_pk_bf16_f32 v214, v220, v221
  v_cvt_pk_bf16_f32 v215, v222, v223
  buffer_store_dwordx4 v[208:211], v17, s[4:7], s56 offen offset:2048 sc1
  buffer_store_dwordx4 v[212:215], v17, s[4:7], s56 offen offset:3072 sc1
  v_cvt_pk_bf16_f32 v224, v224, v225
  v_cvt_pk_bf16_f32 v225, v226, v227
  v_cvt_pk_bf16_f32 v226, v228, v229
  v_cvt_pk_bf16_f32 v227, v230, v231
  v_cvt_pk_bf16_f32 v228, v232, v233
  v_cvt_pk_bf16_f32 v229, v234, v235
  v_cvt_pk_bf16_f32 v230, v236, v237
  v_cvt_pk_bf16_f32 v231, v238, v239
  s_add_u32 s56, s16, 12288
  buffer_store_dwordx4 v[224:227], v17, s[4:7], s56 offen offset:0 sc1
  buffer_store_dwordx4 v[228:231], v17, s[4:7], s56 offen offset:1024 sc1
  v_cvt_pk_bf16_f32 v240, v240, v241
  v_cvt_pk_bf16_f32 v241, v242, v243
  v_cvt_pk_bf16_f32 v242, v244, v245
  v_cvt_pk_bf16_f32 v243, v246, v247
  v_cvt_pk_bf16_f32 v244, v248, v249
  v_cvt_pk_bf16_f32 v245, v250, v251
  v_cvt_pk_bf16_f32 v246, v252, v253
  v_cvt_pk_bf16_f32 v247, v254, v255
  buffer_store_dwordx4 v[240:243], v17, s[4:7], s56 offen offset:2048 sc1
  buffer_store_dwordx4 v[244:247], v17, s[4:7], s56 offen offset:3072 sc1
  s_branch .done
.eop_122:
  s_cmp_lg_u32 s18, 0
  s_cbranch_scc1 .w0_125
  s_bitcmp1_b32 s3, 0
  s_cbranch_scc1 .ini_129
  v_mov_b32 v121, 0
.inl_130:
  buffer_load_dword v120, v121, s[8:11], 0 offen offset:20 sc1
  s_waitcnt vmcnt(0)
  v_readfirstlane_b32 s95, v120
  s_or_b32 s3, s3, s95
  s_bitcmp1_b32 s3, 0
  s_cbranch_scc1 .ini_129
  s_sleep 2
  s_sub_u32 s20, s20, 1
  s_cbranch_scc0 .inl_130
  v_mov_b32 v120, 0xdead
  v_mov_b32 v121, 0
  buffer_store_dword v120, v121, s[8:11], 0 offen offset:28 sc1
  s_mov_b32 s20, 0
  s_mov_b32 s94, 65535
  s_branch .dwo_126
.ini_129:
  s_lshl_b32 s96, s51, 7
  s_add_u32 s96, s96, 123738112
  v_mov_b32 v122, s96
  v_mov_b32 v123, 5
  v_mov_b32 v126, 0
.dwl_127:
  buffer_load_dword v124, v122, s[4:7], 0 offen sc1
  s_bitcmp1_b32 s3, 1
  s_cbranch_scc1 .dwn_131
  buffer_load_dword v125, v126, s[8:11], 0 offen offset:8 sc1
.dwn_131:
  s_waitcnt vmcnt(0)
  s_mov_b32 s94, 0
  v_cmp_lt_u32 vcc, v124, v123
  s_cbranch_vccz .dwo_126
  s_bitcmp1_b32 s3, 1
  s_cbranch_scc1 .dws_128
  v_readfirstlane_b32 s95, v125
  s_and_b32 s94, s95, 65791
  s_cmp_eq_u32 s94, 65
  s_cselect_b32 s94, 2, 0
  s_or_b32 s3, s3, s94
  s_bitcmp0_b32 s95, 16
  s_cbranch_scc1 .dws_128
  v_mov_b32 v120, 1
  v_mov_b32 v121, 0
  s_mov_b64 exec, 1
  buffer_atomic_add v120, v121, s[8:11], 0 offen offset:24 sc0 sc1
  s_mov_b64 exec, -1
  s_waitcnt vmcnt(0)
  v_readfirstlane_b32 s94, v120
  s_or_b32 s3, s3, 2
  s_cmp_ge_u32 s94, 64
  s_cbranch_scc1 .dws_128
  s_or_b32 s94, s94, 65536
  s_branch .dwo_126
.dws_128:
  s_sleep 4
  s_sub_u32 s20, s20, 1
  s_cbranch_scc0 .dwl_127
  v_mov_b32 v120, 0xdead
  v_mov_b32 v121, 0
  buffer_store_dword v120, v121, s[8:11], 0 offen offset:28 sc1
  s_mov_b32 s20, 0
  s_mov_b32 s94, 65535
  s_branch .dwo_126
.dwo_126:
  v_mov_b32 v120, s94
  v_mov_b32 v121, 163776
  ds_write_b32 v121, v120
  s_waitcnt lgkmcnt(0)
.w0_125:
  s_barrier
  v_mov_b32 v121, 163776
  ds_read_b32 v120, v121
  s_waitcnt lgkmcnt(0)
  v_readfirstlane_b32 s94, v120
  s_barrier
  s_cmp_lg_u32 s94, 0
  s_cbranch_scc1 .special
  s_lshl_b32 s58, s51, 2
  s_add_u32 s58, s58, s52
  s_lshl_b32 s58, s58, 2
  s_add_u32 s58, s58, s18
  s_lshl_b32 s58, s58, 14
  s_add_u32 s58, s58, 83886080
  s_lshl_b32 s59, s51, 9
  s_add_u32 s59, s59, 92274688
  s_mov_b32 s36, s88
  s_mov_b32 s37, s89
  s_mov_b32 s38, 0x400000
  s_mov_b32 s39, 0x20000
  v_lshlrev_b32 v18, 4, v16
  v_and_b32 v19, 31, v16
  v_lshlrev_b32 v19, 2, v19
  buffer_load_dword v24, v19, s[4:7], s59 offen offset:0 sc1
  buffer_load_dword v25, v19, s[4:7], s59 offen offset:128 sc1
  buffer_load_dword v26, v19, s[4:7], s59 offen offset:256 sc1
  buffer_load_dword v27, v19, s[4:7], s59 offen offset:384 sc1
  buffer_load_dwordx4 v[32:35], v18, s[4:7], s58 offen offset:0 sc1
  buffer_load_dwordx4 v[36:39], v18, s[4:7], s58 offen offset:1024 sc1
  buffer_load_dwordx4 v[40:43], v18, s[4:7], s58 offen offset:2048 sc1
  buffer_load_dwordx4 v[44:47], v18, s[4:7], s58 offen offset:3072 sc1
  s_add_u32 s58, s58, 4096
  buffer_load_dwordx4 v[48:51], v18, s[4:7], s58 offen offset:0 sc1
  buffer_load_dwordx4 v[52:55], v18, s[4:7], s58 offen offset:1024 sc1
  buffer_load_dwordx4 v[56:59], v18, s[4:7], s58 offen offset:2048 sc1
  buffer_load_dwordx4 v[60:63], v18, s[4:7], s58 offen offset:3072 sc1
  s_add_u32 s58, s58, 4096
  buffer_load_dwordx4 v[64:67], v18, s[4:7], s58 offen offset:0 sc1
  buffer_load_dwordx4 v[68:71], v18, s[4:7], s58 offen offset:1024 sc1
  buffer_load_dwordx4 v[72:75], v18, s[4:7], s58 offen offset:2048 sc1
  buffer_load_dwordx4 v[76:79], v18, s[4:7], s58 offen offset:3072 sc1
  s_add_u32 s58, s58, 4096
  buffer_load_dwordx4 v[80:83], v18, s[4:7], s58 offen offset:0 sc1
  buffer_load_dwordx4 v[84:87], v18, s[4:7], s58 offen offset:1024 sc1
  buffer_load_dwordx4 v[88:91], v18, s[4:7], s58 offen offset:2048 sc1
  buffer_load_dwordx4 v[92:95], v18, s[4:7], s58 offen offset:3072 sc1
  v_bfe_u32 v18, v16, 4, 1
  v_lshlrev_b32 v18, 5, v18
  v_lshrrev_b32 v19, 5, v16
  v_lshl_add_u32 v18, v19, 4, v18
  v_and_b32 v19, 15, v16
  v_lshl_add_u32 v17, v19, 11, v18
  s_waitcnt vmcnt(0)
  v_lshlrev_b32 v96, 16, v32
  v_and_b32 v97, 0xffff0000, v32
  v_lshlrev_b32 v98, 16, v33
  v_and_b32 v99, 0xffff0000, v33
  v_lshlrev_b32 v100, 16, v34
  v_and_b32 v101, 0xffff0000, v34
  v_lshlrev_b32 v102, 16, v35
  v_and_b32 v103, 0xffff0000, v35
  v_lshlrev_b32 v104, 16, v36
  v_and_b32 v105, 0xffff0000, v36
  v_lshlrev_b32 v106, 16, v37
  v_and_b32 v107, 0xffff0000, v37
  v_lshlrev_b32 v108, 16, v38
  v_and_b32 v109, 0xffff0000, v38
  v_lshlrev_b32 v110, 16, v39
  v_and_b32 v111, 0xffff0000, v39
  v_pk_add_f32 v[128:129], v[128:129], v[96:97] neg_lo:[0,1] neg_hi:[0,1]
  v_pk_add_f32 v[130:131], v[130:131], v[98:99] neg_lo:[0,1] neg_hi:[0,1]
  v_pk_add_f32 v[132:133], v[132:133], v[100:101] neg_lo:[0,1] neg_hi:[0,1]
  v_pk_add_f32 v[134:135], v[134:135], v[102:103] neg_lo:[0,1] neg_hi:[0,1]
  v_pk_add_f32 v[136:137], v[136:137], v[104:105] neg_lo:[0,1] neg_hi:[0,1]
  v_pk_add_f32 v[138:139], v[138:139], v[106:107] neg_lo:[0,1] neg_hi:[0,1]
  v_pk_add_f32 v[140:141], v[140:141], v[108:109] neg_lo:[0,1] neg_hi:[0,1]
  v_pk_add_f32 v[142:143], v[142:143], v[110:111] neg_lo:[0,1] neg_hi:[0,1]
  v_pk_fma_f32 v[128:129], v[128:129], v[24:25], v[96:97] op_sel_hi:[1,0,1]
  v_pk_fma_f32 v[130:131], v[130:131], v[24:25], v[98:99] op_sel_hi:[1,0,1]
  v_pk_fma_f32 v[132:133], v[132:133], v[24:25], v[100:101] op_sel_hi:[1,0,1]
  v_pk_fma_f32 v[134:135], v[134:135], v[24:25], v[102:103] op_sel_hi:[1,0,1]
  v_pk_fma_f32 v[136:137], v[136:137], v[24:25], v[104:105] op_sel_hi:[1,0,1]
  v_pk_fma_f32 v[138:139], v[138:139], v[24:25], v[106:107] op_sel_hi:[1,0,1]
  v_pk_fma_f32 v[140:141], v[140:141], v[24:25], v[108:109] op_sel_hi:[1,0,1]
  v_pk_fma_f32 v[142:143], v[142:143], v[24:25], v[110:111] op_sel_hi:[1,0,1]
  v_cvt_pk_bf16_f32 v128, v128, v129
  v_cvt_pk_bf16_f32 v129, v130, v131
  v_cvt_pk_bf16_f32 v130, v132, v133
  v_cvt_pk_bf16_f32 v131, v134, v135
  v_cvt_pk_bf16_f32 v132, v136, v137
  v_cvt_pk_bf16_f32 v133, v138, v139
  v_cvt_pk_bf16_f32 v134, v140, v141
  v_cvt_pk_bf16_f32 v135, v142, v143
  v_lshlrev_b32 v96, 16, v40
  v_and_b32 v97, 0xffff0000, v40
  v_lshlrev_b32 v98, 16, v41
  v_and_b32 v99, 0xffff0000, v41
  v_lshlrev_b32 v100, 16, v42
  v_and_b32 v101, 0xffff0000, v42
  v_lshlrev_b32 v102, 16, v43
  v_and_b32 v103, 0xffff0000, v43
  v_lshlrev_b32 v104, 16, v44
  v_and_b32 v105, 0xffff0000, v44
  v_lshlrev_b32 v106, 16, v45
  v_and_b32 v107, 0xffff0000, v45
  v_lshlrev_b32 v108, 16, v46
  v_and_b32 v109, 0xffff0000, v46
  v_lshlrev_b32 v110, 16, v47
  v_and_b32 v111, 0xffff0000, v47
  v_pk_add_f32 v[144:145], v[144:145], v[96:97] neg_lo:[0,1] neg_hi:[0,1]
  v_pk_add_f32 v[146:147], v[146:147], v[98:99] neg_lo:[0,1] neg_hi:[0,1]
  v_pk_add_f32 v[148:149], v[148:149], v[100:101] neg_lo:[0,1] neg_hi:[0,1]
  v_pk_add_f32 v[150:151], v[150:151], v[102:103] neg_lo:[0,1] neg_hi:[0,1]
  v_pk_add_f32 v[152:153], v[152:153], v[104:105] neg_lo:[0,1] neg_hi:[0,1]
  v_pk_add_f32 v[154:155], v[154:155], v[106:107] neg_lo:[0,1] neg_hi:[0,1]
  v_pk_add_f32 v[156:157], v[156:157], v[108:109] neg_lo:[0,1] neg_hi:[0,1]
  v_pk_add_f32 v[158:159], v[158:159], v[110:111] neg_lo:[0,1] neg_hi:[0,1]
  v_pk_fma_f32 v[144:145], v[144:145], v[24:25], v[96:97] op_sel_hi:[1,0,1]
  v_pk_fma_f32 v[146:147], v[146:147], v[24:25], v[98:99] op_sel_hi:[1,0,1]
  v_pk_fma_f32 v[148:149], v[148:149], v[24:25], v[100:101] op_sel_hi:[1,0,1]
  v_pk_fma_f32 v[150:151], v[150:151], v[24:25], v[102:103] op_sel_hi:[1,0,1]
  v_pk_fma_f32 v[152:153], v[152:153], v[24:25], v[104:105] op_sel_hi:[1,0,1]
  v_pk_fma_f32 v[154:155], v[154:155], v[24:25], v[106:107] op_sel_hi:[1,0,1]
  v_pk_fma_f32 v[156:157], v[156:157], v[24:25], v[108:109] op_sel_hi:[1,0,1]
  v_pk_fma_f32 v[158:159], v[158:159], v[24:25], v[110:111] op_sel_hi:[1,0,1]
  v_cvt_pk_bf16_f32 v144, v144, v145
  v_cvt_pk_bf16_f32 v145, v146, v147
  v_cvt_pk_bf16_f32 v146, v148, v149
  v_cvt_pk_bf16_f32 v147, v150, v151
  v_cvt_pk_bf16_f32 v148, v152, v153
  v_cvt_pk_bf16_f32 v149, v154, v155
  v_cvt_pk_bf16_f32 v150, v156, v157
  v_cvt_pk_bf16_f32 v151, v158, v159
  v_permlane32_swap_b32 v128, v130
  v_permlane32_swap_b32 v129, v131
  v_permlane32_swap_b32 v132, v134
  v_permlane32_swap_b32 v133, v135
  v_lshlrev_b32 v96, 16, v48
  v_and_b32 v97, 0xffff0000, v48
  v_lshlrev_b32 v98, 16, v49
  v_and_b32 v99, 0xffff0000, v49
  v_lshlrev_b32 v100, 16, v50
  v_and_b32 v101, 0xffff0000, v50
  v_lshlrev_b32 v102, 16, v51
  v_and_b32 v103, 0xffff0000, v51
  v_lshlrev_b32 v104, 16, v52
  v_and_b32 v105, 0xffff0000, v52
  v_lshlrev_b32 v106, 16, v53
  v_and_b32 v107, 0xffff0000, v53
  v_lshlrev_b32 v108, 16, v54
  v_and_b32 v109, 0xffff0000, v54
  v_lshlrev_b32 v110, 16, v55
  v_and_b32 v111, 0xffff0000, v55
  v_pk_add_f32 v[160:161], v[160:161], v[96:97] neg_lo:[0,1] neg_hi:[0,1]
  v_pk_add_f32 v[162:163], v[162:163], v[98:99] neg_lo:[0,1] neg_hi:[0,1]
  v_pk_add_f32 v[164:165], v[164:165], v[100:101] neg_lo:[0,1] neg_hi:[0,1]
  v_pk_add_f32 v[166:167], v[166:167], v[102:103] neg_lo:[0,1] neg_hi:[0,1]
  v_pk_add_f32 v[168:169], v[168:169], v[104:105] neg_lo:[0,1] neg_hi:[0,1]
  v_pk_add_f32 v[170:171], v[170:171], v[106:107] neg_lo:[0,1] neg_hi:[0,1]
  v_pk_add_f32 v[172:173], v[172:173], v[108:109] neg_lo:[0,1] neg_hi:[0,1]
  v_pk_add_f32 v[174:175], v[174:175], v[110:111] neg_lo:[0,1] neg_hi:[0,1]
  v_pk_fma_f32 v[160:161], v[160:161], v[24:25], v[96:97] op_sel:[0,1,0] op_sel_hi:[1,1,1]
  v_pk_fma_f32 v[162:163], v[162:163], v[24:25], v[98:99] op_sel:[0,1,0] op_sel_hi:[1,1,1]
  v_pk_fma_f32 v[164:165], v[164:165], v[24:25], v[100:101] op_sel:[0,1,0] op_sel_hi:[1,1,1]
  v_pk_fma_f32 v[166:167], v[166:167], v[24:25], v[102:103] op_sel:[0,1,0] op_sel_hi:[1,1,1]
  v_pk_fma_f32 v[168:169], v[168:169], v[24:25], v[104:105] op_sel:[0,1,0] op_sel_hi:[1,1,1]
  v_pk_fma_f32 v[170:171], v[170:171], v[24:25], v[106:107] op_sel:[0,1,0] op_sel_hi:[1,1,1]
  v_pk_fma_f32 v[172:173], v[172:173], v[24:25], v[108:109] op_sel:[0,1,0] op_sel_hi:[1,1,1]
  v_pk_fma_f32 v[174:175], v[174:175], v[24:25], v[110:111] op_sel:[0,1,0] op_sel_hi:[1,1,1]
  v_cvt_pk_bf16_f32 v160, v160, v161
  v_cvt_pk_bf16_f32 v161, v162, v163
  v_cvt_pk_bf16_f32 v162, v164, v165
  v_cvt_pk_bf16_f32 v163, v166, v167
  v_cvt_pk_bf16_f32 v164, v168, v169
  v_cvt_pk_bf16_f32 v165, v170, v171
  v_cvt_pk_bf16_f32 v166, v172, v173
  v_cvt_pk_bf16_f32 v167, v174, v175
  v_permlane16_swap_b32 v128, v132
  v_permlane16_swap_b32 v129, v133
  v_permlane16_swap_b32 v130, v134
  v_permlane16_swap_b32 v131, v135
  v_permlane32_swap_b32 v144, v146
  v_permlane32_swap_b32 v145, v147
  v_permlane32_swap_b32 v148, v150
  v_permlane32_swap_b32 v149, v151
  s_add_u32 s56, s16, 0x0
  s_add_u32 s57, s16, 0x8000
  buffer_store_dwordx4 v[128:131], v17, s[36:39], s56 offen
  buffer_store_dwordx4 v[132:135], v17, s[36:39], s57 offen
  v_lshlrev_b32 v96, 16, v56
  v_and_b32 v97, 0xffff0000, v56
  v_lshlrev_b32 v98, 16, v57
  v_and_b32 v99, 0xffff0000, v57
  v_lshlrev_b32 v100, 16, v58
  v_and_b32 v101, 0xffff0000, v58
  v_lshlrev_b32 v102, 16, v59
  v_and_b32 v103, 0xffff0000, v59
  v_lshlrev_b32 v104, 16, v60
  v_and_b32 v105, 0xffff0000, v60
  v_lshlrev_b32 v106, 16, v61
  v_and_b32 v107, 0xffff0000, v61
  v_lshlrev_b32 v108, 16, v62
  v_and_b32 v109, 0xffff0000, v62
  v_lshlrev_b32 v110, 16, v63
  v_and_b32 v111, 0xffff0000, v63
  v_pk_add_f32 v[176:177], v[176:177], v[96:97] neg_lo:[0,1] neg_hi:[0,1]
  v_pk_add_f32 v[178:179], v[178:179], v[98:99] neg_lo:[0,1] neg_hi:[0,1]
  v_pk_add_f32 v[180:181], v[180:181], v[100:101] neg_lo:[0,1] neg_hi:[0,1]
  v_pk_add_f32 v[182:183], v[182:183], v[102:103] neg_lo:[0,1] neg_hi:[0,1]
  v_pk_add_f32 v[184:185], v[184:185], v[104:105] neg_lo:[0,1] neg_hi:[0,1]
  v_pk_add_f32 v[186:187], v[186:187], v[106:107] neg_lo:[0,1] neg_hi:[0,1]
  v_pk_add_f32 v[188:189], v[188:189], v[108:109] neg_lo:[0,1] neg_hi:[0,1]
  v_pk_add_f32 v[190:191], v[190:191], v[110:111] neg_lo:[0,1] neg_hi:[0,1]
  v_pk_fma_f32 v[176:177], v[176:177], v[24:25], v[96:97] op_sel:[0,1,0] op_sel_hi:[1,1,1]
  v_pk_fma_f32 v[178:179], v[178:179], v[24:25], v[98:99] op_sel:[0,1,0] op_sel_hi:[1,1,1]
  v_pk_fma_f32 v[180:181], v[180:181], v[24:25], v[100:101] op_sel:[0,1,0] op_sel_hi:[1,1,1]
  v_pk_fma_f32 v[182:183], v[182:183], v[24:25], v[102:103] op_sel:[0,1,0] op_sel_hi:[1,1,1]
  v_pk_fma_f32 v[184:185], v[184:185], v[24:25], v[104:105] op_sel:[0,1,0] op_sel_hi:[1,1,1]
  v_pk_fma_f32 v[186:187], v[186:187], v[24:25], v[106:107] op_sel:[0,1,0] op_sel_hi:[1,1,1]
  v_pk_fma_f32 v[188:189], v[188:189], v[24:25], v[108:109] op_sel:[0,1,0] op_sel_hi:[1,1,1]
  v_pk_fma_f32 v[190:191], v[190:191], v[24:25], v[110:111] op_sel:[0,1,0] op_sel_hi:[1,1,1]
  v_cvt_pk_bf16_f32 v176, v176, v177
  v_cvt_pk_bf16_f32 v177, v178, v179
  v_cvt_pk_bf16_f32 v178, v180, v181
  v_cvt_pk_bf16_f32 v179, v182, v183
  v_cvt_pk_bf16_f32 v180, v184, v185
  v_cvt_pk_bf16_f32 v181, v186, v187
  v_cvt_pk_bf16_f32 v182, v188, v189
  v_cvt_pk_bf16_f32 v183, v190, v191
  v_permlane16_swap_b32 v144, v148
  v_permlane16_swap_b32 v145, v149
  v_permlane16_swap_b32 v146, v150
  v_permlane16_swap_b32 v147, v151
  v_permlane32_swap_b32 v160, v162
  v_permlane32_swap_b32 v161, v163
  v_permlane32_swap_b32 v164, v166
  v_permlane32_swap_b32 v165, v167
  s_add_u32 s56, s16, 0x100
  s_add_u32 s57, s16, 0x8100
  buffer_store_dwordx4 v[144:147], v17, s[36:39], s56 offen
  buffer_store_dwordx4 v[148:151], v17, s[36:39], s57 offen
  v_lshlrev_b32 v96, 16, v64
  v_and_b32 v97, 0xffff0000, v64
  v_lshlrev_b32 v98, 16, v65
  v_and_b32 v99, 0xffff0000, v65
  v_lshlrev_b32 v100, 16, v66
  v_and_b32 v101, 0xffff0000, v66
  v_lshlrev_b32 v102, 16, v67
  v_and_b32 v103, 0xffff0000, v67
  v_lshlrev_b32 v104, 16, v68
  v_and_b32 v105, 0xffff0000, v68
  v_lshlrev_b32 v106, 16, v69
  v_and_b32 v107, 0xffff0000, v69
  v_lshlrev_b32 v108, 16, v70
  v_and_b32 v109, 0xffff0000, v70
  v_lshlrev_b32 v110, 16, v71
  v_and_b32 v111, 0xffff0000, v71
  v_pk_add_f32 v[192:193], v[192:193], v[96:97] neg_lo:[0,1] neg_hi:[0,1]
  v_pk_add_f32 v[194:195], v[194:195], v[98:99] neg_lo:[0,1] neg_hi:[0,1]
  v_pk_add_f32 v[196:197], v[196:197], v[100:101] neg_lo:[0,1] neg_hi:[0,1]
  v_pk_add_f32 v[198:199], v[198:199], v[102:103] neg_lo:[0,1] neg_hi:[0,1]
  v_pk_add_f32 v[200:201], v[200:201], v[104:105] neg_lo:[0,1] neg_hi:[0,1]
  v_pk_add_f32 v[202:203], v[202:203], v[106:107] neg_lo:[0,1] neg_hi:[0,1]
  v_pk_add_f32 v[204:205], v[204:205], v[108:109] neg_lo:[0,1] neg_hi:[0,1]
  v_pk_add_f32 v[206:207], v[206:207], v[110:111] neg_lo:[0,1] neg_hi:[0,1]
  v_pk_fma_f32 v[192:193], v[192:193], v[26:27], v[96:97] op_sel_hi:[1,0,1]
  v_pk_fma_f32 v[194:195], v[194:195], v[26:27], v[98:99] op_sel_hi:[1,0,1]
  v_pk_fma_f32 v[196:197], v[196:197], v[26:27], v[100:101] op_sel_hi:[1,0,1]
  v_pk_fma_f32 v[198:199], v[198:199], v[26:27], v[102:103] op_sel_hi:[1,0,1]
  v_pk_fma_f32 v[200:201], v[200:201], v[26:27], v[104:105] op_sel_hi:[1,0,1]
  v_pk_fma_f32 v[202:203], v[202:203], v[26:27], v[106:107] op_sel_hi:[1,0,1]
  v_pk_fma_f32 v[204:205], v[204:205], v[26:27], v[108:109] op_sel_hi:[1,0,1]
  v_pk_fma_f32 v[206:207], v[206:207], v[26:27], v[110:111] op_sel_hi:[1,0,1]
  v_cvt_pk_bf16_f32 v192, v192, v193
  v_cvt_pk_bf16_f32 v193, v194, v195
  v_cvt_pk_bf16_f32 v194, v196, v197
  v_cvt_pk_bf16_f32 v195, v198, v199
  v_cvt_pk_bf16_f32 v196, v200, v201
  v_cvt_pk_bf16_f32 v197, v202, v203
  v_cvt_pk_bf16_f32 v198, v204, v205
  v_cvt_pk_bf16_f32 v199, v206, v207
  v_permlane16_swap_b32 v160, v164
  v_permlane16_swap_b32 v161, v165
  v_permlane16_swap_b32 v162, v166
  v_permlane16_swap_b32 v163, v167
  v_permlane32_swap_b32 v176, v178
  v_permlane32_swap_b32 v177, v179
  v_permlane32_swap_b32 v180, v182
  v_permlane32_swap_b32 v181, v183
  s_add_u32 s56, s16, 0x10000
  s_add_u32 s57, s16, 0x18000
  buffer_store_dwordx4 v[160:163], v17, s[36:39], s56 offen
  buffer_store_dwordx4 v[164:167], v17, s[36:39], s57 offen
  v_lshlrev_b32 v96, 16, v72
  v_and_b32 v97, 0xffff0000, v72
  v_lshlrev_b32 v98, 16, v73
  v_and_b32 v99, 0xffff0000, v73
  v_lshlrev_b32 v100, 16, v74
  v_and_b32 v101, 0xffff0000, v74
  v_lshlrev_b32 v102, 16, v75
  v_and_b32 v103, 0xffff0000, v75
  v_lshlrev_b32 v104, 16, v76
  v_and_b32 v105, 0xffff0000, v76
  v_lshlrev_b32 v106, 16, v77
  v_and_b32 v107, 0xffff0000, v77
  v_lshlrev_b32 v108, 16, v78
  v_and_b32 v109, 0xffff0000, v78
  v_lshlrev_b32 v110, 16, v79
  v_and_b32 v111, 0xffff0000, v79
  v_pk_add_f32 v[208:209], v[208:209], v[96:97] neg_lo:[0,1] neg_hi:[0,1]
  v_pk_add_f32 v[210:211], v[210:211], v[98:99] neg_lo:[0,1] neg_hi:[0,1]
  v_pk_add_f32 v[212:213], v[212:213], v[100:101] neg_lo:[0,1] neg_hi:[0,1]
  v_pk_add_f32 v[214:215], v[214:215], v[102:103] neg_lo:[0,1] neg_hi:[0,1]
  v_pk_add_f32 v[216:217], v[216:217], v[104:105] neg_lo:[0,1] neg_hi:[0,1]
  v_pk_add_f32 v[218:219], v[218:219], v[106:107] neg_lo:[0,1] neg_hi:[0,1]
  v_pk_add_f32 v[220:221], v[220:221], v[108:109] neg_lo:[0,1] neg_hi:[0,1]
  v_pk_add_f32 v[222:223], v[222:223], v[110:111] neg_lo:[0,1] neg_hi:[0,1]
  v_pk_fma_f32 v[208:209], v[208:209], v[26:27], v[96:97] op_sel_hi:[1,0,1]
  v_pk_fma_f32 v[210:211], v[210:211], v[26:27], v[98:99] op_sel_hi:[1,0,1]
  v_pk_fma_f32 v[212:213], v[212:213], v[26:27], v[100:101] op_sel_hi:[1,0,1]
  v_pk_fma_f32 v[214:215], v[214:215], v[26:27], v[102:103] op_sel_hi:[1,0,1]
  v_pk_fma_f32 v[216:217], v[216:217], v[26:27], v[104:105] op_sel_hi:[1,0,1]
  v_pk_fma_f32 v[218:219], v[218:219], v[26:27], v[106:107] op_sel_hi:[1,0,1]
  v_pk_fma_f32 v[220:221], v[220:221], v[26:27], v[108:109] op_sel_hi:[1,0,1]
  v_pk_fma_f32 v[222:223], v[222:223], v[26:27], v[110:111] op_sel_hi:[1,0,1]
  v_cvt_pk_bf16_f32 v208, v208, v209
  v_cvt_pk_bf16_f32 v209, v210, v211
  v_cvt_pk_bf16_f32 v210, v212, v213
  v_cvt_pk_bf16_f32 v211, v214, v215
  v_cvt_pk_bf16_f32 v212, v216, v217
  v_cvt_pk_bf16_f32 v213, v218, v219
  v_cvt_pk_bf16_f32 v214, v220, v221
  v_cvt_pk_bf16_f32 v215, v222, v223
  v_permlane16_swap_b32 v176, v180
  v_permlane16_swap_b32 v177, v181
  v_permlane16_swap_b32 v178, v182
  v_permlane16_swap_b32 v179, v183
  v_permlane32_swap_b32 v192, v194
  v_permlane32_swap_b32 v193, v195
  v_permlane32_swap_b32 v196, v198
  v_permlane32_swap_b32 v197, v199
  s_add_u32 s56, s16, 0x10100
  s_add_u32 s57, s16, 0x18100
  buffer_store_dwordx4 v[176:179], v17, s[36:39], s56 offen
  buffer_store_dwordx4 v[180:183], v17, s[36:39], s57 offen
  v_lshlrev_b32 v96, 16, v80
  v_and_b32 v97, 0xffff0000, v80
  v_lshlrev_b32 v98, 16, v81
  v_and_b32 v99, 0xffff0000, v81
  v_lshlrev_b32 v100, 16, v82
  v_and_b32 v101, 0xffff0000, v82
  v_lshlrev_b32 v102, 16, v83
  v_and_b32 v103, 0xffff0000, v83
  v_lshlrev_b32 v104, 16, v84
  v_and_b32 v105, 0xffff0000, v84
  v_lshlrev_b32 v106, 16, v85
  v_and_b32 v107, 0xffff0000, v85
  v_lshlrev_b32 v108, 16, v86
  v_and_b32 v109, 0xffff0000, v86
  v_lshlrev_b32 v110, 16, v87
  v_and_b32 v111, 0xffff0000, v87
  v_pk_add_f32 v[224:225], v[224:225], v[96:97] neg_lo:[0,1] neg_hi:[0,1]
  v_pk_add_f32 v[226:227], v[226:227], v[98:99] neg_lo:[0,1] neg_hi:[0,1]
  v_pk_add_f32 v[228:229], v[228:229], v[100:101] neg_lo:[0,1] neg_hi:[0,1]
  v_pk_add_f32 v[230:231], v[230:231], v[102:103] neg_lo:[0,1] neg_hi:[0,1]
  v_pk_add_f32 v[232:233], v[232:233], v[104:105] neg_lo:[0,1] neg_hi:[0,1]
  v_pk_add_f32 v[234:235], v[234:235], v[106:107] neg_lo:[0,1] neg_hi:[0,1]
  v_pk_add_f32 v[236:237], v[236:237], v[108:109] neg_lo:[0,1] neg_hi:[0,1]
  v_pk_add_f32 v[238:239], v[238:239], v[110:111] neg_lo:[0,1] neg_hi:[0,1]
  v_pk_fma_f32 v[224:225], v[224:225], v[26:27], v[96:97] op_sel:[0,1,0] op_sel_hi:[1,1,1]
  v_pk_fma_f32 v[226:227], v[226:227], v[26:27], v[98:99] op_sel:[0,1,0] op_sel_hi:[1,1,1]
  v_pk_fma_f32 v[228:229], v[228:229], v[26:27], v[100:101] op_sel:[0,1,0] op_sel_hi:[1,1,1]
  v_pk_fma_f32 v[230:231], v[230:231], v[26:27], v[102:103] op_sel:[0,1,0] op_sel_hi:[1,1,1]
  v_pk_fma_f32 v[232:233], v[232:233], v[26:27], v[104:105] op_sel:[0,1,0] op_sel_hi:[1,1,1]
  v_pk_fma_f32 v[234:235], v[234:235], v[26:27], v[106:107] op_sel:[0,1,0] op_sel_hi:[1,1,1]
  v_pk_fma_f32 v[236:237], v[236:237], v[26:27], v[108:109] op_sel:[0,1,0] op_sel_hi:[1,1,1]
  v_pk_fma_f32 v[238:239], v[238:239], v[26:27], v[110:111] op_sel:[0,1,0] op_sel_hi:[1,1,1]
  v_cvt_pk_bf16_f32 v224, v224, v225
  v_cvt_pk_bf16_f32 v225, v226, v227
  v_cvt_pk_bf16_f32 v226, v228, v229
  v_cvt_pk_bf16_f32 v227, v230, v231
  v_cvt_pk_bf16_f32 v228, v232, v233
  v_cvt_pk_bf16_f32 v229, v234, v235
  v_cvt_pk_bf16_f32 v230, v236, v237
  v_cvt_pk_bf16_f32 v231, v238, v239
  v_permlane16_swap_b32 v192, v196
  v_permlane16_swap_b32 v193, v197
  v_permlane16_swap_b32 v194, v198
  v_permlane16_swap_b32 v195, v199
  v_permlane32_swap_b32 v208, v210
  v_permlane32_swap_b32 v209, v211
  v_permlane32_swap_b32 v212, v214
  v_permlane32_swap_b32 v213, v215
  s_add_u32 s56, s16, 0x20000
  s_add_u32 s57, s16, 0x28000
  buffer_store_dwordx4 v[192:195], v17, s[36:39], s56 offen
  buffer_store_dwordx4 v[196:199], v17, s[36:39], s57 offen
  v_lshlrev_b32 v96, 16, v88
  v_and_b32 v97, 0xffff0000, v88
  v_lshlrev_b32 v98, 16, v89
  v_and_b32 v99, 0xffff0000, v89
  v_lshlrev_b32 v100, 16, v90
  v_and_b32 v101, 0xffff0000, v90
  v_lshlrev_b32 v102, 16, v91
  v_and_b32 v103, 0xffff0000, v91
  v_lshlrev_b32 v104, 16, v92
  v_and_b32 v105, 0xffff0000, v92
  v_lshlrev_b32 v106, 16, v93
  v_and_b32 v107, 0xffff0000, v93
  v_lshlrev_b32 v108, 16, v94
  v_and_b32 v109, 0xffff0000, v94
  v_lshlrev_b32 v110, 16, v95
  v_and_b32 v111, 0xffff0000, v95
  v_pk_add_f32 v[240:241], v[240:241], v[96:97] neg_lo:[0,1] neg_hi:[0,1]
  v_pk_add_f32 v[242:243], v[242:243], v[98:99] neg_lo:[0,1] neg_hi:[0,1]
  v_pk_add_f32 v[244:245], v[244:245], v[100:101] neg_lo:[0,1] neg_hi:[0,1]
  v_pk_add_f32 v[246:247], v[246:247], v[102:103] neg_lo:[0,1] neg_hi:[0,1]
  v_pk_add_f32 v[248:249], v[248:249], v[104:105] neg_lo:[0,1] neg_hi:[0,1]
  v_pk_add_f32 v[250:251], v[250:251], v[106:107] neg_lo:[0,1] neg_hi:[0,1]
  v_pk_add_f32 v[252:253], v[252:253], v[108:109] neg_lo:[0,1] neg_hi:[0,1]
  v_pk_add_f32 v[254:255], v[254:255], v[110:111] neg_lo:[0,1] neg_hi:[0,1]
  v_pk_fma_f32 v[240:241], v[240:241], v[26:27], v[96:97] op_sel:[0,1,0] op_sel_hi:[1,1,1]
  v_pk_fma_f32 v[242:243], v[242:243], v[26:27], v[98:99] op_sel:[0,1,0] op_sel_hi:[1,1,1]
  v_pk_fma_f32 v[244:245], v[244:245], v[26:27], v[100:101] op_sel:[0,1,0] op_sel_hi:[1,1,1]
  v_pk_fma_f32 v[246:247], v[246:247], v[26:27], v[102:103] op_sel:[0,1,0] op_sel_hi:[1,1,1]
  v_pk_fma_f32 v[248:249], v[248:249], v[26:27], v[104:105] op_sel:[0,1,0] op_sel_hi:[1,1,1]
  v_pk_fma_f32 v[250:251], v[250:251], v[26:27], v[106:107] op_sel:[0,1,0] op_sel_hi:[1,1,1]
  v_pk_fma_f32 v[252:253], v[252:253], v[26:27], v[108:109] op_sel:[0,1,0] op_sel_hi:[1,1,1]
  v_pk_fma_f32 v[254:255], v[254:255], v[26:27], v[110:111] op_sel:[0,1,0] op_sel_hi:[1,1,1]
  v_cvt_pk_bf16_f32 v240, v240, v241
  v_cvt_pk_bf16_f32 v241, v242, v243
  v_cvt_pk_bf16_f32 v242, v244, v245
  v_cvt_pk_bf16_f32 v243, v246, v247
  v_cvt_pk_bf16_f32 v244, v248, v249
  v_cvt_pk_bf16_f32 v245, v250, v251
  v_cvt_pk_bf16_f32 v246, v252, v253
  v_cvt_pk_bf16_f32 v247, v254, v255
  v_permlane16_swap_b32 v208, v212
  v_permlane16_swap_b32 v209, v213
  v_permlane16_swap_b32 v210, v214
  v_permlane16_swap_b32 v211, v215
  v_permlane32_swap_b32 v224, v226
  v_permlane32_swap_b32 v225, v227
  v_permlane32_swap_b32 v228, v230
  v_permlane32_swap_b32 v229, v231
  s_add_u32 s56, s16, 0x20100
  s_add_u32 s57, s16, 0x28100
  buffer_store_dwordx4 v[208:211], v17, s[36:39], s56 offen
  buffer_store_dwordx4 v[212:215], v17, s[36:39], s57 offen
  v_permlane16_swap_b32 v224, v228
  v_permlane16_swap_b32 v225, v229
  v_permlane16_swap_b32 v226, v230
  v_permlane16_swap_b32 v227, v231
  v_permlane32_swap_b32 v240, v242
  v_permlane32_swap_b32 v241, v243
  v_permlane32_swap_b32 v244, v246
  v_permlane32_swap_b32 v245, v247
  s_add_u32 s56, s16, 0x30000
  s_add_u32 s57, s16, 0x38000
  buffer_store_dwordx4 v[224:227], v17, s[36:39], s56 offen
  buffer_store_dwordx4 v[228:231], v17, s[36:39], s57 offen
  v_permlane16_swap_b32 v240, v244
  v_permlane16_swap_b32 v241, v245
  v_permlane16_swap_b32 v242, v246
  v_permlane16_swap_b32 v243, v247
  s_add_u32 s56, s16, 0x30100
  s_add_u32 s57, s16, 0x38100
  buffer_store_dwordx4 v[240:243], v17, s[36:39], s56 offen
  buffer_store_dwordx4 v[244:247], v17, s[36:39], s57 offen
  s_waitcnt vmcnt(0)
  s_branch .next
.done:
  s_waitcnt vmcnt(0)
  s_barrier
  s_cmp_lg_u32 s18, 0
  s_cbranch_scc1 .next
  s_bitcmp1_b32 s3, 0
  s_cbranch_scc1 .ini_132
  v_mov_b32 v121, 0
.inl_133:
  buffer_load_dword v120, v121, s[8:11], 0 offen offset:20 sc1
  s_waitcnt vmcnt(0)
  v_readfirstlane_b32 s95, v120
  s_or_b32 s3, s3, s95
  s_bitcmp1_b32 s3, 0
  s_cbranch_scc1 .ini_132
  s_sleep 2
  s_sub_u32 s20, s20, 1
  s_cbranch_scc0 .inl_133
  v_mov_b32 v120, 0xdead
  v_mov_b32 v121, 0
  buffer_store_dword v120, v121, s[8:11], 0 offen offset:28 sc1
  s_mov_b32 s20, 0
  s_mov_b32 s94, 65535
  s_branch .next
.ini_132:
  v_mov_b32 v120, 1
  v_mov_b32 v121, 0
  s_mov_b64 exec, 1
  buffer_atomic_add v120, v121, s[4:7], s54 offen sc1
  s_mov_b64 exec, -1
  s_branch .next
.chainp:
  s_mov_b32 s16, s2
  s_mov_b32 s17, s94
  v_mbcnt_lo_u32_b32 v16, -1, 0
  v_mbcnt_hi_u32_b32 v16, -1, v16
  v_lshrrev_b32 v17, 4, v16
  v_and_b32 v18, 15, v16
  v_lshrrev_b32 v19, 3, v18
  v_lshlrev_b32 v19, 9, v19
  v_lshl_add_u32 v19, v17, 7, v19
  v_and_b32 v20, 7, v16
  v_lshl_add_u32 v19, v20, 4, v19
  s_lshl_b32 s42, s18, 11
  s_add_u32 s42, s42, 131072
  v_add_u32 v0, s42, v19
  v_xor_b32 v1, 2048, v0
  v_xor_b32 v2, 4096, v0
  v_xor_b32 v3, 6144, v0
  v_lshlrev_b32 v19, 3, v16
  v_add_u32 v4, s42, v19
  s_lshl_b32 s45, s18, 15
  v_lshlrev_b32 v19, 4, v16
  v_add_u32 v5, s45, v19
  v_and_b32 v21, 1, v17
  v_lshlrev_b32 v21, 1, v21
  v_lshrrev_b32 v22, 1, v17
  v_add_u32 v21, v21, v22
  v_lshlrev_b32 v21, 13, v21
  v_lshl_add_u32 v21, v18, 4, v21
  s_lshl_b32 s42, s18, 16
  v_add_u32 v21, s42, v21
  s_lshl_b32 s43, s17, 8
  v_add_u32 v6, s43, v21
  v_lshrrev_b32 v21, 2, v16
  v_lshlrev_b32 v21, 8, v21
  v_and_b32 v22, 3, v16
  v_lshl_add_u32 v21, v22, 4, v21
  s_lshl_b32 s42, s17, 13
  s_lshl_b32 s43, s18, 6
  s_add_u32 s42, s42, s43
  v_add_u32 v7, s42, v21
  v_lshrrev_b32 v21, 3, v16
  v_lshlrev_b32 v21, 4, v21
  v_and_b32 v22, 2, v16
  v_lshl_add_u32 v21, v22, 1, v21
  s_lshl_b32 s42, s17, 8
  s_lshr_b32 s43, s18, 1
  s_lshl_b32 s43, s43, 7
  s_add_u32 s42, s42, s43
  s_and_b32 s43, s18, 1
  s_lshl_b32 s43, s43, 3
  s_add_u32 s42, s42, s43
  v_add_u32 v21, s42, v21
  v_and_b32 v22, 5, v16
  v_cmp_eq_u32 vcc, 0, v22
  v_bfrev_b32 v22, 1
  s_nop 0
  v_cndmask_b32 v8, v22, v21
  v_mov_b32 v21, 0x4444
  v_mov_b32 v22, 0xeeee
  v_cmp_lt_u32 vcc, 7, v18
  s_nop 1
  v_cndmask_b32 v9, v21, v22
  v_lshrrev_b32 v19, 1, v17
  v_lshlrev_b32 v19, 8, v19
  v_and_b32 v20, 1, v16
  v_lshl_add_u32 v19, v20, 7, v19
  v_and_b32 v20, 1, v17
  v_lshl_add_u32 v19, v20, 6, v19
  v_bfe_u32 v20, v16, 2, 2
  v_lshl_add_u32 v19, v20, 3, v19
  v_add_u32 v11, 139264, v19
  v_bfe_u32 v20, v16, 1, 1
  v_mul_u32_u24 v20, 544, v20
  v_add_u32 v19, v19, v20
  v_add_u32 v10, 155648, v19
  v_mov_b32 v12, 0x3f803f80
  v_mov_b32 v14, 0x3f003f00
  v_mov_b32 v13, 0x3f803f80
  v_mov_b32 v15, 0x3f003f00
  s_mov_b32 s40, 0x3e0293ee
  s_mov_b32 s41, 0x3e0293ee
  s_lshl_b32 s42, s16, 14
  s_add_u32 s23, s42, 122683392
  s_add_u32 s21, s42, 122552320
  s_add_u32 s24, s42, 122691584
  s_add_u32 s22, s42, 122560512
  s_lshl_b32 s37, s16, 5
  s_add_u32 s37, s37, s17
  s_lshl_b32 s37, s37, 7
  s_add_u32 s37, s37, 123752448
  s_lshl_b32 s42, s16, 18
  s_add_u32 s29, s42, 121634816
  s_add_u32 s31, s42, 121634816
  s_add_u32 s30, s42, 121667584
  s_add_u32 s32, s42, 121638912
  s_lshl_b32 s42, s17, 13
  s_add_u32 s33, s42, 33423360
  s_add_u32 s34, s42, 16646144
  s_add_u32 s36, s42, 100532224
  s_lshl_b32 s43, s16, 9
  s_add_u32 s36, s36, s43
  v_mov_b32 v32, 1
  v_mov_b32 v33, 1
  v_mov_b32 v34, 1
  v_mov_b32 v35, 1
  v_mov_b32 v36, -1
  s_lshl_b32 s42, s16, 5
  s_add_u32 s42, s42, s17
  s_lshl_b32 s42, s42, 15
  s_add_u32 s42, s42, 117309440
  buffer_store_dwordx4 v[32:35], v0, s[4:7], s42 offen sc1
  buffer_store_dwordx4 v[32:35], v0, s[4:7], s42 offen offset:1024 sc1
  s_add_u32 s42, s42, 8192
  buffer_store_dwordx4 v[32:35], v0, s[4:7], s42 offen sc1
  buffer_store_dwordx4 v[32:35], v0, s[4:7], s42 offen offset:1024 sc1
  s_add_u32 s42, s42, 8192
  buffer_store_dwordx4 v[32:35], v0, s[4:7], s42 offen sc1
  buffer_store_dwordx4 v[32:35], v0, s[4:7], s42 offen offset:1024 sc1
  s_add_u32 s42, s42, 8192
  buffer_store_dwordx4 v[32:35], v0, s[4:7], s42 offen sc1
  buffer_store_dwordx4 v[32:35], v0, s[4:7], s42 offen offset:1024 sc1
  buffer_store_dwordx4 v[32:35], v7, s[4:7], s31 offen sc1
  buffer_store_dwordx4 v[32:35], v7, s[4:7], s32 offen sc1
  buffer_store_dword v36, v8, s[4:7], s23 offen sc1
  buffer_store_dword v36, v8, s[4:7], s24 offen sc1
  v_lshrrev_b32 v19, 3, v16
  v_and_b32 v20, 7, v16
  v_lshlrev_b32 v21, 4, v20
  v_lshl_add_u32 v23, v19, 13, v21
  v_lshl_add_u32 v24, v19, 11, v21
  s_lshl_b32 s42, s16, 22
  s_lshl_b32 s43, s17, 8
  s_add_u32 s42, s42, s43
  s_lshr_b32 s43, s18, 1
  s_lshl_b32 s43, s43, 7
  s_add_u32 s42, s42, s43
  v_add_u32 v23, s42, v23
  s_lshl_b32 s42, s17, 18
  s_lshl_b32 s43, s16, 10
  s_add_u32 s42, s42, s43
  s_lshl_b32 s43, s18, 8
  s_add_u32 s42, s42, s43
  v_add_u32 v24, s42, v24
  v_and_b32 v20, 3, v16
  v_bfe_u32 v31, v16, 3, 1
  v_bfe_u32 v19, v16, 2, 1
  s_and_b32 s42, s18, 1
  s_lshl_b32 s42, s42, 6
  s_add_u32 s42, s42, s45
  v_lshl_add_u32 v22, v17, 2, v19
  v_lshlrev_b32 v22, 7, v22
  v_add_u32 v22, s42, v22
  v_mul_u32_u24 v25, 4128, v31
  v_lshl_add_u32 v25, v20, 3, v25
  v_add_u32 v25, v25, v22
  v_xor_b32 v26, 0x1000, v25
  v_xor_b32 v27, 0x8000, v25
  v_xor_b32 v28, 0x8000, v26
  v_and_b32 v21, 1, v17
  v_lshlrev_b32 v21, 4, v21
  v_lshrrev_b32 v22, 1, v17
  v_lshl_add_u32 v21, v22, 2, v21
  v_add_u32 v21, v21, v19
  v_lshlrev_b32 v21, 7, v21
  v_lshl_add_u32 v21, v31, 5, v21
  v_lshl_add_u32 v21, v20, 3, v21
  v_add_u32 v29, s45, v21
  v_and_b32 v19, 7, v16
  v_lshlrev_b32 v19, 11, v19
  v_lshl_add_u32 v19, v17, 4, v19
  v_lshl_add_u32 v19, v31, 6, v19
  s_lshl_b32 s42, s16, 10
  s_lshl_b32 s43, s18, 8
  s_add_u32 s42, s42, s43
  v_add_u32 v30, s42, v19
  s_mov_b32 s12, s68
  s_mov_b32 s13, s69
  s_mov_b32 s14, 0x800000
  s_mov_b32 s15, 0x20000
  s_xor_b32 s43, s18, 0
  s_lshl_b32 s43, s43, 20
  s_add_u32 s42, s43, 0x0
  s_add_u32 m0, s45, 0
  s_nop 0
  buffer_load_dwordx4 v23, s[12:15], s42 offen lds
  s_add_u32 s42, s43, 0x10000
  s_add_u32 m0, s45, 1024
  s_nop 0
  buffer_load_dwordx4 v23, s[12:15], s42 offen lds
  s_add_u32 s42, s43, 0x20000
  s_add_u32 m0, s45, 2048
  s_nop 0
  buffer_load_dwordx4 v23, s[12:15], s42 offen lds
  s_add_u32 s42, s43, 0x30000
  s_add_u32 m0, s45, 3072
  s_nop 0
  buffer_load_dwordx4 v23, s[12:15], s42 offen lds
  s_add_u32 s42, s43, 0x40000
  s_add_u32 m0, s45, 4096
  s_nop 0
  buffer_load_dwordx4 v23, s[12:15], s42 offen lds
  s_add_u32 s42, s43, 0x50000
  s_add_u32 m0, s45, 5120
  s_nop 0
  buffer_load_dwordx4 v23, s[12:15], s42 offen lds
  s_add_u32 s42, s43, 0x60000
  s_add_u32 m0, s45, 6144
  s_nop 0
  buffer_load_dwordx4 v23, s[12:15], s42 offen lds
  s_add_u32 s42, s43, 0x70000
  s_add_u32 m0, s45, 7168
  s_nop 0
  buffer_load_dwordx4 v23, s[12:15], s42 offen lds
  s_xor_b32 s43, s18, 0
  s_lshl_b32 s43, s43, 20
  s_add_u32 s42, s43, 0x80000
  s_add_u32 m0, s45, 8192
  s_nop 0
  buffer_load_dwordx4 v23, s[12:15], s42 offen lds
  s_add_u32 s42, s43, 0x90000
  s_add_u32 m0, s45, 9216
  s_nop 0
  buffer_load_dwordx4 v23, s[12:15], s42 offen lds
  s_add_u32 s42, s43, 0xa0000
  s_add_u32 m0, s45, 10240
  s_nop 0
  buffer_load_dwordx4 v23, s[12:15], s42 offen lds
  s_add_u32 s42, s43, 0xb0000
  s_add_u32 m0, s45, 11264
  s_nop 0
  buffer_load_dwordx4 v23, s[12:15], s42 offen lds
  s_add_u32 s42, s43, 0xc0000
  s_add_u32 m0, s45, 12288
  s_nop 0
  buffer_load_dwordx4 v23, s[12:15], s42 offen lds
  s_add_u32 s42, s43, 0xd0000
  s_add_u32 m0, s45, 13312
  s_nop 0
  buffer_load_dwordx4 v23, s[12:15], s42 offen lds
  s_add_u32 s42, s43, 0xe0000
  s_add_u32 m0, s45, 14336
  s_nop 0
  buffer_load_dwordx4 v23, s[12:15], s42 offen lds
  s_add_u32 s42, s43, 0xf0000
  s_add_u32 m0, s45, 15360
  s_nop 0
  buffer_load_dwordx4 v23, s[12:15], s42 offen lds
  s_xor_b32 s43, s18, 2
  s_lshl_b32 s43, s43, 20
  s_add_u32 s42, s43, 0x0
  s_add_u32 m0, s45, 16384
  s_nop 0
  buffer_load_dwordx4 v23, s[12:15], s42 offen lds
  s_add_u32 s42, s43, 0x10000
  s_add_u32 m0, s45, 17408
  s_nop 0
  buffer_load_dwordx4 v23, s[12:15], s42 offen lds
  s_add_u32 s42, s43, 0x20000
  s_add_u32 m0, s45, 18432
  s_nop 0
  buffer_load_dwordx4 v23, s[12:15], s42 offen lds
  s_add_u32 s42, s43, 0x30000
  s_add_u32 m0, s45, 19456
  s_nop 0
  buffer_load_dwordx4 v23, s[12:15], s42 offen lds
  s_add_u32 s42, s43, 0x40000
  s_add_u32 m0, s45, 20480
  s_nop 0
  buffer_load_dwordx4 v23, s[12:15], s42 offen lds
  s_add_u32 s42, s43, 0x50000
  s_add_u32 m0, s45, 21504
  s_nop 0
  buffer_load_dwordx4 v23, s[12:15], s42 offen lds
  s_add_u32 s42, s43, 0x60000
  s_add_u32 m0, s45, 22528
  s_nop 0
  buffer_load_dwordx4 v23, s[12:15], s42 offen lds
  s_add_u32 s42, s43, 0x70000
  s_add_u32 m0, s45, 23552
  s_nop 0
  buffer_load_dwordx4 v23, s[12:15], s42 offen lds
  s_xor_b32 s43, s18, 2
  s_lshl_b32 s43, s43, 20
  s_add_u32 s42, s43, 0x80000
  s_add_u32 m0, s45, 24576
  s_nop 0
  buffer_load_dwordx4 v23, s[12:15], s42 offen lds
  s_add_u32 s42, s43, 0x90000
  s_add_u32 m0, s45, 25600
  s_nop 0
  buffer_load_dwordx4 v23, s[12:15], s42 offen lds
  s_add_u32 s42, s43, 0xa0000
  s_add_u32 m0, s45, 26624
  s_nop 0
  buffer_load_dwordx4 v23, s[12:15], s42 offen lds
  s_add_u32 s42, s43, 0xb0000
  s_add_u32 m0, s45, 27648
  s_nop 0
  buffer_load_dwordx4 v23, s[12:15], s42 offen lds
  s_add_u32 s42, s43, 0xc0000
  s_add_u32 m0, s45, 28672
  s_nop 0
  buffer_load_dwordx4 v23, s[12:15], s42 offen lds
  s_add_u32 s42, s43, 0xd0000
  s_add_u32 m0, s45, 29696
  s_nop 0
  buffer_load_dwordx4 v23, s[12:15], s42 offen lds
  s_add_u32 s42, s43, 0xe0000
  s_add_u32 m0, s45, 30720
  s_nop 0
  buffer_load_dwordx4 v23, s[12:15], s42 offen lds
  s_add_u32 s42, s43, 0xf0000
  s_add_u32 m0, s45, 31744
  s_nop 0
  buffer_load_dwordx4 v23, s[12:15], s42 offen lds
  s_waitcnt vmcnt(24)
  s_barrier
  ds_read_b64_tr_b16 a[0:1], v25 offset:0
  ds_read_b64_tr_b16 a[2:3], v25 offset:256
  ds_read_b64_tr_b16 a[4:5], v25 offset:2048
  ds_read_b64_tr_b16 a[6:7], v25 offset:2304
  ds_read_b64_tr_b16 a[8:9], v26 offset:0
  ds_read_b64_tr_b16 a[10:11], v26 offset:256
  ds_read_b64_tr_b16 a[12:13], v26 offset:2048
  ds_read_b64_tr_b16 a[14:15], v26 offset:2304
  ds_read_b64_tr_b16 a[32:33], v27 offset:0
  ds_read_b64_tr_b16 a[34:35], v27 offset:256
  ds_read_b64_tr_b16 a[36:37], v27 offset:2048
  ds_read_b64_tr_b16 a[38:39], v27 offset:2304
  s_waitcnt lgkmcnt(4)
  ds_read_b64_tr_b16 a[40:41], v28 offset:0
  ds_read_b64_tr_b16 a[42:43], v28 offset:256
  ds_read_b64_tr_b16 a[44:45], v28 offset:2048
  ds_read_b64_tr_b16 a[46:47], v28 offset:2304
  s_waitcnt lgkmcnt(0)
  s_barrier
  s_mov_b32 s12, s70
  s_mov_b32 s13, s71
  s_mov_b32 s14, 0x800000
  s_mov_b32 s15, 0x20000
  s_xor_b32 s43, s18, 0
  s_lshl_b32 s43, s43, 20
  s_add_u32 s42, s43, 0x0
  s_add_u32 m0, s45, 0
  s_nop 0
  buffer_load_dwordx4 v23, s[12:15], s42 offen lds
  s_add_u32 s42, s43, 0x10000
  s_add_u32 m0, s45, 1024
  s_nop 0
  buffer_load_dwordx4 v23, s[12:15], s42 offen lds
  s_add_u32 s42, s43, 0x20000
  s_add_u32 m0, s45, 2048
  s_nop 0
  buffer_load_dwordx4 v23, s[12:15], s42 offen lds
  s_add_u32 s42, s43, 0x30000
  s_add_u32 m0, s45, 3072
  s_nop 0
  buffer_load_dwordx4 v23, s[12:15], s42 offen lds
  s_add_u32 s42, s43, 0x40000
  s_add_u32 m0, s45, 4096
  s_nop 0
  buffer_load_dwordx4 v23, s[12:15], s42 offen lds
  s_add_u32 s42, s43, 0x50000
  s_add_u32 m0, s45, 5120
  s_nop 0
  buffer_load_dwordx4 v23, s[12:15], s42 offen lds
  s_add_u32 s42, s43, 0x60000
  s_add_u32 m0, s45, 6144
  s_nop 0
  buffer_load_dwordx4 v23, s[12:15], s42 offen lds
  s_add_u32 s42, s43, 0x70000
  s_add_u32 m0, s45, 7168
  s_nop 0
  buffer_load_dwordx4 v23, s[12:15], s42 offen lds
  s_waitcnt vmcnt(24)
  s_barrier
  ds_read_b64_tr_b16 a[16:17], v25 offset:8192
  ds_read_b64_tr_b16 a[18:19], v25 offset:8448
  ds_read_b64_tr_b16 a[20:21], v25 offset:10240
  ds_read_b64_tr_b16 a[22:23], v25 offset:10496
  ds_read_b64_tr_b16 a[24:25], v26 offset:8192
  ds_read_b64_tr_b16 a[26:27], v26 offset:8448
  ds_read_b64_tr_b16 a[28:29], v26 offset:10240
  ds_read_b64_tr_b16 a[30:31], v26 offset:10496
  ds_read_b64_tr_b16 a[48:49], v27 offset:8192
  ds_read_b64_tr_b16 a[50:51], v27 offset:8448
  ds_read_b64_tr_b16 a[52:53], v27 offset:10240
  ds_read_b64_tr_b16 a[54:55], v27 offset:10496
  s_waitcnt lgkmcnt(4)
  ds_read_b64_tr_b16 a[56:57], v28 offset:8192
  ds_read_b64_tr_b16 a[58:59], v28 offset:8448
  ds_read_b64_tr_b16 a[60:61], v28 offset:10240
  ds_read_b64_tr_b16 a[62:63], v28 offset:10496
  s_waitcnt lgkmcnt(0)
  s_barrier
  s_xor_b32 s43, s18, 0
  s_lshl_b32 s43, s43, 20
  s_add_u32 s42, s43, 0x80000
  s_add_u32 m0, s45, 8192
  s_nop 0
  buffer_load_dwordx4 v23, s[12:15], s42 offen lds
  s_add_u32 s42, s43, 0x90000
  s_add_u32 m0, s45, 9216
  s_nop 0
  buffer_load_dwordx4 v23, s[12:15], s42 offen lds
  s_add_u32 s42, s43, 0xa0000
  s_add_u32 m0, s45, 10240
  s_nop 0
  buffer_load_dwordx4 v23, s[12:15], s42 offen lds
  s_add_u32 s42, s43, 0xb0000
  s_add_u32 m0, s45, 11264
  s_nop 0
  buffer_load_dwordx4 v23, s[12:15], s42 offen lds
  s_add_u32 s42, s43, 0xc0000
  s_add_u32 m0, s45, 12288
  s_nop 0
  buffer_load_dwordx4 v23, s[12:15], s42 offen lds
  s_add_u32 s42, s43, 0xd0000
  s_add_u32 m0, s45, 13312
  s_nop 0
  buffer_load_dwordx4 v23, s[12:15], s42 offen lds
  s_add_u32 s42, s43, 0xe0000
  s_add_u32 m0, s45, 14336
  s_nop 0
  buffer_load_dwordx4 v23, s[12:15], s42 offen lds
  s_add_u32 s42, s43, 0xf0000
  s_add_u32 m0, s45, 15360
  s_nop 0
  buffer_load_dwordx4 v23, s[12:15], s42 offen lds
  s_waitcnt vmcnt(24)
  s_barrier
  ds_read_b64_tr_b16 a[64:65], v25 offset:16384
  ds_read_b64_tr_b16 a[66:67], v25 offset:16640
  ds_read_b64_tr_b16 a[68:69], v25 offset:18432
  ds_read_b64_tr_b16 a[70:71], v25 offset:18688
  ds_read_b64_tr_b16 a[72:73], v26 offset:16384
  ds_read_b64_tr_b16 a[74:75], v26 offset:16640
  ds_read_b64_tr_b16 a[76:77], v26 offset:18432
  ds_read_b64_tr_b16 a[78:79], v26 offset:18688
  ds_read_b64_tr_b16 a[96:97], v27 offset:16384
  ds_read_b64_tr_b16 a[98:99], v27 offset:16640
  ds_read_b64_tr_b16 a[100:101], v27 offset:18432
  ds_read_b64_tr_b16 a[102:103], v27 offset:18688
  s_waitcnt lgkmcnt(4)
  ds_read_b64_tr_b16 a[104:105], v28 offset:16384
  ds_read_b64_tr_b16 a[106:107], v28 offset:16640
  ds_read_b64_tr_b16 a[108:109], v28 offset:18432
  ds_read_b64_tr_b16 a[110:111], v28 offset:18688
  s_waitcnt lgkmcnt(0)
  s_barrier
  s_xor_b32 s43, s18, 2
  s_lshl_b32 s43, s43, 20
  s_add_u32 s42, s43, 0x0
  s_add_u32 m0, s45, 16384
  s_nop 0
  buffer_load_dwordx4 v23, s[12:15], s42 offen lds
  s_add_u32 s42, s43, 0x10000
  s_add_u32 m0, s45, 17408
  s_nop 0
  buffer_load_dwordx4 v23, s[12:15], s42 offen lds
  s_add_u32 s42, s43, 0x20000
  s_add_u32 m0, s45, 18432
  s_nop 0
  buffer_load_dwordx4 v23, s[12:15], s42 offen lds
  s_add_u32 s42, s43, 0x30000
  s_add_u32 m0, s45, 19456
  s_nop 0
  buffer_load_dwordx4 v23, s[12:15], s42 offen lds
  s_add_u32 s42, s43, 0x40000
  s_add_u32 m0, s45, 20480
  s_nop 0
  buffer_load_dwordx4 v23, s[12:15], s42 offen lds
  s_add_u32 s42, s43, 0x50000
  s_add_u32 m0, s45, 21504
  s_nop 0
  buffer_load_dwordx4 v23, s[12:15], s42 offen lds
  s_add_u32 s42, s43, 0x60000
  s_add_u32 m0, s45, 22528
  s_nop 0
  buffer_load_dwordx4 v23, s[12:15], s42 offen lds
  s_add_u32 s42, s43, 0x70000
  s_add_u32 m0, s45, 23552
  s_nop 0
  buffer_load_dwordx4 v23, s[12:15], s42 offen lds
  s_waitcnt vmcnt(24)
  s_barrier
  ds_read_b64_tr_b16 a[80:81], v25 offset:24576
  ds_read_b64_tr_b16 a[82:83], v25 offset:24832
  ds_read_b64_tr_b16 a[84:85], v25 offset:26624
  ds_read_b64_tr_b16 a[86:87], v25 offset:26880
  ds_read_b64_tr_b16 a[88:89], v26 offset:24576
  ds_read_b64_tr_b16 a[90:91], v26 offset:24832
  ds_read_b64_tr_b16 a[92:93], v26 offset:26624
  ds_read_b64_tr_b16 a[94:95], v26 offset:26880
  ds_read_b64_tr_b16 a[112:113], v27 offset:24576
  ds_read_b64_tr_b16 a[114:115], v27 offset:24832
  ds_read_b64_tr_b16 a[116:117], v27 offset:26624
  ds_read_b64_tr_b16 a[118:119], v27 offset:26880
  s_waitcnt lgkmcnt(4)
  ds_read_b64_tr_b16 a[120:121], v28 offset:24576
  ds_read_b64_tr_b16 a[122:123], v28 offset:24832
  ds_read_b64_tr_b16 a[124:125], v28 offset:26624
  ds_read_b64_tr_b16 a[126:127], v28 offset:26880
  s_waitcnt lgkmcnt(0)
  s_barrier
  s_xor_b32 s43, s18, 2
  s_lshl_b32 s43, s43, 20
  s_add_u32 s42, s43, 0x80000
  s_add_u32 m0, s45, 24576
  s_nop 0
  buffer_load_dwordx4 v23, s[12:15], s42 offen lds
  s_add_u32 s42, s43, 0x90000
  s_add_u32 m0, s45, 25600
  s_nop 0
  buffer_load_dwordx4 v23, s[12:15], s42 offen lds
  s_add_u32 s42, s43, 0xa0000
  s_add_u32 m0, s45, 26624
  s_nop 0
  buffer_load_dwordx4 v23, s[12:15], s42 offen lds
  s_add_u32 s42, s43, 0xb0000
  s_add_u32 m0, s45, 27648
  s_nop 0
  buffer_load_dwordx4 v23, s[12:15], s42 offen lds
  s_add_u32 s42, s43, 0xc0000
  s_add_u32 m0, s45, 28672
  s_nop 0
  buffer_load_dwordx4 v23, s[12:15], s42 offen lds
  s_add_u32 s42, s43, 0xd0000
  s_add_u32 m0, s45, 29696
  s_nop 0
  buffer_load_dwordx4 v23, s[12:15], s42 offen lds
  s_add_u32 s42, s43, 0xe0000
  s_add_u32 m0, s45, 30720
  s_nop 0
  buffer_load_dwordx4 v23, s[12:15], s42 offen lds
  s_add_u32 s42, s43, 0xf0000
  s_add_u32 m0, s45, 31744
  s_nop 0
  buffer_load_dwordx4 v23, s[12:15], s42 offen lds
  s_waitcnt vmcnt(24)
  s_barrier
  ds_read_b64_tr_b16 a[128:129], v25 offset:0
  ds_read_b64_tr_b16 a[130:131], v25 offset:256
  ds_read_b64_tr_b16 a[132:133], v25 offset:2048
  ds_read_b64_tr_b16 a[134:135], v25 offset:2304
  ds_read_b64_tr_b16 a[136:137], v26 offset:0
  ds_read_b64_tr_b16 a[138:139], v26 offset:256
  ds_read_b64_tr_b16 a[140:141], v26 offset:2048
  ds_read_b64_tr_b16 a[142:143], v26 offset:2304
  ds_read_b64_tr_b16 a[160:161], v27 offset:0
  ds_read_b64_tr_b16 a[162:163], v27 offset:256
  ds_read_b64_tr_b16 a[164:165], v27 offset:2048
  ds_read_b64_tr_b16 a[166:167], v27 offset:2304
  s_waitcnt lgkmcnt(4)
  ds_read_b64_tr_b16 a[168:169], v28 offset:0
  ds_read_b64_tr_b16 a[170:171], v28 offset:256
  ds_read_b64_tr_b16 a[172:173], v28 offset:2048
  ds_read_b64_tr_b16 a[174:175], v28 offset:2304
  s_waitcnt lgkmcnt(0)
  s_barrier
  s_mov_b32 s12, s72
  s_mov_b32 s13, s73
  s_mov_b32 s14, 0x800000
  s_mov_b32 s15, 0x20000
  s_xor_b32 s43, s18, 0
  s_lshl_b32 s43, s43, 20
  s_add_u32 s42, s43, 0x0
  s_add_u32 m0, s45, 0
  s_nop 0
  buffer_load_dwordx4 v23, s[12:15], s42 offen lds
  s_add_u32 s42, s43, 0x10000
  s_add_u32 m0, s45, 1024
  s_nop 0
  buffer_load_dwordx4 v23, s[12:15], s42 offen lds
  s_add_u32 s42, s43, 0x20000
  s_add_u32 m0, s45, 2048
  s_nop 0
  buffer_load_dwordx4 v23, s[12:15], s42 offen lds
  s_add_u32 s42, s43, 0x30000
  s_add_u32 m0, s45, 3072
  s_nop 0
  buffer_load_dwordx4 v23, s[12:15], s42 offen lds
  s_add_u32 s42, s43, 0x40000
  s_add_u32 m0, s45, 4096
  s_nop 0
  buffer_load_dwordx4 v23, s[12:15], s42 offen lds
  s_add_u32 s42, s43, 0x50000
  s_add_u32 m0, s45, 5120
  s_nop 0
  buffer_load_dwordx4 v23, s[12:15], s42 offen lds
  s_add_u32 s42, s43, 0x60000
  s_add_u32 m0, s45, 6144
  s_nop 0
  buffer_load_dwordx4 v23, s[12:15], s42 offen lds
  s_add_u32 s42, s43, 0x70000
  s_add_u32 m0, s45, 7168
  s_nop 0
  buffer_load_dwordx4 v23, s[12:15], s42 offen lds
  s_waitcnt vmcnt(24)
  s_barrier
  ds_read_b64_tr_b16 a[144:145], v25 offset:8192
  ds_read_b64_tr_b16 a[146:147], v25 offset:8448
  ds_read_b64_tr_b16 a[148:149], v25 offset:10240
  ds_read_b64_tr_b16 a[150:151], v25 offset:10496
  ds_read_b64_tr_b16 a[152:153], v26 offset:8192
  ds_read_b64_tr_b16 a[154:155], v26 offset:8448
  ds_read_b64_tr_b16 a[156:157], v26 offset:10240
  ds_read_b64_tr_b16 a[158:159], v26 offset:10496
  ds_read_b64_tr_b16 a[176:177], v27 offset:8192
  ds_read_b64_tr_b16 a[178:179], v27 offset:8448
  ds_read_b64_tr_b16 a[180:181], v27 offset:10240
  ds_read_b64_tr_b16 a[182:183], v27 offset:10496
  s_waitcnt lgkmcnt(4)
  ds_read_b64_tr_b16 a[184:185], v28 offset:8192
  ds_read_b64_tr_b16 a[186:187], v28 offset:8448
  ds_read_b64_tr_b16 a[188:189], v28 offset:10240
  ds_read_b64_tr_b16 a[190:191], v28 offset:10496
  s_waitcnt lgkmcnt(0)
  s_barrier
  s_xor_b32 s43, s18, 0
  s_lshl_b32 s43, s43, 20
  s_add_u32 s42, s43, 0x80000
  s_add_u32 m0, s45, 8192
  s_nop 0
  buffer_load_dwordx4 v23, s[12:15], s42 offen lds
  s_add_u32 s42, s43, 0x90000
  s_add_u32 m0, s45, 9216
  s_nop 0
  buffer_load_dwordx4 v23, s[12:15], s42 offen lds
  s_add_u32 s42, s43, 0xa0000
  s_add_u32 m0, s45, 10240
  s_nop 0
  buffer_load_dwordx4 v23, s[12:15], s42 offen lds
  s_add_u32 s42, s43, 0xb0000
  s_add_u32 m0, s45, 11264
  s_nop 0
  buffer_load_dwordx4 v23, s[12:15], s42 offen lds
  s_add_u32 s42, s43, 0xc0000
  s_add_u32 m0, s45, 12288
  s_nop 0
  buffer_load_dwordx4 v23, s[12:15], s42 offen lds
  s_add_u32 s42, s43, 0xd0000
  s_add_u32 m0, s45, 13312
  s_nop 0
  buffer_load_dwordx4 v23, s[12:15], s42 offen lds
  s_add_u32 s42, s43, 0xe0000
  s_add_u32 m0, s45, 14336
  s_nop 0
  buffer_load_dwordx4 v23, s[12:15], s42 offen lds
  s_add_u32 s42, s43, 0xf0000
  s_add_u32 m0, s45, 15360
  s_nop 0
  buffer_load_dwordx4 v23, s[12:15], s42 offen lds
  s_waitcnt vmcnt(24)
  s_barrier
  ds_read_b64_tr_b16 a[192:193], v25 offset:16384
  ds_read_b64_tr_b16 a[194:195], v25 offset:16640
  ds_read_b64_tr_b16 a[196:197], v25 offset:18432
  ds_read_b64_tr_b16 a[198:199], v25 offset:18688
  ds_read_b64_tr_b16 a[200:201], v26 offset:16384
  ds_read_b64_tr_b16 a[202:203], v26 offset:16640
  ds_read_b64_tr_b16 a[204:205], v26 offset:18432
  ds_read_b64_tr_b16 a[206:207], v26 offset:18688
  ds_read_b64_tr_b16 a[224:225], v27 offset:16384
  ds_read_b64_tr_b16 a[226:227], v27 offset:16640
  ds_read_b64_tr_b16 a[228:229], v27 offset:18432
  ds_read_b64_tr_b16 a[230:231], v27 offset:18688
  s_waitcnt lgkmcnt(4)
  ds_read_b64_tr_b16 a[232:233], v28 offset:16384
  ds_read_b64_tr_b16 a[234:235], v28 offset:16640
  ds_read_b64_tr_b16 a[236:237], v28 offset:18432
  ds_read_b64_tr_b16 a[238:239], v28 offset:18688
  s_waitcnt lgkmcnt(0)
  s_barrier
  s_mov_b32 s12, s74
  s_mov_b32 s13, s75
  s_mov_b32 s14, 0x800000
  s_mov_b32 s15, 0x20000
  s_xor_b32 s43, s18, 0
  s_lshl_b32 s43, s43, 16
  s_add_u32 s42, s43, 0x0
  s_add_u32 m0, s45, 16384
  s_nop 0
  buffer_load_dwordx4 v24, s[12:15], s42 offen lds
  s_add_u32 s42, s43, 0x4000
  s_add_u32 m0, s45, 17408
  s_nop 0
  buffer_load_dwordx4 v24, s[12:15], s42 offen lds
  s_add_u32 s42, s43, 0x8000
  s_add_u32 m0, s45, 18432
  s_nop 0
  buffer_load_dwordx4 v24, s[12:15], s42 offen lds
  s_add_u32 s42, s43, 0xc000
  s_add_u32 m0, s45, 19456
  s_nop 0
  buffer_load_dwordx4 v24, s[12:15], s42 offen lds
  s_xor_b32 s43, s18, 1
  s_lshl_b32 s43, s43, 16
  s_add_u32 s42, s43, 0x0
  s_add_u32 m0, s45, 20480
  s_nop 0
  buffer_load_dwordx4 v24, s[12:15], s42 offen lds
  s_add_u32 s42, s43, 0x4000
  s_add_u32 m0, s45, 21504
  s_nop 0
  buffer_load_dwordx4 v24, s[12:15], s42 offen lds
  s_add_u32 s42, s43, 0x8000
  s_add_u32 m0, s45, 22528
  s_nop 0
  buffer_load_dwordx4 v24, s[12:15], s42 offen lds
  s_add_u32 s42, s43, 0xc000
  s_add_u32 m0, s45, 23552
  s_nop 0
  buffer_load_dwordx4 v24, s[12:15], s42 offen lds
  s_waitcnt vmcnt(24)
  s_barrier
  ds_read_b64_tr_b16 a[208:209], v25 offset:24576
  ds_read_b64_tr_b16 a[210:211], v25 offset:24832
  ds_read_b64_tr_b16 a[212:213], v25 offset:26624
  ds_read_b64_tr_b16 a[214:215], v25 offset:26880
  ds_read_b64_tr_b16 a[216:217], v26 offset:24576
  ds_read_b64_tr_b16 a[218:219], v26 offset:24832
  ds_read_b64_tr_b16 a[220:221], v26 offset:26624
  ds_read_b64_tr_b16 a[222:223], v26 offset:26880
  ds_read_b64_tr_b16 a[240:241], v27 offset:24576
  ds_read_b64_tr_b16 a[242:243], v27 offset:24832
  ds_read_b64_tr_b16 a[244:245], v27 offset:26624
  ds_read_b64_tr_b16 a[246:247], v27 offset:26880
  s_waitcnt lgkmcnt(4)
  ds_read_b64_tr_b16 a[248:249], v28 offset:24576
  ds_read_b64_tr_b16 a[250:251], v28 offset:24832
  ds_read_b64_tr_b16 a[252:253], v28 offset:26624
  ds_read_b64_tr_b16 a[254:255], v28 offset:26880
  s_waitcnt lgkmcnt(0)
  s_barrier
  s_xor_b32 s43, s18, 2
  s_lshl_b32 s43, s43, 16
  s_add_u32 s42, s43, 0x0
  s_add_u32 m0, s45, 24576
  s_nop 0
  buffer_load_dwordx4 v24, s[12:15], s42 offen lds
  s_add_u32 s42, s43, 0x4000
  s_add_u32 m0, s45, 25600
  s_nop 0
  buffer_load_dwordx4 v24, s[12:15], s42 offen lds
  s_add_u32 s42, s43, 0x8000
  s_add_u32 m0, s45, 26624
  s_nop 0
  buffer_load_dwordx4 v24, s[12:15], s42 offen lds
  s_add_u32 s42, s43, 0xc000
  s_add_u32 m0, s45, 27648
  s_nop 0
  buffer_load_dwordx4 v24, s[12:15], s42 offen lds
  s_xor_b32 s43, s18, 3
  s_lshl_b32 s43, s43, 16
  s_add_u32 s42, s43, 0x0
  s_add_u32 m0, s45, 28672
  s_nop 0
  buffer_load_dwordx4 v24, s[12:15], s42 offen lds
  s_add_u32 s42, s43, 0x4000
  s_add_u32 m0, s45, 29696
  s_nop 0
  buffer_load_dwordx4 v24, s[12:15], s42 offen lds
  s_add_u32 s42, s43, 0x8000
  s_add_u32 m0, s45, 30720
  s_nop 0
  buffer_load_dwordx4 v24, s[12:15], s42 offen lds
  s_add_u32 s42, s43, 0xc000
  s_add_u32 m0, s45, 31744
  s_nop 0
  buffer_load_dwordx4 v24, s[12:15], s42 offen lds
  s_waitcnt vmcnt(24)
  s_barrier
  ds_read_b64_tr_b16 v[128:129], v25 offset:0
  ds_read_b64_tr_b16 v[130:131], v25 offset:256
  ds_read_b64_tr_b16 v[132:133], v25 offset:2048
  ds_read_b64_tr_b16 v[134:135], v25 offset:2304
  ds_read_b64_tr_b16 v[136:137], v26 offset:0
  ds_read_b64_tr_b16 v[138:139], v26 offset:256
  ds_read_b64_tr_b16 v[140:141], v26 offset:2048
  ds_read_b64_tr_b16 v[142:143], v26 offset:2304
  ds_read_b64_tr_b16 v[160:161], v27 offset:0
  ds_read_b64_tr_b16 v[162:163], v27 offset:256
  ds_read_b64_tr_b16 v[164:165], v27 offset:2048
  ds_read_b64_tr_b16 v[166:167], v27 offset:2304
  s_waitcnt lgkmcnt(4)
  ds_read_b64_tr_b16 v[168:169], v28 offset:0
  ds_read_b64_tr_b16 v[170:171], v28 offset:256
  ds_read_b64_tr_b16 v[172:173], v28 offset:2048
  ds_read_b64_tr_b16 v[174:175], v28 offset:2304
  s_waitcnt lgkmcnt(0)
  s_barrier
  s_xor_b32 s43, s18, 0
  s_lshl_b32 s43, s43, 16
  s_add_u32 s42, s43, 0x80
  s_add_u32 m0, s45, 0
  s_nop 0
  buffer_load_dwordx4 v24, s[12:15], s42 offen lds
  s_add_u32 s42, s43, 0x4080
  s_add_u32 m0, s45, 1024
  s_nop 0
  buffer_load_dwordx4 v24, s[12:15], s42 offen lds
  s_add_u32 s42, s43, 0x8080
  s_add_u32 m0, s45, 2048
  s_nop 0
  buffer_load_dwordx4 v24, s[12:15], s42 offen lds
  s_add_u32 s42, s43, 0xc080
  s_add_u32 m0, s45, 3072
  s_nop 0
  buffer_load_dwordx4 v24, s[12:15], s42 offen lds
  s_xor_b32 s43, s18, 1
  s_lshl_b32 s43, s43, 16
  s_add_u32 s42, s43, 0x80
  s_add_u32 m0, s45, 4096
  s_nop 0
  buffer_load_dwordx4 v24, s[12:15], s42 offen lds
  s_add_u32 s42, s43, 0x4080
  s_add_u32 m0, s45, 5120
  s_nop 0
  buffer_load_dwordx4 v24, s[12:15], s42 offen lds
  s_add_u32 s42, s43, 0x8080
  s_add_u32 m0, s45, 6144
  s_nop 0
  buffer_load_dwordx4 v24, s[12:15], s42 offen lds
  s_add_u32 s42, s43, 0xc080
  s_add_u32 m0, s45, 7168
  s_nop 0
  buffer_load_dwordx4 v24, s[12:15], s42 offen lds
  s_waitcnt vmcnt(24)
  s_barrier
  ds_read_b64_tr_b16 v[144:145], v25 offset:8192
  ds_read_b64_tr_b16 v[146:147], v25 offset:8448
  ds_read_b64_tr_b16 v[148:149], v25 offset:10240
  ds_read_b64_tr_b16 v[150:151], v25 offset:10496
  ds_read_b64_tr_b16 v[152:153], v26 offset:8192
  ds_read_b64_tr_b16 v[154:155], v26 offset:8448
  ds_read_b64_tr_b16 v[156:157], v26 offset:10240
  ds_read_b64_tr_b16 v[158:159], v26 offset:10496
  ds_read_b64_tr_b16 v[176:177], v27 offset:8192
  ds_read_b64_tr_b16 v[178:179], v27 offset:8448
  ds_read_b64_tr_b16 v[180:181], v27 offset:10240
  ds_read_b64_tr_b16 v[182:183], v27 offset:10496
  s_waitcnt lgkmcnt(4)
  ds_read_b64_tr_b16 v[184:185], v28 offset:8192
  ds_read_b64_tr_b16 v[186:187], v28 offset:8448
  ds_read_b64_tr_b16 v[188:189], v28 offset:10240
  ds_read_b64_tr_b16 v[190:191], v28 offset:10496
  s_waitcnt lgkmcnt(0)
  s_barrier
  s_xor_b32 s43, s18, 2
  s_lshl_b32 s43, s43, 16
  s_add_u32 s42, s43, 0x80
  s_add_u32 m0, s45, 8192
  s_nop 0
  buffer_load_dwordx4 v24, s[12:15], s42 offen lds
  s_add_u32 s42, s43, 0x4080
  s_add_u32 m0, s45, 9216
  s_nop 0
  buffer_load_dwordx4 v24, s[12:15], s42 offen lds
  s_add_u32 s42, s43, 0x8080
  s_add_u32 m0, s45, 10240
  s_nop 0
  buffer_load_dwordx4 v24, s[12:15], s42 offen lds
  s_add_u32 s42, s43, 0xc080
  s_add_u32 m0, s45, 11264
  s_nop 0
  buffer_load_dwordx4 v24, s[12:15], s42 offen lds
  s_xor_b32 s43, s18, 3
  s_lshl_b32 s43, s43, 16
  s_add_u32 s42, s43, 0x80
  s_add_u32 m0, s45, 12288
  s_nop 0
  buffer_load_dwordx4 v24, s[12:15], s42 offen lds
  s_add_u32 s42, s43, 0x4080
  s_add_u32 m0, s45, 13312
  s_nop 0
  buffer_load_dwordx4 v24, s[12:15], s42 offen lds
  s_add_u32 s42, s43, 0x8080
  s_add_u32 m0, s45, 14336
  s_nop 0
  buffer_load_dwordx4 v24, s[12:15], s42 offen lds
  s_add_u32 s42, s43, 0xc080
  s_add_u32 m0, s45, 15360
  s_nop 0
  buffer_load_dwordx4 v24, s[12:15], s42 offen lds
  s_waitcnt vmcnt(24)
  ds_read_b64_tr_b16 v[32:33], v29 offset:16384
  ds_read_b64_tr_b16 v[34:35], v29 offset:16640
  ds_read_b64_tr_b16 v[36:37], v29 offset:17408
  ds_read_b64_tr_b16 v[38:39], v29 offset:17664
  ds_read_b64_tr_b16 v[40:41], v29 offset:16448
  ds_read_b64_tr_b16 v[42:43], v29 offset:16704
  ds_read_b64_tr_b16 v[44:45], v29 offset:17472
  ds_read_b64_tr_b16 v[46:47], v29 offset:17728
  ds_read_b64_tr_b16 v[192:193], v29 offset:20480
  ds_read_b64_tr_b16 v[194:195], v29 offset:20736
  ds_read_b64_tr_b16 v[196:197], v29 offset:21504
  ds_read_b64_tr_b16 v[198:199], v29 offset:21760
  s_waitcnt lgkmcnt(4)
  ds_read_b64_tr_b16 v[200:201], v29 offset:20544
  ds_read_b64_tr_b16 v[202:203], v29 offset:20800
  ds_read_b64_tr_b16 v[204:205], v29 offset:21568
  ds_read_b64_tr_b16 v[206:207], v29 offset:21824
  s_waitcnt lgkmcnt(0)
  s_mov_b32 s12, s72
  s_mov_b32 s13, s73
  s_mov_b32 s14, 0x800000
  s_mov_b32 s15, 0x20000
  s_xor_b32 s43, s18, 2
  s_lshl_b32 s43, s43, 20
  s_add_u32 s42, s43, 0x0
  s_add_u32 m0, s45, 16384
  s_nop 0
  buffer_load_dwordx4 v23, s[12:15], s42 offen lds
  s_add_u32 s42, s43, 0x10000
  s_add_u32 m0, s45, 17408
  s_nop 0
  buffer_load_dwordx4 v23, s[12:15], s42 offen lds
  s_add_u32 s42, s43, 0x20000
  s_add_u32 m0, s45, 18432
  s_nop 0
  buffer_load_dwordx4 v23, s[12:15], s42 offen lds
  s_add_u32 s42, s43, 0x30000
  s_add_u32 m0, s45, 19456
  s_nop 0
  buffer_load_dwordx4 v23, s[12:15], s42 offen lds
  s_add_u32 s42, s43, 0x40000
  s_add_u32 m0, s45, 20480
  s_nop 0
  buffer_load_dwordx4 v23, s[12:15], s42 offen lds
  s_add_u32 s42, s43, 0x50000
  s_add_u32 m0, s45, 21504
  s_nop 0
  buffer_load_dwordx4 v23, s[12:15], s42 offen lds
  s_add_u32 s42, s43, 0x60000
  s_add_u32 m0, s45, 22528
  s_nop 0
  buffer_load_dwordx4 v23, s[12:15], s42 offen lds
  s_add_u32 s42, s43, 0x70000
  s_add_u32 m0, s45, 23552
  s_nop 0
  buffer_load_dwordx4 v23, s[12:15], s42 offen lds
  s_waitcnt vmcnt(24)
  ds_read_b64_tr_b16 v[224:225], v29 offset:24576
  ds_read_b64_tr_b16 v[226:227], v29 offset:24832
  ds_read_b64_tr_b16 v[228:229], v29 offset:25600
  ds_read_b64_tr_b16 v[230:231], v29 offset:25856
  ds_read_b64_tr_b16 v[232:233], v29 offset:24640
  ds_read_b64_tr_b16 v[234:235], v29 offset:24896
  ds_read_b64_tr_b16 v[236:237], v29 offset:25664
  ds_read_b64_tr_b16 v[238:239], v29 offset:25920
  ds_read_b64_tr_b16 v[64:65], v29 offset:28672
  ds_read_b64_tr_b16 v[66:67], v29 offset:28928
  ds_read_b64_tr_b16 v[68:69], v29 offset:29696
  ds_read_b64_tr_b16 v[70:71], v29 offset:29952
  s_waitcnt lgkmcnt(4)
  ds_read_b64_tr_b16 v[72:73], v29 offset:28736
  ds_read_b64_tr_b16 v[74:75], v29 offset:28992
  ds_read_b64_tr_b16 v[76:77], v29 offset:29760
  ds_read_b64_tr_b16 v[78:79], v29 offset:30016
  s_waitcnt lgkmcnt(0)
  s_xor_b32 s43, s18, 2
  s_lshl_b32 s43, s43, 20
  s_add_u32 s42, s43, 0x80000
  s_add_u32 m0, s45, 24576
  s_nop 0
  buffer_load_dwordx4 v23, s[12:15], s42 offen lds
  s_add_u32 s42, s43, 0x90000
  s_add_u32 m0, s45, 25600
  s_nop 0
  buffer_load_dwordx4 v23, s[12:15], s42 offen lds
  s_add_u32 s42, s43, 0xa0000
  s_add_u32 m0, s45, 26624
  s_nop 0
  buffer_load_dwordx4 v23, s[12:15], s42 offen lds
  s_add_u32 s42, s43, 0xb0000
  s_add_u32 m0, s45, 27648
  s_nop 0
  buffer_load_dwordx4 v23, s[12:15], s42 offen lds
  s_add_u32 s42, s43, 0xc0000
  s_add_u32 m0, s45, 28672
  s_nop 0
  buffer_load_dwordx4 v23, s[12:15], s42 offen lds
  s_add_u32 s42, s43, 0xd0000
  s_add_u32 m0, s45, 29696
  s_nop 0
  buffer_load_dwordx4 v23, s[12:15], s42 offen lds
  s_add_u32 s42, s43, 0xe0000
  s_add_u32 m0, s45, 30720
  s_nop 0
  buffer_load_dwordx4 v23, s[12:15], s42 offen lds
  s_add_u32 s42, s43, 0xf0000
  s_add_u32 m0, s45, 31744
  s_nop 0
  buffer_load_dwordx4 v23, s[12:15], s42 offen lds
  s_waitcnt vmcnt(24)
  ds_read_b64_tr_b16 v[48:49], v29 offset:0
  ds_read_b64_tr_b16 v[50:51], v29 offset:256
  ds_read_b64_tr_b16 v[52:53], v29 offset:1024
  ds_read_b64_tr_b16 v[54:55], v29 offset:1280
  ds_read_b64_tr_b16 v[56:57], v29 offset:64
  ds_read_b64_tr_b16 v[58:59], v29 offset:320
  ds_read_b64_tr_b16 v[60:61], v29 offset:1088
  ds_read_b64_tr_b16 v[62:63], v29 offset:1344
  ds_read_b64_tr_b16 v[208:209], v29 offset:4096
  ds_read_b64_tr_b16 v[210:211], v29 offset:4352
  ds_read_b64_tr_b16 v[212:213], v29 offset:5120
  ds_read_b64_tr_b16 v[214:215], v29 offset:5376
  s_waitcnt lgkmcnt(4)
  ds_read_b64_tr_b16 v[216:217], v29 offset:4160
  ds_read_b64_tr_b16 v[218:219], v29 offset:4416
  ds_read_b64_tr_b16 v[220:221], v29 offset:5184
  ds_read_b64_tr_b16 v[222:223], v29 offset:5440
  s_waitcnt lgkmcnt(0)
  s_waitcnt vmcnt(16)
  ds_read_b64_tr_b16 v[240:241], v29 offset:8192
  ds_read_b64_tr_b16 v[242:243], v29 offset:8448
  ds_read_b64_tr_b16 v[244:245], v29 offset:9216
  ds_read_b64_tr_b16 v[246:247], v29 offset:9472
  ds_read_b64_tr_b16 v[248:249], v29 offset:8256
  ds_read_b64_tr_b16 v[250:251], v29 offset:8512
  ds_read_b64_tr_b16 v[252:253], v29 offset:9280
  ds_read_b64_tr_b16 v[254:255], v29 offset:9536
  ds_read_b64_tr_b16 v[80:81], v29 offset:12288
  ds_read_b64_tr_b16 v[82:83], v29 offset:12544
  ds_read_b64_tr_b16 v[84:85], v29 offset:13312
  ds_read_b64_tr_b16 v[86:87], v29 offset:13568
  s_waitcnt lgkmcnt(4)
  ds_read_b64_tr_b16 v[88:89], v29 offset:12352
  ds_read_b64_tr_b16 v[90:91], v29 offset:12608
  ds_read_b64_tr_b16 v[92:93], v29 offset:13376
  ds_read_b64_tr_b16 v[94:95], v29 offset:13632
  s_waitcnt lgkmcnt(0)
  s_waitcnt vmcnt(8)
  s_barrier
  ds_read_b64_tr_b16 v[96:97], v25 offset:16384
  ds_read_b64_tr_b16 v[98:99], v25 offset:16640
  ds_read_b64_tr_b16 v[100:101], v25 offset:18432
  ds_read_b64_tr_b16 v[102:103], v25 offset:18688
  ds_read_b64_tr_b16 v[104:105], v26 offset:16384
  ds_read_b64_tr_b16 v[106:107], v26 offset:16640
  ds_read_b64_tr_b16 v[108:109], v26 offset:18432
  ds_read_b64_tr_b16 v[110:111], v26 offset:18688
  ds_read_b64_tr_b16 v[112:113], v27 offset:16384
  ds_read_b64_tr_b16 v[114:115], v27 offset:16640
  ds_read_b64_tr_b16 v[116:117], v27 offset:18432
  ds_read_b64_tr_b16 v[118:119], v27 offset:18688
  s_waitcnt lgkmcnt(4)
  ds_read_b64_tr_b16 v[120:121], v28 offset:16384
  ds_read_b64_tr_b16 v[122:123], v28 offset:16640
  ds_read_b64_tr_b16 v[124:125], v28 offset:18432
  ds_read_b64_tr_b16 v[126:127], v28 offset:18688
  s_waitcnt lgkmcnt(0)
  s_barrier
  ds_write_b128 v5, v[96:99] offset:0
  ds_write_b128 v5, v[100:103] offset:1024
  ds_write_b128 v5, v[104:107] offset:2048
  ds_write_b128 v5, v[108:111] offset:3072
  ds_write_b128 v5, v[112:115] offset:8192
  ds_write_b128 v5, v[116:119] offset:9216
  ds_write_b128 v5, v[120:123] offset:10240
  ds_write_b128 v5, v[124:127] offset:11264
  s_waitcnt lgkmcnt(0)
  s_waitcnt vmcnt(0)
  s_barrier
  ds_read_b64_tr_b16 v[96:97], v25 offset:24576
  ds_read_b64_tr_b16 v[98:99], v25 offset:24832
  ds_read_b64_tr_b16 v[100:101], v25 offset:26624
  ds_read_b64_tr_b16 v[102:103], v25 offset:26880
  ds_read_b64_tr_b16 v[104:105], v26 offset:24576
  ds_read_b64_tr_b16 v[106:107], v26 offset:24832
  ds_read_b64_tr_b16 v[108:109], v26 offset:26624
  ds_read_b64_tr_b16 v[110:111], v26 offset:26880
  ds_read_b64_tr_b16 v[112:113], v27 offset:24576
  ds_read_b64_tr_b16 v[114:115], v27 offset:24832
  ds_read_b64_tr_b16 v[116:117], v27 offset:26624
  ds_read_b64_tr_b16 v[118:119], v27 offset:26880
  s_waitcnt lgkmcnt(4)
  ds_read_b64_tr_b16 v[120:121], v28 offset:24576
  ds_read_b64_tr_b16 v[122:123], v28 offset:24832
  ds_read_b64_tr_b16 v[124:125], v28 offset:26624
  ds_read_b64_tr_b16 v[126:127], v28 offset:26880
  s_waitcnt lgkmcnt(0)
  s_barrier
  ds_write_b128 v5, v[96:99] offset:4096
  ds_write_b128 v5, v[100:103] offset:5120
  ds_write_b128 v5, v[104:107] offset:6144
  ds_write_b128 v5, v[108:111] offset:7168
  ds_write_b128 v5, v[112:115] offset:12288
  ds_write_b128 v5, v[116:119] offset:13312
  ds_write_b128 v5, v[120:123] offset:14336
  ds_write_b128 v5, v[124:127] offset:15360
  s_waitcnt lgkmcnt(0)
  ds_write_b128 v5, v[32:35] offset:16384
  ds_write_b128 v5, v[36:39] offset:17408
  ds_write_b128 v5, v[40:43] offset:18432
  ds_write_b128 v5, v[44:47] offset:19456
  ds_write_b128 v5, v[48:51] offset:20480
  ds_write_b128 v5, v[52:55] offset:21504
  ds_write_b128 v5, v[56:59] offset:22528
  ds_write_b128 v5, v[60:63] offset:23552
  ds_write_b128 v5, v[64:67] offset:24576
  ds_write_b128 v5, v[68:71] offset:25600
  ds_write_b128 v5, v[72:75] offset:26624
  ds_write_b128 v5, v[76:79] offset:27648
  ds_write_b128 v5, v[80:83] offset:28672
  ds_write_b128 v5, v[84:87] offset:29696
  ds_write_b128 v5, v[88:91] offset:30720
  ds_write_b128 v5, v[92:95] offset:31744
  s_waitcnt lgkmcnt(0)
  s_mov_b32 s12, s66
  s_mov_b32 s13, s67
  s_mov_b32 s14, 0x4000
  s_mov_b32 s15, 0x20000
  buffer_load_dwordx4 v[32:35], v30, s[12:15], 0 offen offset:0
  buffer_load_dwordx4 v[36:39], v30, s[12:15], 0 offen offset:128
  s_waitcnt vmcnt(0)
  s_barrier
  s_cmp_lg_u32 s18, 0
  s_cbranch_scc1 .w0_134
  v_mov_b32 v120, 1
  v_mov_b32 v121, 0
  s_mov_b64 exec, 1
  buffer_atomic_add v120, v121, s[8:11], 0 offen offset:8 sc0 sc1
  s_mov_b64 exec, -1
  s_waitcnt vmcnt(0)
  v_readfirstlane_b32 s94, v120
  s_and_b32 s94, s94, 255
  s_cbranch_scc1 .hsc_138
  s_lshl_b32 s42, s16, 5
  s_add_u32 s42, s42, s17
  s_lshl_b32 s42, s42, 15
  s_add_u32 s42, s42, 117309440
  s_add_u32 s94, s42, 132608
  v_mbcnt_lo_u32_b32 v122, -1, 0
  v_mbcnt_hi_u32_b32 v122, -1, v122
  v_lshlrev_b32 v122, 4, v122
  v_mov_b32 v124, 1
  v_mov_b32 v125, 1
  v_mov_b32 v126, 1
  v_mov_b32 v127, 1
  s_mov_b32 s95, -1
  s_mov_b32 s96, -1
  s_mov_b64 exec, 0xffffffff
  s_memtime s[98:99]
  s_waitcnt lgkmcnt(0)
  s_mov_b32 s97, s98
  buffer_store_dwordx4 v[124:127], v122, s[4:7], s94 offen sc1
  s_waitcnt vmcnt(0)
  s_memtime s[98:99]
  s_waitcnt lgkmcnt(0)
  s_sub_u32 s97, s98, s97
  s_min_u32 s95, s95, s97
  s_xor_b32 s94, s94, 8192
  s_memtime s[98:99]
  s_waitcnt lgkmcnt(0)
  s_mov_b32 s97, s98
  buffer_store_dwordx4 v[124:127], v122, s[4:7], s94 offen sc1
  s_waitcnt vmcnt(0)
  s_memtime s[98:99]
  s_waitcnt lgkmcnt(0)
  s_sub_u32 s97, s98, s97
  s_min_u32 s96, s96, s97
  s_xor_b32 s94, s94, 8192
  s_memtime s[98:99]
  s_waitcnt lgkmcnt(0)
  s_mov_b32 s97, s98
  buffer_store_dwordx4 v[124:127], v122, s[4:7], s94 offen sc1
  s_waitcnt vmcnt(0)
  s_memtime s[98:99]
  s_waitcnt lgkmcnt(0)
  s_sub_u32 s97, s98, s97
  s_min_u32 s95, s95, s97
  s_xor_b32 s94, s94, 8192
  s_memtime s[98:99]
  s_waitcnt lgkmcnt(0)
  s_mov_b32 s97, s98
  buffer_store_dwordx4 v[124:127], v122, s[4:7], s94 offen sc1
  s_waitcnt vmcnt(0)
  s_memtime s[98:99]
  s_waitcnt lgkmcnt(0)
  s_sub_u32 s97, s98, s97
  s_min_u32 s96, s96, s97
  s_xor_b32 s94, s94, 8192
  s_memtime s[98:99]
  s_waitcnt lgkmcnt(0)
  s_mov_b32 s97, s98
  buffer_store_dwordx4 v[124:127], v122, s[4:7], s94 offen sc1
  s_waitcnt vmcnt(0)
  s_memtime s[98:99]
  s_waitcnt lgkmcnt(0)
  s_sub_u32 s97, s98, s97
  s_min_u32 s95, s95, s97
  s_xor_b32 s94, s94, 8192
  s_memtime s[98:99]
  s_waitcnt lgkmcnt(0)
  s_mov_b32 s97, s98
  buffer_store_dwordx4 v[124:127], v122, s[4:7], s94 offen sc1
  s_waitcnt vmcnt(0)
  s_memtime s[98:99]
  s_waitcnt lgkmcnt(0)
  s_sub_u32 s97, s98, s97
  s_min_u32 s96, s96, s97
  s_xor_b32 s94, s94, 8192
  s_mov_b64 exec, -1
  s_cmp_lt_u32 s96, s95
  s_cselect_b32 s97, 257, 1
  s_bitcmp1_b32 s3, 0
  s_cbranch_scc1 .ini_141
  v_mov_b32 v121, 0
.inl_142:
  buffer_load_dword v120, v121, s[8:11], 0 offen offset:20 sc1
  s_waitcnt vmcnt(0)
  v_readfirstlane_b32 s95, v120
  s_or_b32 s3, s3, s95
  s_bitcmp1_b32 s3, 0
  s_cbranch_scc1 .ini_141
  s_sleep 2
  s_sub_u32 s20, s20, 1
  s_cbranch_scc0 .inl_142
  v_mov_b32 v120, 0xdead
  v_mov_b32 v121, 0
  buffer_store_dword v120, v121, s[8:11], 0 offen offset:28 sc1
  s_mov_b32 s20, 0
  s_mov_b32 s94, 65535
  s_branch .hso_135
.ini_141:
  v_mbcnt_lo_u32_b32 v122, -1, 0
  v_mbcnt_hi_u32_b32 v122, -1, v122
  v_and_b32 v122, 15, v122
  v_lshlrev_b32 v122, 7, v122
  s_mov_b32 s96, 123731968
.hsk_139:
  buffer_load_dword v124, v122, s[4:7], s96 offen sc1
  s_waitcnt vmcnt(0)
  v_cmp_gt_u32 vcc, 32, v124
  s_or_b32 s95, vcc_lo, 65536
  s_ff1_i32_b32 s95, s95
  s_lshl_b32 s95, s95, 20
  s_cbranch_scc1 .hsd_140
  s_sub_u32 s20, s20, 1
  s_cbranch_scc0 .hsk_139
  v_mov_b32 v120, 0xdead
  v_mov_b32 v121, 0
  buffer_store_dword v120, v121, s[8:11], 0 offen offset:28 sc1
  s_mov_b32 s20, 0
  s_mov_b32 s94, 65535
  s_branch .hso_135
.hsd_140:
  s_add_u32 s97, s97, s95
  v_mov_b32 v120, s97
  v_mov_b32 v121, 0
  s_mov_b64 exec, 1
  buffer_atomic_add v120, v121, s[8:11], 0 offen offset:8 sc1
  s_mov_b64 exec, -1
.hsc_138:
  s_mov_b32 s96, 300
.hsl_136:
  buffer_load_dwordx4 v[124:127], v121, s[8:11], 0 offen offset:8 sc1
  s_waitcnt vmcnt(0)
  v_readfirstlane_b32 s95, v124
  v_readfirstlane_b32 s97, v127
  s_or_b32 s3, s3, s97
  s_and_b32 s94, s95, 256
  s_lshl_b32 s94, s94, 5
  s_and_b32 s97, s95, 0x1f00000
  s_or_b32 s94, s94, s97
  s_and_b32 s97, s95, 65791
  s_cmp_lg_u32 s97, 65
  s_cbranch_scc1 .hsn_137
  s_bitcmp1_b32 s3, 0
  s_cbranch_scc1 .hso_135
.hsn_137:
  s_bitcmp0_b32 s95, 16
  s_cbranch_scc1 .hsp_143
  v_mov_b32 v120, 1
  v_mov_b32 v121, 0
  s_mov_b64 exec, 1
  buffer_atomic_add v120, v121, s[8:11], 0 offen offset:24 sc0 sc1
  s_mov_b64 exec, -1
  s_waitcnt vmcnt(0)
  v_readfirstlane_b32 s94, v120
  s_or_b32 s3, s3, 2
  s_cmp_ge_u32 s94, 64
  s_cbranch_scc1 .hsw_144
  s_or_b32 s94, s94, 65536
  s_branch .hso_135
.hsw_144:
  s_mov_b32 s94, 1
  s_branch .hso_135
.hsp_143:
  s_sub_u32 s96, s96, 1
  s_cbranch_scc0 .hsg_145
  s_mov_b32 s96, 0
  s_cmp_ge_u32 s97, 65
  s_cbranch_scc1 .hsg_145
  s_or_b32 s97, s95, 65536
  v_mov_b32 v122, s97
  v_mov_b32 v123, s95
  s_mov_b64 exec, 1
  buffer_atomic_cmpswap v[122:123], v121, s[8:11], 0 offen offset:8 sc1
  s_mov_b64 exec, -1
.hsg_145:
  s_sleep 2
  s_sub_u32 s20, s20, 1
  s_cbranch_scc0 .hsl_136
  v_mov_b32 v120, 0xdead
  v_mov_b32 v121, 0
  buffer_store_dword v120, v121, s[8:11], 0 offen offset:28 sc1
  s_mov_b32 s20, 0
  s_mov_b32 s94, 65535
  s_branch .hso_135
.hso_135:
  v_mov_b32 v120, s94
  v_mov_b32 v121, 163776
  ds_write_b32 v121, v120
  s_waitcnt lgkmcnt(0)
.w0_134:
  s_barrier
  v_mov_b32 v121, 163776
  ds_read_b32 v120, v121
  s_waitcnt lgkmcnt(0)
  v_readfirstlane_b32 s94, v120
  s_barrier
  s_lshr_b32 s38, s94, 20
  s_and_b32 s94, s94, 0xfffff
  s_and_b32 s39, s94, 8192
  s_cmp_lg_u32 s94, s39
  s_cbranch_scc1 .cspecial
  s_lshl_b32 s42, s16, 5
  s_add_u32 s42, s42, s17
  s_lshl_b32 s42, s42, 15
  s_add_u32 s42, s42, 117309440
  s_add_u32 s42, s42, s39
  s_lshl_b32 s43, s16, 21
  s_sub_u32 s43, 1048576, s43
  s_add_u32 s27, s42, 0
  s_add_u32 s25, s27, s43
  s_add_u32 s28, s42, 16384
  s_add_u32 s26, s28, s43
  s_waitcnt vmcnt(0)
  s_mov_b32 s12, 0x00ff00ff
  s_mov_b32 s13, 0x00ff00ff
  s_mov_b32 s19, 0
  s_cmp_lt_u32 s19, s38
  s_cbranch_scc1 .kvok_150
  s_cmp_lg_u32 s18, 0
  s_cbranch_scc1 .kvo_152
  v_bfe_u32 v48, v5, 4, 4
  v_lshlrev_b32 v48, 7, v48
  s_mov_b32 s42, 123731968
.kvw_149:
  buffer_load_dword v49, v48, s[4:7], s42 offen sc1
  s_waitcnt vmcnt(0)
  v_cmp_gt_u32 vcc, 32, v49
  s_or_b32 s38, vcc_lo, 65536
  s_ff1_i32_b32 s38, s38
  s_cmp_lt_u32 s19, s38
  s_cbranch_scc1 .kvg_151
  s_sleep 4
  s_sub_u32 s20, s20, 1
  s_cbranch_scc0 .kvw_149
  s_mov_b32 s38, 0
.kvg_151:
  v_mov_b32 v48, 163792
  v_mov_b32 v49, s38
  ds_write_b32 v48, v49
.kvo_152:
  s_waitcnt vmcnt(0) lgkmcnt(0)
  s_barrier
  v_mov_b32 v48, 163792
  ds_read_b32 v49, v48
  s_waitcnt lgkmcnt(0)
  v_readfirstlane_b32 s38, v49
  s_cmp_eq_u32 s38, 0
  s_cbranch_scc1 .cabort
.kvok_150:
  buffer_load_dwordx4 v[16:19], v0, s[4:7], s33 offen offset:0 sc1
  buffer_load_dwordx4 v[20:23], v0, s[4:7], s33 offen offset:1024 sc1
  buffer_load_dwordx4 v[24:27], v0, s[4:7], s34 offen offset:0 sc1
  buffer_load_dwordx4 v[28:31], v0, s[4:7], s34 offen offset:1024 sc1
  s_add_u32 s33, s33, 262144
  s_add_u32 s34, s34, 262144
  s_branch .cent_147
.ctop_146:
  ds_write_b128 v0, v[16:19] offset:16384
  ds_write_b128 v0, v[20:23] offset:17408
  v_mov_b64 v[104:105], 0
  v_mov_b64 v[106:107], 0
  v_mov_b64 v[108:109], 0
  v_mov_b64 v[110:111], 0
  v_mov_b64 v[112:113], 0
  v_mov_b64 v[114:115], 0
  v_xor_b32 v116, 512, v0
  v_xor_b32 v117, 512, v1
  v_xor_b32 v118, 512, v2
  v_xor_b32 v119, 512, v3
  s_waitcnt vmcnt(0)
  buffer_load_dwordx4 v[32:35], v0, s[4:7], s21 offen offset:0 sc1
  buffer_load_dwordx4 v[36:39], v0, s[4:7], s21 offen offset:1024 sc1
  s_waitcnt vmcnt(0)
.ml_153:
  v_max3_u32 v120, v32, v33, v34
  v_max3_u32 v121, v35, v36, v37
  v_max3_u32 v120, v120, v38, v39
  v_max_u32 v120, v120, v121
  v_cmp_eq_u32 vcc, -1, v120
  s_cbranch_vccnz .mr_154
  ds_write_b128 v0, v[32:35]
  ds_write_b128 v0, v[36:39] offset:1024
  v_smfmac_f32_16x16x64_bf16 v[104:107], v[32:35], a[0:7], v9
  ds_read_b128 v[48:51], v116
  ds_read_b128 v[52:55], v116 offset:1024
  v_smfmac_f32_16x16x64_bf16 v[104:107], v[36:39], a[16:23], v9
  v_smfmac_f32_16x16x64_bf16 v[108:111], v[32:35], a[128:135], v9
  s_waitcnt lgkmcnt(2)
  s_barrier
  ds_read_b128 v[56:59], v1 offset:0
  ds_read_b128 v[60:63], v117 offset:0
  v_smfmac_f32_16x16x64_bf16 v[108:111], v[36:39], a[144:151], v9
  ds_read_b128 v[64:67], v1 offset:1024
  ds_read_b128 v[68:71], v117 offset:1024
  s_waitcnt lgkmcnt(5)
  v_smfmac_f32_16x16x64_bf16 v[104:107], v[48:51], a[8:15], v9
  ds_read_b128 v[72:75], v2 offset:0
  ds_read_b128 v[76:79], v118 offset:0
  s_waitcnt lgkmcnt(6)
  v_smfmac_f32_16x16x64_bf16 v[104:107], v[52:55], a[24:31], v9
  ds_read_b128 v[80:83], v2 offset:1024
  ds_read_b128 v[84:87], v118 offset:1024
  v_smfmac_f32_16x16x64_bf16 v[108:111], v[48:51], a[136:143], v9
  ds_read_b128 v[88:91], v3 offset:0
  ds_read_b128 v[92:95], v119 offset:0
  v_smfmac_f32_16x16x64_bf16 v[108:111], v[52:55], a[152:159], v9
  ds_read_b128 v[96:99], v3 offset:1024
  ds_read_b128 v[100:103], v119 offset:1024
  v_smfmac_f32_16x16x64_bf16 v[112:115], v[32:35], v[128:135], v9
  v_smfmac_f32_16x16x64_bf16 v[112:115], v[36:39], v[144:151], v9
  s_waitcnt lgkmcnt(11)
  v_smfmac_f32_16x16x64_bf16 v[104:107], v[56:59], a[32:39], v9
  s_waitcnt lgkmcnt(10)
  v_smfmac_f32_16x16x64_bf16 v[104:107], v[60:63], a[40:47], v9
  s_waitcnt lgkmcnt(9)
  v_smfmac_f32_16x16x64_bf16 v[104:107], v[64:67], a[48:55], v9
  v_mov_b32 v124, 1
  v_mov_b32 v125, s19
  s_waitcnt lgkmcnt(8)
  v_smfmac_f32_16x16x64_bf16 v[104:107], v[68:71], a[56:63], v9
  s_mov_b32 exec_lo, 0x01010101
  s_mov_b32 exec_hi, 0x01010101
  buffer_store_dword v124, v0, s[4:7], s28 offen offset:0 sc1
  s_mov_b64 exec, -1
  s_waitcnt lgkmcnt(7)
  v_smfmac_f32_16x16x64_bf16 v[104:107], v[72:75], a[64:71], v9
  s_mov_b32 exec_lo, 0x01010101
  s_mov_b32 exec_hi, 0x01010101
  buffer_store_dword v124, v0, s[4:7], s28 offen offset:1024 sc1
  s_mov_b64 exec, -1
  s_waitcnt lgkmcnt(6)
  v_smfmac_f32_16x16x64_bf16 v[104:107], v[76:79], a[72:79], v9
  s_mov_b64 exec, 1
  buffer_store_dword v125, off, s[4:7], s37 sc1
  s_mov_b64 exec, -1
  s_waitcnt lgkmcnt(5)
  v_smfmac_f32_16x16x64_bf16 v[104:107], v[80:83], a[80:87], v9
  s_waitcnt lgkmcnt(4)
  v_smfmac_f32_16x16x64_bf16 v[104:107], v[84:87], a[88:95], v9
  s_waitcnt lgkmcnt(3)
  v_smfmac_f32_16x16x64_bf16 v[104:107], v[88:91], a[96:103], v9
  s_waitcnt lgkmcnt(2)
  v_smfmac_f32_16x16x64_bf16 v[104:107], v[92:95], a[104:111], v9
  s_waitcnt lgkmcnt(1)
  v_smfmac_f32_16x16x64_bf16 v[104:107], v[96:99], a[112:119], v9
  s_waitcnt lgkmcnt(0)
  v_smfmac_f32_16x16x64_bf16 v[104:107], v[100:103], a[120:127], v9
  v_smfmac_f32_16x16x64_bf16 v[108:111], v[56:59], a[160:167], v9
  v_smfmac_f32_16x16x64_bf16 v[108:111], v[60:63], a[168:175], v9
  v_cvt_pk_bf16_f32 v104, v104, v105
  v_cvt_pk_bf16_f32 v105, v106, v107
  v_and_b32 v104, -2, v104
  buffer_store_dwordx2 v[104:105], v4, s[4:7], s25 offen offset:0 sc1
  ds_write_b64 v4, v[104:105] offset:24576
  v_smfmac_f32_16x16x64_bf16 v[108:111], v[64:67], a[176:183], v9
  v_smfmac_f32_16x16x64_bf16 v[108:111], v[68:71], a[184:191], v9
  v_smfmac_f32_16x16x64_bf16 v[108:111], v[72:75], a[192:199], v9
  ds_read_b128 v[40:43], v5 offset:0
  ds_read_b128 v[44:47], v5 offset:1024
  v_smfmac_f32_16x16x64_bf16 v[108:111], v[76:79], a[200:207], v9
  ds_read_b128 v[120:123], v5 offset:2048
  ds_read_b128 v[124:127], v5 offset:3072
  v_smfmac_f32_16x16x64_bf16 v[108:111], v[80:83], a[208:215], v9
  v_smfmac_f32_16x16x64_bf16 v[108:111], v[84:87], a[216:223], v9
  v_and_b32 v116, -6145, v0
  s_lshl_b32 s43, s18, 11
  v_add_u32 v117, s43, v11
  v_smfmac_f32_16x16x64_bf16 v[108:111], v[88:91], a[224:231], v9
  s_waitcnt vmcnt(4)
  ds_read_b128 v[32:35], v5 offset:4096
  ds_read_b128 v[36:39], v5 offset:5120
  v_smfmac_f32_16x16x64_bf16 v[108:111], v[92:95], a[232:239], v9
  v_smfmac_f32_16x16x64_bf16 v[108:111], v[96:99], a[240:247], v9
  v_smfmac_f32_16x16x64_bf16 v[108:111], v[100:103], a[248:255], v9
  v_smfmac_f32_16x16x64_bf16 v[112:115], v[48:51], v[136:143], v9
  v_smfmac_f32_16x16x64_bf16 v[112:115], v[52:55], v[152:159], v9
  v_cvt_pk_bf16_f32 v108, v108, v109
  v_cvt_pk_bf16_f32 v109, v110, v111
  v_and_b32 v108, -2, v108
  buffer_store_dwordx2 v[108:109], v4, s[4:7], s25 offen offset:512 sc1
  ds_write_b64 v4, v[108:109] offset:8192
  ds_read_b128 v[48:51], v5 offset:6144
  ds_read_b128 v[52:55], v5 offset:7168
  s_waitcnt lgkmcnt(7)
  v_smfmac_f32_16x16x64_bf16 v[112:115], v[72:75], v[40:47], v9
  ds_read_b128 v[40:43], v5 offset:8192
  ds_read_b128 v[44:47], v5 offset:9216
  s_waitcnt lgkmcnt(7)
  v_smfmac_f32_16x16x64_bf16 v[112:115], v[76:79], v[120:127], v9
  ds_read_b128 v[120:123], v5 offset:10240
  ds_read_b128 v[124:127], v5 offset:11264
  s_waitcnt lgkmcnt(7)
  v_smfmac_f32_16x16x64_bf16 v[112:115], v[80:83], v[32:39], v9
  ds_read_b128 v[32:35], v5 offset:12288
  ds_read_b128 v[36:39], v5 offset:13312
  v_smfmac_f32_16x16x64_bf16 v[112:115], v[56:59], v[160:167], v9
  v_smfmac_f32_16x16x64_bf16 v[112:115], v[60:63], v[168:175], v9
  buffer_load_dwordx2 v[104:105], v4, s[4:7], s27 offen offset:0 sc1
  s_waitcnt lgkmcnt(6)
  v_smfmac_f32_16x16x64_bf16 v[112:115], v[84:87], v[48:55], v9
  ds_read_b128 v[48:51], v5 offset:14336
  ds_read_b128 v[52:55], v5 offset:15360
  v_smfmac_f32_16x16x64_bf16 v[112:115], v[64:67], v[176:183], v9
  v_smfmac_f32_16x16x64_bf16 v[112:115], v[68:71], v[184:191], v9
  s_waitcnt lgkmcnt(6)
  v_smfmac_f32_16x16x64_bf16 v[112:115], v[88:91], v[40:47], v9
  ds_read_b128 v[56:59], v116 offset:16384
  ds_read_b128 v[60:63], v116 offset:17408
  s_waitcnt lgkmcnt(6)
  v_smfmac_f32_16x16x64_bf16 v[112:115], v[92:95], v[120:127], v9
  ds_read_b128 v[64:67], v116 offset:18432
  ds_read_b128 v[68:71], v116 offset:19456
  s_waitcnt lgkmcnt(6)
  v_smfmac_f32_16x16x64_bf16 v[112:115], v[96:99], v[32:39], v9
  ds_read_b128 v[72:75], v116 offset:20480
  ds_read_b128 v[76:79], v116 offset:21504
  s_waitcnt lgkmcnt(6)
  v_smfmac_f32_16x16x64_bf16 v[112:115], v[100:103], v[48:55], v9
  ds_read_b128 v[80:83], v116 offset:22528
  ds_read_b128 v[84:87], v116 offset:23552
  ds_read_b64_tr_b16 v[120:121], v117 offset:0
  ds_read_b64_tr_b16 v[122:123], v117 offset:32
  s_barrier
  s_waitcnt vmcnt(4)
  s_nop 1
  v_cvt_pk_bf16_f32 v112, v112, v113
  v_cvt_pk_bf16_f32 v113, v114, v115
  v_and_b32 v112, -2, v112
  buffer_store_dwordx2 v[112:113], v4, s[4:7], s25 offen offset:1024 sc1
  ds_read_b64_tr_b16 v[32:33], v11 offset:0
  ds_read_b64_tr_b16 v[34:35], v11 offset:32
  ds_read_b64_tr_b16 v[36:37], v11 offset:2048
  ds_read_b64_tr_b16 v[38:39], v11 offset:2080
  ds_read_b64_tr_b16 v[40:41], v11 offset:4096
  ds_read_b64_tr_b16 v[42:43], v11 offset:4128
  ds_read_b64_tr_b16 v[44:45], v11 offset:6144
  ds_read_b64_tr_b16 v[46:47], v11 offset:6176
  v_mov_b64 v[48:49], v[24:25]
  v_mov_b64 v[50:51], v[26:27]
  v_mov_b64 v[52:53], v[28:29]
  v_mov_b64 v[54:55], v[30:31]
  s_waitcnt vmcnt(2)
  buffer_load_dwordx2 v[20:21], v4, s[4:7], s27 offen offset:512 sc1
  s_waitcnt vmcnt(2)
  v_and_b32 v114, 1, v104
  v_cmp_ne_u32 vcc, 0, v114
  s_cbranch_vccnz .kx_155
.kok_156:
  ds_write_b64 v4, v[104:105] offset:25120
  s_waitcnt lgkmcnt(0)
  s_barrier
  ds_read_b64_tr_b16 v[88:89], v10 offset:0
  ds_read_b64_tr_b16 v[90:91], v10 offset:32
  ds_read_b64_tr_b16 v[92:93], v10 offset:2048
  ds_read_b64_tr_b16 v[94:95], v10 offset:2080
  ds_read_b64_tr_b16 v[96:97], v10 offset:4096
  ds_read_b64_tr_b16 v[98:99], v10 offset:4128
  ds_read_b64_tr_b16 v[100:101], v10 offset:6144
  ds_read_b64_tr_b16 v[102:103], v10 offset:6176
  s_waitcnt lgkmcnt(6)
  v_mfma_f32_16x16x32_bf16 v[124:127], v[32:35], v[88:91], 0
  s_waitcnt lgkmcnt(4)
  v_mfma_f32_16x16x32_bf16 v[124:127], v[36:39], v[92:95], v[124:127]
  s_waitcnt lgkmcnt(2)
  v_mfma_f32_16x16x32_bf16 v[124:127], v[40:43], v[96:99], v[124:127]
  s_waitcnt lgkmcnt(0)
  v_mfma_f32_16x16x32_bf16 v[124:127], v[44:47], v[100:103], v[124:127]
  buffer_load_dwordx2 v[118:119], v4, s[4:7], s27 offen offset:1024 sc1
  s_waitcnt vmcnt(1)
  v_and_b32 v114, 1, v20
  v_cmp_ne_u32 vcc, 0, v114
  s_cbranch_vccnz .kx_157
.kok_158:
  ds_write_b64 v4, v[20:21] offset:8704
  v_mfma_f32_16x16x32_bf16 v[104:107], v[56:59], v[88:91], 0
  buffer_store_dwordx2 v[112:113], v4, s[4:7], s36 offen offset:1024 sc1
  v_mfma_f32_16x16x32_bf16 v[108:111], v[60:63], v[88:91], 0
  s_mov_b64 exec, s[12:13]
  buffer_store_dwordx4 v[120:123], v0, s[4:7], s36 offen sc1
  s_mov_b64 exec, -1
  v_mfma_f32_16x16x32_bf16 v[104:107], v[64:67], v[92:95], v[104:107]
  v_mfma_f32_16x16x32_bf16 v[108:111], v[68:71], v[92:95], v[108:111]
  s_waitcnt lgkmcnt(0)
  s_barrier
  ds_read_b64_tr_b16 v[32:33], v11 offset:512
  ds_read_b64_tr_b16 v[34:35], v11 offset:544
  ds_read_b64_tr_b16 v[36:37], v11 offset:2560
  ds_read_b64_tr_b16 v[38:39], v11 offset:2592
  ds_read_b64_tr_b16 v[40:41], v11 offset:4608
  ds_read_b64_tr_b16 v[42:43], v11 offset:4640
  ds_read_b64_tr_b16 v[44:45], v11 offset:6656
  ds_read_b64_tr_b16 v[46:47], v11 offset:6688
  v_mfma_f32_16x16x32_bf16 v[104:107], v[72:75], v[96:99], v[104:107]
  buffer_load_dwordx4 v[16:19], v0, s[4:7], s33 offen offset:0 sc1
  v_mfma_f32_16x16x32_bf16 v[108:111], v[76:79], v[96:99], v[108:111]
  buffer_load_dwordx4 v[20:23], v0, s[4:7], s33 offen offset:1024 sc1
  v_mfma_f32_16x16x32_bf16 v[104:107], v[80:83], v[100:103], v[104:107]
  buffer_load_dwordx4 v[24:27], v0, s[4:7], s34 offen offset:0 sc1
  v_mfma_f32_16x16x32_bf16 v[108:111], v[84:87], v[100:103], v[108:111]
  buffer_load_dwordx4 v[28:31], v0, s[4:7], s34 offen offset:1024 sc1
  s_add_u32 s33, s33, 262144
  s_add_u32 s34, s34, 262144
  s_add_u32 s36, s36, 262144
  ds_read_b128 v[56:59], v5 offset:16384
  ds_read_b128 v[60:63], v5 offset:17408
  s_waitcnt lgkmcnt(8)
  v_mfma_f32_16x16x32_bf16 v[124:127], v[32:35], v[88:91], v[124:127]
  v_add_f32_dpp v104, v104, v104 row_ror:8 row_mask:0xf bank_mask:0xf
  v_add_f32_dpp v105, v105, v105 row_ror:8 row_mask:0xf bank_mask:0xf
  v_add_f32_dpp v106, v106, v106 row_ror:8 row_mask:0xf bank_mask:0xf
  s_waitcnt lgkmcnt(6)
  v_mfma_f32_16x16x32_bf16 v[124:127], v[36:39], v[92:95], v[124:127]
  v_add_f32_dpp v107, v107, v107 row_ror:8 row_mask:0xf bank_mask:0xf
  v_add_f32_dpp v108, v108, v108 row_ror:8 row_mask:0xf bank_mask:0xf
  v_add_f32_dpp v109, v109, v109 row_ror:8 row_mask:0xf bank_mask:0xf
  s_waitcnt lgkmcnt(4)
  v_mfma_f32_16x16x32_bf16 v[124:127], v[40:43], v[96:99], v[124:127]
  v_add_f32_dpp v110, v110, v110 row_ror:8 row_mask:0xf bank_mask:0xf
  v_add_f32_dpp v111, v111, v111 row_ror:8 row_mask:0xf bank_mask:0xf
  v_max3_f32 v120, v104, v105, v106
  s_waitcnt lgkmcnt(2)
  v_mfma_f32_16x16x32_bf16 v[124:127], v[44:47], v[100:103], v[124:127]
  v_max3_f32 v120, v120, v107, v108
  v_max3_f32 v121, v109, v110, v111
  v_max_f32 v120, v120, v121
  v_mov_b32 v121, v120
  ds_read_b128 v[64:67], v5 offset:18432
  ds_read_b128 v[68:71], v5 offset:19456
  v_permlane32_swap_b32 v120, v121
  v_max_f32 v120, v120, v121
  v_add_f32_dpp v124, v124, v124 row_ror:8 row_mask:0xf bank_mask:0xf
  v_add_f32_dpp v125, v125, v125 row_ror:8 row_mask:0xf bank_mask:0xf
  v_add_f32_dpp v126, v126, v126 row_ror:8 row_mask:0xf bank_mask:0xf
  v_add_f32_dpp v127, v127, v127 row_ror:8 row_mask:0xf bank_mask:0xf
  v_max3_f32 v120, v120, v124, v125
  v_max3_f32 v120, v120, v126, v127
  v_mov_b32 v121, v120
  ds_read_b128 v[72:75], v5 offset:20480
  ds_read_b128 v[76:79], v5 offset:21504
  v_permlane16_swap_b32 v120, v121
  v_max_f32 v120, v120, v121
  v_mul_f32 v120, s40, v120
  v_pk_fma_f32 v[104:105], v[104:105], s[40:41], v[120:121] op_sel_hi:[1,1,0] neg_lo:[0,0,1] neg_hi:[0,0,1]
  v_pk_fma_f32 v[106:107], v[106:107], s[40:41], v[120:121] op_sel_hi:[1,1,0] neg_lo:[0,0,1] neg_hi:[0,0,1]
  v_pk_fma_f32 v[108:109], v[108:109], s[40:41], v[120:121] op_sel_hi:[1,1,0] neg_lo:[0,0,1] neg_hi:[0,0,1]
  v_pk_fma_f32 v[110:111], v[110:111], s[40:41], v[120:121] op_sel_hi:[1,1,0] neg_lo:[0,0,1] neg_hi:[0,0,1]
  v_exp_f32 v104, v104
  ds_read_b128 v[80:83], v5 offset:22528
  v_exp_f32 v105, v105
  ds_read_b128 v[84:87], v5 offset:23552
  v_exp_f32 v106, v106
  v_cvt_pk_bf16_f32 v32, v104, v105
  v_exp_f32 v107, v107
  ds_read_b128 v[40:43], v5 offset:24576
  v_exp_f32 v108, v108
  v_cvt_pk_bf16_f32 v33, v106, v107
  v_exp_f32 v109, v109
  ds_read_b128 v[44:47], v5 offset:25600
  v_exp_f32 v110, v110
  v_cvt_pk_bf16_f32 v34, v108, v109
  v_exp_f32 v111, v111
  ds_read_b128 v[88:91], v5 offset:26624
  ds_read_b128 v[92:95], v5 offset:27648
  v_pk_fma_f32 v[124:125], v[124:125], s[40:41], v[120:121] op_sel_hi:[1,1,0] neg_lo:[0,0,1] neg_hi:[0,0,1]
  v_cvt_pk_bf16_f32 v35, v110, v111
  v_pk_fma_f32 v[126:127], v[126:127], s[40:41], v[120:121] op_sel_hi:[1,1,0] neg_lo:[0,0,1] neg_hi:[0,0,1]
  v_exp_f32 v124, v124
  v_mfma_f32_16x16x32_bf16 v[96:99], v[48:51], v[32:35], 0
  v_exp_f32 v125, v125
  v_exp_f32 v126, v126
  v_mfma_f32_16x16x32_bf16 v[100:103], v[52:55], v[32:35], 0
  v_exp_f32 v127, v127
  v_cvt_pk_bf16_f32 v36, v124, v125
  v_mfma_f32_16x16x16_bf16 v[48:51], v[12:13], v[32:33], 0
  v_cvt_pk_bf16_f32 v37, v126, v127
  s_waitcnt vmcnt(6)
  v_and_b32 v121, 1, v118
  v_mfma_f32_16x16x16_bf16 v[48:51], v[12:13], v[34:35], v[48:51]
  v_cmp_ne_u32 vcc, 0, v121
  s_cbranch_vccnz .vs_159
.vc_160:
  v_permlane32_swap_b32 v112, v118
  v_permlane32_swap_b32 v113, v119
  v_mfma_f32_16x16x16_bf16 v[48:51], v[14:15], v[36:37], v[48:51]
  v_mov_b64 v[104:105], 0
  v_mfma_f32_16x16x16_bf16 v[96:99], v[112:113], v[36:37], v[96:99]
  v_mov_b64 v[106:107], 0
  v_mfma_f32_16x16x16_bf16 v[100:103], v[118:119], v[36:37], v[100:103]
  v_mov_b64 v[108:109], 0
  v_mov_b64 v[110:111], 0
  v_mov_b64 v[120:121], 0
  v_mov_b64 v[122:123], 0
  v_mov_b64 v[124:125], 0
  v_rcp_f32 v48, v48
  v_mov_b64 v[126:127], 0
  v_pk_mul_f32 v[96:97], v[96:97], v[48:49] op_sel_hi:[1,0]
  v_pk_mul_f32 v[98:99], v[98:99], v[48:49] op_sel_hi:[1,0]
  v_pk_mul_f32 v[100:101], v[100:101], v[48:49] op_sel_hi:[1,0]
  v_pk_mul_f32 v[102:103], v[102:103], v[48:49] op_sel_hi:[1,0]
  v_cvt_pk_bf16_f32 v52, v96, v97
  v_cvt_pk_bf16_f32 v53, v98, v99
  v_cvt_pk_bf16_f32 v54, v100, v101
  v_cvt_pk_bf16_f32 v55, v102, v103
  ds_write_b128 v0, v[52:55] offset:9216
  s_waitcnt lgkmcnt(11)
  v_smfmac_f32_16x16x64_bf16 v[104:107], v[52:55], v[56:63], v9
  s_waitcnt lgkmcnt(9)
  v_smfmac_f32_16x16x64_bf16 v[108:111], v[52:55], v[64:71], v9
  s_waitcnt lgkmcnt(7)
  v_smfmac_f32_16x16x64_bf16 v[120:123], v[52:55], v[72:79], v9
  s_waitcnt lgkmcnt(0)
  s_barrier
  ds_read_b128 v[96:99], v1 offset:9216
  v_smfmac_f32_16x16x64_bf16 v[124:127], v[52:55], v[80:87], v9
  ds_read_b128 v[100:103], v2 offset:9216
  ds_read_b128 v[32:35], v3 offset:9216
  ds_read_b128 v[56:59], v5 offset:28672
  ds_read_b128 v[60:63], v5 offset:29696
  ds_read_b128 v[64:67], v5 offset:30720
  ds_read_b128 v[68:71], v5 offset:31744
  s_waitcnt lgkmcnt(6)
  v_smfmac_f32_16x16x64_bf16 v[104:107], v[96:99], v[192:199], v9
  v_smfmac_f32_16x16x64_bf16 v[108:111], v[96:99], v[200:207], v9
  s_waitcnt lgkmcnt(5)
  v_smfmac_f32_16x16x64_bf16 v[104:107], v[100:103], v[224:231], v9
  v_smfmac_f32_16x16x64_bf16 v[108:111], v[100:103], v[232:239], v9
  s_waitcnt lgkmcnt(4)
  v_smfmac_f32_16x16x64_bf16 v[104:107], v[32:35], v[40:47], v9
  v_smfmac_f32_16x16x64_bf16 v[108:111], v[32:35], v[88:95], v9
  v_smfmac_f32_16x16x64_bf16 v[120:123], v[96:99], v[208:215], v9
  v_smfmac_f32_16x16x64_bf16 v[124:127], v[96:99], v[216:223], v9
  v_cvt_pk_bf16_f32 v104, v104, v105
  v_cvt_pk_bf16_f32 v105, v106, v107
  v_smfmac_f32_16x16x64_bf16 v[120:123], v[100:103], v[240:247], v9
  v_cvt_pk_bf16_f32 v106, v108, v109
  v_cvt_pk_bf16_f32 v107, v110, v111
  v_smfmac_f32_16x16x64_bf16 v[124:127], v[100:103], v[248:255], v9
  v_permlane16_swap_b32 v104, v106
  v_permlane16_swap_b32 v105, v107
  s_waitcnt lgkmcnt(2)
  v_smfmac_f32_16x16x64_bf16 v[120:123], v[32:35], v[56:63], v9
  v_and_b32 v104, -2, v104
  buffer_store_dwordx4 v[104:107], v6, s[4:7], s29 offen
  s_waitcnt lgkmcnt(0)
  v_smfmac_f32_16x16x64_bf16 v[124:127], v[32:35], v[64:71], v9
  s_nop 3
  v_cvt_pk_bf16_f32 v120, v120, v121
  v_cvt_pk_bf16_f32 v121, v122, v123
  s_nop 1
  v_cvt_pk_bf16_f32 v122, v124, v125
  v_cvt_pk_bf16_f32 v123, v126, v127
  s_nop 0
  v_permlane16_swap_b32 v120, v122
  v_permlane16_swap_b32 v121, v123
  v_and_b32 v120, -2, v120
  buffer_store_dwordx4 v[120:123], v6, s[4:7], s30 offen
  v_and_b32 v52, 16, v5
  v_mov_b32 v53, 0x3f80
  v_lshlrev_b32 v52, v52, v53
  s_mov_b32 vcc_lo, 0x30003
  s_mov_b32 vcc_hi, 0x30003
  v_cndmask_b32 v48, 0, v52, vcc
  s_mov_b32 vcc_lo, 0x300030
  s_mov_b32 vcc_hi, 0x300030
  v_cndmask_b32 v49, 0, v52, vcc
  s_mov_b32 vcc_lo, 0x3000300
  s_mov_b32 vcc_hi, 0x3000300
  v_cndmask_b32 v50, 0, v52, vcc
  s_mov_b32 vcc_lo, 0x30003000
  s_mov_b32 vcc_hi, 0x30003000
  v_cndmask_b32 v51, 0, v52, vcc
  v_mov_b32 v52, -1
  s_waitcnt vmcnt(0)
  buffer_load_dwordx4 v[64:67], v7, s[4:7], s31 offen offset:0 sc1
  buffer_load_dwordx4 v[68:71], v7, s[4:7], s32 offen offset:0 sc1
  s_waitcnt vmcnt(0)
.pl_162:
  v_bitop3_b32 v60, v64, v68, 1 bitop3:0xa8
  v_cmp_ne_u32 vcc, 0, v60
  s_cbranch_vccnz .pr_163
  v_mfma_f32_16x16x32_bf16 v[56:59], v[48:51], v[64:67], 0
  v_mfma_f32_16x16x32_bf16 v[56:59], v[48:51], v[68:71], v[56:59]
  s_nop 7
  v_add_f32_dpp v60, v56, v56 row_ror:8 row_mask:0xf bank_mask:0x3
  v_add_f32_dpp v60, v57, v57 row_ror:8 row_mask:0xf bank_mask:0xc
  s_nop 1
  v_add_f32_dpp v60, v60, v60 row_shl:4 row_mask:0xf bank_mask:0xf
  s_nop 1
  v_mov_b32_dpp v61, v60 quad_perm:[1,1,3,3] row_mask:0xf bank_mask:0xf
  v_cvt_pk_bf16_f32 v62, v60, v61
  v_min_u32 v62, -2, v62
  buffer_store_dword v62, v8, s[4:7], s24 offen offset:0
  buffer_store_dword v52, v8, s[4:7], s23 offen offset:0
  s_add_u32 s19, s19, 1
  ds_write_b128 v0, v[16:19] offset:16384
  ds_write_b128 v0, v[20:23] offset:17408
  v_mov_b64 v[104:105], 0
  v_mov_b64 v[106:107], 0
  v_mov_b64 v[108:109], 0
  v_mov_b64 v[110:111], 0
  v_mov_b64 v[112:113], 0
  v_mov_b64 v[114:115], 0
  v_xor_b32 v116, 512, v0
  v_xor_b32 v117, 512, v1
  v_xor_b32 v118, 512, v2
  v_xor_b32 v119, 512, v3
  s_waitcnt vmcnt(0)
  buffer_load_dwordx4 v[32:35], v0, s[4:7], s22 offen offset:0 sc1
  buffer_load_dwordx4 v[36:39], v0, s[4:7], s22 offen offset:1024 sc1
  s_waitcnt vmcnt(0)
.ml_164:
  v_max3_u32 v120, v32, v33, v34
  v_max3_u32 v121, v35, v36, v37
  v_max3_u32 v120, v120, v38, v39
  v_max_u32 v120, v120, v121
  v_cmp_eq_u32 vcc, -1, v120
  s_cbranch_vccnz .mr_165
  ds_write_b128 v0, v[32:35]
  ds_write_b128 v0, v[36:39] offset:1024
  v_smfmac_f32_16x16x64_bf16 v[104:107], v[32:35], a[0:7], v9
  ds_read_b128 v[48:51], v116
  ds_read_b128 v[52:55], v116 offset:1024
  v_smfmac_f32_16x16x64_bf16 v[104:107], v[36:39], a[16:23], v9
  v_smfmac_f32_16x16x64_bf16 v[108:111], v[32:35], a[128:135], v9
  s_waitcnt lgkmcnt(2)
  s_barrier
  ds_read_b128 v[56:59], v1 offset:0
  ds_read_b128 v[60:63], v117 offset:0
  v_smfmac_f32_16x16x64_bf16 v[108:111], v[36:39], a[144:151], v9
  ds_read_b128 v[64:67], v1 offset:1024
  ds_read_b128 v[68:71], v117 offset:1024
  s_waitcnt lgkmcnt(5)
  v_smfmac_f32_16x16x64_bf16 v[104:107], v[48:51], a[8:15], v9
  ds_read_b128 v[72:75], v2 offset:0
  ds_read_b128 v[76:79], v118 offset:0
  s_waitcnt lgkmcnt(6)
  v_smfmac_f32_16x16x64_bf16 v[104:107], v[52:55], a[24:31], v9
  ds_read_b128 v[80:83], v2 offset:1024
  ds_read_b128 v[84:87], v118 offset:1024
  v_smfmac_f32_16x16x64_bf16 v[108:111], v[48:51], a[136:143], v9
  ds_read_b128 v[88:91], v3 offset:0
  ds_read_b128 v[92:95], v119 offset:0
  v_smfmac_f32_16x16x64_bf16 v[108:111], v[52:55], a[152:159], v9
  ds_read_b128 v[96:99], v3 offset:1024
  ds_read_b128 v[100:103], v119 offset:1024
  v_smfmac_f32_16x16x64_bf16 v[112:115], v[32:35], v[128:135], v9
  v_smfmac_f32_16x16x64_bf16 v[112:115], v[36:39], v[144:151], v9
  s_waitcnt lgkmcnt(11)
  v_smfmac_f32_16x16x64_bf16 v[104:107], v[56:59], a[32:39], v9
  s_waitcnt lgkmcnt(10)
  v_smfmac_f32_16x16x64_bf16 v[104:107], v[60:63], a[40:47], v9
  s_waitcnt lgkmcnt(9)
  v_smfmac_f32_16x16x64_bf16 v[104:107], v[64:67], a[48:55], v9
  v_mov_b64 v[124:125], -1
  s_lshr_b32 s42, s19, 2
  s_mul_i32 s43, s42, -786432
  s_add_u32 s43, s43, s36
  s_add_u32 s43, s43, 14417920
  s_cmp_lt_u32 s42, 8
  s_cselect_b64 exec, -1, 0
  s_cselect_b32 s43, s43, s36
  buffer_store_dwordx2 v[124:125], v4, s[4:7], s43 offen offset:0 sc1
  buffer_store_dwordx2 v[124:125], v4, s[4:7], s43 offen offset:1024 sc1
  s_mov_b64 exec, -1
  s_waitcnt lgkmcnt(8)
  v_smfmac_f32_16x16x64_bf16 v[104:107], v[68:71], a[56:63], v9
  v_mov_b32 v124, 0
  v_mov_b32 v125, s19
  s_waitcnt lgkmcnt(7)
  v_smfmac_f32_16x16x64_bf16 v[104:107], v[72:75], a[64:71], v9
  s_mov_b32 exec_lo, 0x01010101
  s_mov_b32 exec_hi, 0x01010101
  buffer_store_dword v124, v0, s[4:7], s27 offen offset:0 sc1
  s_mov_b64 exec, -1
  s_waitcnt lgkmcnt(6)
  v_smfmac_f32_16x16x64_bf16 v[104:107], v[76:79], a[72:79], v9
  s_mov_b32 exec_lo, 0x01010101
  s_mov_b32 exec_hi, 0x01010101
  buffer_store_dword v124, v0, s[4:7], s27 offen offset:1024 sc1
  s_mov_b64 exec, -1
  s_waitcnt lgkmcnt(5)
  v_smfmac_f32_16x16x64_bf16 v[104:107], v[80:83], a[80:87], v9
  s_mov_b64 exec, 1
  buffer_store_dword v125, off, s[4:7], s37 sc1
  s_mov_b64 exec, -1
  s_waitcnt lgkmcnt(4)
  v_smfmac_f32_16x16x64_bf16 v[104:107], v[84:87], a[88:95], v9
  s_waitcnt lgkmcnt(3)
  v_smfmac_f32_16x16x64_bf16 v[104:107], v[88:91], a[96:103], v9
  s_waitcnt lgkmcnt(2)
  v_smfmac_f32_16x16x64_bf16 v[104:107], v[92:95], a[104:111], v9
  s_waitcnt lgkmcnt(1)
  v_smfmac_f32_16x16x64_bf16 v[104:107], v[96:99], a[112:119], v9
  s_waitcnt lgkmcnt(0)
  v_smfmac_f32_16x16x64_bf16 v[104:107], v[100:103], a[120:127], v9
  v_smfmac_f32_16x16x64_bf16 v[108:111], v[56:59], a[160:167], v9
  v_smfmac_f32_16x16x64_bf16 v[108:111], v[60:63], a[168:175], v9
  v_cvt_pk_bf16_f32 v104, v104, v105
  v_cvt_pk_bf16_f32 v105, v106, v107
  v_and_b32 v104, -2, v104
  buffer_store_dwordx2 v[104:105], v4, s[4:7], s26 offen offset:0 sc1
  ds_write_b64 v4, v[104:105] offset:24576
  v_smfmac_f32_16x16x64_bf16 v[108:111], v[64:67], a[176:183], v9
  v_smfmac_f32_16x16x64_bf16 v[108:111], v[68:71], a[184:191], v9
  v_smfmac_f32_16x16x64_bf16 v[108:111], v[72:75], a[192:199], v9
  ds_read_b128 v[40:43], v5 offset:0
  ds_read_b128 v[44:47], v5 offset:1024
  v_smfmac_f32_16x16x64_bf16 v[108:111], v[76:79], a[200:207], v9
  ds_read_b128 v[120:123], v5 offset:2048
  ds_read_b128 v[124:127], v5 offset:3072
  v_smfmac_f32_16x16x64_bf16 v[108:111], v[80:83], a[208:215], v9
  v_smfmac_f32_16x16x64_bf16 v[108:111], v[84:87], a[216:223], v9
  v_and_b32 v116, -6145, v0
  s_lshl_b32 s43, s18, 11
  v_add_u32 v117, s43, v11
  v_smfmac_f32_16x16x64_bf16 v[108:111], v[88:91], a[224:231], v9
  s_waitcnt vmcnt(6)
  ds_read_b128 v[32:35], v5 offset:4096
  ds_read_b128 v[36:39], v5 offset:5120
  v_smfmac_f32_16x16x64_bf16 v[108:111], v[92:95], a[232:239], v9
  v_smfmac_f32_16x16x64_bf16 v[108:111], v[96:99], a[240:247], v9
  v_smfmac_f32_16x16x64_bf16 v[108:111], v[100:103], a[248:255], v9
  v_smfmac_f32_16x16x64_bf16 v[112:115], v[48:51], v[136:143], v9
  v_smfmac_f32_16x16x64_bf16 v[112:115], v[52:55], v[152:159], v9
  v_cvt_pk_bf16_f32 v108, v108, v109
  v_cvt_pk_bf16_f32 v109, v110, v111
  v_and_b32 v108, -2, v108
  buffer_store_dwordx2 v[108:109], v4, s[4:7], s26 offen offset:512 sc1
  ds_write_b64 v4, v[108:109] offset:8192
  ds_read_b128 v[48:51], v5 offset:6144
  ds_read_b128 v[52:55], v5 offset:7168
  s_waitcnt lgkmcnt(7)
  v_smfmac_f32_16x16x64_bf16 v[112:115], v[72:75], v[40:47], v9
  ds_read_b128 v[40:43], v5 offset:8192
  ds_read_b128 v[44:47], v5 offset:9216
  s_waitcnt lgkmcnt(7)
  v_smfmac_f32_16x16x64_bf16 v[112:115], v[76:79], v[120:127], v9
  ds_read_b128 v[120:123], v5 offset:10240
  ds_read_b128 v[124:127], v5 offset:11264
  s_waitcnt lgkmcnt(7)
  v_smfmac_f32_16x16x64_bf16 v[112:115], v[80:83], v[32:39], v9
  ds_read_b128 v[32:35], v5 offset:12288
  ds_read_b128 v[36:39], v5 offset:13312
  v_smfmac_f32_16x16x64_bf16 v[112:115], v[56:59], v[160:167], v9
  v_smfmac_f32_16x16x64_bf16 v[112:115], v[60:63], v[168:175], v9
  buffer_load_dwordx2 v[104:105], v4, s[4:7], s28 offen offset:0 sc1
  s_waitcnt lgkmcnt(6)
  v_smfmac_f32_16x16x64_bf16 v[112:115], v[84:87], v[48:55], v9
  ds_read_b128 v[48:51], v5 offset:14336
  ds_read_b128 v[52:55], v5 offset:15360
  v_smfmac_f32_16x16x64_bf16 v[112:115], v[64:67], v[176:183], v9
  v_smfmac_f32_16x16x64_bf16 v[112:115], v[68:71], v[184:191], v9
  s_waitcnt lgkmcnt(6)
  v_smfmac_f32_16x16x64_bf16 v[112:115], v[88:91], v[40:47], v9
  ds_read_b128 v[56:59], v116 offset:16384
  ds_read_b128 v[60:63], v116 offset:17408
  s_waitcnt lgkmcnt(6)
  v_smfmac_f32_16x16x64_bf16 v[112:115], v[92:95], v[120:127], v9
  ds_read_b128 v[64:67], v116 offset:18432
  ds_read_b128 v[68:71], v116 offset:19456
  s_waitcnt lgkmcnt(6)
  v_smfmac_f32_16x16x64_bf16 v[112:115], v[96:99], v[32:39], v9
  ds_read_b128 v[72:75], v116 offset:20480
  ds_read_b128 v[76:79], v116 offset:21504
  s_waitcnt lgkmcnt(6)
  v_smfmac_f32_16x16x64_bf16 v[112:115], v[100:103], v[48:55], v9
  ds_read_b128 v[80:83], v116 offset:22528
  ds_read_b128 v[84:87], v116 offset:23552
  ds_read_b64_tr_b16 v[120:121], v117 offset:0
  ds_read_b64_tr_b16 v[122:123], v117 offset:32
  s_barrier
  s_waitcnt vmcnt(4)
  s_nop 1
  v_cvt_pk_bf16_f32 v112, v112, v113
  v_cvt_pk_bf16_f32 v113, v114, v115
  v_and_b32 v112, -2, v112
  buffer_store_dwordx2 v[112:113], v4, s[4:7], s26 offen offset:1024 sc1
  ds_read_b64_tr_b16 v[32:33], v11 offset:0
  ds_read_b64_tr_b16 v[34:35], v11 offset:32
  ds_read_b64_tr_b16 v[36:37], v11 offset:2048
  ds_read_b64_tr_b16 v[38:39], v11 offset:2080
  ds_read_b64_tr_b16 v[40:41], v11 offset:4096
  ds_read_b64_tr_b16 v[42:43], v11 offset:4128
  ds_read_b64_tr_b16 v[44:45], v11 offset:6144
  ds_read_b64_tr_b16 v[46:47], v11 offset:6176
  v_mov_b64 v[48:49], v[24:25]
  v_mov_b64 v[50:51], v[26:27]
  v_mov_b64 v[52:53], v[28:29]
  v_mov_b64 v[54:55], v[30:31]
  s_waitcnt vmcnt(2)
  buffer_load_dwordx2 v[20:21], v4, s[4:7], s28 offen offset:512 sc1
  s_waitcnt vmcnt(2)
  v_and_b32 v114, 1, v104
  v_cmp_ne_u32 vcc, 0, v114
  s_cbranch_vccnz .kx_166
.kok_167:
  ds_write_b64 v4, v[104:105] offset:25120
  s_waitcnt lgkmcnt(0)
  s_barrier
  ds_read_b64_tr_b16 v[88:89], v10 offset:0
  ds_read_b64_tr_b16 v[90:91], v10 offset:32
  ds_read_b64_tr_b16 v[92:93], v10 offset:2048
  ds_read_b64_tr_b16 v[94:95], v10 offset:2080
  ds_read_b64_tr_b16 v[96:97], v10 offset:4096
  ds_read_b64_tr_b16 v[98:99], v10 offset:4128
  ds_read_b64_tr_b16 v[100:101], v10 offset:6144
  ds_read_b64_tr_b16 v[102:103], v10 offset:6176
  s_waitcnt lgkmcnt(6)
  v_mfma_f32_16x16x32_bf16 v[124:127], v[32:35], v[88:91], 0
  s_waitcnt lgkmcnt(4)
  v_mfma_f32_16x16x32_bf16 v[124:127], v[36:39], v[92:95], v[124:127]
  s_waitcnt lgkmcnt(2)
  v_mfma_f32_16x16x32_bf16 v[124:127], v[40:43], v[96:99], v[124:127]
  s_waitcnt lgkmcnt(0)
  v_mfma_f32_16x16x32_bf16 v[124:127], v[44:47], v[100:103], v[124:127]
  buffer_load_dwordx2 v[118:119], v4, s[4:7], s28 offen offset:1024 sc1
  s_waitcnt vmcnt(1)
  v_and_b32 v114, 1, v20
  v_cmp_ne_u32 vcc, 0, v114
  s_cbranch_vccnz .kx_168
.kok_169:
  ds_write_b64 v4, v[20:21] offset:8704
  v_mfma_f32_16x16x32_bf16 v[104:107], v[56:59], v[88:91], 0
  buffer_store_dwordx2 v[112:113], v4, s[4:7], s36 offen offset:1024 sc1
  v_mfma_f32_16x16x32_bf16 v[108:111], v[60:63], v[88:91], 0
  s_mov_b64 exec, s[12:13]
  buffer_store_dwordx4 v[120:123], v0, s[4:7], s36 offen sc1
  s_mov_b64 exec, -1
  v_mfma_f32_16x16x32_bf16 v[104:107], v[64:67], v[92:95], v[104:107]
  v_mfma_f32_16x16x32_bf16 v[108:111], v[68:71], v[92:95], v[108:111]
  s_waitcnt lgkmcnt(0)
  s_barrier
  ds_read_b64_tr_b16 v[32:33], v11 offset:512
  ds_read_b64_tr_b16 v[34:35], v11 offset:544
  ds_read_b64_tr_b16 v[36:37], v11 offset:2560
  ds_read_b64_tr_b16 v[38:39], v11 offset:2592
  ds_read_b64_tr_b16 v[40:41], v11 offset:4608
  ds_read_b64_tr_b16 v[42:43], v11 offset:4640
  ds_read_b64_tr_b16 v[44:45], v11 offset:6656
  ds_read_b64_tr_b16 v[46:47], v11 offset:6688
  v_mfma_f32_16x16x32_bf16 v[104:107], v[72:75], v[96:99], v[104:107]
  buffer_load_dwordx4 v[16:19], v0, s[4:7], s33 offen offset:0 sc1
  v_mfma_f32_16x16x32_bf16 v[108:111], v[76:79], v[96:99], v[108:111]
  buffer_load_dwordx4 v[20:23], v0, s[4:7], s33 offen offset:1024 sc1
  v_mfma_f32_16x16x32_bf16 v[104:107], v[80:83], v[100:103], v[104:107]
  buffer_load_dwordx4 v[24:27], v0, s[4:7], s34 offen offset:0 sc1
  v_mfma_f32_16x16x32_bf16 v[108:111], v[84:87], v[100:103], v[108:111]
  buffer_load_dwordx4 v[28:31], v0, s[4:7], s34 offen offset:1024 sc1
  s_add_u32 s33, s33, 262144
  s_add_u32 s34, s34, 262144
  s_add_u32 s36, s36, 262144
  ds_read_b128 v[56:59], v5 offset:16384
  ds_read_b128 v[60:63], v5 offset:17408
  s_waitcnt lgkmcnt(8)
  v_mfma_f32_16x16x32_bf16 v[124:127], v[32:35], v[88:91], v[124:127]
  v_add_f32_dpp v104, v104, v104 row_ror:8 row_mask:0xf bank_mask:0xf
  v_add_f32_dpp v105, v105, v105 row_ror:8 row_mask:0xf bank_mask:0xf
  v_add_f32_dpp v106, v106, v106 row_ror:8 row_mask:0xf bank_mask:0xf
  s_waitcnt lgkmcnt(6)
  v_mfma_f32_16x16x32_bf16 v[124:127], v[36:39], v[92:95], v[124:127]
  v_add_f32_dpp v107, v107, v107 row_ror:8 row_mask:0xf bank_mask:0xf
  v_add_f32_dpp v108, v108, v108 row_ror:8 row_mask:0xf bank_mask:0xf
  v_add_f32_dpp v109, v109, v109 row_ror:8 row_mask:0xf bank_mask:0xf
  s_waitcnt lgkmcnt(4)
  v_mfma_f32_16x16x32_bf16 v[124:127], v[40:43], v[96:99], v[124:127]
  v_add_f32_dpp v110, v110, v110 row_ror:8 row_mask:0xf bank_mask:0xf
  v_add_f32_dpp v111, v111, v111 row_ror:8 row_mask:0xf bank_mask:0xf
  v_max3_f32 v120, v104, v105, v106
  s_waitcnt lgkmcnt(2)
  v_mfma_f32_16x16x32_bf16 v[124:127], v[44:47], v[100:103], v[124:127]
  v_max3_f32 v120, v120, v107, v108
  v_max3_f32 v121, v109, v110, v111
  v_max_f32 v120, v120, v121
  v_mov_b32 v121, v120
  ds_read_b128 v[64:67], v5 offset:18432
  ds_read_b128 v[68:71], v5 offset:19456
  v_permlane32_swap_b32 v120, v121
  v_max_f32 v120, v120, v121
  v_add_f32_dpp v124, v124, v124 row_ror:8 row_mask:0xf bank_mask:0xf
  v_add_f32_dpp v125, v125, v125 row_ror:8 row_mask:0xf bank_mask:0xf
  v_add_f32_dpp v126, v126, v126 row_ror:8 row_mask:0xf bank_mask:0xf
  v_add_f32_dpp v127, v127, v127 row_ror:8 row_mask:0xf bank_mask:0xf
  v_max3_f32 v120, v120, v124, v125
  v_max3_f32 v120, v120, v126, v127
  v_mov_b32 v121, v120
  ds_read_b128 v[72:75], v5 offset:20480
  ds_read_b128 v[76:79], v5 offset:21504
  v_permlane16_swap_b32 v120, v121
  v_max_f32 v120, v120, v121
  v_mul_f32 v120, s40, v120
  v_pk_fma_f32 v[104:105], v[104:105], s[40:41], v[120:121] op_sel_hi:[1,1,0] neg_lo:[0,0,1] neg_hi:[0,0,1]
  v_pk_fma_f32 v[106:107], v[106:107], s[40:41], v[120:121] op_sel_hi:[1,1,0] neg_lo:[0,0,1] neg_hi:[0,0,1]
  v_pk_fma_f32 v[108:109], v[108:109], s[40:41], v[120:121] op_sel_hi:[1,1,0] neg_lo:[0,0,1] neg_hi:[0,0,1]
  v_pk_fma_f32 v[110:111], v[110:111], s[40:41], v[120:121] op_sel_hi:[1,1,0] neg_lo:[0,0,1] neg_hi:[0,0,1]
  v_exp_f32 v104, v104
  ds_read_b128 v[80:83], v5 offset:22528
  v_exp_f32 v105, v105
  ds_read_b128 v[84:87], v5 offset:23552
  v_exp_f32 v106, v106
  v_cvt_pk_bf16_f32 v32, v104, v105
  v_exp_f32 v107, v107
  ds_read_b128 v[40:43], v5 offset:24576
  v_exp_f32 v108, v108
  v_cvt_pk_bf16_f32 v33, v106, v107
  v_exp_f32 v109, v109
  ds_read_b128 v[44:47], v5 offset:25600
  v_exp_f32 v110, v110
  v_cvt_pk_bf16_f32 v34, v108, v109
  v_exp_f32 v111, v111
  ds_read_b128 v[88:91], v5 offset:26624
  ds_read_b128 v[92:95], v5 offset:27648
  v_pk_fma_f32 v[124:125], v[124:125], s[40:41], v[120:121] op_sel_hi:[1,1,0] neg_lo:[0,0,1] neg_hi:[0,0,1]
  v_cvt_pk_bf16_f32 v35, v110, v111
  v_pk_fma_f32 v[126:127], v[126:127], s[40:41], v[120:121] op_sel_hi:[1,1,0] neg_lo:[0,0,1] neg_hi:[0,0,1]
  v_exp_f32 v124, v124
  v_mfma_f32_16x16x32_bf16 v[96:99], v[48:51], v[32:35], 0
  v_exp_f32 v125, v125
  v_exp_f32 v126, v126
  v_mfma_f32_16x16x32_bf16 v[100:103], v[52:55], v[32:35], 0
  v_exp_f32 v127, v127
  v_cvt_pk_bf16_f32 v36, v124, v125
  v_mfma_f32_16x16x16_bf16 v[48:51], v[12:13], v[32:33], 0
  v_cvt_pk_bf16_f32 v37, v126, v127
  s_waitcnt vmcnt(6)
  v_and_b32 v121, 1, v118
  v_mfma_f32_16x16x16_bf16 v[48:51], v[12:13], v[34:35], v[48:51]
  v_cmp_ne_u32 vcc, 0, v121
  s_cbranch_vccnz .vs_170
.vc_171:
  v_permlane32_swap_b32 v112, v118
  v_permlane32_swap_b32 v113, v119
  v_mfma_f32_16x16x16_bf16 v[48:51], v[14:15], v[36:37], v[48:51]
  v_mov_b64 v[104:105], 0
  v_mfma_f32_16x16x16_bf16 v[96:99], v[112:113], v[36:37], v[96:99]
  v_mov_b64 v[106:107], 0
  v_mfma_f32_16x16x16_bf16 v[100:103], v[118:119], v[36:37], v[100:103]
  v_mov_b64 v[108:109], 0
  v_mov_b64 v[110:111], 0
  v_mov_b64 v[120:121], 0
  v_mov_b64 v[122:123], 0
  v_mov_b64 v[124:125], 0
  v_rcp_f32 v48, v48
  v_mov_b64 v[126:127], 0
  v_pk_mul_f32 v[96:97], v[96:97], v[48:49] op_sel_hi:[1,0]
  v_pk_mul_f32 v[98:99], v[98:99], v[48:49] op_sel_hi:[1,0]
  v_pk_mul_f32 v[100:101], v[100:101], v[48:49] op_sel_hi:[1,0]
  v_pk_mul_f32 v[102:103], v[102:103], v[48:49] op_sel_hi:[1,0]
  v_cvt_pk_bf16_f32 v52, v96, v97
  v_cvt_pk_bf16_f32 v53, v98, v99
  v_cvt_pk_bf16_f32 v54, v100, v101
  v_cvt_pk_bf16_f32 v55, v102, v103
  ds_write_b128 v0, v[52:55] offset:9216
  s_waitcnt lgkmcnt(11)
  v_smfmac_f32_16x16x64_bf16 v[104:107], v[52:55], v[56:63], v9
  s_waitcnt lgkmcnt(9)
  v_smfmac_f32_16x16x64_bf16 v[108:111], v[52:55], v[64:71], v9
  s_waitcnt lgkmcnt(7)
  v_smfmac_f32_16x16x64_bf16 v[120:123], v[52:55], v[72:79], v9
  s_waitcnt lgkmcnt(0)
  s_barrier
  ds_read_b128 v[96:99], v1 offset:9216
  v_smfmac_f32_16x16x64_bf16 v[124:127], v[52:55], v[80:87], v9
  ds_read_b128 v[100:103], v2 offset:9216
  ds_read_b128 v[32:35], v3 offset:9216
  ds_read_b128 v[56:59], v5 offset:28672
  ds_read_b128 v[60:63], v5 offset:29696
  ds_read_b128 v[64:67], v5 offset:30720
  ds_read_b128 v[68:71], v5 offset:31744
  s_waitcnt lgkmcnt(6)
  v_smfmac_f32_16x16x64_bf16 v[104:107], v[96:99], v[192:199], v9
  v_smfmac_f32_16x16x64_bf16 v[108:111], v[96:99], v[200:207], v9
  s_waitcnt lgkmcnt(5)
  v_smfmac_f32_16x16x64_bf16 v[104:107], v[100:103], v[224:231], v9
  v_smfmac_f32_16x16x64_bf16 v[108:111], v[100:103], v[232:239], v9
  s_waitcnt lgkmcnt(4)
  v_smfmac_f32_16x16x64_bf16 v[104:107], v[32:35], v[40:47], v9
  v_smfmac_f32_16x16x64_bf16 v[108:111], v[32:35], v[88:95], v9
  v_smfmac_f32_16x16x64_bf16 v[120:123], v[96:99], v[208:215], v9
  v_smfmac_f32_16x16x64_bf16 v[124:127], v[96:99], v[216:223], v9
  v_cvt_pk_bf16_f32 v104, v104, v105
  v_cvt_pk_bf16_f32 v105, v106, v107
  v_smfmac_f32_16x16x64_bf16 v[120:123], v[100:103], v[240:247], v9
  v_cvt_pk_bf16_f32 v106, v108, v109
  v_cvt_pk_bf16_f32 v107, v110, v111
  v_smfmac_f32_16x16x64_bf16 v[124:127], v[100:103], v[248:255], v9
  v_permlane16_swap_b32 v104, v106
  v_permlane16_swap_b32 v105, v107
  s_waitcnt lgkmcnt(2)
  v_smfmac_f32_16x16x64_bf16 v[120:123], v[32:35], v[56:63], v9
  v_or_b32 v104, 1, v104
  buffer_store_dwordx4 v[104:107], v6, s[4:7], s29 offen
  s_waitcnt lgkmcnt(0)
  v_smfmac_f32_16x16x64_bf16 v[124:127], v[32:35], v[64:71], v9
  s_nop 3
  v_cvt_pk_bf16_f32 v120, v120, v121
  v_cvt_pk_bf16_f32 v121, v122, v123
  s_nop 1
  v_cvt_pk_bf16_f32 v122, v124, v125
  v_cvt_pk_bf16_f32 v123, v126, v127
  s_nop 0
  v_permlane16_swap_b32 v120, v122
  v_permlane16_swap_b32 v121, v123
  v_or_b32 v120, 1, v120
  buffer_store_dwordx4 v[120:123], v6, s[4:7], s30 offen
  v_and_b32 v52, 16, v5
  v_mov_b32 v53, 0x3f80
  v_lshlrev_b32 v52, v52, v53
  s_mov_b32 vcc_lo, 0x30003
  s_mov_b32 vcc_hi, 0x30003
  v_cndmask_b32 v48, 0, v52, vcc
  s_mov_b32 vcc_lo, 0x300030
  s_mov_b32 vcc_hi, 0x300030
  v_cndmask_b32 v49, 0, v52, vcc
  s_mov_b32 vcc_lo, 0x3000300
  s_mov_b32 vcc_hi, 0x3000300
  v_cndmask_b32 v50, 0, v52, vcc
  s_mov_b32 vcc_lo, 0x30003000
  s_mov_b32 vcc_hi, 0x30003000
  v_cndmask_b32 v51, 0, v52, vcc
  v_mov_b32 v52, -1
  s_waitcnt vmcnt(0)
  buffer_load_dwordx4 v[64:67], v7, s[4:7], s31 offen offset:0 sc1
  buffer_load_dwordx4 v[68:71], v7, s[4:7], s32 offen offset:0 sc1
  s_waitcnt vmcnt(0)
.pl_173:
  v_bitop3_b32 v60, v64, v68, 1 bitop3:0x80
  v_cmp_ne_u32 vcc, 1, v60
  s_cbranch_vccnz .pr_174
  v_mfma_f32_16x16x32_bf16 v[56:59], v[48:51], v[64:67], 0
  v_mfma_f32_16x16x32_bf16 v[56:59], v[48:51], v[68:71], v[56:59]
  s_nop 7
  v_add_f32_dpp v60, v56, v56 row_ror:8 row_mask:0xf bank_mask:0x3
  v_add_f32_dpp v60, v57, v57 row_ror:8 row_mask:0xf bank_mask:0xc
  s_nop 1
  v_add_f32_dpp v60, v60, v60 row_shl:4 row_mask:0xf bank_mask:0xf
  s_nop 1
  v_mov_b32_dpp v61, v60 quad_perm:[1,1,3,3] row_mask:0xf bank_mask:0xf
  v_cvt_pk_bf16_f32 v62, v60, v61
  v_min_u32 v62, -2, v62
  buffer_store_dword v62, v8, s[4:7], s23 offen offset:0
  buffer_store_dword v52, v8, s[4:7], s24 offen offset:0
  s_add_u32 s19, s19, 1
  ds_write_b128 v0, v[16:19] offset:16384
  ds_write_b128 v0, v[20:23] offset:17408
  v_mov_b64 v[104:105], 0
  v_mov_b64 v[106:107], 0
  v_mov_b64 v[108:109], 0
  v_mov_b64 v[110:111], 0
  v_mov_b64 v[112:113], 0
  v_mov_b64 v[114:115], 0
  v_xor_b32 v116, 512, v0
  v_xor_b32 v117, 512, v1
  v_xor_b32 v118, 512, v2
  v_xor_b32 v119, 512, v3
  s_waitcnt vmcnt(0)
  buffer_load_dwordx4 v[32:35], v0, s[4:7], s21 offen offset:0 sc1
  buffer_load_dwordx4 v[36:39], v0, s[4:7], s21 offen offset:1024 sc1
  s_waitcnt vmcnt(0)
.ml_175:
  v_max3_u32 v120, v32, v33, v34
  v_max3_u32 v121, v35, v36, v37
  v_max3_u32 v120, v120, v38, v39
  v_max_u32 v120, v120, v121
  v_cmp_eq_u32 vcc, -1, v120
  s_cbranch_vccnz .mr_176
  ds_write_b128 v0, v[32:35]
  ds_write_b128 v0, v[36:39] offset:1024
  v_smfmac_f32_16x16x64_bf16 v[104:107], v[32:35], a[0:7], v9
  ds_read_b128 v[48:51], v116
  ds_read_b128 v[52:55], v116 offset:1024
  v_smfmac_f32_16x16x64_bf16 v[104:107], v[36:39], a[16:23], v9
  v_smfmac_f32_16x16x64_bf16 v[108:111], v[32:35], a[128:135], v9
  s_waitcnt lgkmcnt(2)
  s_barrier
  ds_read_b128 v[56:59], v1 offset:0
  ds_read_b128 v[60:63], v117 offset:0
  v_smfmac_f32_16x16x64_bf16 v[108:111], v[36:39], a[144:151], v9
  ds_read_b128 v[64:67], v1 offset:1024
  ds_read_b128 v[68:71], v117 offset:1024
  s_waitcnt lgkmcnt(5)
  v_smfmac_f32_16x16x64_bf16 v[104:107], v[48:51], a[8:15], v9
  ds_read_b128 v[72:75], v2 offset:0
  ds_read_b128 v[76:79], v118 offset:0
  s_waitcnt lgkmcnt(6)
  v_smfmac_f32_16x16x64_bf16 v[104:107], v[52:55], a[24:31], v9
  ds_read_b128 v[80:83], v2 offset:1024
  ds_read_b128 v[84:87], v118 offset:1024
  v_smfmac_f32_16x16x64_bf16 v[108:111], v[48:51], a[136:143], v9
  ds_read_b128 v[88:91], v3 offset:0
  ds_read_b128 v[92:95], v119 offset:0
  v_smfmac_f32_16x16x64_bf16 v[108:111], v[52:55], a[152:159], v9
  ds_read_b128 v[96:99], v3 offset:1024
  ds_read_b128 v[100:103], v119 offset:1024
  v_smfmac_f32_16x16x64_bf16 v[112:115], v[32:35], v[128:135], v9
  v_smfmac_f32_16x16x64_bf16 v[112:115], v[36:39], v[144:151], v9
  s_waitcnt lgkmcnt(11)
  v_smfmac_f32_16x16x64_bf16 v[104:107], v[56:59], a[32:39], v9
  s_waitcnt lgkmcnt(10)
  v_smfmac_f32_16x16x64_bf16 v[104:107], v[60:63], a[40:47], v9
  s_waitcnt lgkmcnt(9)
  v_smfmac_f32_16x16x64_bf16 v[104:107], v[64:67], a[48:55], v9
  v_mov_b32 v124, 0
  v_mov_b32 v125, s19
  s_waitcnt lgkmcnt(8)
  v_smfmac_f32_16x16x64_bf16 v[104:107], v[68:71], a[56:63], v9
  s_mov_b32 exec_lo, 0x01010101
  s_mov_b32 exec_hi, 0x01010101
  buffer_store_dword v124, v0, s[4:7], s28 offen offset:0 sc1
  s_mov_b64 exec, -1
  s_waitcnt lgkmcnt(7)
  v_smfmac_f32_16x16x64_bf16 v[104:107], v[72:75], a[64:71], v9
  s_mov_b32 exec_lo, 0x01010101
  s_mov_b32 exec_hi, 0x01010101
  buffer_store_dword v124, v0, s[4:7], s28 offen offset:1024 sc1
  s_mov_b64 exec, -1
  s_waitcnt lgkmcnt(6)
  v_smfmac_f32_16x16x64_bf16 v[104:107], v[76:79], a[72:79], v9
  s_mov_b64 exec, 1
  buffer_store_dword v125, off, s[4:7], s37 sc1
  s_mov_b64 exec, -1
  s_waitcnt lgkmcnt(5)
  v_smfmac_f32_16x16x64_bf16 v[104:107], v[80:83], a[80:87], v9
  s_waitcnt lgkmcnt(4)
  v_smfmac_f32_16x16x64_bf16 v[104:107], v[84:87], a[88:95], v9
  s_waitcnt lgkmcnt(3)
  v_smfmac_f32_16x16x64_bf16 v[104:107], v[88:91], a[96:103], v9
  s_waitcnt lgkmcnt(2)
  v_smfmac_f32_16x16x64_bf16 v[104:107], v[92:95], a[104:111], v9
  s_waitcnt lgkmcnt(1)
  v_smfmac_f32_16x16x64_bf16 v[104:107], v[96:99], a[112:119], v9
  s_waitcnt lgkmcnt(0)
  v_smfmac_f32_16x16x64_bf16 v[104:107], v[100:103], a[120:127], v9
  v_smfmac_f32_16x16x64_bf16 v[108:111], v[56:59], a[160:167], v9
  v_smfmac_f32_16x16x64_bf16 v[108:111], v[60:63], a[168:175], v9
  v_cvt_pk_bf16_f32 v104, v104, v105
  v_cvt_pk_bf16_f32 v105, v106, v107
  v_or_b32 v104, 1, v104
  buffer_store_dwordx2 v[104:105], v4, s[4:7], s25 offen offset:0 sc1
  ds_write_b64 v4, v[104:105] offset:24576
  v_smfmac_f32_16x16x64_bf16 v[108:111], v[64:67], a[176:183], v9
  v_smfmac_f32_16x16x64_bf16 v[108:111], v[68:71], a[184:191], v9
  v_smfmac_f32_16x16x64_bf16 v[108:111], v[72:75], a[192:199], v9
  ds_read_b128 v[40:43], v5 offset:0
  ds_read_b128 v[44:47], v5 offset:1024
  v_smfmac_f32_16x16x64_bf16 v[108:111], v[76:79], a[200:207], v9
  ds_read_b128 v[120:123], v5 offset:2048
  ds_read_b128 v[124:127], v5 offset:3072
  v_smfmac_f32_16x16x64_bf16 v[108:111], v[80:83], a[208:215], v9
  v_smfmac_f32_16x16x64_bf16 v[108:111], v[84:87], a[216:223], v9
  v_and_b32 v116, -6145, v0
  s_lshl_b32 s43, s18, 11
  v_add_u32 v117, s43, v11
  v_smfmac_f32_16x16x64_bf16 v[108:111], v[88:91], a[224:231], v9
  s_waitcnt vmcnt(4)
  ds_read_b128 v[32:35], v5 offset:4096
  ds_read_b128 v[36:39], v5 offset:5120
  v_smfmac_f32_16x16x64_bf16 v[108:111], v[92:95], a[232:239], v9
  v_smfmac_f32_16x16x64_bf16 v[108:111], v[96:99], a[240:247], v9
  v_smfmac_f32_16x16x64_bf16 v[108:111], v[100:103], a[248:255], v9
  v_smfmac_f32_16x16x64_bf16 v[112:115], v[48:51], v[136:143], v9
  v_smfmac_f32_16x16x64_bf16 v[112:115], v[52:55], v[152:159], v9
  v_cvt_pk_bf16_f32 v108, v108, v109
  v_cvt_pk_bf16_f32 v109, v110, v111
  v_or_b32 v108, 1, v108
  buffer_store_dwordx2 v[108:109], v4, s[4:7], s25 offen offset:512 sc1
  ds_write_b64 v4, v[108:109] offset:8192
  ds_read_b128 v[48:51], v5 offset:6144
  ds_read_b128 v[52:55], v5 offset:7168
  s_waitcnt lgkmcnt(7)
  v_smfmac_f32_16x16x64_bf16 v[112:115], v[72:75], v[40:47], v9
  ds_read_b128 v[40:43], v5 offset:8192
  ds_read_b128 v[44:47], v5 offset:9216
  s_waitcnt lgkmcnt(7)
  v_smfmac_f32_16x16x64_bf16 v[112:115], v[76:79], v[120:127], v9
  ds_read_b128 v[120:123], v5 offset:10240
  ds_read_b128 v[124:127], v5 offset:11264
  s_waitcnt lgkmcnt(7)
  v_smfmac_f32_16x16x64_bf16 v[112:115], v[80:83], v[32:39], v9
  ds_read_b128 v[32:35], v5 offset:12288
  ds_read_b128 v[36:39], v5 offset:13312
  v_smfmac_f32_16x16x64_bf16 v[112:115], v[56:59], v[160:167], v9
  v_smfmac_f32_16x16x64_bf16 v[112:115], v[60:63], v[168:175], v9
  buffer_load_dwordx2 v[104:105], v4, s[4:7], s27 offen offset:0 sc1
  s_waitcnt lgkmcnt(6)
  v_smfmac_f32_16x16x64_bf16 v[112:115], v[84:87], v[48:55], v9
  ds_read_b128 v[48:51], v5 offset:14336
  ds_read_b128 v[52:55], v5 offset:15360
  v_smfmac_f32_16x16x64_bf16 v[112:115], v[64:67], v[176:183], v9
  v_smfmac_f32_16x16x64_bf16 v[112:115], v[68:71], v[184:191], v9
  s_waitcnt lgkmcnt(6)
  v_smfmac_f32_16x16x64_bf16 v[112:115], v[88:91], v[40:47], v9
  ds_read_b128 v[56:59], v116 offset:16384
  ds_read_b128 v[60:63], v116 offset:17408
  s_waitcnt lgkmcnt(6)
  v_smfmac_f32_16x16x64_bf16 v[112:115], v[92:95], v[120:127], v9
  ds_read_b128 v[64:67], v116 offset:18432
  ds_read_b128 v[68:71], v116 offset:19456
  s_waitcnt lgkmcnt(6)
  v_smfmac_f32_16x16x64_bf16 v[112:115], v[96:99], v[32:39], v9
  ds_read_b128 v[72:75], v116 offset:20480
  ds_read_b128 v[76:79], v116 offset:21504
  s_waitcnt lgkmcnt(6)
  v_smfmac_f32_16x16x64_bf16 v[112:115], v[100:103], v[48:55], v9
  ds_read_b128 v[80:83], v116 offset:22528
  ds_read_b128 v[84:87], v116 offset:23552
  ds_read_b64_tr_b16 v[120:121], v117 offset:0
  ds_read_b64_tr_b16 v[122:123], v117 offset:32
  s_barrier
  s_waitcnt vmcnt(4)
  s_nop 1
  v_cvt_pk_bf16_f32 v112, v112, v113
  v_cvt_pk_bf16_f32 v113, v114, v115
  v_or_b32 v112, 1, v112
  buffer_store_dwordx2 v[112:113], v4, s[4:7], s25 offen offset:1024 sc1
  ds_read_b64_tr_b16 v[32:33], v11 offset:0
  ds_read_b64_tr_b16 v[34:35], v11 offset:32
  ds_read_b64_tr_b16 v[36:37], v11 offset:2048
  ds_read_b64_tr_b16 v[38:39], v11 offset:2080
  ds_read_b64_tr_b16 v[40:41], v11 offset:4096
  ds_read_b64_tr_b16 v[42:43], v11 offset:4128
  ds_read_b64_tr_b16 v[44:45], v11 offset:6144
  ds_read_b64_tr_b16 v[46:47], v11 offset:6176
  v_mov_b64 v[48:49], v[24:25]
  v_mov_b64 v[50:51], v[26:27]
  v_mov_b64 v[52:53], v[28:29]
  v_mov_b64 v[54:55], v[30:31]
  s_waitcnt vmcnt(2)
  buffer_load_dwordx2 v[20:21], v4, s[4:7], s27 offen offset:512 sc1
  s_waitcnt vmcnt(2)
  v_and_b32 v114, 1, v104
  v_cmp_ne_u32 vcc, 1, v114
  s_cbranch_vccnz .kx_177
.kok_178:
  ds_write_b64 v4, v[104:105] offset:25120
  s_waitcnt lgkmcnt(0)
  s_barrier
  ds_read_b64_tr_b16 v[88:89], v10 offset:0
  ds_read_b64_tr_b16 v[90:91], v10 offset:32
  ds_read_b64_tr_b16 v[92:93], v10 offset:2048
  ds_read_b64_tr_b16 v[94:95], v10 offset:2080
  ds_read_b64_tr_b16 v[96:97], v10 offset:4096
  ds_read_b64_tr_b16 v[98:99], v10 offset:4128
  ds_read_b64_tr_b16 v[100:101], v10 offset:6144
  ds_read_b64_tr_b16 v[102:103], v10 offset:6176
  s_waitcnt lgkmcnt(6)
  v_mfma_f32_16x16x32_bf16 v[124:127], v[32:35], v[88:91], 0
  s_waitcnt lgkmcnt(4)
  v_mfma_f32_16x16x32_bf16 v[124:127], v[36:39], v[92:95], v[124:127]
  s_waitcnt lgkmcnt(2)
  v_mfma_f32_16x16x32_bf16 v[124:127], v[40:43], v[96:99], v[124:127]
  s_waitcnt lgkmcnt(0)
  v_mfma_f32_16x16x32_bf16 v[124:127], v[44:47], v[100:103], v[124:127]
  buffer_load_dwordx2 v[118:119], v4, s[4:7], s27 offen offset:1024 sc1
  s_waitcnt vmcnt(1)
  v_and_b32 v114, 1, v20
  v_cmp_ne_u32 vcc, 1, v114
  s_cbranch_vccnz .kx_179
.kok_180:
  ds_write_b64 v4, v[20:21] offset:8704
  v_mfma_f32_16x16x32_bf16 v[104:107], v[56:59], v[88:91], 0
  buffer_store_dwordx2 v[112:113], v4, s[4:7], s36 offen offset:1024 sc1
  v_mfma_f32_16x16x32_bf16 v[108:111], v[60:63], v[88:91], 0
  s_mov_b64 exec, s[12:13]
  buffer_store_dwordx4 v[120:123], v0, s[4:7], s36 offen sc1
  s_mov_b64 exec, -1
  v_mfma_f32_16x16x32_bf16 v[104:107], v[64:67], v[92:95], v[104:107]
  v_mfma_f32_16x16x32_bf16 v[108:111], v[68:71], v[92:95], v[108:111]
  s_waitcnt lgkmcnt(0)
  s_barrier
  ds_read_b64_tr_b16 v[32:33], v11 offset:512
  ds_read_b64_tr_b16 v[34:35], v11 offset:544
  ds_read_b64_tr_b16 v[36:37], v11 offset:2560
  ds_read_b64_tr_b16 v[38:39], v11 offset:2592
  ds_read_b64_tr_b16 v[40:41], v11 offset:4608
  ds_read_b64_tr_b16 v[42:43], v11 offset:4640
  ds_read_b64_tr_b16 v[44:45], v11 offset:6656
  ds_read_b64_tr_b16 v[46:47], v11 offset:6688
  v_mfma_f32_16x16x32_bf16 v[104:107], v[72:75], v[96:99], v[104:107]
  buffer_load_dwordx4 v[16:19], v0, s[4:7], s33 offen offset:0 sc1
  v_mfma_f32_16x16x32_bf16 v[108:111], v[76:79], v[96:99], v[108:111]
  buffer_load_dwordx4 v[20:23], v0, s[4:7], s33 offen offset:1024 sc1
  v_mfma_f32_16x16x32_bf16 v[104:107], v[80:83], v[100:103], v[104:107]
  buffer_load_dwordx4 v[24:27], v0, s[4:7], s34 offen offset:0 sc1
  v_mfma_f32_16x16x32_bf16 v[108:111], v[84:87], v[100:103], v[108:111]
  buffer_load_dwordx4 v[28:31], v0, s[4:7], s34 offen offset:1024 sc1
  s_add_u32 s33, s33, 262144
  s_add_u32 s34, s34, 262144
  s_add_u32 s36, s36, 262144
  ds_read_b128 v[56:59], v5 offset:16384
  ds_read_b128 v[60:63], v5 offset:17408
  s_waitcnt lgkmcnt(8)
  v_mfma_f32_16x16x32_bf16 v[124:127], v[32:35], v[88:91], v[124:127]
  v_add_f32_dpp v104, v104, v104 row_ror:8 row_mask:0xf bank_mask:0xf
  v_add_f32_dpp v105, v105, v105 row_ror:8 row_mask:0xf bank_mask:0xf
  v_add_f32_dpp v106, v106, v106 row_ror:8 row_mask:0xf bank_mask:0xf
  s_waitcnt lgkmcnt(6)
  v_mfma_f32_16x16x32_bf16 v[124:127], v[36:39], v[92:95], v[124:127]
  v_add_f32_dpp v107, v107, v107 row_ror:8 row_mask:0xf bank_mask:0xf
  v_add_f32_dpp v108, v108, v108 row_ror:8 row_mask:0xf bank_mask:0xf
  v_add_f32_dpp v109, v109, v109 row_ror:8 row_mask:0xf bank_mask:0xf
  s_waitcnt lgkmcnt(4)
  v_mfma_f32_16x16x32_bf16 v[124:127], v[40:43], v[96:99], v[124:127]
  v_add_f32_dpp v110, v110, v110 row_ror:8 row_mask:0xf bank_mask:0xf
  v_add_f32_dpp v111, v111, v111 row_ror:8 row_mask:0xf bank_mask:0xf
  v_max3_f32 v120, v104, v105, v106
  s_waitcnt lgkmcnt(2)
  v_mfma_f32_16x16x32_bf16 v[124:127], v[44:47], v[100:103], v[124:127]
  v_max3_f32 v120, v120, v107, v108
  v_max3_f32 v121, v109, v110, v111
  v_max_f32 v120, v120, v121
  v_mov_b32 v121, v120
  ds_read_b128 v[64:67], v5 offset:18432
  ds_read_b128 v[68:71], v5 offset:19456
  v_permlane32_swap_b32 v120, v121
  v_max_f32 v120, v120, v121
  v_add_f32_dpp v124, v124, v124 row_ror:8 row_mask:0xf bank_mask:0xf
  v_add_f32_dpp v125, v125, v125 row_ror:8 row_mask:0xf bank_mask:0xf
  v_add_f32_dpp v126, v126, v126 row_ror:8 row_mask:0xf bank_mask:0xf
  v_add_f32_dpp v127, v127, v127 row_ror:8 row_mask:0xf bank_mask:0xf
  v_max3_f32 v120, v120, v124, v125
  v_max3_f32 v120, v120, v126, v127
  v_mov_b32 v121, v120
  ds_read_b128 v[72:75], v5 offset:20480
  ds_read_b128 v[76:79], v5 offset:21504
  v_permlane16_swap_b32 v120, v121
  v_max_f32 v120, v120, v121
  v_mul_f32 v120, s40, v120
  v_pk_fma_f32 v[104:105], v[104:105], s[40:41], v[120:121] op_sel_hi:[1,1,0] neg_lo:[0,0,1] neg_hi:[0,0,1]
  v_pk_fma_f32 v[106:107], v[106:107], s[40:41], v[120:121] op_sel_hi:[1,1,0] neg_lo:[0,0,1] neg_hi:[0,0,1]
  v_pk_fma_f32 v[108:109], v[108:109], s[40:41], v[120:121] op_sel_hi:[1,1,0] neg_lo:[0,0,1] neg_hi:[0,0,1]
  v_pk_fma_f32 v[110:111], v[110:111], s[40:41], v[120:121] op_sel_hi:[1,1,0] neg_lo:[0,0,1] neg_hi:[0,0,1]
  v_exp_f32 v104, v104
  ds_read_b128 v[80:83], v5 offset:22528
  v_exp_f32 v105, v105
  ds_read_b128 v[84:87], v5 offset:23552
  v_exp_f32 v106, v106
  v_cvt_pk_bf16_f32 v32, v104, v105
  v_exp_f32 v107, v107
  ds_read_b128 v[40:43], v5 offset:24576
  v_exp_f32 v108, v108
  v_cvt_pk_bf16_f32 v33, v106, v107
  v_exp_f32 v109, v109
  ds_read_b128 v[44:47], v5 offset:25600
  v_exp_f32 v110, v110
  v_cvt_pk_bf16_f32 v34, v108, v109
  v_exp_f32 v111, v111
  ds_read_b128 v[88:91], v5 offset:26624
  ds_read_b128 v[92:95], v5 offset:27648
  v_pk_fma_f32 v[124:125], v[124:125], s[40:41], v[120:121] op_sel_hi:[1,1,0] neg_lo:[0,0,1] neg_hi:[0,0,1]
  v_cvt_pk_bf16_f32 v35, v110, v111
  v_pk_fma_f32 v[126:127], v[126:127], s[40:41], v[120:121] op_sel_hi:[1,1,0] neg_lo:[0,0,1] neg_hi:[0,0,1]
  v_exp_f32 v124, v124
  v_mfma_f32_16x16x32_bf16 v[96:99], v[48:51], v[32:35], 0
  v_exp_f32 v125, v125
  v_exp_f32 v126, v126
  v_mfma_f32_16x16x32_bf16 v[100:103], v[52:55], v[32:35], 0
  v_exp_f32 v127, v127
  v_cvt_pk_bf16_f32 v36, v124, v125
  v_mfma_f32_16x16x16_bf16 v[48:51], v[12:13], v[32:33], 0
  v_cvt_pk_bf16_f32 v37, v126, v127
  s_waitcnt vmcnt(6)
  v_and_b32 v121, 1, v118
  v_mfma_f32_16x16x16_bf16 v[48:51], v[12:13], v[34:35], v[48:51]
  v_cmp_ne_u32 vcc, 1, v121
  s_cbranch_vccnz .vs_181
.vc_182:
  v_permlane32_swap_b32 v112, v118
  v_permlane32_swap_b32 v113, v119
  v_mfma_f32_16x16x16_bf16 v[48:51], v[14:15], v[36:37], v[48:51]
  v_mov_b64 v[104:105], 0
  v_mfma_f32_16x16x16_bf16 v[96:99], v[112:113], v[36:37], v[96:99]
  v_mov_b64 v[106:107], 0
  v_mfma_f32_16x16x16_bf16 v[100:103], v[118:119], v[36:37], v[100:103]
  v_mov_b64 v[108:109], 0
  v_mov_b64 v[110:111], 0
  v_mov_b64 v[120:121], 0
  v_mov_b64 v[122:123], 0
  v_mov_b64 v[124:125], 0
  v_rcp_f32 v48, v48
  v_mov_b64 v[126:127], 0
  v_pk_mul_f32 v[96:97], v[96:97], v[48:49] op_sel_hi:[1,0]
  v_pk_mul_f32 v[98:99], v[98:99], v[48:49] op_sel_hi:[1,0]
  v_pk_mul_f32 v[100:101], v[100:101], v[48:49] op_sel_hi:[1,0]
  v_pk_mul_f32 v[102:103], v[102:103], v[48:49] op_sel_hi:[1,0]
  v_cvt_pk_bf16_f32 v52, v96, v97
  v_cvt_pk_bf16_f32 v53, v98, v99
  v_cvt_pk_bf16_f32 v54, v100, v101
  v_cvt_pk_bf16_f32 v55, v102, v103
  ds_write_b128 v0, v[52:55] offset:9216
  s_waitcnt lgkmcnt(11)
  v_smfmac_f32_16x16x64_bf16 v[104:107], v[52:55], v[56:63], v9
  s_waitcnt lgkmcnt(9)
  v_smfmac_f32_16x16x64_bf16 v[108:111], v[52:55], v[64:71], v9
  s_waitcnt lgkmcnt(7)
  v_smfmac_f32_16x16x64_bf16 v[120:123], v[52:55], v[72:79], v9
  s_waitcnt lgkmcnt(0)
  s_barrier
  ds_read_b128 v[96:99], v1 offset:9216
  v_smfmac_f32_16x16x64_bf16 v[124:127], v[52:55], v[80:87], v9
  ds_read_b128 v[100:103], v2 offset:9216
  ds_read_b128 v[32:35], v3 offset:9216
  ds_read_b128 v[56:59], v5 offset:28672
  ds_read_b128 v[60:63], v5 offset:29696
  ds_read_b128 v[64:67], v5 offset:30720
  ds_read_b128 v[68:71], v5 offset:31744
  s_waitcnt lgkmcnt(6)
  v_smfmac_f32_16x16x64_bf16 v[104:107], v[96:99], v[192:199], v9
  v_smfmac_f32_16x16x64_bf16 v[108:111], v[96:99], v[200:207], v9
  s_waitcnt lgkmcnt(5)
  v_smfmac_f32_16x16x64_bf16 v[104:107], v[100:103], v[224:231], v9
  v_smfmac_f32_16x16x64_bf16 v[108:111], v[100:103], v[232:239], v9
  s_waitcnt lgkmcnt(4)
  v_smfmac_f32_16x16x64_bf16 v[104:107], v[32:35], v[40:47], v9
  v_smfmac_f32_16x16x64_bf16 v[108:111], v[32:35], v[88:95], v9
  v_smfmac_f32_16x16x64_bf16 v[120:123], v[96:99], v[208:215], v9
  v_smfmac_f32_16x16x64_bf16 v[124:127], v[96:99], v[216:223], v9
  v_cvt_pk_bf16_f32 v104, v104, v105
  v_cvt_pk_bf16_f32 v105, v106, v107
  v_smfmac_f32_16x16x64_bf16 v[120:123], v[100:103], v[240:247], v9
  v_cvt_pk_bf16_f32 v106, v108, v109
  v_cvt_pk_bf16_f32 v107, v110, v111
  v_smfmac_f32_16x16x64_bf16 v[124:127], v[100:103], v[248:255], v9
  v_permlane16_swap_b32 v104, v106
  v_permlane16_swap_b32 v105, v107
  s_waitcnt lgkmcnt(2)
  v_smfmac_f32_16x16x64_bf16 v[120:123], v[32:35], v[56:63], v9
  v_and_b32 v104, -2, v104
  buffer_store_dwordx4 v[104:107], v6, s[4:7], s29 offen
  s_waitcnt lgkmcnt(0)
  v_smfmac_f32_16x16x64_bf16 v[124:127], v[32:35], v[64:71], v9
  s_nop 3
  v_cvt_pk_bf16_f32 v120, v120, v121
  v_cvt_pk_bf16_f32 v121, v122, v123
  s_nop 1
  v_cvt_pk_bf16_f32 v122, v124, v125
  v_cvt_pk_bf16_f32 v123, v126, v127
  s_nop 0
  v_permlane16_swap_b32 v120, v122
  v_permlane16_swap_b32 v121, v123
  v_and_b32 v120, -2, v120
  buffer_store_dwordx4 v[120:123], v6, s[4:7], s30 offen
  v_and_b32 v52, 16, v5
  v_mov_b32 v53, 0x3f80
  v_lshlrev_b32 v52, v52, v53
  s_mov_b32 vcc_lo, 0x30003
  s_mov_b32 vcc_hi, 0x30003
  v_cndmask_b32 v48, 0, v52, vcc
  s_mov_b32 vcc_lo, 0x300030
  s_mov_b32 vcc_hi, 0x300030
  v_cndmask_b32 v49, 0, v52, vcc
  s_mov_b32 vcc_lo, 0x3000300
  s_mov_b32 vcc_hi, 0x3000300
  v_cndmask_b32 v50, 0, v52, vcc
  s_mov_b32 vcc_lo, 0x30003000
  s_mov_b32 vcc_hi, 0x30003000
  v_cndmask_b32 v51, 0, v52, vcc
  v_mov_b32 v52, -1
  s_waitcnt vmcnt(0)
  buffer_load_dwordx4 v[64:67], v7, s[4:7], s31 offen offset:0 sc1
  buffer_load_dwordx4 v[68:71], v7, s[4:7], s32 offen offset:0 sc1
  s_waitcnt vmcnt(0)
.pl_184:
  v_bitop3_b32 v60, v64, v68, 1 bitop3:0xa8
  v_cmp_ne_u32 vcc, 0, v60
  s_cbranch_vccnz .pr_185
  v_mfma_f32_16x16x32_bf16 v[56:59], v[48:51], v[64:67], 0
  v_mfma_f32_16x16x32_bf16 v[56:59], v[48:51], v[68:71], v[56:59]
  s_nop 7
  v_add_f32_dpp v60, v56, v56 row_ror:8 row_mask:0xf bank_mask:0x3
  v_add_f32_dpp v60, v57, v57 row_ror:8 row_mask:0xf bank_mask:0xc
  s_nop 1
  v_add_f32_dpp v60, v60, v60 row_shl:4 row_mask:0xf bank_mask:0xf
  s_nop 1
  v_mov_b32_dpp v61, v60 quad_perm:[1,1,3,3] row_mask:0xf bank_mask:0xf
  v_cvt_pk_bf16_f32 v62, v60, v61
  v_min_u32 v62, -2, v62
  buffer_store_dword v62, v8, s[4:7], s24 offen offset:0
  buffer_store_dword v52, v8, s[4:7], s23 offen offset:0
  s_add_u32 s19, s19, 1
  s_cmp_eq_u32 s19, 63
  s_cbranch_scc1 .clast_148
  ds_write_b128 v0, v[16:19] offset:16384
  ds_write_b128 v0, v[20:23] offset:17408
  v_mov_b64 v[104:105], 0
  v_mov_b64 v[106:107], 0
  v_mov_b64 v[108:109], 0
  v_mov_b64 v[110:111], 0
  v_mov_b64 v[112:113], 0
  v_mov_b64 v[114:115], 0
  v_xor_b32 v116, 512, v0
  v_xor_b32 v117, 512, v1
  v_xor_b32 v118, 512, v2
  v_xor_b32 v119, 512, v3
  s_waitcnt vmcnt(0)
  buffer_load_dwordx4 v[32:35], v0, s[4:7], s22 offen offset:0 sc1
  buffer_load_dwordx4 v[36:39], v0, s[4:7], s22 offen offset:1024 sc1
  s_waitcnt vmcnt(0)
.ml_186:
  v_max3_u32 v120, v32, v33, v34
  v_max3_u32 v121, v35, v36, v37
  v_max3_u32 v120, v120, v38, v39
  v_max_u32 v120, v120, v121
  v_cmp_eq_u32 vcc, -1, v120
  s_cbranch_vccnz .mr_187
  ds_write_b128 v0, v[32:35]
  ds_write_b128 v0, v[36:39] offset:1024
  v_smfmac_f32_16x16x64_bf16 v[104:107], v[32:35], a[0:7], v9
  ds_read_b128 v[48:51], v116
  ds_read_b128 v[52:55], v116 offset:1024
  v_smfmac_f32_16x16x64_bf16 v[104:107], v[36:39], a[16:23], v9
  v_smfmac_f32_16x16x64_bf16 v[108:111], v[32:35], a[128:135], v9
  s_waitcnt lgkmcnt(2)
  s_barrier
  ds_read_b128 v[56:59], v1 offset:0
  ds_read_b128 v[60:63], v117 offset:0
  v_smfmac_f32_16x16x64_bf16 v[108:111], v[36:39], a[144:151], v9
  ds_read_b128 v[64:67], v1 offset:1024
  ds_read_b128 v[68:71], v117 offset:1024
  s_waitcnt lgkmcnt(5)
  v_smfmac_f32_16x16x64_bf16 v[104:107], v[48:51], a[8:15], v9
  ds_read_b128 v[72:75], v2 offset:0
  ds_read_b128 v[76:79], v118 offset:0
  s_waitcnt lgkmcnt(6)
  v_smfmac_f32_16x16x64_bf16 v[104:107], v[52:55], a[24:31], v9
  ds_read_b128 v[80:83], v2 offset:1024
  ds_read_b128 v[84:87], v118 offset:1024
  v_smfmac_f32_16x16x64_bf16 v[108:111], v[48:51], a[136:143], v9
  ds_read_b128 v[88:91], v3 offset:0
  ds_read_b128 v[92:95], v119 offset:0
  v_smfmac_f32_16x16x64_bf16 v[108:111], v[52:55], a[152:159], v9
  ds_read_b128 v[96:99], v3 offset:1024
  ds_read_b128 v[100:103], v119 offset:1024
  v_smfmac_f32_16x16x64_bf16 v[112:115], v[32:35], v[128:135], v9
  v_smfmac_f32_16x16x64_bf16 v[112:115], v[36:39], v[144:151], v9
  s_waitcnt lgkmcnt(11)
  v_smfmac_f32_16x16x64_bf16 v[104:107], v[56:59], a[32:39], v9
  s_waitcnt lgkmcnt(10)
  v_smfmac_f32_16x16x64_bf16 v[104:107], v[60:63], a[40:47], v9
  s_waitcnt lgkmcnt(9)
  v_smfmac_f32_16x16x64_bf16 v[104:107], v[64:67], a[48:55], v9
  v_mov_b32 v124, 1
  v_mov_b32 v125, s19
  s_waitcnt lgkmcnt(8)
  v_smfmac_f32_16x16x64_bf16 v[104:107], v[68:71], a[56:63], v9
  s_mov_b32 exec_lo, 0x01010101
  s_mov_b32 exec_hi, 0x01010101
  buffer_store_dword v124, v0, s[4:7], s27 offen offset:0 sc1
  s_mov_b64 exec, -1
  s_waitcnt lgkmcnt(7)
  v_smfmac_f32_16x16x64_bf16 v[104:107], v[72:75], a[64:71], v9
  s_mov_b32 exec_lo, 0x01010101
  s_mov_b32 exec_hi, 0x01010101
  buffer_store_dword v124, v0, s[4:7], s27 offen offset:1024 sc1
  s_mov_b64 exec, -1
  s_waitcnt lgkmcnt(6)
  v_smfmac_f32_16x16x64_bf16 v[104:107], v[76:79], a[72:79], v9
  s_mov_b64 exec, 1
  buffer_store_dword v125, off, s[4:7], s37 sc1
  s_mov_b64 exec, -1
  s_waitcnt lgkmcnt(5)
  v_smfmac_f32_16x16x64_bf16 v[104:107], v[80:83], a[80:87], v9
  s_waitcnt lgkmcnt(4)
  v_smfmac_f32_16x16x64_bf16 v[104:107], v[84:87], a[88:95], v9
  s_waitcnt lgkmcnt(3)
  v_smfmac_f32_16x16x64_bf16 v[104:107], v[88:91], a[96:103], v9
  s_waitcnt lgkmcnt(2)
  v_smfmac_f32_16x16x64_bf16 v[104:107], v[92:95], a[104:111], v9
  s_waitcnt lgkmcnt(1)
  v_smfmac_f32_16x16x64_bf16 v[104:107], v[96:99], a[112:119], v9
  s_waitcnt lgkmcnt(0)
  v_smfmac_f32_16x16x64_bf16 v[104:107], v[100:103], a[120:127], v9
  v_smfmac_f32_16x16x64_bf16 v[108:111], v[56:59], a[160:167], v9
  v_smfmac_f32_16x16x64_bf16 v[108:111], v[60:63], a[168:175], v9
  v_cvt_pk_bf16_f32 v104, v104, v105
  v_cvt_pk_bf16_f32 v105, v106, v107
  v_or_b32 v104, 1, v104
  buffer_store_dwordx2 v[104:105], v4, s[4:7], s26 offen offset:0 sc1
  ds_write_b64 v4, v[104:105] offset:24576
  v_smfmac_f32_16x16x64_bf16 v[108:111], v[64:67], a[176:183], v9
  v_smfmac_f32_16x16x64_bf16 v[108:111], v[68:71], a[184:191], v9
  v_smfmac_f32_16x16x64_bf16 v[108:111], v[72:75], a[192:199], v9
  ds_read_b128 v[40:43], v5 offset:0
  ds_read_b128 v[44:47], v5 offset:1024
  v_smfmac_f32_16x16x64_bf16 v[108:111], v[76:79], a[200:207], v9
  ds_read_b128 v[120:123], v5 offset:2048
  ds_read_b128 v[124:127], v5 offset:3072
  v_smfmac_f32_16x16x64_bf16 v[108:111], v[80:83], a[208:215], v9
  v_smfmac_f32_16x16x64_bf16 v[108:111], v[84:87], a[216:223], v9
  v_and_b32 v116, -6145, v0
  s_lshl_b32 s43, s18, 11
  v_add_u32 v117, s43, v11
  v_smfmac_f32_16x16x64_bf16 v[108:111], v[88:91], a[224:231], v9
  s_waitcnt vmcnt(4)
  ds_read_b128 v[32:35], v5 offset:4096
  ds_read_b128 v[36:39], v5 offset:5120
  v_smfmac_f32_16x16x64_bf16 v[108:111], v[92:95], a[232:239], v9
  v_smfmac_f32_16x16x64_bf16 v[108:111], v[96:99], a[240:247], v9
  v_smfmac_f32_16x16x64_bf16 v[108:111], v[100:103], a[248:255], v9
  v_smfmac_f32_16x16x64_bf16 v[112:115], v[48:51], v[136:143], v9
  v_smfmac_f32_16x16x64_bf16 v[112:115], v[52:55], v[152:159], v9
  v_cvt_pk_bf16_f32 v108, v108, v109
  v_cvt_pk_bf16_f32 v109, v110, v111
  v_or_b32 v108, 1, v108
  buffer_store_dwordx2 v[108:109], v4, s[4:7], s26 offen offset:512 sc1
  ds_write_b64 v4, v[108:109] offset:8192
  ds_read_b128 v[48:51], v5 offset:6144
  ds_read_b128 v[52:55], v5 offset:7168
  s_waitcnt lgkmcnt(7)
  v_smfmac_f32_16x16x64_bf16 v[112:115], v[72:75], v[40:47], v9
  ds_read_b128 v[40:43], v5 offset:8192
  ds_read_b128 v[44:47], v5 offset:9216
  s_waitcnt lgkmcnt(7)
  v_smfmac_f32_16x16x64_bf16 v[112:115], v[76:79], v[120:127], v9
  ds_read_b128 v[120:123], v5 offset:10240
  ds_read_b128 v[124:127], v5 offset:11264
  s_waitcnt lgkmcnt(7)
  v_smfmac_f32_16x16x64_bf16 v[112:115], v[80:83], v[32:39], v9
  ds_read_b128 v[32:35], v5 offset:12288
  ds_read_b128 v[36:39], v5 offset:13312
  v_smfmac_f32_16x16x64_bf16 v[112:115], v[56:59], v[160:167], v9
  v_smfmac_f32_16x16x64_bf16 v[112:115], v[60:63], v[168:175], v9
  buffer_load_dwordx2 v[104:105], v4, s[4:7], s28 offen offset:0 sc1
  s_waitcnt lgkmcnt(6)
  v_smfmac_f32_16x16x64_bf16 v[112:115], v[84:87], v[48:55], v9
  ds_read_b128 v[48:51], v5 offset:14336
  ds_read_b128 v[52:55], v5 offset:15360
  v_smfmac_f32_16x16x64_bf16 v[112:115], v[64:67], v[176:183], v9
  v_smfmac_f32_16x16x64_bf16 v[112:115], v[68:71], v[184:191], v9
  s_waitcnt lgkmcnt(6)
  v_smfmac_f32_16x16x64_bf16 v[112:115], v[88:91], v[40:47], v9
  ds_read_b128 v[56:59], v116 offset:16384
  ds_read_b128 v[60:63], v116 offset:17408
  s_waitcnt lgkmcnt(6)
  v_smfmac_f32_16x16x64_bf16 v[112:115], v[92:95], v[120:127], v9
  ds_read_b128 v[64:67], v116 offset:18432
  ds_read_b128 v[68:71], v116 offset:19456
  s_waitcnt lgkmcnt(6)
  v_smfmac_f32_16x16x64_bf16 v[112:115], v[96:99], v[32:39], v9
  ds_read_b128 v[72:75], v116 offset:20480
  ds_read_b128 v[76:79], v116 offset:21504
  s_waitcnt lgkmcnt(6)
  v_smfmac_f32_16x16x64_bf16 v[112:115], v[100:103], v[48:55], v9
  ds_read_b128 v[80:83], v116 offset:22528
  ds_read_b128 v[84:87], v116 offset:23552
  ds_read_b64_tr_b16 v[120:121], v117 offset:0
  ds_read_b64_tr_b16 v[122:123], v117 offset:32
  s_barrier
  s_waitcnt vmcnt(4)
  s_nop 1
  v_cvt_pk_bf16_f32 v112, v112, v113
  v_cvt_pk_bf16_f32 v113, v114, v115
  v_or_b32 v112, 1, v112
  buffer_store_dwordx2 v[112:113], v4, s[4:7], s26 offen offset:1024 sc1
  ds_read_b64_tr_b16 v[32:33], v11 offset:0
  ds_read_b64_tr_b16 v[34:35], v11 offset:32
  ds_read_b64_tr_b16 v[36:37], v11 offset:2048
  ds_read_b64_tr_b16 v[38:39], v11 offset:2080
  ds_read_b64_tr_b16 v[40:41], v11 offset:4096
  ds_read_b64_tr_b16 v[42:43], v11 offset:4128
  ds_read_b64_tr_b16 v[44:45], v11 offset:6144
  ds_read_b64_tr_b16 v[46:47], v11 offset:6176
  v_mov_b64 v[48:49], v[24:25]
  v_mov_b64 v[50:51], v[26:27]
  v_mov_b64 v[52:53], v[28:29]
  v_mov_b64 v[54:55], v[30:31]
  s_add_u32 s43, s19, 1
  s_lshr_b32 s43, s43, 2
  s_waitcnt vmcnt(2)
  buffer_load_dwordx2 v[20:21], v4, s[4:7], s28 offen offset:512 sc1
  s_waitcnt vmcnt(2)
  v_and_b32 v114, 1, v104
  v_cmp_ne_u32 vcc, 1, v114
  s_cbranch_vccnz .kx_188
.kok_189:
  ds_write_b64 v4, v[104:105] offset:25120
  s_waitcnt lgkmcnt(0)
  s_barrier
  ds_read_b64_tr_b16 v[88:89], v10 offset:0
  ds_read_b64_tr_b16 v[90:91], v10 offset:32
  ds_read_b64_tr_b16 v[92:93], v10 offset:2048
  ds_read_b64_tr_b16 v[94:95], v10 offset:2080
  ds_read_b64_tr_b16 v[96:97], v10 offset:4096
  ds_read_b64_tr_b16 v[98:99], v10 offset:4128
  ds_read_b64_tr_b16 v[100:101], v10 offset:6144
  ds_read_b64_tr_b16 v[102:103], v10 offset:6176
  s_waitcnt lgkmcnt(6)
  v_mfma_f32_16x16x32_bf16 v[124:127], v[32:35], v[88:91], 0
  s_waitcnt lgkmcnt(4)
  v_mfma_f32_16x16x32_bf16 v[124:127], v[36:39], v[92:95], v[124:127]
  s_waitcnt lgkmcnt(2)
  v_mfma_f32_16x16x32_bf16 v[124:127], v[40:43], v[96:99], v[124:127]
  s_waitcnt lgkmcnt(0)
  v_mfma_f32_16x16x32_bf16 v[124:127], v[44:47], v[100:103], v[124:127]
  buffer_load_dwordx2 v[118:119], v4, s[4:7], s28 offen offset:1024 sc1
  s_waitcnt vmcnt(1)
  v_and_b32 v114, 1, v20
  v_cmp_ne_u32 vcc, 1, v114
  s_cbranch_vccnz .kx_190
.kok_191:
  ds_write_b64 v4, v[20:21] offset:8704
  v_mfma_f32_16x16x32_bf16 v[104:107], v[56:59], v[88:91], 0
  buffer_store_dwordx2 v[112:113], v4, s[4:7], s36 offen offset:1024 sc1
  v_mfma_f32_16x16x32_bf16 v[108:111], v[60:63], v[88:91], 0
  s_mov_b64 exec, s[12:13]
  buffer_store_dwordx4 v[120:123], v0, s[4:7], s36 offen sc1
  s_mov_b64 exec, -1
  v_mfma_f32_16x16x32_bf16 v[104:107], v[64:67], v[92:95], v[104:107]
  v_mfma_f32_16x16x32_bf16 v[108:111], v[68:71], v[92:95], v[108:111]
  s_waitcnt lgkmcnt(0)
  s_barrier
  ds_read_b64_tr_b16 v[32:33], v11 offset:512
  ds_read_b64_tr_b16 v[34:35], v11 offset:544
  ds_read_b64_tr_b16 v[36:37], v11 offset:2560
  ds_read_b64_tr_b16 v[38:39], v11 offset:2592
  ds_read_b64_tr_b16 v[40:41], v11 offset:4608
  ds_read_b64_tr_b16 v[42:43], v11 offset:4640
  ds_read_b64_tr_b16 v[44:45], v11 offset:6656
  ds_read_b64_tr_b16 v[46:47], v11 offset:6688
  s_cmp_lt_u32 s43, s38
  s_cbranch_scc1 .kvok_193
  s_cmp_lg_u32 s18, 0
  s_cbranch_scc1 .kvo_195
  v_bfe_u32 v120, v5, 4, 4
  v_lshlrev_b32 v120, 7, v120
  s_mov_b32 s42, 123731968
.kvw_192:
  buffer_load_dword v121, v120, s[4:7], s42 offen sc1
  s_waitcnt vmcnt(0)
  v_cmp_gt_u32 vcc, 32, v121
  s_or_b32 s38, vcc_lo, 65536
  s_ff1_i32_b32 s38, s38
  s_cmp_lt_u32 s43, s38
  s_cbranch_scc1 .kvg_194
  s_sleep 4
  s_sub_u32 s20, s20, 1
  s_cbranch_scc0 .kvw_192
  s_mov_b32 s38, 0
.kvg_194:
  v_mov_b32 v120, 163792
  v_mov_b32 v121, s38
  ds_write_b32 v120, v121
.kvo_195:
  s_waitcnt vmcnt(0) lgkmcnt(0)
  s_barrier
  v_mov_b32 v120, 163792
  ds_read_b32 v121, v120
  s_waitcnt lgkmcnt(0)
  v_readfirstlane_b32 s38, v121
  s_cmp_eq_u32 s38, 0
  s_cbranch_scc1 .cabort
.kvok_193:
  v_mfma_f32_16x16x32_bf16 v[104:107], v[72:75], v[96:99], v[104:107]
  buffer_load_dwordx4 v[16:19], v0, s[4:7], s33 offen offset:0 sc1
  v_mfma_f32_16x16x32_bf16 v[108:111], v[76:79], v[96:99], v[108:111]
  buffer_load_dwordx4 v[20:23], v0, s[4:7], s33 offen offset:1024 sc1
  v_mfma_f32_16x16x32_bf16 v[104:107], v[80:83], v[100:103], v[104:107]
  buffer_load_dwordx4 v[24:27], v0, s[4:7], s34 offen offset:0 sc1
  v_mfma_f32_16x16x32_bf16 v[108:111], v[84:87], v[100:103], v[108:111]
  buffer_load_dwordx4 v[28:31], v0, s[4:7], s34 offen offset:1024 sc1
  s_add_u32 s33, s33, 262144
  s_add_u32 s34, s34, 262144
  s_add_u32 s36, s36, 262144
  ds_read_b128 v[56:59], v5 offset:16384
  ds_read_b128 v[60:63], v5 offset:17408
  s_waitcnt lgkmcnt(8)
  v_mfma_f32_16x16x32_bf16 v[124:127], v[32:35], v[88:91], v[124:127]
  v_add_f32_dpp v104, v104, v104 row_ror:8 row_mask:0xf bank_mask:0xf
  v_add_f32_dpp v105, v105, v105 row_ror:8 row_mask:0xf bank_mask:0xf
  v_add_f32_dpp v106, v106, v106 row_ror:8 row_mask:0xf bank_mask:0xf
  s_waitcnt lgkmcnt(6)
  v_mfma_f32_16x16x32_bf16 v[124:127], v[36:39], v[92:95], v[124:127]
  v_add_f32_dpp v107, v107, v107 row_ror:8 row_mask:0xf bank_mask:0xf
  v_add_f32_dpp v108, v108, v108 row_ror:8 row_mask:0xf bank_mask:0xf
  v_add_f32_dpp v109, v109, v109 row_ror:8 row_mask:0xf bank_mask:0xf
  s_waitcnt lgkmcnt(4)
  v_mfma_f32_16x16x32_bf16 v[124:127], v[40:43], v[96:99], v[124:127]
  v_add_f32_dpp v110, v110, v110 row_ror:8 row_mask:0xf bank_mask:0xf
  v_add_f32_dpp v111, v111, v111 row_ror:8 row_mask:0xf bank_mask:0xf
  v_max3_f32 v120, v104, v105, v106
  s_waitcnt lgkmcnt(2)
  v_mfma_f32_16x16x32_bf16 v[124:127], v[44:47], v[100:103], v[124:127]
  v_max3_f32 v120, v120, v107, v108
  v_max3_f32 v121, v109, v110, v111
  v_max_f32 v120, v120, v121
  v_mov_b32 v121, v120
  ds_read_b128 v[64:67], v5 offset:18432
  ds_read_b128 v[68:71], v5 offset:19456
  v_permlane32_swap_b32 v120, v121
  v_max_f32 v120, v120, v121
  v_add_f32_dpp v124, v124, v124 row_ror:8 row_mask:0xf bank_mask:0xf
  v_add_f32_dpp v125, v125, v125 row_ror:8 row_mask:0xf bank_mask:0xf
  v_add_f32_dpp v126, v126, v126 row_ror:8 row_mask:0xf bank_mask:0xf
  v_add_f32_dpp v127, v127, v127 row_ror:8 row_mask:0xf bank_mask:0xf
  v_max3_f32 v120, v120, v124, v125
  v_max3_f32 v120, v120, v126, v127
  v_mov_b32 v121, v120
  ds_read_b128 v[72:75], v5 offset:20480
  ds_read_b128 v[76:79], v5 offset:21504
  v_permlane16_swap_b32 v120, v121
  v_max_f32 v120, v120, v121
  v_mul_f32 v120, s40, v120
  v_pk_fma_f32 v[104:105], v[104:105], s[40:41], v[120:121] op_sel_hi:[1,1,0] neg_lo:[0,0,1] neg_hi:[0,0,1]
  v_pk_fma_f32 v[106:107], v[106:107], s[40:41], v[120:121] op_sel_hi:[1,1,0] neg_lo:[0,0,1] neg_hi:[0,0,1]
  v_pk_fma_f32 v[108:109], v[108:109], s[40:41], v[120:121] op_sel_hi:[1,1,0] neg_lo:[0,0,1] neg_hi:[0,0,1]
  v_pk_fma_f32 v[110:111], v[110:111], s[40:41], v[120:121] op_sel_hi:[1,1,0] neg_lo:[0,0,1] neg_hi:[0,0,1]
  v_exp_f32 v104, v104
  ds_read_b128 v[80:83], v5 offset:22528
  v_exp_f32 v105, v105
  ds_read_b128 v[84:87], v5 offset:23552
  v_exp_f32 v106, v106
  v_cvt_pk_bf16_f32 v32, v104, v105
  v_exp_f32 v107, v107
  ds_read_b128 v[40:43], v5 offset:24576
  v_exp_f32 v108, v108
  v_cvt_pk_bf16_f32 v33, v106, v107
  v_exp_f32 v109, v109
  ds_read_b128 v[44:47], v5 offset:25600
  v_exp_f32 v110, v110
  v_cvt_pk_bf16_f32 v34, v108, v109
  v_exp_f32 v111, v111
  ds_read_b128 v[88:91], v5 offset:26624
  ds_read_b128 v[92:95], v5 offset:27648
  v_pk_fma_f32 v[124:125], v[124:125], s[40:41], v[120:121] op_sel_hi:[1,1,0] neg_lo:[0,0,1] neg_hi:[0,0,1]
  v_cvt_pk_bf16_f32 v35, v110, v111
  v_pk_fma_f32 v[126:127], v[126:127], s[40:41], v[120:121] op_sel_hi:[1,1,0] neg_lo:[0,0,1] neg_hi:[0,0,1]
  v_exp_f32 v124, v124
  v_mfma_f32_16x16x32_bf16 v[96:99], v[48:51], v[32:35], 0
  v_exp_f32 v125, v125
  v_exp_f32 v126, v126
  v_mfma_f32_16x16x32_bf16 v[100:103], v[52:55], v[32:35], 0
  v_exp_f32 v127, v127
  v_cvt_pk_bf16_f32 v36, v124, v125
  v_mfma_f32_16x16x16_bf16 v[48:51], v[12:13], v[32:33], 0
  v_cvt_pk_bf16_f32 v37, v126, v127
  s_waitcnt vmcnt(6)
  v_and_b32 v121, 1, v118
  v_mfma_f32_16x16x16_bf16 v[48:51], v[12:13], v[34:35], v[48:51]
  v_cmp_ne_u32 vcc, 1, v121
  s_cbranch_vccnz .vs_196
.vc_197:
  v_permlane32_swap_b32 v112, v118
  v_permlane32_swap_b32 v113, v119
  v_mfma_f32_16x16x16_bf16 v[48:51], v[14:15], v[36:37], v[48:51]
  v_mov_b64 v[104:105], 0
  v_mfma_f32_16x16x16_bf16 v[96:99], v[112:113], v[36:37], v[96:99]
  v_mov_b64 v[106:107], 0
  v_mfma_f32_16x16x16_bf16 v[100:103], v[118:119], v[36:37], v[100:103]
  v_mov_b64 v[108:109], 0
  v_mov_b64 v[110:111], 0
  v_mov_b64 v[120:121], 0
  v_mov_b64 v[122:123], 0
  v_mov_b64 v[124:125], 0
  v_rcp_f32 v48, v48
  v_mov_b64 v[126:127], 0
  v_pk_mul_f32 v[96:97], v[96:97], v[48:49] op_sel_hi:[1,0]
  v_pk_mul_f32 v[98:99], v[98:99], v[48:49] op_sel_hi:[1,0]
  v_pk_mul_f32 v[100:101], v[100:101], v[48:49] op_sel_hi:[1,0]
  v_pk_mul_f32 v[102:103], v[102:103], v[48:49] op_sel_hi:[1,0]
  v_cvt_pk_bf16_f32 v52, v96, v97
  v_cvt_pk_bf16_f32 v53, v98, v99
  v_cvt_pk_bf16_f32 v54, v100, v101
  v_cvt_pk_bf16_f32 v55, v102, v103
  ds_write_b128 v0, v[52:55] offset:9216
  s_waitcnt lgkmcnt(11)
  v_smfmac_f32_16x16x64_bf16 v[104:107], v[52:55], v[56:63], v9
  s_waitcnt lgkmcnt(9)
  v_smfmac_f32_16x16x64_bf16 v[108:111], v[52:55], v[64:71], v9
  s_waitcnt lgkmcnt(7)
  v_smfmac_f32_16x16x64_bf16 v[120:123], v[52:55], v[72:79], v9
  s_waitcnt lgkmcnt(0)
  s_barrier
  ds_read_b128 v[96:99], v1 offset:9216
  v_smfmac_f32_16x16x64_bf16 v[124:127], v[52:55], v[80:87], v9
  ds_read_b128 v[100:103], v2 offset:9216
  ds_read_b128 v[32:35], v3 offset:9216
  ds_read_b128 v[56:59], v5 offset:28672
  ds_read_b128 v[60:63], v5 offset:29696
  ds_read_b128 v[64:67], v5 offset:30720
  ds_read_b128 v[68:71], v5 offset:31744
  s_waitcnt lgkmcnt(6)
  v_smfmac_f32_16x16x64_bf16 v[104:107], v[96:99], v[192:199], v9
  v_smfmac_f32_16x16x64_bf16 v[108:111], v[96:99], v[200:207], v9
  s_waitcnt lgkmcnt(5)
  v_smfmac_f32_16x16x64_bf16 v[104:107], v[100:103], v[224:231], v9
  v_smfmac_f32_16x16x64_bf16 v[108:111], v[100:103], v[232:239], v9
  s_waitcnt lgkmcnt(4)
  v_smfmac_f32_16x16x64_bf16 v[104:107], v[32:35], v[40:47], v9
  v_smfmac_f32_16x16x64_bf16 v[108:111], v[32:35], v[88:95], v9
  v_smfmac_f32_16x16x64_bf16 v[120:123], v[96:99], v[208:215], v9
  v_smfmac_f32_16x16x64_bf16 v[124:127], v[96:99], v[216:223], v9
  v_cvt_pk_bf16_f32 v104, v104, v105
  v_cvt_pk_bf16_f32 v105, v106, v107
  v_smfmac_f32_16x16x64_bf16 v[120:123], v[100:103], v[240:247], v9
  v_cvt_pk_bf16_f32 v106, v108, v109
  v_cvt_pk_bf16_f32 v107, v110, v111
  v_smfmac_f32_16x16x64_bf16 v[124:127], v[100:103], v[248:255], v9
  v_permlane16_swap_b32 v104, v106
  v_permlane16_swap_b32 v105, v107
  s_waitcnt lgkmcnt(2)
  v_smfmac_f32_16x16x64_bf16 v[120:123], v[32:35], v[56:63], v9
  v_or_b32 v104, 1, v104
  buffer_store_dwordx4 v[104:107], v6, s[4:7], s29 offen
  s_waitcnt lgkmcnt(0)
  v_smfmac_f32_16x16x64_bf16 v[124:127], v[32:35], v[64:71], v9
  s_nop 3
  v_cvt_pk_bf16_f32 v120, v120, v121
  v_cvt_pk_bf16_f32 v121, v122, v123
  s_nop 1
  v_cvt_pk_bf16_f32 v122, v124, v125
  v_cvt_pk_bf16_f32 v123, v126, v127
  s_nop 0
  v_permlane16_swap_b32 v120, v122
  v_permlane16_swap_b32 v121, v123
  v_or_b32 v120, 1, v120
  buffer_store_dwordx4 v[120:123], v6, s[4:7], s30 offen
  v_and_b32 v52, 16, v5
  v_mov_b32 v53, 0x3f80
  v_lshlrev_b32 v52, v52, v53
  s_mov_b32 vcc_lo, 0x30003
  s_mov_b32 vcc_hi, 0x30003
  v_cndmask_b32 v48, 0, v52, vcc
  s_mov_b32 vcc_lo, 0x300030
  s_mov_b32 vcc_hi, 0x300030
  v_cndmask_b32 v49, 0, v52, vcc
  s_mov_b32 vcc_lo, 0x3000300
  s_mov_b32 vcc_hi, 0x3000300
  v_cndmask_b32 v50, 0, v52, vcc
  s_mov_b32 vcc_lo, 0x30003000
  s_mov_b32 vcc_hi, 0x30003000
  v_cndmask_b32 v51, 0, v52, vcc
  v_mov_b32 v52, -1
  s_waitcnt vmcnt(0)
  buffer_load_dwordx4 v[64:67], v7, s[4:7], s31 offen offset:0 sc1
  buffer_load_dwordx4 v[68:71], v7, s[4:7], s32 offen offset:0 sc1
  s_waitcnt vmcnt(0)
.pl_199:
  v_bitop3_b32 v60, v64, v68, 1 bitop3:0x80
  v_cmp_ne_u32 vcc, 1, v60
  s_cbranch_vccnz .pr_200
  v_mfma_f32_16x16x32_bf16 v[56:59], v[48:51], v[64:67], 0
  v_mfma_f32_16x16x32_bf16 v[56:59], v[48:51], v[68:71], v[56:59]
  s_nop 7
  v_add_f32_dpp v60, v56, v56 row_ror:8 row_mask:0xf bank_mask:0x3
  v_add_f32_dpp v60, v57, v57 row_ror:8 row_mask:0xf bank_mask:0xc
  s_nop 1
  v_add_f32_dpp v60, v60, v60 row_shl:4 row_mask:0xf bank_mask:0xf
  s_nop 1
  v_mov_b32_dpp v61, v60 quad_perm:[1,1,3,3] row_mask:0xf bank_mask:0xf
  v_cvt_pk_bf16_f32 v62, v60, v61
  v_min_u32 v62, -2, v62
  buffer_store_dword v62, v8, s[4:7], s23 offen offset:0
  buffer_store_dword v52, v8, s[4:7], s24 offen offset:0
  s_add_u32 s19, s19, 1
  s_branch .ctop_146
.clast_148:
  ds_write_b128 v0, v[16:19] offset:16384
  ds_write_b128 v0, v[20:23] offset:17408
  v_mov_b64 v[104:105], 0
  v_mov_b64 v[106:107], 0
  v_mov_b64 v[108:109], 0
  v_mov_b64 v[110:111], 0
  v_mov_b64 v[112:113], 0
  v_mov_b64 v[114:115], 0
  v_xor_b32 v116, 512, v0
  v_xor_b32 v117, 512, v1
  v_xor_b32 v118, 512, v2
  v_xor_b32 v119, 512, v3
  s_waitcnt vmcnt(0)
  buffer_load_dwordx4 v[32:35], v0, s[4:7], s22 offen offset:0 sc1
  buffer_load_dwordx4 v[36:39], v0, s[4:7], s22 offen offset:1024 sc1
  s_waitcnt vmcnt(0)
.ml_201:
  v_max3_u32 v120, v32, v33, v34
  v_max3_u32 v121, v35, v36, v37
  v_max3_u32 v120, v120, v38, v39
  v_max_u32 v120, v120, v121
  v_cmp_eq_u32 vcc, -1, v120
  s_cbranch_vccnz .mr_202
  ds_write_b128 v0, v[32:35]
  ds_write_b128 v0, v[36:39] offset:1024
  ds_read_b128 v[48:51], v116
  ds_read_b128 v[52:55], v116 offset:1024
  v_smfmac_f32_16x16x64_bf16 v[108:111], v[32:35], a[128:135], v9
  s_waitcnt lgkmcnt(2)
  s_barrier
  ds_read_b128 v[56:59], v1 offset:0
  ds_read_b128 v[60:63], v117 offset:0
  v_smfmac_f32_16x16x64_bf16 v[108:111], v[36:39], a[144:151], v9
  ds_read_b128 v[64:67], v1 offset:1024
  ds_read_b128 v[68:71], v117 offset:1024
  s_waitcnt lgkmcnt(5)
  v_smfmac_f32_16x16x64_bf16 v[108:111], v[48:51], a[136:143], v9
  ds_read_b128 v[72:75], v2 offset:0
  ds_read_b128 v[76:79], v118 offset:0
  s_waitcnt lgkmcnt(6)
  v_smfmac_f32_16x16x64_bf16 v[108:111], v[52:55], a[152:159], v9
  ds_read_b128 v[80:83], v2 offset:1024
  ds_read_b128 v[84:87], v118 offset:1024
  v_smfmac_f32_16x16x64_bf16 v[112:115], v[32:35], v[128:135], v9
  ds_read_b128 v[88:91], v3 offset:0
  ds_read_b128 v[92:95], v119 offset:0
  v_smfmac_f32_16x16x64_bf16 v[112:115], v[36:39], v[144:151], v9
  ds_read_b128 v[96:99], v3 offset:1024
  ds_read_b128 v[100:103], v119 offset:1024
  v_mov_b32 v124, 1
  v_mov_b32 v125, s19
  s_mov_b64 exec, 1
  buffer_store_dword v125, off, s[4:7], s37 sc1
  s_mov_b64 exec, -1
  s_waitcnt lgkmcnt(11)
  v_smfmac_f32_16x16x64_bf16 v[108:111], v[56:59], a[160:167], v9
  s_waitcnt lgkmcnt(10)
  v_smfmac_f32_16x16x64_bf16 v[108:111], v[60:63], a[168:175], v9
  s_waitcnt lgkmcnt(9)
  v_smfmac_f32_16x16x64_bf16 v[108:111], v[64:67], a[176:183], v9
  s_waitcnt lgkmcnt(8)
  v_smfmac_f32_16x16x64_bf16 v[108:111], v[68:71], a[184:191], v9
  s_waitcnt lgkmcnt(7)
  v_smfmac_f32_16x16x64_bf16 v[108:111], v[72:75], a[192:199], v9
  ds_read_b128 v[40:43], v5 offset:0
  ds_read_b128 v[44:47], v5 offset:1024
  s_waitcnt lgkmcnt(8)
  v_smfmac_f32_16x16x64_bf16 v[108:111], v[76:79], a[200:207], v9
  ds_read_b128 v[120:123], v5 offset:2048
  ds_read_b128 v[124:127], v5 offset:3072
  s_waitcnt lgkmcnt(9)
  v_smfmac_f32_16x16x64_bf16 v[108:111], v[80:83], a[208:215], v9
  s_waitcnt lgkmcnt(8)
  v_smfmac_f32_16x16x64_bf16 v[108:111], v[84:87], a[216:223], v9
  v_and_b32 v116, -6145, v0
  s_lshl_b32 s43, s18, 11
  v_add_u32 v117, s43, v11
  s_waitcnt lgkmcnt(7)
  v_smfmac_f32_16x16x64_bf16 v[108:111], v[88:91], a[224:231], v9
  s_waitcnt vmcnt(1)
  ds_read_b128 v[32:35], v5 offset:4096
  ds_read_b128 v[36:39], v5 offset:5120
  s_waitcnt lgkmcnt(8)
  v_smfmac_f32_16x16x64_bf16 v[108:111], v[92:95], a[232:239], v9
  s_waitcnt lgkmcnt(7)
  v_smfmac_f32_16x16x64_bf16 v[108:111], v[96:99], a[240:247], v9
  s_waitcnt lgkmcnt(6)
  v_smfmac_f32_16x16x64_bf16 v[108:111], v[100:103], a[248:255], v9
  v_smfmac_f32_16x16x64_bf16 v[112:115], v[48:51], v[136:143], v9
  v_smfmac_f32_16x16x64_bf16 v[112:115], v[52:55], v[152:159], v9
  v_cvt_pk_bf16_f32 v108, v108, v109
  v_cvt_pk_bf16_f32 v109, v110, v111
  ds_write_b64 v4, v[108:109] offset:8192
  ds_read_b128 v[48:51], v5 offset:6144
  ds_read_b128 v[52:55], v5 offset:7168
  s_waitcnt lgkmcnt(7)
  v_smfmac_f32_16x16x64_bf16 v[112:115], v[72:75], v[40:47], v9
  ds_read_b128 v[40:43], v5 offset:8192
  ds_read_b128 v[44:47], v5 offset:9216
  s_waitcnt lgkmcnt(7)
  v_smfmac_f32_16x16x64_bf16 v[112:115], v[76:79], v[120:127], v9
  ds_read_b128 v[120:123], v5 offset:10240
  ds_read_b128 v[124:127], v5 offset:11264
  s_waitcnt lgkmcnt(7)
  v_smfmac_f32_16x16x64_bf16 v[112:115], v[80:83], v[32:39], v9
  ds_read_b128 v[32:35], v5 offset:12288
  ds_read_b128 v[36:39], v5 offset:13312
  v_smfmac_f32_16x16x64_bf16 v[112:115], v[56:59], v[160:167], v9
  v_smfmac_f32_16x16x64_bf16 v[112:115], v[60:63], v[168:175], v9
  s_waitcnt lgkmcnt(6)
  v_smfmac_f32_16x16x64_bf16 v[112:115], v[84:87], v[48:55], v9
  ds_read_b128 v[48:51], v5 offset:14336
  ds_read_b128 v[52:55], v5 offset:15360
  v_smfmac_f32_16x16x64_bf16 v[112:115], v[64:67], v[176:183], v9
  v_smfmac_f32_16x16x64_bf16 v[112:115], v[68:71], v[184:191], v9
  s_waitcnt lgkmcnt(6)
  v_smfmac_f32_16x16x64_bf16 v[112:115], v[88:91], v[40:47], v9
  s_waitcnt lgkmcnt(4)
  v_smfmac_f32_16x16x64_bf16 v[112:115], v[92:95], v[120:127], v9
  s_waitcnt lgkmcnt(2)
  v_smfmac_f32_16x16x64_bf16 v[112:115], v[96:99], v[32:39], v9
  s_waitcnt lgkmcnt(0)
  v_smfmac_f32_16x16x64_bf16 v[112:115], v[100:103], v[48:55], v9
  ds_read_b64_tr_b16 v[120:121], v117 offset:0
  ds_read_b64_tr_b16 v[122:123], v117 offset:32
  s_nop 5
  v_cvt_pk_bf16_f32 v112, v112, v113
  v_cvt_pk_bf16_f32 v113, v114, v115
  buffer_store_dwordx2 v[112:113], v4, s[4:7], s36 offen offset:1024 sc1
  s_waitcnt lgkmcnt(0)
  s_mov_b64 exec, s[12:13]
  buffer_store_dwordx4 v[120:123], v0, s[4:7], s36 offen sc1
  s_mov_b64 exec, -1
  s_waitcnt vmcnt(0)
  s_barrier
  v_mov_b32 v32, 64
  buffer_store_dword v32, off, s[4:7], s37 sc1
  s_branch .cdone
.mr_154:
  s_mov_b64 exec, vcc
  buffer_load_dwordx4 v[32:35], v0, s[4:7], s21 offen offset:0 sc1
  buffer_load_dwordx4 v[36:39], v0, s[4:7], s21 offen offset:1024 sc1
  s_mov_b64 exec, -1
  s_sub_u32 s20, s20, 1
  s_cbranch_scc1 .cabort
  s_waitcnt vmcnt(2)
  s_branch .ml_153
.cent_147:
  s_waitcnt vmcnt(0)
  v_min_u32 v32, -2, v32
  v_min_u32 v33, -2, v33
  v_min_u32 v34, -2, v34
  v_min_u32 v35, -2, v35
  v_min_u32 v36, -2, v36
  v_min_u32 v37, -2, v37
  v_min_u32 v38, -2, v38
  v_min_u32 v39, -2, v39
  ds_write_b128 v0, v[16:19] offset:16384
  ds_write_b128 v0, v[20:23] offset:17408
  v_mov_b64 v[104:105], 0
  v_mov_b64 v[106:107], 0
  v_mov_b64 v[108:109], 0
  v_mov_b64 v[110:111], 0
  v_mov_b64 v[112:113], 0
  v_mov_b64 v[114:115], 0
  v_xor_b32 v116, 512, v0
  v_xor_b32 v117, 512, v1
  v_xor_b32 v118, 512, v2
  v_xor_b32 v119, 512, v3
  v_mov_b32 v124, 1
  v_mov_b32 v125, 0
  s_branch .ml_153
.kx_155:
  buffer_load_dwordx2 v[24:25], v4, s[4:7], s27 offen offset:0 sc1
  s_nop 15
  buffer_load_dwordx2 v[28:29], v4, s[4:7], s27 offen offset:0 sc1
.kxl_203:
  s_waitcnt vmcnt(1)
  v_mov_b64 v[104:105], v[24:25]
  v_and_b32 v114, 1, v104
  v_cmp_ne_u32 vcc, 0, v114
  s_cbranch_vccz .kxk_204
  buffer_load_dwordx2 v[24:25], v4, s[4:7], s27 offen offset:0 sc1
  s_waitcnt vmcnt(1)
  v_mov_b64 v[104:105], v[28:29]
  v_and_b32 v114, 1, v104
  v_cmp_ne_u32 vcc, 0, v114
  s_cbranch_vccz .kxk_204
  buffer_load_dwordx2 v[28:29], v4, s[4:7], s27 offen offset:0 sc1
  s_sub_u32 s20, s20, 1
  s_cbranch_scc0 .kxl_203
  s_branch .cabort
.kxk_204:
  buffer_load_dwordx2 v[20:21], v4, s[4:7], s27 offen offset:512 sc1
  s_branch .kok_156
.kx_157:
  buffer_load_dwordx2 v[24:25], v4, s[4:7], s27 offen offset:512 sc1
  s_nop 15
  buffer_load_dwordx2 v[28:29], v4, s[4:7], s27 offen offset:512 sc1
.kxl_205:
  s_waitcnt vmcnt(1)
  v_mov_b64 v[20:21], v[24:25]
  v_and_b32 v114, 1, v20
  v_cmp_ne_u32 vcc, 0, v114
  s_cbranch_vccz .kok_158
  buffer_load_dwordx2 v[24:25], v4, s[4:7], s27 offen offset:512 sc1
  s_waitcnt vmcnt(1)
  v_mov_b64 v[20:21], v[28:29]
  v_and_b32 v114, 1, v20
  v_cmp_ne_u32 vcc, 0, v114
  s_cbranch_vccz .kok_158
  buffer_load_dwordx2 v[28:29], v4, s[4:7], s27 offen offset:512 sc1
  s_sub_u32 s20, s20, 1
  s_cbranch_scc0 .kxl_205
  s_branch .cabort
.vs_159:
  buffer_load_dwordx2 v[118:119], v4, s[4:7], s27 offen offset:1024 sc1
  s_waitcnt vmcnt(0)
  v_and_b32 v121, 1, v118
  v_cmp_ne_u32 vcc, 0, v121
  s_cbranch_vccz .vc_160
  s_sub_u32 s20, s20, 1
  s_cbranch_scc0 .vs_159
  s_branch .cabort
.pr_163:
  s_mov_b64 exec, vcc
  buffer_load_dwordx4 v[64:67], v7, s[4:7], s31 offen offset:0 sc1
  buffer_load_dwordx4 v[68:71], v7, s[4:7], s32 offen offset:0 sc1
  s_mov_b64 exec, -1
  s_sub_u32 s20, s20, 1
  s_cbranch_scc1 .cabort
  s_waitcnt vmcnt(2)
  s_branch .pl_162
.mr_165:
  s_mov_b64 exec, vcc
  buffer_load_dwordx4 v[32:35], v0, s[4:7], s22 offen offset:0 sc1
  buffer_load_dwordx4 v[36:39], v0, s[4:7], s22 offen offset:1024 sc1
  s_mov_b64 exec, -1
  s_sub_u32 s20, s20, 1
  s_cbranch_scc1 .cabort
  s_waitcnt vmcnt(2)
  s_branch .ml_164
.kx_166:
  buffer_load_dwordx2 v[24:25], v4, s[4:7], s28 offen offset:0 sc1
  s_nop 15
  buffer_load_dwordx2 v[28:29], v4, s[4:7], s28 offen offset:0 sc1
.kxl_206:
  s_waitcnt vmcnt(1)
  v_mov_b64 v[104:105], v[24:25]
  v_and_b32 v114, 1, v104
  v_cmp_ne_u32 vcc, 0, v114
  s_cbranch_vccz .kxk_207
  buffer_load_dwordx2 v[24:25], v4, s[4:7], s28 offen offset:0 sc1
  s_waitcnt vmcnt(1)
  v_mov_b64 v[104:105], v[28:29]
  v_and_b32 v114, 1, v104
  v_cmp_ne_u32 vcc, 0, v114
  s_cbranch_vccz .kxk_207
  buffer_load_dwordx2 v[28:29], v4, s[4:7], s28 offen offset:0 sc1
  s_sub_u32 s20, s20, 1
  s_cbranch_scc0 .kxl_206
  s_branch .cabort
.kxk_207:
  buffer_load_dwordx2 v[20:21], v4, s[4:7], s28 offen offset:512 sc1
  s_branch .kok_167
.kx_168:
  buffer_load_dwordx2 v[24:25], v4, s[4:7], s28 offen offset:512 sc1
  s_nop 15
  buffer_load_dwordx2 v[28:29], v4, s[4:7], s28 offen offset:512 sc1
.kxl_208:
  s_waitcnt vmcnt(1)
  v_mov_b64 v[20:21], v[24:25]
  v_and_b32 v114, 1, v20
  v_cmp_ne_u32 vcc, 0, v114
  s_cbranch_vccz .kok_169
  buffer_load_dwordx2 v[24:25], v4, s[4:7], s28 offen offset:512 sc1
  s_waitcnt vmcnt(1)
  v_mov_b64 v[20:21], v[28:29]
  v_and_b32 v114, 1, v20
  v_cmp_ne_u32 vcc, 0, v114
  s_cbranch_vccz .kok_169
  buffer_load_dwordx2 v[28:29], v4, s[4:7], s28 offen offset:512 sc1
  s_sub_u32 s20, s20, 1
  s_cbranch_scc0 .kxl_208
  s_branch .cabort
.vs_170:
  buffer_load_dwordx2 v[118:119], v4, s[4:7], s28 offen offset:1024 sc1
  s_waitcnt vmcnt(0)
  v_and_b32 v121, 1, v118
  v_cmp_ne_u32 vcc, 0, v121
  s_cbranch_vccz .vc_171
  s_sub_u32 s20, s20, 1
  s_cbranch_scc0 .vs_170
  s_branch .cabort
.pr_174:
  s_mov_b64 exec, vcc
  buffer_load_dwordx4 v[64:67], v7, s[4:7], s31 offen offset:0 sc1
  buffer_load_dwordx4 v[68:71], v7, s[4:7], s32 offen offset:0 sc1
  s_mov_b64 exec, -1
  s_sub_u32 s20, s20, 1
  s_cbranch_scc1 .cabort
  s_waitcnt vmcnt(2)
  s_branch .pl_173
.mr_176:
  s_mov_b64 exec, vcc
  buffer_load_dwordx4 v[32:35], v0, s[4:7], s21 offen offset:0 sc1
  buffer_load_dwordx4 v[36:39], v0, s[4:7], s21 offen offset:1024 sc1
  s_mov_b64 exec, -1
  s_sub_u32 s20, s20, 1
  s_cbranch_scc1 .cabort
  s_waitcnt vmcnt(2)
  s_branch .ml_175
.kx_177:
  buffer_load_dwordx2 v[24:25], v4, s[4:7], s27 offen offset:0 sc1
  s_nop 15
  buffer_load_dwordx2 v[28:29], v4, s[4:7], s27 offen offset:0 sc1
.kxl_209:
  s_waitcnt vmcnt(1)
  v_mov_b64 v[104:105], v[24:25]
  v_and_b32 v114, 1, v104
  v_cmp_ne_u32 vcc, 1, v114
  s_cbranch_vccz .kxk_210
  buffer_load_dwordx2 v[24:25], v4, s[4:7], s27 offen offset:0 sc1
  s_waitcnt vmcnt(1)
  v_mov_b64 v[104:105], v[28:29]
  v_and_b32 v114, 1, v104
  v_cmp_ne_u32 vcc, 1, v114
  s_cbranch_vccz .kxk_210
  buffer_load_dwordx2 v[28:29], v4, s[4:7], s27 offen offset:0 sc1
  s_sub_u32 s20, s20, 1
  s_cbranch_scc0 .kxl_209
  s_branch .cabort
.kxk_210:
  buffer_load_dwordx2 v[20:21], v4, s[4:7], s27 offen offset:512 sc1
  s_branch .kok_178
.kx_179:
  buffer_load_dwordx2 v[24:25], v4, s[4:7], s27 offen offset:512 sc1
  s_nop 15
  buffer_load_dwordx2 v[28:29], v4, s[4:7], s27 offen offset:512 sc1
.kxl_211:
  s_waitcnt vmcnt(1)
  v_mov_b64 v[20:21], v[24:25]
  v_and_b32 v114, 1, v20
  v_cmp_ne_u32 vcc, 1, v114
  s_cbranch_vccz .kok_180
  buffer_load_dwordx2 v[24:25], v4, s[4:7], s27 offen offset:512 sc1
  s_waitcnt vmcnt(1)
  v_mov_b64 v[20:21], v[28:29]
  v_and_b32 v114, 1, v20
  v_cmp_ne_u32 vcc, 1, v114
  s_cbranch_vccz .kok_180
  buffer_load_dwordx2 v[28:29], v4, s[4:7], s27 offen offset:512 sc1
  s_sub_u32 s20, s20, 1
  s_cbranch_scc0 .kxl_211
  s_branch .cabort
.vs_181:
  buffer_load_dwordx2 v[118:119], v4, s[4:7], s27 offen offset:1024 sc1
  s_waitcnt vmcnt(0)
  v_and_b32 v121, 1, v118
  v_cmp_ne_u32 vcc, 1, v121
  s_cbranch_vccz .vc_182
  s_sub_u32 s20, s20, 1
  s_cbranch_scc0 .vs_181
  s_branch .cabort
.pr_185:
  s_mov_b64 exec, vcc
  buffer_load_dwordx4 v[64:67], v7, s[4:7], s31 offen offset:0 sc1
  buffer_load_dwordx4 v[68:71], v7, s[4:7], s32 offen offset:0 sc1
  s_mov_b64 exec, -1
  s_sub_u32 s20, s20, 1
  s_cbranch_scc1 .cabort
  s_waitcnt vmcnt(2)
  s_branch .pl_184
.mr_187:
  s_mov_b64 exec, vcc
  buffer_load_dwordx4 v[32:35], v0, s[4:7], s22 offen offset:0 sc1
  buffer_load_dwordx4 v[36:39], v0, s[4:7], s22 offen offset:1024 sc1
  s_mov_b64 exec, -1
  s_sub_u32 s20, s20, 1
  s_cbranch_scc1 .cabort
  s_waitcnt vmcnt(2)
  s_branch .ml_186
.kx_188:
  buffer_load_dwordx2 v[24:25], v4, s[4:7], s28 offen offset:0 sc1
  s_nop 15
  buffer_load_dwordx2 v[28:29], v4, s[4:7], s28 offen offset:0 sc1
.kxl_212:
  s_waitcnt vmcnt(1)
  v_mov_b64 v[104:105], v[24:25]
  v_and_b32 v114, 1, v104
  v_cmp_ne_u32 vcc, 1, v114
  s_cbranch_vccz .kxk_213
  buffer_load_dwordx2 v[24:25], v4, s[4:7], s28 offen offset:0 sc1
  s_waitcnt vmcnt(1)
  v_mov_b64 v[104:105], v[28:29]
  v_and_b32 v114, 1, v104
  v_cmp_ne_u32 vcc, 1, v114
  s_cbranch_vccz .kxk_213
  buffer_load_dwordx2 v[28:29], v4, s[4:7], s28 offen offset:0 sc1
  s_sub_u32 s20, s20, 1
  s_cbranch_scc0 .kxl_212
  s_branch .cabort
.kxk_213:
  buffer_load_dwordx2 v[20:21], v4, s[4:7], s28 offen offset:512 sc1
  s_branch .kok_189
.kx_190:
  buffer_load_dwordx2 v[24:25], v4, s[4:7], s28 offen offset:512 sc1
  s_nop 15
  buffer_load_dwordx2 v[28:29], v4, s[4:7], s28 offen offset:512 sc1
.kxl_214:
  s_waitcnt vmcnt(1)
  v_mov_b64 v[20:21], v[24:25]
  v_and_b32 v114, 1, v20
  v_cmp_ne_u32 vcc, 1, v114
  s_cbranch_vccz .kok_191
  buffer_load_dwordx2 v[24:25], v4, s[4:7], s28 offen offset:512 sc1
  s_waitcnt vmcnt(1)
  v_mov_b64 v[20:21], v[28:29]
  v_and_b32 v114, 1, v20
  v_cmp_ne_u32 vcc, 1, v114
  s_cbranch_vccz .kok_191
  buffer_load_dwordx2 v[28:29], v4, s[4:7], s28 offen offset:512 sc1
  s_sub_u32 s20, s20, 1
  s_cbranch_scc0 .kxl_214
  s_branch .cabort
.vs_196:
  buffer_load_dwordx2 v[118:119], v4, s[4:7], s28 offen offset:1024 sc1
  s_waitcnt vmcnt(0)
  v_and_b32 v121, 1, v118
  v_cmp_ne_u32 vcc, 1, v121
  s_cbranch_vccz .vc_197
  s_sub_u32 s20, s20, 1
  s_cbranch_scc0 .vs_196
  s_branch .cabort
.pr_200:
  s_mov_b64 exec, vcc
  buffer_load_dwordx4 v[64:67], v7, s[4:7], s31 offen offset:0 sc1
  buffer_load_dwordx4 v[68:71], v7, s[4:7], s32 offen offset:0 sc1
  s_mov_b64 exec, -1
  s_sub_u32 s20, s20, 1
  s_cbranch_scc1 .cabort
  s_waitcnt vmcnt(2)
  s_branch .pl_199
.mr_202:
  s_mov_b64 exec, vcc
  buffer_load_dwordx4 v[32:35], v0, s[4:7], s22 offen offset:0 sc1
  buffer_load_dwordx4 v[36:39], v0, s[4:7], s22 offen offset:1024 sc1
  s_mov_b64 exec, -1
  s_sub_u32 s20, s20, 1
  s_cbranch_scc1 .cabort
  s_waitcnt vmcnt(2)
  s_branch .ml_201
.cspecial:
  s_cmp_eq_u32 s94, 1
  s_cbranch_scc1 .next
  s_branch .special
.chainf:
  s_and_b32 s16, s94, 1
  s_lshr_b32 s17, s94, 1
  s_waitcnt vmcnt(0) lgkmcnt(0)
  s_barrier
  v_mbcnt_lo_u32_b32 v16, -1, 0
  v_mbcnt_hi_u32_b32 v16, -1, v16
  v_lshrrev_b32 v17, 4, v16
  v_and_b32 v18, 15, v16
  v_lshrrev_b32 v19, 3, v18
  v_lshlrev_b32 v19, 9, v19
  v_lshl_add_u32 v19, v17, 7, v19
  v_and_b32 v20, 7, v16
  v_lshl_add_u32 v19, v20, 4, v19
  s_lshl_b32 s42, s18, 11
  s_add_u32 s42, s42, 131072
  v_add_u32 v0, s42, v19
  v_xor_b32 v1, 2048, v0
  v_xor_b32 v2, 4096, v0
  v_xor_b32 v3, 6144, v0
  v_lshlrev_b32 v19, 3, v16
  v_add_u32 v4, s42, v19
  s_lshl_b32 s45, s18, 15
  v_lshlrev_b32 v19, 4, v16
  v_add_u32 v5, s45, v19
  v_and_b32 v21, 1, v17
  v_lshlrev_b32 v21, 1, v21
  v_lshrrev_b32 v22, 1, v17
  v_add_u32 v21, v21, v22
  v_lshlrev_b32 v21, 13, v21
  v_lshl_add_u32 v21, v18, 4, v21
  s_lshl_b32 s42, s18, 16
  v_add_u32 v21, s42, v21
  s_lshl_b32 s43, s17, 8
  v_add_u32 v6, s43, v21
  v_lshrrev_b32 v21, 2, v16
  v_lshlrev_b32 v21, 8, v21
  v_and_b32 v22, 3, v16
  v_lshl_add_u32 v21, v22, 4, v21
  s_lshl_b32 s42, s17, 13
  s_lshl_b32 s43, s18, 6
  s_add_u32 s42, s42, s43
  v_add_u32 v7, s42, v21
  v_lshrrev_b32 v21, 3, v16
  v_lshlrev_b32 v21, 4, v21
  v_and_b32 v22, 2, v16
  v_lshl_add_u32 v21, v22, 1, v21
  s_lshl_b32 s42, s17, 8
  s_lshr_b32 s43, s18, 1
  s_lshl_b32 s43, s43, 7
  s_add_u32 s42, s42, s43
  s_and_b32 s43, s18, 1
  s_lshl_b32 s43, s43, 3
  s_add_u32 s42, s42, s43
  v_add_u32 v21, s42, v21
  v_and_b32 v22, 5, v16
  v_cmp_eq_u32 vcc, 0, v22
  v_bfrev_b32 v22, 1
  s_nop 0
  v_cndmask_b32 v8, v22, v21
  v_mov_b32 v21, 0x4444
  v_mov_b32 v22, 0xeeee
  v_cmp_lt_u32 vcc, 7, v18
  s_nop 1
  v_cndmask_b32 v9, v21, v22
  v_lshrrev_b32 v19, 1, v17
  v_lshlrev_b32 v19, 8, v19
  v_and_b32 v20, 1, v16
  v_lshl_add_u32 v19, v20, 7, v19
  v_and_b32 v20, 1, v17
  v_lshl_add_u32 v19, v20, 6, v19
  v_bfe_u32 v20, v16, 2, 2
  v_lshl_add_u32 v19, v20, 3, v19
  v_add_u32 v11, 139264, v19
  v_bfe_u32 v20, v16, 1, 1
  v_mul_u32_u24 v20, 544, v20
  v_add_u32 v19, v19, v20
  v_add_u32 v10, 155648, v19
  v_mov_b32 v12, 0x3f803f80
  v_mov_b32 v14, 0x3f003f00
  v_mov_b32 v13, 0x3f803f80
  v_mov_b32 v15, 0x3f003f00
  s_mov_b32 s40, 0x3e0293ee
  s_mov_b32 s41, 0x3e0293ee
  s_lshl_b32 s42, s16, 14
  s_add_u32 s23, s42, 122716160
  s_add_u32 s21, s42, 122585088
  s_add_u32 s24, s42, 122724352
  s_add_u32 s22, s42, 122593280
  s_lshl_b32 s37, s16, 5
  s_add_u32 s37, s37, s17
  s_lshl_b32 s37, s37, 7
  s_add_u32 s37, s37, 123752448
  s_lshl_b32 s42, s16, 18
  s_add_u32 s29, s42, 122159104
  s_add_u32 s31, s42, 122159104
  s_add_u32 s30, s42, 122191872
  s_add_u32 s32, s42, 122163200
  s_lshl_b32 s42, s17, 13
  s_add_u32 s33, s42, 33423360
  s_add_u32 s34, s42, 16646144
  s_add_u32 s36, s42, 100532224
  s_lshl_b32 s43, s16, 9
  s_add_u32 s36, s36, s43
  v_mov_b32 v32, 1
  v_mov_b32 v33, 1
  v_mov_b32 v34, 1
  v_mov_b32 v35, 1
  v_mov_b32 v36, -1
  s_lshl_b32 s42, s16, 5
  s_add_u32 s42, s42, s17
  s_lshl_b32 s42, s42, 15
  s_add_u32 s42, s42, 119406592
  buffer_store_dwordx4 v[32:35], v0, s[4:7], s42 offen sc1
  buffer_store_dwordx4 v[32:35], v0, s[4:7], s42 offen offset:1024 sc1
  s_add_u32 s42, s42, 8192
  buffer_store_dwordx4 v[32:35], v0, s[4:7], s42 offen sc1
  buffer_store_dwordx4 v[32:35], v0, s[4:7], s42 offen offset:1024 sc1
  s_add_u32 s42, s42, 8192
  buffer_store_dwordx4 v[32:35], v0, s[4:7], s42 offen sc1
  buffer_store_dwordx4 v[32:35], v0, s[4:7], s42 offen offset:1024 sc1
  s_add_u32 s42, s42, 8192
  buffer_store_dwordx4 v[32:35], v0, s[4:7], s42 offen sc1
  buffer_store_dwordx4 v[32:35], v0, s[4:7], s42 offen offset:1024 sc1
  buffer_store_dwordx4 v[32:35], v7, s[4:7], s31 offen sc1
  buffer_store_dwordx4 v[32:35], v7, s[4:7], s32 offen sc1
  buffer_store_dword v36, v8, s[4:7], s23 offen sc1
  buffer_store_dword v36, v8, s[4:7], s24 offen sc1
  v_lshrrev_b32 v19, 3, v16
  v_and_b32 v20, 7, v16
  v_lshlrev_b32 v21, 4, v20
  v_lshl_add_u32 v23, v19, 13, v21
  v_lshl_add_u32 v24, v19, 11, v21
  s_lshl_b32 s42, s16, 22
  s_lshl_b32 s43, s17, 8
  s_add_u32 s42, s42, s43
  s_lshr_b32 s43, s18, 1
  s_lshl_b32 s43, s43, 7
  s_add_u32 s42, s42, s43
  v_add_u32 v23, s42, v23
  s_lshl_b32 s42, s17, 18
  s_lshl_b32 s43, s16, 10
  s_add_u32 s42, s42, s43
  s_lshl_b32 s43, s18, 8
  s_add_u32 s42, s42, s43
  v_add_u32 v24, s42, v24
  v_and_b32 v20, 3, v16
  v_bfe_u32 v31, v16, 3, 1
  v_bfe_u32 v19, v16, 2, 1
  s_and_b32 s42, s18, 1
  s_lshl_b32 s42, s42, 6
  s_add_u32 s42, s42, s45
  v_lshl_add_u32 v22, v17, 2, v19
  v_lshlrev_b32 v22, 7, v22
  v_add_u32 v22, s42, v22
  v_mul_u32_u24 v25, 4128, v31
  v_lshl_add_u32 v25, v20, 3, v25
  v_add_u32 v25, v25, v22
  v_xor_b32 v26, 0x1000, v25
  v_xor_b32 v27, 0x8000, v25
  v_xor_b32 v28, 0x8000, v26
  v_and_b32 v21, 1, v17
  v_lshlrev_b32 v21, 4, v21
  v_lshrrev_b32 v22, 1, v17
  v_lshl_add_u32 v21, v22, 2, v21
  v_add_u32 v21, v21, v19
  v_lshlrev_b32 v21, 7, v21
  v_lshl_add_u32 v21, v31, 5, v21
  v_lshl_add_u32 v21, v20, 3, v21
  v_add_u32 v29, s45, v21
  v_and_b32 v19, 7, v16
  v_lshlrev_b32 v19, 11, v19
  v_lshl_add_u32 v19, v17, 4, v19
  v_lshl_add_u32 v19, v31, 6, v19
  s_lshl_b32 s42, s16, 10
  s_lshl_b32 s43, s18, 8
  s_add_u32 s42, s42, s43
  v_add_u32 v30, s42, v19
  s_mov_b32 s12, s68
  s_mov_b32 s13, s69
  s_mov_b32 s14, 0x800000
  s_mov_b32 s15, 0x20000
  s_xor_b32 s43, s18, 0
  s_lshl_b32 s43, s43, 20
  s_add_u32 s42, s43, 0x0
  s_add_u32 m0, s45, 0
  s_nop 0
  buffer_load_dwordx4 v23, s[12:15], s42 offen lds
  s_add_u32 s42, s43, 0x10000
  s_add_u32 m0, s45, 1024
  s_nop 0
  buffer_load_dwordx4 v23, s[12:15], s42 offen lds
  s_add_u32 s42, s43, 0x20000
  s_add_u32 m0, s45, 2048
  s_nop 0
  buffer_load_dwordx4 v23, s[12:15], s42 offen lds
  s_add_u32 s42, s43, 0x30000
  s_add_u32 m0, s45, 3072
  s_nop 0
  buffer_load_dwordx4 v23, s[12:15], s42 offen lds
  s_add_u32 s42, s43, 0x40000
  s_add_u32 m0, s45, 4096
  s_nop 0
  buffer_load_dwordx4 v23, s[12:15], s42 offen lds
  s_add_u32 s42, s43, 0x50000
  s_add_u32 m0, s45, 5120
  s_nop 0
  buffer_load_dwordx4 v23, s[12:15], s42 offen lds
  s_add_u32 s42, s43, 0x60000
  s_add_u32 m0, s45, 6144
  s_nop 0
  buffer_load_dwordx4 v23, s[12:15], s42 offen lds
  s_add_u32 s42, s43, 0x70000
  s_add_u32 m0, s45, 7168
  s_nop 0
  buffer_load_dwordx4 v23, s[12:15], s42 offen lds
  s_xor_b32 s43, s18, 0
  s_lshl_b32 s43, s43, 20
  s_add_u32 s42, s43, 0x80000
  s_add_u32 m0, s45, 8192
  s_nop 0
  buffer_load_dwordx4 v23, s[12:15], s42 offen lds
  s_add_u32 s42, s43, 0x90000
  s_add_u32 m0, s45, 9216
  s_nop 0
  buffer_load_dwordx4 v23, s[12:15], s42 offen lds
  s_add_u32 s42, s43, 0xa0000
  s_add_u32 m0, s45, 10240
  s_nop 0
  buffer_load_dwordx4 v23, s[12:15], s42 offen lds
  s_add_u32 s42, s43, 0xb0000
  s_add_u32 m0, s45, 11264
  s_nop 0
  buffer_load_dwordx4 v23, s[12:15], s42 offen lds
  s_add_u32 s42, s43, 0xc0000
  s_add_u32 m0, s45, 12288
  s_nop 0
  buffer_load_dwordx4 v23, s[12:15], s42 offen lds
  s_add_u32 s42, s43, 0xd0000
  s_add_u32 m0, s45, 13312
  s_nop 0
  buffer_load_dwordx4 v23, s[12:15], s42 offen lds
  s_add_u32 s42, s43, 0xe0000
  s_add_u32 m0, s45, 14336
  s_nop 0
  buffer_load_dwordx4 v23, s[12:15], s42 offen lds
  s_add_u32 s42, s43, 0xf0000
  s_add_u32 m0, s45, 15360
  s_nop 0
  buffer_load_dwordx4 v23, s[12:15], s42 offen lds
  s_xor_b32 s43, s18, 2
  s_lshl_b32 s43, s43, 20
  s_add_u32 s42, s43, 0x0
  s_add_u32 m0, s45, 16384
  s_nop 0
  buffer_load_dwordx4 v23, s[12:15], s42 offen lds
  s_add_u32 s42, s43, 0x10000
  s_add_u32 m0, s45, 17408
  s_nop 0
  buffer_load_dwordx4 v23, s[12:15], s42 offen lds
  s_add_u32 s42, s43, 0x20000
  s_add_u32 m0, s45, 18432
  s_nop 0
  buffer_load_dwordx4 v23, s[12:15], s42 offen lds
  s_add_u32 s42, s43, 0x30000
  s_add_u32 m0, s45, 19456
  s_nop 0
  buffer_load_dwordx4 v23, s[12:15], s42 offen lds
  s_add_u32 s42, s43, 0x40000
  s_add_u32 m0, s45, 20480
  s_nop 0
  buffer_load_dwordx4 v23, s[12:15], s42 offen lds
  s_add_u32 s42, s43, 0x50000
  s_add_u32 m0, s45, 21504
  s_nop 0
  buffer_load_dwordx4 v23, s[12:15], s42 offen lds
  s_add_u32 s42, s43, 0x60000
  s_add_u32 m0, s45, 22528
  s_nop 0
  buffer_load_dwordx4 v23, s[12:15], s42 offen lds
  s_add_u32 s42, s43, 0x70000
  s_add_u32 m0, s45, 23552
  s_nop 0
  buffer_load_dwordx4 v23, s[12:15], s42 offen lds
  s_xor_b32 s43, s18, 2
  s_lshl_b32 s43, s43, 20
  s_add_u32 s42, s43, 0x80000
  s_add_u32 m0, s45, 24576
  s_nop 0
  buffer_load_dwordx4 v23, s[12:15], s42 offen lds
  s_add_u32 s42, s43, 0x90000
  s_add_u32 m0, s45, 25600
  s_nop 0
  buffer_load_dwordx4 v23, s[12:15], s42 offen lds
  s_add_u32 s42, s43, 0xa0000
  s_add_u32 m0, s45, 26624
  s_nop 0
  buffer_load_dwordx4 v23, s[12:15], s42 offen lds
  s_add_u32 s42, s43, 0xb0000
  s_add_u32 m0, s45, 27648
  s_nop 0
  buffer_load_dwordx4 v23, s[12:15], s42 offen lds
  s_add_u32 s42, s43, 0xc0000
  s_add_u32 m0, s45, 28672
  s_nop 0
  buffer_load_dwordx4 v23, s[12:15], s42 offen lds
  s_add_u32 s42, s43, 0xd0000
  s_add_u32 m0, s45, 29696
  s_nop 0
  buffer_load_dwordx4 v23, s[12:15], s42 offen lds
  s_add_u32 s42, s43, 0xe0000
  s_add_u32 m0, s45, 30720
  s_nop 0
  buffer_load_dwordx4 v23, s[12:15], s42 offen lds
  s_add_u32 s42, s43, 0xf0000
  s_add_u32 m0, s45, 31744
  s_nop 0
  buffer_load_dwordx4 v23, s[12:15], s42 offen lds
  s_waitcnt vmcnt(24)
  s_barrier
  ds_read_b64_tr_b16 a[0:1], v25 offset:0
  ds_read_b64_tr_b16 a[2:3], v25 offset:256
  ds_read_b64_tr_b16 a[4:5], v25 offset:2048
  ds_read_b64_tr_b16 a[6:7], v25 offset:2304
  ds_read_b64_tr_b16 a[8:9], v26 offset:0
  ds_read_b64_tr_b16 a[10:11], v26 offset:256
  ds_read_b64_tr_b16 a[12:13], v26 offset:2048
  ds_read_b64_tr_b16 a[14:15], v26 offset:2304
  ds_read_b64_tr_b16 a[32:33], v27 offset:0
  ds_read_b64_tr_b16 a[34:35], v27 offset:256
  ds_read_b64_tr_b16 a[36:37], v27 offset:2048
  ds_read_b64_tr_b16 a[38:39], v27 offset:2304
  s_waitcnt lgkmcnt(4)
  ds_read_b64_tr_b16 a[40:41], v28 offset:0
  ds_read_b64_tr_b16 a[42:43], v28 offset:256
  ds_read_b64_tr_b16 a[44:45], v28 offset:2048
  ds_read_b64_tr_b16 a[46:47], v28 offset:2304
  s_waitcnt lgkmcnt(0)
  s_barrier
  s_mov_b32 s12, s70
  s_mov_b32 s13, s71
  s_mov_b32 s14, 0x800000
  s_mov_b32 s15, 0x20000
  s_xor_b32 s43, s18, 0
  s_lshl_b32 s43, s43, 20
  s_add_u32 s42, s43, 0x0
  s_add_u32 m0, s45, 0
  s_nop 0
  buffer_load_dwordx4 v23, s[12:15], s42 offen lds
  s_add_u32 s42, s43, 0x10000
  s_add_u32 m0, s45, 1024
  s_nop 0
  buffer_load_dwordx4 v23, s[12:15], s42 offen lds
  s_add_u32 s42, s43, 0x20000
  s_add_u32 m0, s45, 2048
  s_nop 0
  buffer_load_dwordx4 v23, s[12:15], s42 offen lds
  s_add_u32 s42, s43, 0x30000
  s_add_u32 m0, s45, 3072
  s_nop 0
  buffer_load_dwordx4 v23, s[12:15], s42 offen lds
  s_add_u32 s42, s43, 0x40000
  s_add_u32 m0, s45, 4096
  s_nop 0
  buffer_load_dwordx4 v23, s[12:15], s42 offen lds
  s_add_u32 s42, s43, 0x50000
  s_add_u32 m0, s45, 5120
  s_nop 0
  buffer_load_dwordx4 v23, s[12:15], s42 offen lds
  s_add_u32 s42, s43, 0x60000
  s_add_u32 m0, s45, 6144
  s_nop 0
  buffer_load_dwordx4 v23, s[12:15], s42 offen lds
  s_add_u32 s42, s43, 0x70000
  s_add_u32 m0, s45, 7168
  s_nop 0
  buffer_load_dwordx4 v23, s[12:15], s42 offen lds
  s_waitcnt vmcnt(24)
  s_barrier
  ds_read_b64_tr_b16 a[16:17], v25 offset:8192
  ds_read_b64_tr_b16 a[18:19], v25 offset:8448
  ds_read_b64_tr_b16 a[20:21], v25 offset:10240
  ds_read_b64_tr_b16 a[22:23], v25 offset:10496
  ds_read_b64_tr_b16 a[24:25], v26 offset:8192
  ds_read_b64_tr_b16 a[26:27], v26 offset:8448
  ds_read_b64_tr_b16 a[28:29], v26 offset:10240
  ds_read_b64_tr_b16 a[30:31], v26 offset:10496
  ds_read_b64_tr_b16 a[48:49], v27 offset:8192
  ds_read_b64_tr_b16 a[50:51], v27 offset:8448
  ds_read_b64_tr_b16 a[52:53], v27 offset:10240
  ds_read_b64_tr_b16 a[54:55], v27 offset:10496
  s_waitcnt lgkmcnt(4)
  ds_read_b64_tr_b16 a[56:57], v28 offset:8192
  ds_read_b64_tr_b16 a[58:59], v28 offset:8448
  ds_read_b64_tr_b16 a[60:61], v28 offset:10240
  ds_read_b64_tr_b16 a[62:63], v28 offset:10496
  s_waitcnt lgkmcnt(0)
  s_barrier
  s_xor_b32 s43, s18, 0
  s_lshl_b32 s43, s43, 20
  s_add_u32 s42, s43, 0x80000
  s_add_u32 m0, s45, 8192
  s_nop 0
  buffer_load_dwordx4 v23, s[12:15], s42 offen lds
  s_add_u32 s42, s43, 0x90000
  s_add_u32 m0, s45, 9216
  s_nop 0
  buffer_load_dwordx4 v23, s[12:15], s42 offen lds
  s_add_u32 s42, s43, 0xa0000
  s_add_u32 m0, s45, 10240
  s_nop 0
  buffer_load_dwordx4 v23, s[12:15], s42 offen lds
  s_add_u32 s42, s43, 0xb0000
  s_add_u32 m0, s45, 11264
  s_nop 0
  buffer_load_dwordx4 v23, s[12:15], s42 offen lds
  s_add_u32 s42, s43, 0xc0000
  s_add_u32 m0, s45, 12288
  s_nop 0
  buffer_load_dwordx4 v23, s[12:15], s42 offen lds
  s_add_u32 s42, s43, 0xd0000
  s_add_u32 m0, s45, 13312
  s_nop 0
  buffer_load_dwordx4 v23, s[12:15], s42 offen lds
  s_add_u32 s42, s43, 0xe0000
  s_add_u32 m0, s45, 14336
  s_nop 0
  buffer_load_dwordx4 v23, s[12:15], s42 offen lds
  s_add_u32 s42, s43, 0xf0000
  s_add_u32 m0, s45, 15360
  s_nop 0
  buffer_load_dwordx4 v23, s[12:15], s42 offen lds
  s_waitcnt vmcnt(24)
  s_barrier
  ds_read_b64_tr_b16 a[64:65], v25 offset:16384
  ds_read_b64_tr_b16 a[66:67], v25 offset:16640
  ds_read_b64_tr_b16 a[68:69], v25 offset:18432
  ds_read_b64_tr_b16 a[70:71], v25 offset:18688
  ds_read_b64_tr_b16 a[72:73], v26 offset:16384
  ds_read_b64_tr_b16 a[74:75], v26 offset:16640
  ds_read_b64_tr_b16 a[76:77], v26 offset:18432
  ds_read_b64_tr_b16 a[78:79], v26 offset:18688
  ds_read_b64_tr_b16 a[96:97], v27 offset:16384
  ds_read_b64_tr_b16 a[98:99], v27 offset:16640
  ds_read_b64_tr_b16 a[100:101], v27 offset:18432
  ds_read_b64_tr_b16 a[102:103], v27 offset:18688
  s_waitcnt lgkmcnt(4)
  ds_read_b64_tr_b16 a[104:105], v28 offset:16384
  ds_read_b64_tr_b16 a[106:107], v28 offset:16640
  ds_read_b64_tr_b16 a[108:109], v28 offset:18432
  ds_read_b64_tr_b16 a[110:111], v28 offset:18688
  s_waitcnt lgkmcnt(0)
  s_barrier
  s_xor_b32 s43, s18, 2
  s_lshl_b32 s43, s43, 20
  s_add_u32 s42, s43, 0x0
  s_add_u32 m0, s45, 16384
  s_nop 0
  buffer_load_dwordx4 v23, s[12:15], s42 offen lds
  s_add_u32 s42, s43, 0x10000
  s_add_u32 m0, s45, 17408
  s_nop 0
  buffer_load_dwordx4 v23, s[12:15], s42 offen lds
  s_add_u32 s42, s43, 0x20000
  s_add_u32 m0, s45, 18432
  s_nop 0
  buffer_load_dwordx4 v23, s[12:15], s42 offen lds
  s_add_u32 s42, s43, 0x30000
  s_add_u32 m0, s45, 19456
  s_nop 0
  buffer_load_dwordx4 v23, s[12:15], s42 offen lds
  s_add_u32 s42, s43, 0x40000
  s_add_u32 m0, s45, 20480
  s_nop 0
  buffer_load_dwordx4 v23, s[12:15], s42 offen lds
  s_add_u32 s42, s43, 0x50000
  s_add_u32 m0, s45, 21504
  s_nop 0
  buffer_load_dwordx4 v23, s[12:15], s42 offen lds
  s_add_u32 s42, s43, 0x60000
  s_add_u32 m0, s45, 22528
  s_nop 0
  buffer_load_dwordx4 v23, s[12:15], s42 offen lds
  s_add_u32 s42, s43, 0x70000
  s_add_u32 m0, s45, 23552
  s_nop 0
  buffer_load_dwordx4 v23, s[12:15], s42 offen lds
  s_waitcnt vmcnt(24)
  s_barrier
  ds_read_b64_tr_b16 a[80:81], v25 offset:24576
  ds_read_b64_tr_b16 a[82:83], v25 offset:24832
  ds_read_b64_tr_b16 a[84:85], v25 offset:26624
  ds_read_b64_tr_b16 a[86:87], v25 offset:26880
  ds_read_b64_tr_b16 a[88:89], v26 offset:24576
  ds_read_b64_tr_b16 a[90:91], v26 offset:24832
  ds_read_b64_tr_b16 a[92:93], v26 offset:26624
  ds_read_b64_tr_b16 a[94:95], v26 offset:26880
  ds_read_b64_tr_b16 a[112:113], v27 offset:24576
  ds_read_b64_tr_b16 a[114:115], v27 offset:24832
  ds_read_b64_tr_b16 a[116:117], v27 offset:26624
  ds_read_b64_tr_b16 a[118:119], v27 offset:26880
  s_waitcnt lgkmcnt(4)
  ds_read_b64_tr_b16 a[120:121], v28 offset:24576
  ds_read_b64_tr_b16 a[122:123], v28 offset:24832
  ds_read_b64_tr_b16 a[124:125], v28 offset:26624
  ds_read_b64_tr_b16 a[126:127], v28 offset:26880
  s_waitcnt lgkmcnt(0)
  s_barrier
  s_xor_b32 s43, s18, 2
  s_lshl_b32 s43, s43, 20
  s_add_u32 s42, s43, 0x80000
  s_add_u32 m0, s45, 24576
  s_nop 0
  buffer_load_dwordx4 v23, s[12:15], s42 offen lds
  s_add_u32 s42, s43, 0x90000
  s_add_u32 m0, s45, 25600
  s_nop 0
  buffer_load_dwordx4 v23, s[12:15], s42 offen lds
  s_add_u32 s42, s43, 0xa0000
  s_add_u32 m0, s45, 26624
  s_nop 0
  buffer_load_dwordx4 v23, s[12:15], s42 offen lds
  s_add_u32 s42, s43, 0xb0000
  s_add_u32 m0, s45, 27648
  s_nop 0
  buffer_load_dwordx4 v23, s[12:15], s42 offen lds
  s_add_u32 s42, s43, 0xc0000
  s_add_u32 m0, s45, 28672
  s_nop 0
  buffer_load_dwordx4 v23, s[12:15], s42 offen lds
  s_add_u32 s42, s43, 0xd0000
  s_add_u32 m0, s45, 29696
  s_nop 0
  buffer_load_dwordx4 v23, s[12:15], s42 offen lds
  s_add_u32 s42, s43, 0xe0000
  s_add_u32 m0, s45, 30720
  s_nop 0
  buffer_load_dwordx4 v23, s[12:15], s42 offen lds
  s_add_u32 s42, s43, 0xf0000
  s_add_u32 m0, s45, 31744
  s_nop 0
  buffer_load_dwordx4 v23, s[12:15], s42 offen lds
  s_waitcnt vmcnt(24)
  s_barrier
  ds_read_b64_tr_b16 a[128:129], v25 offset:0
  ds_read_b64_tr_b16 a[130:131], v25 offset:256
  ds_read_b64_tr_b16 a[132:133], v25 offset:2048
  ds_read_b64_tr_b16 a[134:135], v25 offset:2304
  ds_read_b64_tr_b16 a[136:137], v26 offset:0
  ds_read_b64_tr_b16 a[138:139], v26 offset:256
  ds_read_b64_tr_b16 a[140:141], v26 offset:2048
  ds_read_b64_tr_b16 a[142:143], v26 offset:2304
  ds_read_b64_tr_b16 a[160:161], v27 offset:0
  ds_read_b64_tr_b16 a[162:163], v27 offset:256
  ds_read_b64_tr_b16 a[164:165], v27 offset:2048
  ds_read_b64_tr_b16 a[166:167], v27 offset:2304
  s_waitcnt lgkmcnt(4)
  ds_read_b64_tr_b16 a[168:169], v28 offset:0
  ds_read_b64_tr_b16 a[170:171], v28 offset:256
  ds_read_b64_tr_b16 a[172:173], v28 offset:2048
  ds_read_b64_tr_b16 a[174:175], v28 offset:2304
  s_waitcnt lgkmcnt(0)
  s_barrier
  s_mov_b32 s12, s72
  s_mov_b32 s13, s73
  s_mov_b32 s14, 0x800000
  s_mov_b32 s15, 0x20000
  s_xor_b32 s43, s18, 0
  s_lshl_b32 s43, s43, 20
  s_add_u32 s42, s43, 0x0
  s_add_u32 m0, s45, 0
  s_nop 0
  buffer_load_dwordx4 v23, s[12:15], s42 offen lds
  s_add_u32 s42, s43, 0x10000
  s_add_u32 m0, s45, 1024
  s_nop 0
  buffer_load_dwordx4 v23, s[12:15], s42 offen lds
  s_add_u32 s42, s43, 0x20000
  s_add_u32 m0, s45, 2048
  s_nop 0
  buffer_load_dwordx4 v23, s[12:15], s42 offen lds
  s_add_u32 s42, s43, 0x30000
  s_add_u32 m0, s45, 3072
  s_nop 0
  buffer_load_dwordx4 v23, s[12:15], s42 offen lds
  s_add_u32 s42, s43, 0x40000
  s_add_u32 m0, s45, 4096
  s_nop 0
  buffer_load_dwordx4 v23, s[12:15], s42 offen lds
  s_add_u32 s42, s43, 0x50000
  s_add_u32 m0, s45, 5120
  s_nop 0
  buffer_load_dwordx4 v23, s[12:15], s42 offen lds
  s_add_u32 s42, s43, 0x60000
  s_add_u32 m0, s45, 6144
  s_nop 0
  buffer_load_dwordx4 v23, s[12:15], s42 offen lds
  s_add_u32 s42, s43, 0x70000
  s_add_u32 m0, s45, 7168
  s_nop 0
  buffer_load_dwordx4 v23, s[12:15], s42 offen lds
  s_waitcnt vmcnt(24)
  s_barrier
  ds_read_b64_tr_b16 a[144:145], v25 offset:8192
  ds_read_b64_tr_b16 a[146:147], v25 offset:8448
  ds_read_b64_tr_b16 a[148:149], v25 offset:10240
  ds_read_b64_tr_b16 a[150:151], v25 offset:10496
  ds_read_b64_tr_b16 a[152:153], v26 offset:8192
  ds_read_b64_tr_b16 a[154:155], v26 offset:8448
  ds_read_b64_tr_b16 a[156:157], v26 offset:10240
  ds_read_b64_tr_b16 a[158:159], v26 offset:10496
  ds_read_b64_tr_b16 a[176:177], v27 offset:8192
  ds_read_b64_tr_b16 a[178:179], v27 offset:8448
  ds_read_b64_tr_b16 a[180:181], v27 offset:10240
  ds_read_b64_tr_b16 a[182:183], v27 offset:10496
  s_waitcnt lgkmcnt(4)
  ds_read_b64_tr_b16 a[184:185], v28 offset:8192
  ds_read_b64_tr_b16 a[186:187], v28 offset:8448
  ds_read_b64_tr_b16 a[188:189], v28 offset:10240
  ds_read_b64_tr_b16 a[190:191], v28 offset:10496
  s_waitcnt lgkmcnt(0)
  s_barrier
  s_xor_b32 s43, s18, 0
  s_lshl_b32 s43, s43, 20
  s_add_u32 s42, s43, 0x80000
  s_add_u32 m0, s45, 8192
  s_nop 0
  buffer_load_dwordx4 v23, s[12:15], s42 offen lds
  s_add_u32 s42, s43, 0x90000
  s_add_u32 m0, s45, 9216
  s_nop 0
  buffer_load_dwordx4 v23, s[12:15], s42 offen lds
  s_add_u32 s42, s43, 0xa0000
  s_add_u32 m0, s45, 10240
  s_nop 0
  buffer_load_dwordx4 v23, s[12:15], s42 offen lds
  s_add_u32 s42, s43, 0xb0000
  s_add_u32 m0, s45, 11264
  s_nop 0
  buffer_load_dwordx4 v23, s[12:15], s42 offen lds
  s_add_u32 s42, s43, 0xc0000
  s_add_u32 m0, s45, 12288
  s_nop 0
  buffer_load_dwordx4 v23, s[12:15], s42 offen lds
  s_add_u32 s42, s43, 0xd0000
  s_add_u32 m0, s45, 13312
  s_nop 0
  buffer_load_dwordx4 v23, s[12:15], s42 offen lds
  s_add_u32 s42, s43, 0xe0000
  s_add_u32 m0, s45, 14336
  s_nop 0
  buffer_load_dwordx4 v23, s[12:15], s42 offen lds
  s_add_u32 s42, s43, 0xf0000
  s_add_u32 m0, s45, 15360
  s_nop 0
  buffer_load_dwordx4 v23, s[12:15], s42 offen lds
  s_waitcnt vmcnt(24)
  s_barrier
  ds_read_b64_tr_b16 a[192:193], v25 offset:16384
  ds_read_b64_tr_b16 a[194:195], v25 offset:16640
  ds_read_b64_tr_b16 a[196:197], v25 offset:18432
  ds_read_b64_tr_b16 a[198:199], v25 offset:18688
  ds_read_b64_tr_b16 a[200:201], v26 offset:16384
  ds_read_b64_tr_b16 a[202:203], v26 offset:16640
  ds_read_b64_tr_b16 a[204:205], v26 offset:18432
  ds_read_b64_tr_b16 a[206:207], v26 offset:18688
  ds_read_b64_tr_b16 a[224:225], v27 offset:16384
  ds_read_b64_tr_b16 a[226:227], v27 offset:16640
  ds_read_b64_tr_b16 a[228:229], v27 offset:18432
  ds_read_b64_tr_b16 a[230:231], v27 offset:18688
  s_waitcnt lgkmcnt(4)
  ds_read_b64_tr_b16 a[232:233], v28 offset:16384
  ds_read_b64_tr_b16 a[234:235], v28 offset:16640
  ds_read_b64_tr_b16 a[236:237], v28 offset:18432
  ds_read_b64_tr_b16 a[238:239], v28 offset:18688
  s_waitcnt lgkmcnt(0)
  s_barrier
  s_mov_b32 s12, s74
  s_mov_b32 s13, s75
  s_mov_b32 s14, 0x800000
  s_mov_b32 s15, 0x20000
  s_xor_b32 s43, s18, 0
  s_lshl_b32 s43, s43, 16
  s_add_u32 s42, s43, 0x0
  s_add_u32 m0, s45, 16384
  s_nop 0
  buffer_load_dwordx4 v24, s[12:15], s42 offen lds
  s_add_u32 s42, s43, 0x4000
  s_add_u32 m0, s45, 17408
  s_nop 0
  buffer_load_dwordx4 v24, s[12:15], s42 offen lds
  s_add_u32 s42, s43, 0x8000
  s_add_u32 m0, s45, 18432
  s_nop 0
  buffer_load_dwordx4 v24, s[12:15], s42 offen lds
  s_add_u32 s42, s43, 0xc000
  s_add_u32 m0, s45, 19456
  s_nop 0
  buffer_load_dwordx4 v24, s[12:15], s42 offen lds
  s_xor_b32 s43, s18, 1
  s_lshl_b32 s43, s43, 16
  s_add_u32 s42, s43, 0x0
  s_add_u32 m0, s45, 20480
  s_nop 0
  buffer_load_dwordx4 v24, s[12:15], s42 offen lds
  s_add_u32 s42, s43, 0x4000
  s_add_u32 m0, s45, 21504
  s_nop 0
  buffer_load_dwordx4 v24, s[12:15], s42 offen lds
  s_add_u32 s42, s43, 0x8000
  s_add_u32 m0, s45, 22528
  s_nop 0
  buffer_load_dwordx4 v24, s[12:15], s42 offen lds
  s_add_u32 s42, s43, 0xc000
  s_add_u32 m0, s45, 23552
  s_nop 0
  buffer_load_dwordx4 v24, s[12:15], s42 offen lds
  s_waitcnt vmcnt(24)
  s_barrier
  ds_read_b64_tr_b16 a[208:209], v25 offset:24576
  ds_read_b64_tr_b16 a[210:211], v25 offset:24832
  ds_read_b64_tr_b16 a[212:213], v25 offset:26624
  ds_read_b64_tr_b16 a[214:215], v25 offset:26880
  ds_read_b64_tr_b16 a[216:217], v26 offset:24576
  ds_read_b64_tr_b16 a[218:219], v26 offset:24832
  ds_read_b64_tr_b16 a[220:221], v26 offset:26624
  ds_read_b64_tr_b16 a[222:223], v26 offset:26880
  ds_read_b64_tr_b16 a[240:241], v27 offset:24576
  ds_read_b64_tr_b16 a[242:243], v27 offset:24832
  ds_read_b64_tr_b16 a[244:245], v27 offset:26624
  ds_read_b64_tr_b16 a[246:247], v27 offset:26880
  s_waitcnt lgkmcnt(4)
  ds_read_b64_tr_b16 a[248:249], v28 offset:24576
  ds_read_b64_tr_b16 a[250:251], v28 offset:24832
  ds_read_b64_tr_b16 a[252:253], v28 offset:26624
  ds_read_b64_tr_b16 a[254:255], v28 offset:26880
  s_waitcnt lgkmcnt(0)
  s_barrier
  s_xor_b32 s43, s18, 2
  s_lshl_b32 s43, s43, 16
  s_add_u32 s42, s43, 0x0
  s_add_u32 m0, s45, 24576
  s_nop 0
  buffer_load_dwordx4 v24, s[12:15], s42 offen lds
  s_add_u32 s42, s43, 0x4000
  s_add_u32 m0, s45, 25600
  s_nop 0
  buffer_load_dwordx4 v24, s[12:15], s42 offen lds
  s_add_u32 s42, s43, 0x8000
  s_add_u32 m0, s45, 26624
  s_nop 0
  buffer_load_dwordx4 v24, s[12:15], s42 offen lds
  s_add_u32 s42, s43, 0xc000
  s_add_u32 m0, s45, 27648
  s_nop 0
  buffer_load_dwordx4 v24, s[12:15], s42 offen lds
  s_xor_b32 s43, s18, 3
  s_lshl_b32 s43, s43, 16
  s_add_u32 s42, s43, 0x0
  s_add_u32 m0, s45, 28672
  s_nop 0
  buffer_load_dwordx4 v24, s[12:15], s42 offen lds
  s_add_u32 s42, s43, 0x4000
  s_add_u32 m0, s45, 29696
  s_nop 0
  buffer_load_dwordx4 v24, s[12:15], s42 offen lds
  s_add_u32 s42, s43, 0x8000
  s_add_u32 m0, s45, 30720
  s_nop 0
  buffer_load_dwordx4 v24, s[12:15], s42 offen lds
  s_add_u32 s42, s43, 0xc000
  s_add_u32 m0, s45, 31744
  s_nop 0
  buffer_load_dwordx4 v24, s[12:15], s42 offen lds
  s_waitcnt vmcnt(24)
  s_barrier
  ds_read_b64_tr_b16 v[128:129], v25 offset:0
  ds_read_b64_tr_b16 v[130:131], v25 offset:256
  ds_read_b64_tr_b16 v[132:133], v25 offset:2048
  ds_read_b64_tr_b16 v[134:135], v25 offset:2304
  ds_read_b64_tr_b16 v[136:137], v26 offset:0
  ds_read_b64_tr_b16 v[138:139], v26 offset:256
  ds_read_b64_tr_b16 v[140:141], v26 offset:2048
  ds_read_b64_tr_b16 v[142:143], v26 offset:2304
  ds_read_b64_tr_b16 v[160:161], v27 offset:0
  ds_read_b64_tr_b16 v[162:163], v27 offset:256
  ds_read_b64_tr_b16 v[164:165], v27 offset:2048
  ds_read_b64_tr_b16 v[166:167], v27 offset:2304
  s_waitcnt lgkmcnt(4)
  ds_read_b64_tr_b16 v[168:169], v28 offset:0
  ds_read_b64_tr_b16 v[170:171], v28 offset:256
  ds_read_b64_tr_b16 v[172:173], v28 offset:2048
  ds_read_b64_tr_b16 v[174:175], v28 offset:2304
  s_waitcnt lgkmcnt(0)
  s_barrier
  s_xor_b32 s43, s18, 0
  s_lshl_b32 s43, s43, 16
  s_add_u32 s42, s43, 0x80
  s_add_u32 m0, s45, 0
  s_nop 0
  buffer_load_dwordx4 v24, s[12:15], s42 offen lds
  s_add_u32 s42, s43, 0x4080
  s_add_u32 m0, s45, 1024
  s_nop 0
  buffer_load_dwordx4 v24, s[12:15], s42 offen lds
  s_add_u32 s42, s43, 0x8080
  s_add_u32 m0, s45, 2048
  s_nop 0
  buffer_load_dwordx4 v24, s[12:15], s42 offen lds
  s_add_u32 s42, s43, 0xc080
  s_add_u32 m0, s45, 3072
  s_nop 0
  buffer_load_dwordx4 v24, s[12:15], s42 offen lds
  s_xor_b32 s43, s18, 1
  s_lshl_b32 s43, s43, 16
  s_add_u32 s42, s43, 0x80
  s_add_u32 m0, s45, 4096
  s_nop 0
  buffer_load_dwordx4 v24, s[12:15], s42 offen lds
  s_add_u32 s42, s43, 0x4080
  s_add_u32 m0, s45, 5120
  s_nop 0
  buffer_load_dwordx4 v24, s[12:15], s42 offen lds
  s_add_u32 s42, s43, 0x8080
  s_add_u32 m0, s45, 6144
  s_nop 0
  buffer_load_dwordx4 v24, s[12:15], s42 offen lds
  s_add_u32 s42, s43, 0xc080
  s_add_u32 m0, s45, 7168
  s_nop 0
  buffer_load_dwordx4 v24, s[12:15], s42 offen lds
  s_waitcnt vmcnt(24)
  s_barrier
  ds_read_b64_tr_b16 v[144:145], v25 offset:8192
  ds_read_b64_tr_b16 v[146:147], v25 offset:8448
  ds_read_b64_tr_b16 v[148:149], v25 offset:10240
  ds_read_b64_tr_b16 v[150:151], v25 offset:10496
  ds_read_b64_tr_b16 v[152:153], v26 offset:8192
  ds_read_b64_tr_b16 v[154:155], v26 offset:8448
  ds_read_b64_tr_b16 v[156:157], v26 offset:10240
  ds_read_b64_tr_b16 v[158:159], v26 offset:10496
  ds_read_b64_tr_b16 v[176:177], v27 offset:8192
  ds_read_b64_tr_b16 v[178:179], v27 offset:8448
  ds_read_b64_tr_b16 v[180:181], v27 offset:10240
  ds_read_b64_tr_b16 v[182:183], v27 offset:10496
  s_waitcnt lgkmcnt(4)
  ds_read_b64_tr_b16 v[184:185], v28 offset:8192
  ds_read_b64_tr_b16 v[186:187], v28 offset:8448
  ds_read_b64_tr_b16 v[188:189], v28 offset:10240
  ds_read_b64_tr_b16 v[190:191], v28 offset:10496
  s_waitcnt lgkmcnt(0)
  s_barrier
  s_xor_b32 s43, s18, 2
  s_lshl_b32 s43, s43, 16
  s_add_u32 s42, s43, 0x80
  s_add_u32 m0, s45, 8192
  s_nop 0
  buffer_load_dwordx4 v24, s[12:15], s42 offen lds
  s_add_u32 s42, s43, 0x4080
  s_add_u32 m0, s45, 9216
  s_nop 0
  buffer_load_dwordx4 v24, s[12:15], s42 offen lds
  s_add_u32 s42, s43, 0x8080
  s_add_u32 m0, s45, 10240
  s_nop 0
  buffer_load_dwordx4 v24, s[12:15], s42 offen lds
  s_add_u32 s42, s43, 0xc080
  s_add_u32 m0, s45, 11264
  s_nop 0
  buffer_load_dwordx4 v24, s[12:15], s42 offen lds
  s_xor_b32 s43, s18, 3
  s_lshl_b32 s43, s43, 16
  s_add_u32 s42, s43, 0x80
  s_add_u32 m0, s45, 12288
  s_nop 0
  buffer_load_dwordx4 v24, s[12:15], s42 offen lds
  s_add_u32 s42, s43, 0x4080
  s_add_u32 m0, s45, 13312
  s_nop 0
  buffer_load_dwordx4 v24, s[12:15], s42 offen lds
  s_add_u32 s42, s43, 0x8080
  s_add_u32 m0, s45, 14336
  s_nop 0
  buffer_load_dwordx4 v24, s[12:15], s42 offen lds
  s_add_u32 s42, s43, 0xc080
  s_add_u32 m0, s45, 15360
  s_nop 0
  buffer_load_dwordx4 v24, s[12:15], s42 offen lds
  s_waitcnt vmcnt(24)
  ds_read_b64_tr_b16 v[32:33], v29 offset:16384
  ds_read_b64_tr_b16 v[34:35], v29 offset:16640
  ds_read_b64_tr_b16 v[36:37], v29 offset:17408
  ds_read_b64_tr_b16 v[38:39], v29 offset:17664
  ds_read_b64_tr_b16 v[40:41], v29 offset:16448
  ds_read_b64_tr_b16 v[42:43], v29 offset:16704
  ds_read_b64_tr_b16 v[44:45], v29 offset:17472
  ds_read_b64_tr_b16 v[46:47], v29 offset:17728
  ds_read_b64_tr_b16 v[192:193], v29 offset:20480
  ds_read_b64_tr_b16 v[194:195], v29 offset:20736
  ds_read_b64_tr_b16 v[196:197], v29 offset:21504
  ds_read_b64_tr_b16 v[198:199], v29 offset:21760
  s_waitcnt lgkmcnt(4)
  ds_read_b64_tr_b16 v[200:201], v29 offset:20544
  ds_read_b64_tr_b16 v[202:203], v29 offset:20800
  ds_read_b64_tr_b16 v[204:205], v29 offset:21568
  ds_read_b64_tr_b16 v[206:207], v29 offset:21824
  s_waitcnt lgkmcnt(0)
  s_mov_b32 s12, s72
  s_mov_b32 s13, s73
  s_mov_b32 s14, 0x800000
  s_mov_b32 s15, 0x20000
  s_xor_b32 s43, s18, 2
  s_lshl_b32 s43, s43, 20
  s_add_u32 s42, s43, 0x0
  s_add_u32 m0, s45, 16384
  s_nop 0
  buffer_load_dwordx4 v23, s[12:15], s42 offen lds
  s_add_u32 s42, s43, 0x10000
  s_add_u32 m0, s45, 17408
  s_nop 0
  buffer_load_dwordx4 v23, s[12:15], s42 offen lds
  s_add_u32 s42, s43, 0x20000
  s_add_u32 m0, s45, 18432
  s_nop 0
  buffer_load_dwordx4 v23, s[12:15], s42 offen lds
  s_add_u32 s42, s43, 0x30000
  s_add_u32 m0, s45, 19456
  s_nop 0
  buffer_load_dwordx4 v23, s[12:15], s42 offen lds
  s_add_u32 s42, s43, 0x40000
  s_add_u32 m0, s45, 20480
  s_nop 0
  buffer_load_dwordx4 v23, s[12:15], s42 offen lds
  s_add_u32 s42, s43, 0x50000
  s_add_u32 m0, s45, 21504
  s_nop 0
  buffer_load_dwordx4 v23, s[12:15], s42 offen lds
  s_add_u32 s42, s43, 0x60000
  s_add_u32 m0, s45, 22528
  s_nop 0
  buffer_load_dwordx4 v23, s[12:15], s42 offen lds
  s_add_u32 s42, s43, 0x70000
  s_add_u32 m0, s45, 23552
  s_nop 0
  buffer_load_dwordx4 v23, s[12:15], s42 offen lds
  s_waitcnt vmcnt(24)
  ds_read_b64_tr_b16 v[224:225], v29 offset:24576
  ds_read_b64_tr_b16 v[226:227], v29 offset:24832
  ds_read_b64_tr_b16 v[228:229], v29 offset:25600
  ds_read_b64_tr_b16 v[230:231], v29 offset:25856
  ds_read_b64_tr_b16 v[232:233], v29 offset:24640
  ds_read_b64_tr_b16 v[234:235], v29 offset:24896
  ds_read_b64_tr_b16 v[236:237], v29 offset:25664
  ds_read_b64_tr_b16 v[238:239], v29 offset:25920
  ds_read_b64_tr_b16 v[64:65], v29 offset:28672
  ds_read_b64_tr_b16 v[66:67], v29 offset:28928
  ds_read_b64_tr_b16 v[68:69], v29 offset:29696
  ds_read_b64_tr_b16 v[70:71], v29 offset:29952
  s_waitcnt lgkmcnt(4)
  ds_read_b64_tr_b16 v[72:73], v29 offset:28736
  ds_read_b64_tr_b16 v[74:75], v29 offset:28992
  ds_read_b64_tr_b16 v[76:77], v29 offset:29760
  ds_read_b64_tr_b16 v[78:79], v29 offset:30016
  s_waitcnt lgkmcnt(0)
  s_xor_b32 s43, s18, 2
  s_lshl_b32 s43, s43, 20
  s_add_u32 s42, s43, 0x80000
  s_add_u32 m0, s45, 24576
  s_nop 0
  buffer_load_dwordx4 v23, s[12:15], s42 offen lds
  s_add_u32 s42, s43, 0x90000
  s_add_u32 m0, s45, 25600
  s_nop 0
  buffer_load_dwordx4 v23, s[12:15], s42 offen lds
  s_add_u32 s42, s43, 0xa0000
  s_add_u32 m0, s45, 26624
  s_nop 0
  buffer_load_dwordx4 v23, s[12:15], s42 offen lds
  s_add_u32 s42, s43, 0xb0000
  s_add_u32 m0, s45, 27648
  s_nop 0
  buffer_load_dwordx4 v23, s[12:15], s42 offen lds
  s_add_u32 s42, s43, 0xc0000
  s_add_u32 m0, s45, 28672
  s_nop 0
  buffer_load_dwordx4 v23, s[12:15], s42 offen lds
  s_add_u32 s42, s43, 0xd0000
  s_add_u32 m0, s45, 29696
  s_nop 0
  buffer_load_dwordx4 v23, s[12:15], s42 offen lds
  s_add_u32 s42, s43, 0xe0000
  s_add_u32 m0, s45, 30720
  s_nop 0
  buffer_load_dwordx4 v23, s[12:15], s42 offen lds
  s_add_u32 s42, s43, 0xf0000
  s_add_u32 m0, s45, 31744
  s_nop 0
  buffer_load_dwordx4 v23, s[12:15], s42 offen lds
  s_waitcnt vmcnt(24)
  ds_read_b64_tr_b16 v[48:49], v29 offset:0
  ds_read_b64_tr_b16 v[50:51], v29 offset:256
  ds_read_b64_tr_b16 v[52:53], v29 offset:1024
  ds_read_b64_tr_b16 v[54:55], v29 offset:1280
  ds_read_b64_tr_b16 v[56:57], v29 offset:64
  ds_read_b64_tr_b16 v[58:59], v29 offset:320
  ds_read_b64_tr_b16 v[60:61], v29 offset:1088
  ds_read_b64_tr_b16 v[62:63], v29 offset:1344
  ds_read_b64_tr_b16 v[208:209], v29 offset:4096
  ds_read_b64_tr_b16 v[210:211], v29 offset:4352
  ds_read_b64_tr_b16 v[212:213], v29 offset:5120
  ds_read_b64_tr_b16 v[214:215], v29 offset:5376
  s_waitcnt lgkmcnt(4)
  ds_read_b64_tr_b16 v[216:217], v29 offset:4160
  ds_read_b64_tr_b16 v[218:219], v29 offset:4416
  ds_read_b64_tr_b16 v[220:221], v29 offset:5184
  ds_read_b64_tr_b16 v[222:223], v29 offset:5440
  s_waitcnt lgkmcnt(0)
  s_waitcnt vmcnt(16)
  ds_read_b64_tr_b16 v[240:241], v29 offset:8192
  ds_read_b64_tr_b16 v[242:243], v29 offset:8448
  ds_read_b64_tr_b16 v[244:245], v29 offset:9216
  ds_read_b64_tr_b16 v[246:247], v29 offset:9472
  ds_read_b64_tr_b16 v[248:249], v29 offset:8256
  ds_read_b64_tr_b16 v[250:251], v29 offset:8512
  ds_read_b64_tr_b16 v[252:253], v29 offset:9280
  ds_read_b64_tr_b16 v[254:255], v29 offset:9536
  ds_read_b64_tr_b16 v[80:81], v29 offset:12288
  ds_read_b64_tr_b16 v[82:83], v29 offset:12544
  ds_read_b64_tr_b16 v[84:85], v29 offset:13312
  ds_read_b64_tr_b16 v[86:87], v29 offset:13568
  s_waitcnt lgkmcnt(4)
  ds_read_b64_tr_b16 v[88:89], v29 offset:12352
  ds_read_b64_tr_b16 v[90:91], v29 offset:12608
  ds_read_b64_tr_b16 v[92:93], v29 offset:13376
  ds_read_b64_tr_b16 v[94:95], v29 offset:13632
  s_waitcnt lgkmcnt(0)
  s_waitcnt vmcnt(8)
  s_barrier
  ds_read_b64_tr_b16 v[96:97], v25 offset:16384
  ds_read_b64_tr_b16 v[98:99], v25 offset:16640
  ds_read_b64_tr_b16 v[100:101], v25 offset:18432
  ds_read_b64_tr_b16 v[102:103], v25 offset:18688
  ds_read_b64_tr_b16 v[104:105], v26 offset:16384
  ds_read_b64_tr_b16 v[106:107], v26 offset:16640
  ds_read_b64_tr_b16 v[108:109], v26 offset:18432
  ds_read_b64_tr_b16 v[110:111], v26 offset:18688
  ds_read_b64_tr_b16 v[112:113], v27 offset:16384
  ds_read_b64_tr_b16 v[114:115], v27 offset:16640
  ds_read_b64_tr_b16 v[116:117], v27 offset:18432
  ds_read_b64_tr_b16 v[118:119], v27 offset:18688
  s_waitcnt lgkmcnt(4)
  ds_read_b64_tr_b16 v[120:121], v28 offset:16384
  ds_read_b64_tr_b16 v[122:123], v28 offset:16640
  ds_read_b64_tr_b16 v[124:125], v28 offset:18432
  ds_read_b64_tr_b16 v[126:127], v28 offset:18688
  s_waitcnt lgkmcnt(0)
  s_barrier
  ds_write_b128 v5, v[96:99] offset:0
  ds_write_b128 v5, v[100:103] offset:1024
  ds_write_b128 v5, v[104:107] offset:2048
  ds_write_b128 v5, v[108:111] offset:3072
  ds_write_b128 v5, v[112:115] offset:8192
  ds_write_b128 v5, v[116:119] offset:9216
  ds_write_b128 v5, v[120:123] offset:10240
  ds_write_b128 v5, v[124:127] offset:11264
  s_waitcnt lgkmcnt(0)
  s_waitcnt vmcnt(0)
  s_barrier
  ds_read_b64_tr_b16 v[96:97], v25 offset:24576
  ds_read_b64_tr_b16 v[98:99], v25 offset:24832
  ds_read_b64_tr_b16 v[100:101], v25 offset:26624
  ds_read_b64_tr_b16 v[102:103], v25 offset:26880
  ds_read_b64_tr_b16 v[104:105], v26 offset:24576
  ds_read_b64_tr_b16 v[106:107], v26 offset:24832
  ds_read_b64_tr_b16 v[108:109], v26 offset:26624
  ds_read_b64_tr_b16 v[110:111], v26 offset:26880
  ds_read_b64_tr_b16 v[112:113], v27 offset:24576
  ds_read_b64_tr_b16 v[114:115], v27 offset:24832
  ds_read_b64_tr_b16 v[116:117], v27 offset:26624
  ds_read_b64_tr_b16 v[118:119], v27 offset:26880
  s_waitcnt lgkmcnt(4)
  ds_read_b64_tr_b16 v[120:121], v28 offset:24576
  ds_read_b64_tr_b16 v[122:123], v28 offset:24832
  ds_read_b64_tr_b16 v[124:125], v28 offset:26624
  ds_read_b64_tr_b16 v[126:127], v28 offset:26880
  s_waitcnt lgkmcnt(0)
  s_barrier
  ds_write_b128 v5, v[96:99] offset:4096
  ds_write_b128 v5, v[100:103] offset:5120
  ds_write_b128 v5, v[104:107] offset:6144
  ds_write_b128 v5, v[108:111] offset:7168
  ds_write_b128 v5, v[112:115] offset:12288
  ds_write_b128 v5, v[116:119] offset:13312
  ds_write_b128 v5, v[120:123] offset:14336
  ds_write_b128 v5, v[124:127] offset:15360
  s_waitcnt lgkmcnt(0)
  ds_write_b128 v5, v[32:35] offset:16384
  ds_write_b128 v5, v[36:39] offset:17408
  ds_write_b128 v5, v[40:43] offset:18432
  ds_write_b128 v5, v[44:47] offset:19456
  ds_write_b128 v5, v[48:51] offset:20480
  ds_write_b128 v5, v[52:55] offset:21504
  ds_write_b128 v5, v[56:59] offset:22528
  ds_write_b128 v5, v[60:63] offset:23552
  ds_write_b128 v5, v[64:67] offset:24576
  ds_write_b128 v5, v[68:71] offset:25600
  ds_write_b128 v5, v[72:75] offset:26624
  ds_write_b128 v5, v[76:79] offset:27648
  ds_write_b128 v5, v[80:83] offset:28672
  ds_write_b128 v5, v[84:87] offset:29696
  ds_write_b128 v5, v[88:91] offset:30720
  ds_write_b128 v5, v[92:95] offset:31744
  s_waitcnt lgkmcnt(0)
  s_mov_b32 s12, s66
  s_mov_b32 s13, s67
  s_mov_b32 s14, 0x4000
  s_mov_b32 s15, 0x20000
  buffer_load_dwordx4 v[32:35], v30, s[12:15], 0 offen offset:0
  buffer_load_dwordx4 v[36:39], v30, s[12:15], 0 offen offset:128
  s_waitcnt vmcnt(0)
  s_barrier
  s_cmp_lg_u32 s18, 0
  s_cbranch_scc1 .w0_215
  v_mov_b32 v120, 1
  v_mov_b32 v121, 0
  s_mov_b64 exec, 1
  buffer_atomic_add v120, v121, s[8:11], 0 offen offset:12 sc0 sc1
  s_mov_b64 exec, -1
  s_waitcnt vmcnt(0)
  v_readfirstlane_b32 s94, v120
  s_and_b32 s94, s94, 255
  s_cbranch_scc1 .hsc_219
  s_lshl_b32 s42, s16, 5
  s_add_u32 s42, s42, s17
  s_lshl_b32 s42, s42, 15
  s_add_u32 s42, s42, 119406592
  s_add_u32 s94, s42, 132608
  v_mbcnt_lo_u32_b32 v122, -1, 0
  v_mbcnt_hi_u32_b32 v122, -1, v122
  v_lshlrev_b32 v122, 4, v122
  v_mov_b32 v124, 1
  v_mov_b32 v125, 1
  v_mov_b32 v126, 1
  v_mov_b32 v127, 1
  s_mov_b32 s95, -1
  s_mov_b32 s96, -1
  s_mov_b64 exec, 0xffffffff
  s_memtime s[98:99]
  s_waitcnt lgkmcnt(0)
  s_mov_b32 s97, s98
  buffer_store_dwordx4 v[124:127], v122, s[4:7], s94 offen sc1
  s_waitcnt vmcnt(0)
  s_memtime s[98:99]
  s_waitcnt lgkmcnt(0)
  s_sub_u32 s97, s98, s97
  s_min_u32 s95, s95, s97
  s_xor_b32 s94, s94, 8192
  s_memtime s[98:99]
  s_waitcnt lgkmcnt(0)
  s_mov_b32 s97, s98
  buffer_store_dwordx4 v[124:127], v122, s[4:7], s94 offen sc1
  s_waitcnt vmcnt(0)
  s_memtime s[98:99]
  s_waitcnt lgkmcnt(0)
  s_sub_u32 s97, s98, s97
  s_min_u32 s96, s96, s97
  s_xor_b32 s94, s94, 8192
  s_memtime s[98:99]
  s_waitcnt lgkmcnt(0)
  s_mov_b32 s97, s98
  buffer_store_dwordx4 v[124:127], v122, s[4:7], s94 offen sc1
  s_waitcnt vmcnt(0)
  s_memtime s[98:99]
  s_waitcnt lgkmcnt(0)
  s_sub_u32 s97, s98, s97
  s_min_u32 s95, s95, s97
  s_xor_b32 s94, s94, 8192
  s_memtime s[98:99]
  s_waitcnt lgkmcnt(0)
  s_mov_b32 s97, s98
  buffer_store_dwordx4 v[124:127], v122, s[4:7], s94 offen sc1
  s_waitcnt vmcnt(0)
  s_memtime s[98:99]
  s_waitcnt lgkmcnt(0)
  s_sub_u32 s97, s98, s97
  s_min_u32 s96, s96, s97
  s_xor_b32 s94, s94, 8192
  s_memtime s[98:99]
  s_waitcnt lgkmcnt(0)
  s_mov_b32 s97, s98
  buffer_store_dwordx4 v[124:127], v122, s[4:7], s94 offen sc1
  s_waitcnt vmcnt(0)
  s_memtime s[98:99]
  s_waitcnt lgkmcnt(0)
  s_sub_u32 s97, s98, s97
  s_min_u32 s95, s95, s97
  s_xor_b32 s94, s94, 8192
  s_memtime s[98:99]
  s_waitcnt lgkmcnt(0)
  s_mov_b32 s97, s98
  buffer_store_dwordx4 v[124:127], v122, s[4:7], s94 offen sc1
  s_waitcnt vmcnt(0)
  s_memtime s[98:99]
  s_waitcnt lgkmcnt(0)
  s_sub_u32 s97, s98, s97
  s_min_u32 s96, s96, s97
  s_xor_b32 s94, s94, 8192
  s_mov_b64 exec, -1
  s_cmp_lt_u32 s96, s95
  s_cselect_b32 s97, 257, 1
  v_mov_b32 v120, s97
  v_mov_b32 v121, 0
  s_mov_b64 exec, 1
  buffer_atomic_add v120, v121, s[8:11], 0 offen offset:12 sc1
  s_mov_b64 exec, -1
.hsc_219:
  s_mov_b32 s96, 300
.hsl_217:
  buffer_load_dwordx4 v[124:127], v121, s[8:11], 0 offen offset:8 sc1
  s_waitcnt vmcnt(0)
  v_readfirstlane_b32 s95, v125
  v_readfirstlane_b32 s97, v127
  s_or_b32 s3, s3, s97
  s_and_b32 s94, s95, 256
  s_lshl_b32 s94, s94, 5
  s_and_b32 s97, s95, 0x1f00000
  s_or_b32 s94, s94, s97
  s_and_b32 s97, s95, 65791
  s_cmp_lg_u32 s97, 65
  s_cbranch_scc1 .hsn_218
  s_bitcmp1_b32 s3, 0
  s_cbranch_scc1 .hso_216
.hsn_218:
  s_sleep 2
  s_sub_u32 s20, s20, 1
  s_cbranch_scc0 .hsl_217
  v_mov_b32 v120, 0xdead
  v_mov_b32 v121, 0
  buffer_store_dword v120, v121, s[8:11], 0 offen offset:28 sc1
  s_mov_b32 s20, 0
  s_mov_b32 s94, 65535
  s_branch .hso_216
.hso_216:
  v_mov_b32 v120, s94
  v_mov_b32 v121, 163776
  ds_write_b32 v121, v120
  s_waitcnt lgkmcnt(0)
.w0_215:
  s_barrier
  v_mov_b32 v121, 163776
  ds_read_b32 v120, v121
  s_waitcnt lgkmcnt(0)
  v_readfirstlane_b32 s94, v120
  s_barrier
  s_lshr_b32 s38, s94, 20
  s_and_b32 s94, s94, 0xfffff
  s_and_b32 s39, s94, 8192
  s_cmp_lg_u32 s94, s39
  s_cbranch_scc1 .cspecial
  s_lshl_b32 s42, s16, 5
  s_add_u32 s42, s42, s17
  s_lshl_b32 s42, s42, 15
  s_add_u32 s42, s42, 119406592
  s_add_u32 s42, s42, s39
  s_lshl_b32 s43, s16, 21
  s_sub_u32 s43, 1048576, s43
  s_add_u32 s27, s42, 0
  s_add_u32 s25, s27, s43
  s_add_u32 s28, s42, 16384
  s_add_u32 s26, s28, s43
  s_waitcnt vmcnt(0)
  s_mov_b32 s12, 0x00ff00ff
  s_mov_b32 s13, 0x00ff00ff
  s_mov_b32 s19, 0
  s_cmp_lt_u32 s19, s38
  s_cbranch_scc1 .kvok_224
  s_cmp_lg_u32 s18, 0
  s_cbranch_scc1 .kvo_226
  v_bfe_u32 v48, v5, 4, 4
  v_lshlrev_b32 v48, 7, v48
  s_mov_b32 s42, 123731968
.kvw_223:
  buffer_load_dword v49, v48, s[4:7], s42 offen sc1
  s_waitcnt vmcnt(0)
  v_cmp_gt_u32 vcc, 32, v49
  s_or_b32 s38, vcc_lo, 65536
  s_ff1_i32_b32 s38, s38
  s_cmp_lt_u32 s19, s38
  s_cbranch_scc1 .kvg_225
  s_sleep 4
  s_sub_u32 s20, s20, 1
  s_cbranch_scc0 .kvw_223
  s_mov_b32 s38, 0
.kvg_225:
  v_mov_b32 v48, 163792
  v_mov_b32 v49, s38
  ds_write_b32 v48, v49
.kvo_226:
  s_waitcnt vmcnt(0) lgkmcnt(0)
  s_barrier
  v_mov_b32 v48, 163792
  ds_read_b32 v49, v48
  s_waitcnt lgkmcnt(0)
  v_readfirstlane_b32 s38, v49
  s_cmp_eq_u32 s38, 0
  s_cbranch_scc1 .cabort
.kvok_224:
  buffer_load_dwordx4 v[16:19], v0, s[4:7], s33 offen offset:0 sc1
  buffer_load_dwordx4 v[20:23], v0, s[4:7], s33 offen offset:1024 sc1
  buffer_load_dwordx4 v[24:27], v0, s[4:7], s34 offen offset:0 sc1
  buffer_load_dwordx4 v[28:31], v0, s[4:7], s34 offen offset:1024 sc1
  s_add_u32 s33, s33, 262144
  s_add_u32 s34, s34, 262144
  s_branch .cent_221
.ctop_220:
  ds_write_b128 v0, v[16:19] offset:16384
  ds_write_b128 v0, v[20:23] offset:17408
  v_mov_b64 v[104:105], 0
  v_mov_b64 v[106:107], 0
  v_mov_b64 v[108:109], 0
  v_mov_b64 v[110:111], 0
  v_mov_b64 v[112:113], 0
  v_mov_b64 v[114:115], 0
  v_xor_b32 v116, 512, v0
  v_xor_b32 v117, 512, v1
  v_xor_b32 v118, 512, v2
  v_xor_b32 v119, 512, v3
  s_waitcnt vmcnt(0)
  buffer_load_dwordx4 v[32:35], v0, s[4:7], s21 offen offset:0 sc1
  buffer_load_dwordx4 v[36:39], v0, s[4:7], s21 offen offset:1024 sc1
  s_waitcnt vmcnt(0)
.ml_227:
  v_max3_u32 v120, v32, v33, v34
  v_max3_u32 v121, v35, v36, v37
  v_max3_u32 v120, v120, v38, v39
  v_max_u32 v120, v120, v121
  v_cmp_eq_u32 vcc, -1, v120
  s_cbranch_vccnz .mr_228
  ds_write_b128 v0, v[32:35]
  ds_write_b128 v0, v[36:39] offset:1024
  v_smfmac_f32_16x16x64_bf16 v[104:107], v[32:35], a[0:7], v9
  ds_read_b128 v[48:51], v116
  ds_read_b128 v[52:55], v116 offset:1024
  v_smfmac_f32_16x16x64_bf16 v[104:107], v[36:39], a[16:23], v9
  v_smfmac_f32_16x16x64_bf16 v[108:111], v[32:35], a[128:135], v9
  s_waitcnt lgkmcnt(2)
  s_barrier
  ds_read_b128 v[56:59], v1 offset:0
  ds_read_b128 v[60:63], v117 offset:0
  v_smfmac_f32_16x16x64_bf16 v[108:111], v[36:39], a[144:151], v9
  ds_read_b128 v[64:67], v1 offset:1024
  ds_read_b128 v[68:71], v117 offset:1024
  s_waitcnt lgkmcnt(5)
  v_smfmac_f32_16x16x64_bf16 v[104:107], v[48:51], a[8:15], v9
  ds_read_b128 v[72:75], v2 offset:0
  ds_read_b128 v[76:79], v118 offset:0
  s_waitcnt lgkmcnt(6)
  v_smfmac_f32_16x16x64_bf16 v[104:107], v[52:55], a[24:31], v9
  ds_read_b128 v[80:83], v2 offset:1024
  ds_read_b128 v[84:87], v118 offset:1024
  v_smfmac_f32_16x16x64_bf16 v[108:111], v[48:51], a[136:143], v9
  ds_read_b128 v[88:91], v3 offset:0
  ds_read_b128 v[92:95], v119 offset:0
  v_smfmac_f32_16x16x64_bf16 v[108:111], v[52:55], a[152:159], v9
  ds_read_b128 v[96:99], v3 offset:1024
  ds_read_b128 v[100:103], v119 offset:1024
  v_smfmac_f32_16x16x64_bf16 v[112:115], v[32:35], v[128:135], v9
  v_smfmac_f32_16x16x64_bf16 v[112:115], v[36:39], v[144:151], v9
  s_waitcnt lgkmcnt(11)
  v_smfmac_f32_16x16x64_bf16 v[104:107], v[56:59], a[32:39], v9
  s_waitcnt lgkmcnt(10)
  v_smfmac_f32_16x16x64_bf16 v[104:107], v[60:63], a[40:47], v9
  s_waitcnt lgkmcnt(9)
  v_smfmac_f32_16x16x64_bf16 v[104:107], v[64:67], a[48:55], v9
  v_mov_b32 v124, 1
  v_mov_b32 v125, s19
  s_waitcnt lgkmcnt(8)
  v_smfmac_f32_16x16x64_bf16 v[104:107], v[68:71], a[56:63], v9
  s_mov_b32 exec_lo, 0x01010101
  s_mov_b32 exec_hi, 0x01010101
  buffer_store_dword v124, v0, s[4:7], s28 offen offset:0 sc1
  s_mov_b64 exec, -1
  s_waitcnt lgkmcnt(7)
  v_smfmac_f32_16x16x64_bf16 v[104:107], v[72:75], a[64:71], v9
  s_mov_b32 exec_lo, 0x01010101
  s_mov_b32 exec_hi, 0x01010101
  buffer_store_dword v124, v0, s[4:7], s28 offen offset:1024 sc1
  s_mov_b64 exec, -1
  s_waitcnt lgkmcnt(6)
  v_smfmac_f32_16x16x64_bf16 v[104:107], v[76:79], a[72:79], v9
  s_mov_b64 exec, 1
  buffer_store_dword v125, off, s[4:7], s37 sc1
  s_mov_b64 exec, -1
  s_waitcnt lgkmcnt(5)
  v_smfmac_f32_16x16x64_bf16 v[104:107], v[80:83], a[80:87], v9
  s_waitcnt lgkmcnt(4)
  v_smfmac_f32_16x16x64_bf16 v[104:107], v[84:87], a[88:95], v9
  s_waitcnt lgkmcnt(3)
  v_smfmac_f32_16x16x64_bf16 v[104:107], v[88:91], a[96:103], v9
  s_waitcnt lgkmcnt(2)
  v_smfmac_f32_16x16x64_bf16 v[104:107], v[92:95], a[104:111], v9
  s_waitcnt lgkmcnt(1)
  v_smfmac_f32_16x16x64_bf16 v[104:107], v[96:99], a[112:119], v9
  s_waitcnt lgkmcnt(0)
  v_smfmac_f32_16x16x64_bf16 v[104:107], v[100:103], a[120:127], v9
  v_smfmac_f32_16x16x64_bf16 v[108:111], v[56:59], a[160:167], v9
  v_smfmac_f32_16x16x64_bf16 v[108:111], v[60:63], a[168:175], v9
  v_cvt_pk_bf16_f32 v104, v104, v105
  v_cvt_pk_bf16_f32 v105, v106, v107
  v_and_b32 v104, -2, v104
  buffer_store_dwordx2 v[104:105], v4, s[4:7], s25 offen offset:0 sc1
  ds_write_b64 v4, v[104:105] offset:24576
  v_smfmac_f32_16x16x64_bf16 v[108:111], v[64:67], a[176:183], v9
  v_smfmac_f32_16x16x64_bf16 v[108:111], v[68:71], a[184:191], v9
  v_smfmac_f32_16x16x64_bf16 v[108:111], v[72:75], a[192:199], v9
  ds_read_b128 v[40:43], v5 offset:0
  ds_read_b128 v[44:47], v5 offset:1024
  v_smfmac_f32_16x16x64_bf16 v[108:111], v[76:79], a[200:207], v9
  ds_read_b128 v[120:123], v5 offset:2048
  ds_read_b128 v[124:127], v5 offset:3072
  v_smfmac_f32_16x16x64_bf16 v[108:111], v[80:83], a[208:215], v9
  v_smfmac_f32_16x16x64_bf16 v[108:111], v[84:87], a[216:223], v9
  v_and_b32 v116, -6145, v0
  s_lshl_b32 s43, s18, 11
  v_add_u32 v117, s43, v11
  v_smfmac_f32_16x16x64_bf16 v[108:111], v[88:91], a[224:231], v9
  s_waitcnt vmcnt(4)
  ds_read_b128 v[32:35], v5 offset:4096
  ds_read_b128 v[36:39], v5 offset:5120
  v_smfmac_f32_16x16x64_bf16 v[108:111], v[92:95], a[232:239], v9
  v_smfmac_f32_16x16x64_bf16 v[108:111], v[96:99], a[240:247], v9
  v_smfmac_f32_16x16x64_bf16 v[108:111], v[100:103], a[248:255], v9
  v_smfmac_f32_16x16x64_bf16 v[112:115], v[48:51], v[136:143], v9
  v_smfmac_f32_16x16x64_bf16 v[112:115], v[52:55], v[152:159], v9
  v_cvt_pk_bf16_f32 v108, v108, v109
  v_cvt_pk_bf16_f32 v109, v110, v111
  v_and_b32 v108, -2, v108
  buffer_store_dwordx2 v[108:109], v4, s[4:7], s25 offen offset:512 sc1
  ds_write_b64 v4, v[108:109] offset:8192
  ds_read_b128 v[48:51], v5 offset:6144
  ds_read_b128 v[52:55], v5 offset:7168
  s_waitcnt lgkmcnt(7)
  v_smfmac_f32_16x16x64_bf16 v[112:115], v[72:75], v[40:47], v9
  ds_read_b128 v[40:43], v5 offset:8192
  ds_read_b128 v[44:47], v5 offset:9216
  s_waitcnt lgkmcnt(7)
  v_smfmac_f32_16x16x64_bf16 v[112:115], v[76:79], v[120:127], v9
  ds_read_b128 v[120:123], v5 offset:10240
  ds_read_b128 v[124:127], v5 offset:11264
  s_waitcnt lgkmcnt(7)
  v_smfmac_f32_16x16x64_bf16 v[112:115], v[80:83], v[32:39], v9
  ds_read_b128 v[32:35], v5 offset:12288
  ds_read_b128 v[36:39], v5 offset:13312
  v_smfmac_f32_16x16x64_bf16 v[112:115], v[56:59], v[160:167], v9
  v_smfmac_f32_16x16x64_bf16 v[112:115], v[60:63], v[168:175], v9
  buffer_load_dwordx2 v[104:105], v4, s[4:7], s27 offen offset:0 sc1
  s_waitcnt lgkmcnt(6)
  v_smfmac_f32_16x16x64_bf16 v[112:115], v[84:87], v[48:55], v9
  ds_read_b128 v[48:51], v5 offset:14336
  ds_read_b128 v[52:55], v5 offset:15360
  v_smfmac_f32_16x16x64_bf16 v[112:115], v[64:67], v[176:183], v9
  v_smfmac_f32_16x16x64_bf16 v[112:115], v[68:71], v[184:191], v9
  s_waitcnt lgkmcnt(6)
  v_smfmac_f32_16x16x64_bf16 v[112:115], v[88:91], v[40:47], v9
  ds_read_b128 v[56:59], v116 offset:16384
  ds_read_b128 v[60:63], v116 offset:17408
  s_waitcnt lgkmcnt(6)
  v_smfmac_f32_16x16x64_bf16 v[112:115], v[92:95], v[120:127], v9
  ds_read_b128 v[64:67], v116 offset:18432
  ds_read_b128 v[68:71], v116 offset:19456
  s_waitcnt lgkmcnt(6)
  v_smfmac_f32_16x16x64_bf16 v[112:115], v[96:99], v[32:39], v9
  ds_read_b128 v[72:75], v116 offset:20480
  ds_read_b128 v[76:79], v116 offset:21504
  s_waitcnt lgkmcnt(6)
  v_smfmac_f32_16x16x64_bf16 v[112:115], v[100:103], v[48:55], v9
  ds_read_b128 v[80:83], v116 offset:22528
  ds_read_b128 v[84:87], v116 offset:23552
  ds_read_b64_tr_b16 v[120:121], v117 offset:0
  ds_read_b64_tr_b16 v[122:123], v117 offset:32
  s_barrier
  s_waitcnt vmcnt(4)
  s_nop 1
  v_cvt_pk_bf16_f32 v112, v112, v113
  v_cvt_pk_bf16_f32 v113, v114, v115
  v_and_b32 v112, -2, v112
  buffer_store_dwordx2 v[112:113], v4, s[4:7], s25 offen offset:1024 sc1
  ds_read_b64_tr_b16 v[32:33], v11 offset:0
  ds_read_b64_tr_b16 v[34:35], v11 offset:32
  ds_read_b64_tr_b16 v[36:37], v11 offset:2048
  ds_read_b64_tr_b16 v[38:39], v11 offset:2080
  ds_read_b64_tr_b16 v[40:41], v11 offset:4096
  ds_read_b64_tr_b16 v[42:43], v11 offset:4128
  ds_read_b64_tr_b16 v[44:45], v11 offset:6144
  ds_read_b64_tr_b16 v[46:47], v11 offset:6176
  v_mov_b64 v[48:49], v[24:25]
  v_mov_b64 v[50:51], v[26:27]
  v_mov_b64 v[52:53], v[28:29]
  v_mov_b64 v[54:55], v[30:31]
  s_waitcnt vmcnt(2)
  buffer_load_dwordx2 v[20:21], v4, s[4:7], s27 offen offset:512 sc1
  s_waitcnt vmcnt(2)
  v_and_b32 v114, 1, v104
  v_cmp_ne_u32 vcc, 0, v114
  s_cbranch_vccnz .kx_229
.kok_230:
  ds_write_b64 v4, v[104:105] offset:25120
  s_waitcnt lgkmcnt(0)
  s_barrier
  ds_read_b64_tr_b16 v[88:89], v10 offset:0
  ds_read_b64_tr_b16 v[90:91], v10 offset:32
  ds_read_b64_tr_b16 v[92:93], v10 offset:2048
  ds_read_b64_tr_b16 v[94:95], v10 offset:2080
  ds_read_b64_tr_b16 v[96:97], v10 offset:4096
  ds_read_b64_tr_b16 v[98:99], v10 offset:4128
  ds_read_b64_tr_b16 v[100:101], v10 offset:6144
  ds_read_b64_tr_b16 v[102:103], v10 offset:6176
  s_waitcnt lgkmcnt(6)
  v_mfma_f32_16x16x32_bf16 v[124:127], v[32:35], v[88:91], 0
  s_waitcnt lgkmcnt(4)
  v_mfma_f32_16x16x32_bf16 v[124:127], v[36:39], v[92:95], v[124:127]
  s_waitcnt lgkmcnt(2)
  v_mfma_f32_16x16x32_bf16 v[124:127], v[40:43], v[96:99], v[124:127]
  s_waitcnt lgkmcnt(0)
  v_mfma_f32_16x16x32_bf16 v[124:127], v[44:47], v[100:103], v[124:127]
  buffer_load_dwordx2 v[118:119], v4, s[4:7], s27 offen offset:1024 sc1
  s_waitcnt vmcnt(1)
  v_and_b32 v114, 1, v20
  v_cmp_ne_u32 vcc, 0, v114
  s_cbranch_vccnz .kx_231
.kok_232:
  ds_write_b64 v4, v[20:21] offset:8704
  v_mfma_f32_16x16x32_bf16 v[104:107], v[56:59], v[88:91], 0
  buffer_store_dwordx2 v[112:113], v4, s[4:7], s36 offen offset:1024 sc1
  v_mfma_f32_16x16x32_bf16 v[108:111], v[60:63], v[88:91], 0
  s_mov_b64 exec, s[12:13]
  buffer_store_dwordx4 v[120:123], v0, s[4:7], s36 offen sc1
  s_mov_b64 exec, -1
  v_mfma_f32_16x16x32_bf16 v[104:107], v[64:67], v[92:95], v[104:107]
  v_mfma_f32_16x16x32_bf16 v[108:111], v[68:71], v[92:95], v[108:111]
  s_waitcnt lgkmcnt(0)
  s_barrier
  ds_read_b64_tr_b16 v[32:33], v11 offset:512
  ds_read_b64_tr_b16 v[34:35], v11 offset:544
  ds_read_b64_tr_b16 v[36:37], v11 offset:2560
  ds_read_b64_tr_b16 v[38:39], v11 offset:2592
  ds_read_b64_tr_b16 v[40:41], v11 offset:4608
  ds_read_b64_tr_b16 v[42:43], v11 offset:4640
  ds_read_b64_tr_b16 v[44:45], v11 offset:6656
  ds_read_b64_tr_b16 v[46:47], v11 offset:6688
  v_mfma_f32_16x16x32_bf16 v[104:107], v[72:75], v[96:99], v[104:107]
  buffer_load_dwordx4 v[16:19], v0, s[4:7], s33 offen offset:0 sc1
  v_mfma_f32_16x16x32_bf16 v[108:111], v[76:79], v[96:99], v[108:111]
  buffer_load_dwordx4 v[20:23], v0, s[4:7], s33 offen offset:1024 sc1
  v_mfma_f32_16x16x32_bf16 v[104:107], v[80:83], v[100:103], v[104:107]
  buffer_load_dwordx4 v[24:27], v0, s[4:7], s34 offen offset:0 sc1
  v_mfma_f32_16x16x32_bf16 v[108:111], v[84:87], v[100:103], v[108:111]
  buffer_load_dwordx4 v[28:31], v0, s[4:7], s34 offen offset:1024 sc1
  s_add_u32 s33, s33, 262144
  s_add_u32 s34, s34, 262144
  s_add_u32 s36, s36, 262144
  ds_read_b128 v[56:59], v5 offset:16384
  ds_read_b128 v[60:63], v5 offset:17408
  s_waitcnt lgkmcnt(8)
  v_mfma_f32_16x16x32_bf16 v[124:127], v[32:35], v[88:91], v[124:127]
  v_add_f32_dpp v104, v104, v104 row_ror:8 row_mask:0xf bank_mask:0xf
  v_add_f32_dpp v105, v105, v105 row_ror:8 row_mask:0xf bank_mask:0xf
  v_add_f32_dpp v106, v106, v106 row_ror:8 row_mask:0xf bank_mask:0xf
  s_waitcnt lgkmcnt(6)
  v_mfma_f32_16x16x32_bf16 v[124:127], v[36:39], v[92:95], v[124:127]
  v_add_f32_dpp v107, v107, v107 row_ror:8 row_mask:0xf bank_mask:0xf
  v_add_f32_dpp v108, v108, v108 row_ror:8 row_mask:0xf bank_mask:0xf
  v_add_f32_dpp v109, v109, v109 row_ror:8 row_mask:0xf bank_mask:0xf
  s_waitcnt lgkmcnt(4)
  v_mfma_f32_16x16x32_bf16 v[124:127], v[40:43], v[96:99], v[124:127]
  v_add_f32_dpp v110, v110, v110 row_ror:8 row_mask:0xf bank_mask:0xf
  v_add_f32_dpp v111, v111, v111 row_ror:8 row_mask:0xf bank_mask:0xf
  v_max3_f32 v120, v104, v105, v106
  s_waitcnt lgkmcnt(2)
  v_mfma_f32_16x16x32_bf16 v[124:127], v[44:47], v[100:103], v[124:127]
  v_max3_f32 v120, v120, v107, v108
  v_max3_f32 v121, v109, v110, v111
  v_max_f32 v120, v120, v121
  v_mov_b32 v121, v120
  ds_read_b128 v[64:67], v5 offset:18432
  ds_read_b128 v[68:71], v5 offset:19456
  v_permlane32_swap_b32 v120, v121
  v_max_f32 v120, v120, v121
  v_add_f32_dpp v124, v124, v124 row_ror:8 row_mask:0xf bank_mask:0xf
  v_add_f32_dpp v125, v125, v125 row_ror:8 row_mask:0xf bank_mask:0xf
  v_add_f32_dpp v126, v126, v126 row_ror:8 row_mask:0xf bank_mask:0xf
  v_add_f32_dpp v127, v127, v127 row_ror:8 row_mask:0xf bank_mask:0xf
  v_max3_f32 v120, v120, v124, v125
  v_max3_f32 v120, v120, v126, v127
  v_mov_b32 v121, v120
  ds_read_b128 v[72:75], v5 offset:20480
  ds_read_b128 v[76:79], v5 offset:21504
  v_permlane16_swap_b32 v120, v121
  v_max_f32 v120, v120, v121
  v_mul_f32 v120, s40, v120
  v_pk_fma_f32 v[104:105], v[104:105], s[40:41], v[120:121] op_sel_hi:[1,1,0] neg_lo:[0,0,1] neg_hi:[0,0,1]
  v_pk_fma_f32 v[106:107], v[106:107], s[40:41], v[120:121] op_sel_hi:[1,1,0] neg_lo:[0,0,1] neg_hi:[0,0,1]
  v_pk_fma_f32 v[108:109], v[108:109], s[40:41], v[120:121] op_sel_hi:[1,1,0] neg_lo:[0,0,1] neg_hi:[0,0,1]
  v_pk_fma_f32 v[110:111], v[110:111], s[40:41], v[120:121] op_sel_hi:[1,1,0] neg_lo:[0,0,1] neg_hi:[0,0,1]
  v_exp_f32 v104, v104
  ds_read_b128 v[80:83], v5 offset:22528
  v_exp_f32 v105, v105
  ds_read_b128 v[84:87], v5 offset:23552
  v_exp_f32 v106, v106
  v_cvt_pk_bf16_f32 v32, v104, v105
  v_exp_f32 v107, v107
  ds_read_b128 v[40:43], v5 offset:24576
  v_exp_f32 v108, v108
  v_cvt_pk_bf16_f32 v33, v106, v107
  v_exp_f32 v109, v109
  ds_read_b128 v[44:47], v5 offset:25600
  v_exp_f32 v110, v110
  v_cvt_pk_bf16_f32 v34, v108, v109
  v_exp_f32 v111, v111
  ds_read_b128 v[88:91], v5 offset:26624
  ds_read_b128 v[92:95], v5 offset:27648
  v_pk_fma_f32 v[124:125], v[124:125], s[40:41], v[120:121] op_sel_hi:[1,1,0] neg_lo:[0,0,1] neg_hi:[0,0,1]
  v_cvt_pk_bf16_f32 v35, v110, v111
  v_pk_fma_f32 v[126:127], v[126:127], s[40:41], v[120:121] op_sel_hi:[1,1,0] neg_lo:[0,0,1] neg_hi:[0,0,1]
  v_exp_f32 v124, v124
  v_mfma_f32_16x16x32_bf16 v[96:99], v[48:51], v[32:35], 0
  v_exp_f32 v125, v125
  v_exp_f32 v126, v126
  v_mfma_f32_16x16x32_bf16 v[100:103], v[52:55], v[32:35], 0
  v_exp_f32 v127, v127
  v_cvt_pk_bf16_f32 v36, v124, v125
  v_mfma_f32_16x16x16_bf16 v[48:51], v[12:13], v[32:33], 0
  v_cvt_pk_bf16_f32 v37, v126, v127
  s_waitcnt vmcnt(6)
  v_and_b32 v121, 1, v118
  v_mfma_f32_16x16x16_bf16 v[48:51], v[12:13], v[34:35], v[48:51]
  v_cmp_ne_u32 vcc, 0, v121
  s_cbranch_vccnz .vs_233
.vc_234:
  v_permlane32_swap_b32 v112, v118
  v_permlane32_swap_b32 v113, v119
  v_mfma_f32_16x16x16_bf16 v[48:51], v[14:15], v[36:37], v[48:51]
  v_mov_b64 v[104:105], 0
  v_mfma_f32_16x16x16_bf16 v[96:99], v[112:113], v[36:37], v[96:99]
  v_mov_b64 v[106:107], 0
  v_mfma_f32_16x16x16_bf16 v[100:103], v[118:119], v[36:37], v[100:103]
  v_mov_b64 v[108:109], 0
  v_mov_b64 v[110:111], 0
  v_mov_b64 v[120:121], 0
  v_mov_b64 v[122:123], 0
  v_mov_b64 v[124:125], 0
  v_rcp_f32 v48, v48
  v_mov_b64 v[126:127], 0
  v_pk_mul_f32 v[96:97], v[96:97], v[48:49] op_sel_hi:[1,0]
  v_pk_mul_f32 v[98:99], v[98:99], v[48:49] op_sel_hi:[1,0]
  v_pk_mul_f32 v[100:101], v[100:101], v[48:49] op_sel_hi:[1,0]
  v_pk_mul_f32 v[102:103], v[102:103], v[48:49] op_sel_hi:[1,0]
  v_cvt_pk_bf16_f32 v52, v96, v97
  v_cvt_pk_bf16_f32 v53, v98, v99
  v_cvt_pk_bf16_f32 v54, v100, v101
  v_cvt_pk_bf16_f32 v55, v102, v103
  ds_write_b128 v0, v[52:55] offset:9216
  s_waitcnt lgkmcnt(11)
  v_smfmac_f32_16x16x64_bf16 v[104:107], v[52:55], v[56:63], v9
  s_waitcnt lgkmcnt(9)
  v_smfmac_f32_16x16x64_bf16 v[108:111], v[52:55], v[64:71], v9
  s_waitcnt lgkmcnt(7)
  v_smfmac_f32_16x16x64_bf16 v[120:123], v[52:55], v[72:79], v9
  s_waitcnt lgkmcnt(0)
  s_barrier
  ds_read_b128 v[96:99], v1 offset:9216
  v_smfmac_f32_16x16x64_bf16 v[124:127], v[52:55], v[80:87], v9
  ds_read_b128 v[100:103], v2 offset:9216
  ds_read_b128 v[32:35], v3 offset:9216
  ds_read_b128 v[56:59], v5 offset:28672
  ds_read_b128 v[60:63], v5 offset:29696
  ds_read_b128 v[64:67], v5 offset:30720
  ds_read_b128 v[68:71], v5 offset:31744
  s_waitcnt lgkmcnt(6)
  v_smfmac_f32_16x16x64_bf16 v[104:107], v[96:99], v[192:199], v9
  v_smfmac_f32_16x16x64_bf16 v[108:111], v[96:99], v[200:207], v9
  s_waitcnt lgkmcnt(5)
  v_smfmac_f32_16x16x64_bf16 v[104:107], v[100:103], v[224:231], v9
  v_smfmac_f32_16x16x64_bf16 v[108:111], v[100:103], v[232:239], v9
  s_waitcnt lgkmcnt(4)
  v_smfmac_f32_16x16x64_bf16 v[104:107], v[32:35], v[40:47], v9
  v_smfmac_f32_16x16x64_bf16 v[108:111], v[32:35], v[88:95], v9
  v_smfmac_f32_16x16x64_bf16 v[120:123], v[96:99], v[208:215], v9
  v_smfmac_f32_16x16x64_bf16 v[124:127], v[96:99], v[216:223], v9
  v_cvt_pk_bf16_f32 v104, v104, v105
  v_cvt_pk_bf16_f32 v105, v106, v107
  v_smfmac_f32_16x16x64_bf16 v[120:123], v[100:103], v[240:247], v9
  v_cvt_pk_bf16_f32 v106, v108, v109
  v_cvt_pk_bf16_f32 v107, v110, v111
  v_smfmac_f32_16x16x64_bf16 v[124:127], v[100:103], v[248:255], v9
  v_permlane16_swap_b32 v104, v106
  v_permlane16_swap_b32 v105, v107
  s_waitcnt lgkmcnt(2)
  v_smfmac_f32_16x16x64_bf16 v[120:123], v[32:35], v[56:63], v9
  v_and_b32 v104, -2, v104
  buffer_store_dwordx4 v[104:107], v6, s[4:7], s29 offen sc1
  s_waitcnt lgkmcnt(0)
  v_smfmac_f32_16x16x64_bf16 v[124:127], v[32:35], v[64:71], v9
  s_nop 3
  v_cvt_pk_bf16_f32 v120, v120, v121
  v_cvt_pk_bf16_f32 v121, v122, v123
  s_nop 1
  v_cvt_pk_bf16_f32 v122, v124, v125
  v_cvt_pk_bf16_f32 v123, v126, v127
  s_nop 0
  v_permlane16_swap_b32 v120, v122
  v_permlane16_swap_b32 v121, v123
  v_and_b32 v120, -2, v120
  buffer_store_dwordx4 v[120:123], v6, s[4:7], s30 offen sc1
  v_and_b32 v52, 16, v5
  v_mov_b32 v53, 0x3f80
  v_lshlrev_b32 v52, v52, v53
  s_mov_b32 vcc_lo, 0x30003
  s_mov_b32 vcc_hi, 0x30003
  v_cndmask_b32 v48, 0, v52, vcc
  s_mov_b32 vcc_lo, 0x300030
  s_mov_b32 vcc_hi, 0x300030
  v_cndmask_b32 v49, 0, v52, vcc
  s_mov_b32 vcc_lo, 0x3000300
  s_mov_b32 vcc_hi, 0x3000300
  v_cndmask_b32 v50, 0, v52, vcc
  s_mov_b32 vcc_lo, 0x30003000
  s_mov_b32 vcc_hi, 0x30003000
  v_cndmask_b32 v51, 0, v52, vcc
  v_mov_b32 v52, -1
  s_waitcnt vmcnt(0)
  buffer_load_dwordx4 v[64:67], v7, s[4:7], s31 offen offset:0 sc1
  buffer_load_dwordx4 v[68:71], v7, s[4:7], s32 offen offset:0 sc1
  s_waitcnt vmcnt(0)
.pl_236:
  v_bitop3_b32 v60, v64, v68, 1 bitop3:0xa8
  v_cmp_ne_u32 vcc, 0, v60
  s_cbranch_vccnz .pr_237
  v_mfma_f32_16x16x32_bf16 v[56:59], v[48:51], v[64:67], 0
  v_mfma_f32_16x16x32_bf16 v[56:59], v[48:51], v[68:71], v[56:59]
  s_nop 7
  v_add_f32_dpp v60, v56, v56 row_ror:8 row_mask:0xf bank_mask:0x3
  v_add_f32_dpp v60, v57, v57 row_ror:8 row_mask:0xf bank_mask:0xc
  s_nop 1
  v_add_f32_dpp v60, v60, v60 row_shl:4 row_mask:0xf bank_mask:0xf
  s_nop 1
  v_mov_b32_dpp v61, v60 quad_perm:[1,1,3,3] row_mask:0xf bank_mask:0xf
  v_cvt_pk_bf16_f32 v62, v60, v61
  v_min_u32 v62, -2, v62
  buffer_store_dword v62, v8, s[4:7], s24 offen offset:0 sc1
  buffer_store_dword v52, v8, s[4:7], s23 offen offset:0 sc1
  s_add_u32 s19, s19, 1
  ds_write_b128 v0, v[16:19] offset:16384
  ds_write_b128 v0, v[20:23] offset:17408
  v_mov_b64 v[104:105], 0
  v_mov_b64 v[106:107], 0
  v_mov_b64 v[108:109], 0
  v_mov_b64 v[110:111], 0
  v_mov_b64 v[112:113], 0
  v_mov_b64 v[114:115], 0
  v_xor_b32 v116, 512, v0
  v_xor_b32 v117, 512, v1
  v_xor_b32 v118, 512, v2
  v_xor_b32 v119, 512, v3
  s_waitcnt vmcnt(0)
  buffer_load_dwordx4 v[32:35], v0, s[4:7], s22 offen offset:0 sc1
  buffer_load_dwordx4 v[36:39], v0, s[4:7], s22 offen offset:1024 sc1
  s_waitcnt vmcnt(0)
.ml_238:
  v_max3_u32 v120, v32, v33, v34
  v_max3_u32 v121, v35, v36, v37
  v_max3_u32 v120, v120, v38, v39
  v_max_u32 v120, v120, v121
  v_cmp_eq_u32 vcc, -1, v120
  s_cbranch_vccnz .mr_239
  ds_write_b128 v0, v[32:35]
  ds_write_b128 v0, v[36:39] offset:1024
  v_smfmac_f32_16x16x64_bf16 v[104:107], v[32:35], a[0:7], v9
  ds_read_b128 v[48:51], v116
  ds_read_b128 v[52:55], v116 offset:1024
  v_smfmac_f32_16x16x64_bf16 v[104:107], v[36:39], a[16:23], v9
  v_smfmac_f32_16x16x64_bf16 v[108:111], v[32:35], a[128:135], v9
  s_waitcnt lgkmcnt(2)
  s_barrier
  ds_read_b128 v[56:59], v1 offset:0
  ds_read_b128 v[60:63], v117 offset:0
  v_smfmac_f32_16x16x64_bf16 v[108:111], v[36:39], a[144:151], v9
  ds_read_b128 v[64:67], v1 offset:1024
  ds_read_b128 v[68:71], v117 offset:1024
  s_waitcnt lgkmcnt(5)
  v_smfmac_f32_16x16x64_bf16 v[104:107], v[48:51], a[8:15], v9
  ds_read_b128 v[72:75], v2 offset:0
  ds_read_b128 v[76:79], v118 offset:0
  s_waitcnt lgkmcnt(6)
  v_smfmac_f32_16x16x64_bf16 v[104:107], v[52:55], a[24:31], v9
  ds_read_b128 v[80:83], v2 offset:1024
  ds_read_b128 v[84:87], v118 offset:1024
  v_smfmac_f32_16x16x64_bf16 v[108:111], v[48:51], a[136:143], v9
  ds_read_b128 v[88:91], v3 offset:0
  ds_read_b128 v[92:95], v119 offset:0
  v_smfmac_f32_16x16x64_bf16 v[108:111], v[52:55], a[152:159], v9
  ds_read_b128 v[96:99], v3 offset:1024
  ds_read_b128 v[100:103], v119 offset:1024
  v_smfmac_f32_16x16x64_bf16 v[112:115], v[32:35], v[128:135], v9
  v_smfmac_f32_16x16x64_bf16 v[112:115], v[36:39], v[144:151], v9
  s_waitcnt lgkmcnt(11)
  v_smfmac_f32_16x16x64_bf16 v[104:107], v[56:59], a[32:39], v9
  s_waitcnt lgkmcnt(10)
  v_smfmac_f32_16x16x64_bf16 v[104:107], v[60:63], a[40:47], v9
  s_waitcnt lgkmcnt(9)
  v_smfmac_f32_16x16x64_bf16 v[104:107], v[64:67], a[48:55], v9
  v_mov_b64 v[124:125], -1
  s_lshr_b32 s42, s19, 2
  s_mul_i32 s43, s42, -786432
  s_add_u32 s43, s43, s36
  s_add_u32 s43, s43, 14417920
  s_cmp_lt_u32 s42, 8
  s_cselect_b64 exec, -1, 0
  s_cselect_b32 s43, s43, s36
  buffer_store_dwordx2 v[124:125], v4, s[4:7], s43 offen offset:0 sc1
  buffer_store_dwordx2 v[124:125], v4, s[4:7], s43 offen offset:1024 sc1
  s_mov_b64 exec, -1
  s_waitcnt lgkmcnt(8)
  v_smfmac_f32_16x16x64_bf16 v[104:107], v[68:71], a[56:63], v9
  v_mov_b32 v124, 0
  v_mov_b32 v125, s19
  s_waitcnt lgkmcnt(7)
  v_smfmac_f32_16x16x64_bf16 v[104:107], v[72:75], a[64:71], v9
  s_mov_b32 exec_lo, 0x01010101
  s_mov_b32 exec_hi, 0x01010101
  buffer_store_dword v124, v0, s[4:7], s27 offen offset:0 sc1
  s_mov_b64 exec, -1
  s_waitcnt lgkmcnt(6)
  v_smfmac_f32_16x16x64_bf16 v[104:107], v[76:79], a[72:79], v9
  s_mov_b32 exec_lo, 0x01010101
  s_mov_b32 exec_hi, 0x01010101
  buffer_store_dword v124, v0, s[4:7], s27 offen offset:1024 sc1
  s_mov_b64 exec, -1
  s_waitcnt lgkmcnt(5)
  v_smfmac_f32_16x16x64_bf16 v[104:107], v[80:83], a[80:87], v9
  s_mov_b64 exec, 1
  buffer_store_dword v125, off, s[4:7], s37 sc1
  s_mov_b64 exec, -1
  s_waitcnt lgkmcnt(4)
  v_smfmac_f32_16x16x64_bf16 v[104:107], v[84:87], a[88:95], v9
  s_waitcnt lgkmcnt(3)
  v_smfmac_f32_16x16x64_bf16 v[104:107], v[88:91], a[96:103], v9
  s_waitcnt lgkmcnt(2)
  v_smfmac_f32_16x16x64_bf16 v[104:107], v[92:95], a[104:111], v9
  s_waitcnt lgkmcnt(1)
  v_smfmac_f32_16x16x64_bf16 v[104:107], v[96:99], a[112:119], v9
  s_waitcnt lgkmcnt(0)
  v_smfmac_f32_16x16x64_bf16 v[104:107], v[100:103], a[120:127], v9
  v_smfmac_f32_16x16x64_bf16 v[108:111], v[56:59], a[160:167], v9
  v_smfmac_f32_16x16x64_bf16 v[108:111], v[60:63], a[168:175], v9
  v_cvt_pk_bf16_f32 v104, v104, v105
  v_cvt_pk_bf16_f32 v105, v106, v107
  v_and_b32 v104, -2, v104
  buffer_store_dwordx2 v[104:105], v4, s[4:7], s26 offen offset:0 sc1
  ds_write_b64 v4, v[104:105] offset:24576
  v_smfmac_f32_16x16x64_bf16 v[108:111], v[64:67], a[176:183], v9
  v_smfmac_f32_16x16x64_bf16 v[108:111], v[68:71], a[184:191], v9
  v_smfmac_f32_16x16x64_bf16 v[108:111], v[72:75], a[192:199], v9
  ds_read_b128 v[40:43], v5 offset:0
  ds_read_b128 v[44:47], v5 offset:1024
  v_smfmac_f32_16x16x64_bf16 v[108:111], v[76:79], a[200:207], v9
  ds_read_b128 v[120:123], v5 offset:2048
  ds_read_b128 v[124:127], v5 offset:3072
  v_smfmac_f32_16x16x64_bf16 v[108:111], v[80:83], a[208:215], v9
  v_smfmac_f32_16x16x64_bf16 v[108:111], v[84:87], a[216:223], v9
  v_and_b32 v116, -6145, v0
  s_lshl_b32 s43, s18, 11
  v_add_u32 v117, s43, v11
  v_smfmac_f32_16x16x64_bf16 v[108:111], v[88:91], a[224:231], v9
  s_waitcnt vmcnt(6)
  ds_read_b128 v[32:35], v5 offset:4096
  ds_read_b128 v[36:39], v5 offset:5120
  v_smfmac_f32_16x16x64_bf16 v[108:111], v[92:95], a[232:239], v9
  v_smfmac_f32_16x16x64_bf16 v[108:111], v[96:99], a[240:247], v9
  v_smfmac_f32_16x16x64_bf16 v[108:111], v[100:103], a[248:255], v9
  v_smfmac_f32_16x16x64_bf16 v[112:115], v[48:51], v[136:143], v9
  v_smfmac_f32_16x16x64_bf16 v[112:115], v[52:55], v[152:159], v9
  v_cvt_pk_bf16_f32 v108, v108, v109
  v_cvt_pk_bf16_f32 v109, v110, v111
  v_and_b32 v108, -2, v108
  buffer_store_dwordx2 v[108:109], v4, s[4:7], s26 offen offset:512 sc1
  ds_write_b64 v4, v[108:109] offset:8192
  ds_read_b128 v[48:51], v5 offset:6144
  ds_read_b128 v[52:55], v5 offset:7168
  s_waitcnt lgkmcnt(7)
  v_smfmac_f32_16x16x64_bf16 v[112:115], v[72:75], v[40:47], v9
  ds_read_b128 v[40:43], v5 offset:8192
  ds_read_b128 v[44:47], v5 offset:9216
  s_waitcnt lgkmcnt(7)
  v_smfmac_f32_16x16x64_bf16 v[112:115], v[76:79], v[120:127], v9
  ds_read_b128 v[120:123], v5 offset:10240
  ds_read_b128 v[124:127], v5 offset:11264
  s_waitcnt lgkmcnt(7)
  v_smfmac_f32_16x16x64_bf16 v[112:115], v[80:83], v[32:39], v9
  ds_read_b128 v[32:35], v5 offset:12288
  ds_read_b128 v[36:39], v5 offset:13312
  v_smfmac_f32_16x16x64_bf16 v[112:115], v[56:59], v[160:167], v9
  v_smfmac_f32_16x16x64_bf16 v[112:115], v[60:63], v[168:175], v9
  buffer_load_dwordx2 v[104:105], v4, s[4:7], s28 offen offset:0 sc1
  s_waitcnt lgkmcnt(6)
  v_smfmac_f32_16x16x64_bf16 v[112:115], v[84:87], v[48:55], v9
  ds_read_b128 v[48:51], v5 offset:14336
  ds_read_b128 v[52:55], v5 offset:15360
  v_smfmac_f32_16x16x64_bf16 v[112:115], v[64:67], v[176:183], v9
  v_smfmac_f32_16x16x64_bf16 v[112:115], v[68:71], v[184:191], v9
  s_waitcnt lgkmcnt(6)
  v_smfmac_f32_16x16x64_bf16 v[112:115], v[88:91], v[40:47], v9
  ds_read_b128 v[56:59], v116 offset:16384
  ds_read_b128 v[60:63], v116 offset:17408
  s_waitcnt lgkmcnt(6)
  v_smfmac_f32_16x16x64_bf16 v[112:115], v[92:95], v[120:127], v9
  ds_read_b128 v[64:67], v116 offset:18432
  ds_read_b128 v[68:71], v116 offset:19456
  s_waitcnt lgkmcnt(6)
  v_smfmac_f32_16x16x64_bf16 v[112:115], v[96:99], v[32:39], v9
  ds_read_b128 v[72:75], v116 offset:20480
  ds_read_b128 v[76:79], v116 offset:21504
  s_waitcnt lgkmcnt(6)
  v_smfmac_f32_16x16x64_bf16 v[112:115], v[100:103], v[48:55], v9
  ds_read_b128 v[80:83], v116 offset:22528
  ds_read_b128 v[84:87], v116 offset:23552
  ds_read_b64_tr_b16 v[120:121], v117 offset:0
  ds_read_b64_tr_b16 v[122:123], v117 offset:32
  s_barrier
  s_waitcnt vmcnt(4)
  s_nop 1
  v_cvt_pk_bf16_f32 v112, v112, v113
  v_cvt_pk_bf16_f32 v113, v114, v115
  v_and_b32 v112, -2, v112
  buffer_store_dwordx2 v[112:113], v4, s[4:7], s26 offen offset:1024 sc1
  ds_read_b64_tr_b16 v[32:33], v11 offset:0
  ds_read_b64_tr_b16 v[34:35], v11 offset:32
  ds_read_b64_tr_b16 v[36:37], v11 offset:2048
  ds_read_b64_tr_b16 v[38:39], v11 offset:2080
  ds_read_b64_tr_b16 v[40:41], v11 offset:4096
  ds_read_b64_tr_b16 v[42:43], v11 offset:4128
  ds_read_b64_tr_b16 v[44:45], v11 offset:6144
  ds_read_b64_tr_b16 v[46:47], v11 offset:6176
  v_mov_b64 v[48:49], v[24:25]
  v_mov_b64 v[50:51], v[26:27]
  v_mov_b64 v[52:53], v[28:29]
  v_mov_b64 v[54:55], v[30:31]
  s_waitcnt vmcnt(2)
  buffer_load_dwordx2 v[20:21], v4, s[4:7], s28 offen offset:512 sc1
  s_waitcnt vmcnt(2)
  v_and_b32 v114, 1, v104
  v_cmp_ne_u32 vcc, 0, v114
  s_cbranch_vccnz .kx_240
.kok_241:
  ds_write_b64 v4, v[104:105] offset:25120
  s_waitcnt lgkmcnt(0)
  s_barrier
  ds_read_b64_tr_b16 v[88:89], v10 offset:0
  ds_read_b64_tr_b16 v[90:91], v10 offset:32
  ds_read_b64_tr_b16 v[92:93], v10 offset:2048
  ds_read_b64_tr_b16 v[94:95], v10 offset:2080
  ds_read_b64_tr_b16 v[96:97], v10 offset:4096
  ds_read_b64_tr_b16 v[98:99], v10 offset:4128
  ds_read_b64_tr_b16 v[100:101], v10 offset:6144
  ds_read_b64_tr_b16 v[102:103], v10 offset:6176
  s_waitcnt lgkmcnt(6)
  v_mfma_f32_16x16x32_bf16 v[124:127], v[32:35], v[88:91], 0
  s_waitcnt lgkmcnt(4)
  v_mfma_f32_16x16x32_bf16 v[124:127], v[36:39], v[92:95], v[124:127]
  s_waitcnt lgkmcnt(2)
  v_mfma_f32_16x16x32_bf16 v[124:127], v[40:43], v[96:99], v[124:127]
  s_waitcnt lgkmcnt(0)
  v_mfma_f32_16x16x32_bf16 v[124:127], v[44:47], v[100:103], v[124:127]
  buffer_load_dwordx2 v[118:119], v4, s[4:7], s28 offen offset:1024 sc1
  s_waitcnt vmcnt(1)
  v_and_b32 v114, 1, v20
  v_cmp_ne_u32 vcc, 0, v114
  s_cbranch_vccnz .kx_242
.kok_243:
  ds_write_b64 v4, v[20:21] offset:8704
  v_mfma_f32_16x16x32_bf16 v[104:107], v[56:59], v[88:91], 0
  buffer_store_dwordx2 v[112:113], v4, s[4:7], s36 offen offset:1024 sc1
  v_mfma_f32_16x16x32_bf16 v[108:111], v[60:63], v[88:91], 0
  s_mov_b64 exec, s[12:13]
  buffer_store_dwordx4 v[120:123], v0, s[4:7], s36 offen sc1
  s_mov_b64 exec, -1
  v_mfma_f32_16x16x32_bf16 v[104:107], v[64:67], v[92:95], v[104:107]
  v_mfma_f32_16x16x32_bf16 v[108:111], v[68:71], v[92:95], v[108:111]
  s_waitcnt lgkmcnt(0)
  s_barrier
  ds_read_b64_tr_b16 v[32:33], v11 offset:512
  ds_read_b64_tr_b16 v[34:35], v11 offset:544
  ds_read_b64_tr_b16 v[36:37], v11 offset:2560
  ds_read_b64_tr_b16 v[38:39], v11 offset:2592
  ds_read_b64_tr_b16 v[40:41], v11 offset:4608
  ds_read_b64_tr_b16 v[42:43], v11 offset:4640
  ds_read_b64_tr_b16 v[44:45], v11 offset:6656
  ds_read_b64_tr_b16 v[46:47], v11 offset:6688
  v_mfma_f32_16x16x32_bf16 v[104:107], v[72:75], v[96:99], v[104:107]
  buffer_load_dwordx4 v[16:19], v0, s[4:7], s33 offen offset:0 sc1
  v_mfma_f32_16x16x32_bf16 v[108:111], v[76:79], v[96:99], v[108:111]
  buffer_load_dwordx4 v[20:23], v0, s[4:7], s33 offen offset:1024 sc1
  v_mfma_f32_16x16x32_bf16 v[104:107], v[80:83], v[100:103], v[104:107]
  buffer_load_dwordx4 v[24:27], v0, s[4:7], s34 offen offset:0 sc1
  v_mfma_f32_16x16x32_bf16 v[108:111], v[84:87], v[100:103], v[108:111]
  buffer_load_dwordx4 v[28:31], v0, s[4:7], s34 offen offset:1024 sc1
  s_add_u32 s33, s33, 262144
  s_add_u32 s34, s34, 262144
  s_add_u32 s36, s36, 262144
  ds_read_b128 v[56:59], v5 offset:16384
  ds_read_b128 v[60:63], v5 offset:17408
  s_waitcnt lgkmcnt(8)
  v_mfma_f32_16x16x32_bf16 v[124:127], v[32:35], v[88:91], v[124:127]
  v_add_f32_dpp v104, v104, v104 row_ror:8 row_mask:0xf bank_mask:0xf
  v_add_f32_dpp v105, v105, v105 row_ror:8 row_mask:0xf bank_mask:0xf
  v_add_f32_dpp v106, v106, v106 row_ror:8 row_mask:0xf bank_mask:0xf
  s_waitcnt lgkmcnt(6)
  v_mfma_f32_16x16x32_bf16 v[124:127], v[36:39], v[92:95], v[124:127]
  v_add_f32_dpp v107, v107, v107 row_ror:8 row_mask:0xf bank_mask:0xf
  v_add_f32_dpp v108, v108, v108 row_ror:8 row_mask:0xf bank_mask:0xf
  v_add_f32_dpp v109, v109, v109 row_ror:8 row_mask:0xf bank_mask:0xf
  s_waitcnt lgkmcnt(4)
  v_mfma_f32_16x16x32_bf16 v[124:127], v[40:43], v[96:99], v[124:127]
  v_add_f32_dpp v110, v110, v110 row_ror:8 row_mask:0xf bank_mask:0xf
  v_add_f32_dpp v111, v111, v111 row_ror:8 row_mask:0xf bank_mask:0xf
  v_max3_f32 v120, v104, v105, v106
  s_waitcnt lgkmcnt(2)
  v_mfma_f32_16x16x32_bf16 v[124:127], v[44:47], v[100:103], v[124:127]
  v_max3_f32 v120, v120, v107, v108
  v_max3_f32 v121, v109, v110, v111
  v_max_f32 v120, v120, v121
  v_mov_b32 v121, v120
  ds_read_b128 v[64:67], v5 offset:18432
  ds_read_b128 v[68:71], v5 offset:19456
  v_permlane32_swap_b32 v120, v121
  v_max_f32 v120, v120, v121
  v_add_f32_dpp v124, v124, v124 row_ror:8 row_mask:0xf bank_mask:0xf
  v_add_f32_dpp v125, v125, v125 row_ror:8 row_mask:0xf bank_mask:0xf
  v_add_f32_dpp v126, v126, v126 row_ror:8 row_mask:0xf bank_mask:0xf
  v_add_f32_dpp v127, v127, v127 row_ror:8 row_mask:0xf bank_mask:0xf
  v_max3_f32 v120, v120, v124, v125
  v_max3_f32 v120, v120, v126, v127
  v_mov_b32 v121, v120
  ds_read_b128 v[72:75], v5 offset:20480
  ds_read_b128 v[76:79], v5 offset:21504
  v_permlane16_swap_b32 v120, v121
  v_max_f32 v120, v120, v121
  v_mul_f32 v120, s40, v120
  v_pk_fma_f32 v[104:105], v[104:105], s[40:41], v[120:121] op_sel_hi:[1,1,0] neg_lo:[0,0,1] neg_hi:[0,0,1]
  v_pk_fma_f32 v[106:107], v[106:107], s[40:41], v[120:121] op_sel_hi:[1,1,0] neg_lo:[0,0,1] neg_hi:[0,0,1]
  v_pk_fma_f32 v[108:109], v[108:109], s[40:41], v[120:121] op_sel_hi:[1,1,0] neg_lo:[0,0,1] neg_hi:[0,0,1]
  v_pk_fma_f32 v[110:111], v[110:111], s[40:41], v[120:121] op_sel_hi:[1,1,0] neg_lo:[0,0,1] neg_hi:[0,0,1]
  v_exp_f32 v104, v104
  ds_read_b128 v[80:83], v5 offset:22528
  v_exp_f32 v105, v105
  ds_read_b128 v[84:87], v5 offset:23552
  v_exp_f32 v106, v106
  v_cvt_pk_bf16_f32 v32, v104, v105
  v_exp_f32 v107, v107
  ds_read_b128 v[40:43], v5 offset:24576
  v_exp_f32 v108, v108
  v_cvt_pk_bf16_f32 v33, v106, v107
  v_exp_f32 v109, v109
  ds_read_b128 v[44:47], v5 offset:25600
  v_exp_f32 v110, v110
  v_cvt_pk_bf16_f32 v34, v108, v109
  v_exp_f32 v111, v111
  ds_read_b128 v[88:91], v5 offset:26624
  ds_read_b128 v[92:95], v5 offset:27648
  v_pk_fma_f32 v[124:125], v[124:125], s[40:41], v[120:121] op_sel_hi:[1,1,0] neg_lo:[0,0,1] neg_hi:[0,0,1]
  v_cvt_pk_bf16_f32 v35, v110, v111
  v_pk_fma_f32 v[126:127], v[126:127], s[40:41], v[120:121] op_sel_hi:[1,1,0] neg_lo:[0,0,1] neg_hi:[0,0,1]
  v_exp_f32 v124, v124
  v_mfma_f32_16x16x32_bf16 v[96:99], v[48:51], v[32:35], 0
  v_exp_f32 v125, v125
  v_exp_f32 v126, v126
  v_mfma_f32_16x16x32_bf16 v[100:103], v[52:55], v[32:35], 0
  v_exp_f32 v127, v127
  v_cvt_pk_bf16_f32 v36, v124, v125
  v_mfma_f32_16x16x16_bf16 v[48:51], v[12:13], v[32:33], 0
  v_cvt_pk_bf16_f32 v37, v126, v127
  s_waitcnt vmcnt(6)
  v_and_b32 v121, 1, v118
  v_mfma_f32_16x16x16_bf16 v[48:51], v[12:13], v[34:35], v[48:51]
  v_cmp_ne_u32 vcc, 0, v121
  s_cbranch_vccnz .vs_244
.vc_245:
  v_permlane32_swap_b32 v112, v118
  v_permlane32_swap_b32 v113, v119
  v_mfma_f32_16x16x16_bf16 v[48:51], v[14:15], v[36:37], v[48:51]
  v_mov_b64 v[104:105], 0
  v_mfma_f32_16x16x16_bf16 v[96:99], v[112:113], v[36:37], v[96:99]
  v_mov_b64 v[106:107], 0
  v_mfma_f32_16x16x16_bf16 v[100:103], v[118:119], v[36:37], v[100:103]
  v_mov_b64 v[108:109], 0
  v_mov_b64 v[110:111], 0
  v_mov_b64 v[120:121], 0
  v_mov_b64 v[122:123], 0
  v_mov_b64 v[124:125], 0
  v_rcp_f32 v48, v48
  v_mov_b64 v[126:127], 0
  v_pk_mul_f32 v[96:97], v[96:97], v[48:49] op_sel_hi:[1,0]
  v_pk_mul_f32 v[98:99], v[98:99], v[48:49] op_sel_hi:[1,0]
  v_pk_mul_f32 v[100:101], v[100:101], v[48:49] op_sel_hi:[1,0]
  v_pk_mul_f32 v[102:103], v[102:103], v[48:49] op_sel_hi:[1,0]
  v_cvt_pk_bf16_f32 v52, v96, v97
  v_cvt_pk_bf16_f32 v53, v98, v99
  v_cvt_pk_bf16_f32 v54, v100, v101
  v_cvt_pk_bf16_f32 v55, v102, v103
  ds_write_b128 v0, v[52:55] offset:9216
  s_waitcnt lgkmcnt(11)
  v_smfmac_f32_16x16x64_bf16 v[104:107], v[52:55], v[56:63], v9
  s_waitcnt lgkmcnt(9)
  v_smfmac_f32_16x16x64_bf16 v[108:111], v[52:55], v[64:71], v9
  s_waitcnt lgkmcnt(7)
  v_smfmac_f32_16x16x64_bf16 v[120:123], v[52:55], v[72:79], v9
  s_waitcnt lgkmcnt(0)
  s_barrier
  ds_read_b128 v[96:99], v1 offset:9216
  v_smfmac_f32_16x16x64_bf16 v[124:127], v[52:55], v[80:87], v9
  ds_read_b128 v[100:103], v2 offset:9216
  ds_read_b128 v[32:35], v3 offset:9216
  ds_read_b128 v[56:59], v5 offset:28672
  ds_read_b128 v[60:63], v5 offset:29696
  ds_read_b128 v[64:67], v5 offset:30720
  ds_read_b128 v[68:71], v5 offset:31744
  s_waitcnt lgkmcnt(6)
  v_smfmac_f32_16x16x64_bf16 v[104:107], v[96:99], v[192:199], v9
  v_smfmac_f32_16x16x64_bf16 v[108:111], v[96:99], v[200:207], v9
  s_waitcnt lgkmcnt(5)
  v_smfmac_f32_16x16x64_bf16 v[104:107], v[100:103], v[224:231], v9
  v_smfmac_f32_16x16x64_bf16 v[108:111], v[100:103], v[232:239], v9
  s_waitcnt lgkmcnt(4)
  v_smfmac_f32_16x16x64_bf16 v[104:107], v[32:35], v[40:47], v9
  v_smfmac_f32_16x16x64_bf16 v[108:111], v[32:35], v[88:95], v9
  v_smfmac_f32_16x16x64_bf16 v[120:123], v[96:99], v[208:215], v9
  v_smfmac_f32_16x16x64_bf16 v[124:127], v[96:99], v[216:223], v9
  v_cvt_pk_bf16_f32 v104, v104, v105
  v_cvt_pk_bf16_f32 v105, v106, v107
  v_smfmac_f32_16x16x64_bf16 v[120:123], v[100:103], v[240:247], v9
  v_cvt_pk_bf16_f32 v106, v108, v109
  v_cvt_pk_bf16_f32 v107, v110, v111
  v_smfmac_f32_16x16x64_bf16 v[124:127], v[100:103], v[248:255], v9
  v_permlane16_swap_b32 v104, v106
  v_permlane16_swap_b32 v105, v107
  s_waitcnt lgkmcnt(2)
  v_smfmac_f32_16x16x64_bf16 v[120:123], v[32:35], v[56:63], v9
  v_or_b32 v104, 1, v104
  buffer_store_dwordx4 v[104:107], v6, s[4:7], s29 offen sc1
  s_waitcnt lgkmcnt(0)
  v_smfmac_f32_16x16x64_bf16 v[124:127], v[32:35], v[64:71], v9
  s_nop 3
  v_cvt_pk_bf16_f32 v120, v120, v121
  v_cvt_pk_bf16_f32 v121, v122, v123
  s_nop 1
  v_cvt_pk_bf16_f32 v122, v124, v125
  v_cvt_pk_bf16_f32 v123, v126, v127
  s_nop 0
  v_permlane16_swap_b32 v120, v122
  v_permlane16_swap_b32 v121, v123
  v_or_b32 v120, 1, v120
  buffer_store_dwordx4 v[120:123], v6, s[4:7], s30 offen sc1
  v_and_b32 v52, 16, v5
  v_mov_b32 v53, 0x3f80
  v_lshlrev_b32 v52, v52, v53
  s_mov_b32 vcc_lo, 0x30003
  s_mov_b32 vcc_hi, 0x30003
  v_cndmask_b32 v48, 0, v52, vcc
  s_mov_b32 vcc_lo, 0x300030
  s_mov_b32 vcc_hi, 0x300030
  v_cndmask_b32 v49, 0, v52, vcc
  s_mov_b32 vcc_lo, 0x3000300
  s_mov_b32 vcc_hi, 0x3000300
  v_cndmask_b32 v50, 0, v52, vcc
  s_mov_b32 vcc_lo, 0x30003000
  s_mov_b32 vcc_hi, 0x30003000
  v_cndmask_b32 v51, 0, v52, vcc
  v_mov_b32 v52, -1
  s_waitcnt vmcnt(0)
  buffer_load_dwordx4 v[64:67], v7, s[4:7], s31 offen offset:0 sc1
  buffer_load_dwordx4 v[68:71], v7, s[4:7], s32 offen offset:0 sc1
  s_waitcnt vmcnt(0)
.pl_247:
  v_bitop3_b32 v60, v64, v68, 1 bitop3:0x80
  v_cmp_ne_u32 vcc, 1, v60
  s_cbranch_vccnz .pr_248
  v_mfma_f32_16x16x32_bf16 v[56:59], v[48:51], v[64:67], 0
  v_mfma_f32_16x16x32_bf16 v[56:59], v[48:51], v[68:71], v[56:59]
  s_nop 7
  v_add_f32_dpp v60, v56, v56 row_ror:8 row_mask:0xf bank_mask:0x3
  v_add_f32_dpp v60, v57, v57 row_ror:8 row_mask:0xf bank_mask:0xc
  s_nop 1
  v_add_f32_dpp v60, v60, v60 row_shl:4 row_mask:0xf bank_mask:0xf
  s_nop 1
  v_mov_b32_dpp v61, v60 quad_perm:[1,1,3,3] row_mask:0xf bank_mask:0xf
  v_cvt_pk_bf16_f32 v62, v60, v61
  v_min_u32 v62, -2, v62
  buffer_store_dword v62, v8, s[4:7], s23 offen offset:0 sc1
  buffer_store_dword v52, v8, s[4:7], s24 offen offset:0 sc1
  s_add_u32 s19, s19, 1
  ds_write_b128 v0, v[16:19] offset:16384
  ds_write_b128 v0, v[20:23] offset:17408
  v_mov_b64 v[104:105], 0
  v_mov_b64 v[106:107], 0
  v_mov_b64 v[108:109], 0
  v_mov_b64 v[110:111], 0
  v_mov_b64 v[112:113], 0
  v_mov_b64 v[114:115], 0
  v_xor_b32 v116, 512, v0
  v_xor_b32 v117, 512, v1
  v_xor_b32 v118, 512, v2
  v_xor_b32 v119, 512, v3
  s_waitcnt vmcnt(0)
  buffer_load_dwordx4 v[32:35], v0, s[4:7], s21 offen offset:0 sc1
  buffer_load_dwordx4 v[36:39], v0, s[4:7], s21 offen offset:1024 sc1
  s_waitcnt vmcnt(0)
.ml_249:
  v_max3_u32 v120, v32, v33, v34
  v_max3_u32 v121, v35, v36, v37
  v_max3_u32 v120, v120, v38, v39
  v_max_u32 v120, v120, v121
  v_cmp_eq_u32 vcc, -1, v120
  s_cbranch_vccnz .mr_250
  ds_write_b128 v0, v[32:35]
  ds_write_b128 v0, v[36:39] offset:1024
  v_smfmac_f32_16x16x64_bf16 v[104:107], v[32:35], a[0:7], v9
  ds_read_b128 v[48:51], v116
  ds_read_b128 v[52:55], v116 offset:1024
  v_smfmac_f32_16x16x64_bf16 v[104:107], v[36:39], a[16:23], v9
  v_smfmac_f32_16x16x64_bf16 v[108:111], v[32:35], a[128:135], v9
  s_waitcnt lgkmcnt(2)
  s_barrier
  ds_read_b128 v[56:59], v1 offset:0
  ds_read_b128 v[60:63], v117 offset:0
  v_smfmac_f32_16x16x64_bf16 v[108:111], v[36:39], a[144:151], v9
  ds_read_b128 v[64:67], v1 offset:1024
  ds_read_b128 v[68:71], v117 offset:1024
  s_waitcnt lgkmcnt(5)
  v_smfmac_f32_16x16x64_bf16 v[104:107], v[48:51], a[8:15], v9
  ds_read_b128 v[72:75], v2 offset:0
  ds_read_b128 v[76:79], v118 offset:0
  s_waitcnt lgkmcnt(6)
  v_smfmac_f32_16x16x64_bf16 v[104:107], v[52:55], a[24:31], v9
  ds_read_b128 v[80:83], v2 offset:1024
  ds_read_b128 v[84:87], v118 offset:1024
  v_smfmac_f32_16x16x64_bf16 v[108:111], v[48:51], a[136:143], v9
  ds_read_b128 v[88:91], v3 offset:0
  ds_read_b128 v[92:95], v119 offset:0
  v_smfmac_f32_16x16x64_bf16 v[108:111], v[52:55], a[152:159], v9
  ds_read_b128 v[96:99], v3 offset:1024
  ds_read_b128 v[100:103], v119 offset:1024
  v_smfmac_f32_16x16x64_bf16 v[112:115], v[32:35], v[128:135], v9
  v_smfmac_f32_16x16x64_bf16 v[112:115], v[36:39], v[144:151], v9
  s_waitcnt lgkmcnt(11)
  v_smfmac_f32_16x16x64_bf16 v[104:107], v[56:59], a[32:39], v9
  s_waitcnt lgkmcnt(10)
  v_smfmac_f32_16x16x64_bf16 v[104:107], v[60:63], a[40:47], v9
  s_waitcnt lgkmcnt(9)
  v_smfmac_f32_16x16x64_bf16 v[104:107], v[64:67], a[48:55], v9
  v_mov_b32 v124, 0
  v_mov_b32 v125, s19
  s_waitcnt lgkmcnt(8)
  v_smfmac_f32_16x16x64_bf16 v[104:107], v[68:71], a[56:63], v9
  s_mov_b32 exec_lo, 0x01010101
  s_mov_b32 exec_hi, 0x01010101
  buffer_store_dword v124, v0, s[4:7], s28 offen offset:0 sc1
  s_mov_b64 exec, -1
  s_waitcnt lgkmcnt(7)
  v_smfmac_f32_16x16x64_bf16 v[104:107], v[72:75], a[64:71], v9
  s_mov_b32 exec_lo, 0x01010101
  s_mov_b32 exec_hi, 0x01010101
  buffer_store_dword v124, v0, s[4:7], s28 offen offset:1024 sc1
  s_mov_b64 exec, -1
  s_waitcnt lgkmcnt(6)
  v_smfmac_f32_16x16x64_bf16 v[104:107], v[76:79], a[72:79], v9
  s_mov_b64 exec, 1
  buffer_store_dword v125, off, s[4:7], s37 sc1
  s_mov_b64 exec, -1
  s_waitcnt lgkmcnt(5)
  v_smfmac_f32_16x16x64_bf16 v[104:107], v[80:83], a[80:87], v9
  s_waitcnt lgkmcnt(4)
  v_smfmac_f32_16x16x64_bf16 v[104:107], v[84:87], a[88:95], v9
  s_waitcnt lgkmcnt(3)
  v_smfmac_f32_16x16x64_bf16 v[104:107], v[88:91], a[96:103], v9
  s_waitcnt lgkmcnt(2)
  v_smfmac_f32_16x16x64_bf16 v[104:107], v[92:95], a[104:111], v9
  s_waitcnt lgkmcnt(1)
  v_smfmac_f32_16x16x64_bf16 v[104:107], v[96:99], a[112:119], v9
  s_waitcnt lgkmcnt(0)
  v_smfmac_f32_16x16x64_bf16 v[104:107], v[100:103], a[120:127], v9
  v_smfmac_f32_16x16x64_bf16 v[108:111], v[56:59], a[160:167], v9
  v_smfmac_f32_16x16x64_bf16 v[108:111], v[60:63], a[168:175], v9
  v_cvt_pk_bf16_f32 v104, v104, v105
  v_cvt_pk_bf16_f32 v105, v106, v107
  v_or_b32 v104, 1, v104
  buffer_store_dwordx2 v[104:105], v4, s[4:7], s25 offen offset:0 sc1
  ds_write_b64 v4, v[104:105] offset:24576
  v_smfmac_f32_16x16x64_bf16 v[108:111], v[64:67], a[176:183], v9
  v_smfmac_f32_16x16x64_bf16 v[108:111], v[68:71], a[184:191], v9
  v_smfmac_f32_16x16x64_bf16 v[108:111], v[72:75], a[192:199], v9
  ds_read_b128 v[40:43], v5 offset:0
  ds_read_b128 v[44:47], v5 offset:1024
  v_smfmac_f32_16x16x64_bf16 v[108:111], v[76:79], a[200:207], v9
  ds_read_b128 v[120:123], v5 offset:2048
  ds_read_b128 v[124:127], v5 offset:3072
  v_smfmac_f32_16x16x64_bf16 v[108:111], v[80:83], a[208:215], v9
  v_smfmac_f32_16x16x64_bf16 v[108:111], v[84:87], a[216:223], v9
  v_and_b32 v116, -6145, v0
  s_lshl_b32 s43, s18, 11
  v_add_u32 v117, s43, v11
  v_smfmac_f32_16x16x64_bf16 v[108:111], v[88:91], a[224:231], v9
  s_waitcnt vmcnt(4)
  ds_read_b128 v[32:35], v5 offset:4096
  ds_read_b128 v[36:39], v5 offset:5120
  v_smfmac_f32_16x16x64_bf16 v[108:111], v[92:95], a[232:239], v9
  v_smfmac_f32_16x16x64_bf16 v[108:111], v[96:99], a[240:247], v9
  v_smfmac_f32_16x16x64_bf16 v[108:111], v[100:103], a[248:255], v9
  v_smfmac_f32_16x16x64_bf16 v[112:115], v[48:51], v[136:143], v9
  v_smfmac_f32_16x16x64_bf16 v[112:115], v[52:55], v[152:159], v9
  v_cvt_pk_bf16_f32 v108, v108, v109
  v_cvt_pk_bf16_f32 v109, v110, v111
  v_or_b32 v108, 1, v108
  buffer_store_dwordx2 v[108:109], v4, s[4:7], s25 offen offset:512 sc1
  ds_write_b64 v4, v[108:109] offset:8192
  ds_read_b128 v[48:51], v5 offset:6144
  ds_read_b128 v[52:55], v5 offset:7168
  s_waitcnt lgkmcnt(7)
  v_smfmac_f32_16x16x64_bf16 v[112:115], v[72:75], v[40:47], v9
  ds_read_b128 v[40:43], v5 offset:8192
  ds_read_b128 v[44:47], v5 offset:9216
  s_waitcnt lgkmcnt(7)
  v_smfmac_f32_16x16x64_bf16 v[112:115], v[76:79], v[120:127], v9
  ds_read_b128 v[120:123], v5 offset:10240
  ds_read_b128 v[124:127], v5 offset:11264
  s_waitcnt lgkmcnt(7)
  v_smfmac_f32_16x16x64_bf16 v[112:115], v[80:83], v[32:39], v9
  ds_read_b128 v[32:35], v5 offset:12288
  ds_read_b128 v[36:39], v5 offset:13312
  v_smfmac_f32_16x16x64_bf16 v[112:115], v[56:59], v[160:167], v9
  v_smfmac_f32_16x16x64_bf16 v[112:115], v[60:63], v[168:175], v9
  buffer_load_dwordx2 v[104:105], v4, s[4:7], s27 offen offset:0 sc1
  s_waitcnt lgkmcnt(6)
  v_smfmac_f32_16x16x64_bf16 v[112:115], v[84:87], v[48:55], v9
  ds_read_b128 v[48:51], v5 offset:14336
  ds_read_b128 v[52:55], v5 offset:15360
  v_smfmac_f32_16x16x64_bf16 v[112:115], v[64:67], v[176:183], v9
  v_smfmac_f32_16x16x64_bf16 v[112:115], v[68:71], v[184:191], v9
  s_waitcnt lgkmcnt(6)
  v_smfmac_f32_16x16x64_bf16 v[112:115], v[88:91], v[40:47], v9
  ds_read_b128 v[56:59], v116 offset:16384
  ds_read_b128 v[60:63], v116 offset:17408
  s_waitcnt lgkmcnt(6)
  v_smfmac_f32_16x16x64_bf16 v[112:115], v[92:95], v[120:127], v9
  ds_read_b128 v[64:67], v116 offset:18432
  ds_read_b128 v[68:71], v116 offset:19456
  s_waitcnt lgkmcnt(6)
  v_smfmac_f32_16x16x64_bf16 v[112:115], v[96:99], v[32:39], v9
  ds_read_b128 v[72:75], v116 offset:20480
  ds_read_b128 v[76:79], v116 offset:21504
  s_waitcnt lgkmcnt(6)
  v_smfmac_f32_16x16x64_bf16 v[112:115], v[100:103], v[48:55], v9
  ds_read_b128 v[80:83], v116 offset:22528
  ds_read_b128 v[84:87], v116 offset:23552
  ds_read_b64_tr_b16 v[120:121], v117 offset:0
  ds_read_b64_tr_b16 v[122:123], v117 offset:32
  s_barrier
  s_waitcnt vmcnt(4)
  s_nop 1
  v_cvt_pk_bf16_f32 v112, v112, v113
  v_cvt_pk_bf16_f32 v113, v114, v115
  v_or_b32 v112, 1, v112
  buffer_store_dwordx2 v[112:113], v4, s[4:7], s25 offen offset:1024 sc1
  ds_read_b64_tr_b16 v[32:33], v11 offset:0
  ds_read_b64_tr_b16 v[34:35], v11 offset:32
  ds_read_b64_tr_b16 v[36:37], v11 offset:2048
  ds_read_b64_tr_b16 v[38:39], v11 offset:2080
  ds_read_b64_tr_b16 v[40:41], v11 offset:4096
  ds_read_b64_tr_b16 v[42:43], v11 offset:4128
  ds_read_b64_tr_b16 v[44:45], v11 offset:6144
  ds_read_b64_tr_b16 v[46:47], v11 offset:6176
  v_mov_b64 v[48:49], v[24:25]
  v_mov_b64 v[50:51], v[26:27]
  v_mov_b64 v[52:53], v[28:29]
  v_mov_b64 v[54:55], v[30:31]
  s_waitcnt vmcnt(2)
  buffer_load_dwordx2 v[20:21], v4, s[4:7], s27 offen offset:512 sc1
  s_waitcnt vmcnt(2)
  v_and_b32 v114, 1, v104
  v_cmp_ne_u32 vcc, 1, v114
  s_cbranch_vccnz .kx_251
.kok_252:
  ds_write_b64 v4, v[104:105] offset:25120
  s_waitcnt lgkmcnt(0)
  s_barrier
  ds_read_b64_tr_b16 v[88:89], v10 offset:0
  ds_read_b64_tr_b16 v[90:91], v10 offset:32
  ds_read_b64_tr_b16 v[92:93], v10 offset:2048
  ds_read_b64_tr_b16 v[94:95], v10 offset:2080
  ds_read_b64_tr_b16 v[96:97], v10 offset:4096
  ds_read_b64_tr_b16 v[98:99], v10 offset:4128
  ds_read_b64_tr_b16 v[100:101], v10 offset:6144
  ds_read_b64_tr_b16 v[102:103], v10 offset:6176
  s_waitcnt lgkmcnt(6)
  v_mfma_f32_16x16x32_bf16 v[124:127], v[32:35], v[88:91], 0
  s_waitcnt lgkmcnt(4)
  v_mfma_f32_16x16x32_bf16 v[124:127], v[36:39], v[92:95], v[124:127]
  s_waitcnt lgkmcnt(2)
  v_mfma_f32_16x16x32_bf16 v[124:127], v[40:43], v[96:99], v[124:127]
  s_waitcnt lgkmcnt(0)
  v_mfma_f32_16x16x32_bf16 v[124:127], v[44:47], v[100:103], v[124:127]
  buffer_load_dwordx2 v[118:119], v4, s[4:7], s27 offen offset:1024 sc1
  s_waitcnt vmcnt(1)
  v_and_b32 v114, 1, v20
  v_cmp_ne_u32 vcc, 1, v114
  s_cbranch_vccnz .kx_253
.kok_254:
  ds_write_b64 v4, v[20:21] offset:8704
  v_mfma_f32_16x16x32_bf16 v[104:107], v[56:59], v[88:91], 0
  buffer_store_dwordx2 v[112:113], v4, s[4:7], s36 offen offset:1024 sc1
  v_mfma_f32_16x16x32_bf16 v[108:111], v[60:63], v[88:91], 0
  s_mov_b64 exec, s[12:13]
  buffer_store_dwordx4 v[120:123], v0, s[4:7], s36 offen sc1
  s_mov_b64 exec, -1
  v_mfma_f32_16x16x32_bf16 v[104:107], v[64:67], v[92:95], v[104:107]
  v_mfma_f32_16x16x32_bf16 v[108:111], v[68:71], v[92:95], v[108:111]
  s_waitcnt lgkmcnt(0)
  s_barrier
  ds_read_b64_tr_b16 v[32:33], v11 offset:512
  ds_read_b64_tr_b16 v[34:35], v11 offset:544
  ds_read_b64_tr_b16 v[36:37], v11 offset:2560
  ds_read_b64_tr_b16 v[38:39], v11 offset:2592
  ds_read_b64_tr_b16 v[40:41], v11 offset:4608
  ds_read_b64_tr_b16 v[42:43], v11 offset:4640
  ds_read_b64_tr_b16 v[44:45], v11 offset:6656
  ds_read_b64_tr_b16 v[46:47], v11 offset:6688
  v_mfma_f32_16x16x32_bf16 v[104:107], v[72:75], v[96:99], v[104:107]
  buffer_load_dwordx4 v[16:19], v0, s[4:7], s33 offen offset:0 sc1
  v_mfma_f32_16x16x32_bf16 v[108:111], v[76:79], v[96:99], v[108:111]
  buffer_load_dwordx4 v[20:23], v0, s[4:7], s33 offen offset:1024 sc1
  v_mfma_f32_16x16x32_bf16 v[104:107], v[80:83], v[100:103], v[104:107]
  buffer_load_dwordx4 v[24:27], v0, s[4:7], s34 offen offset:0 sc1
  v_mfma_f32_16x16x32_bf16 v[108:111], v[84:87], v[100:103], v[108:111]
  buffer_load_dwordx4 v[28:31], v0, s[4:7], s34 offen offset:1024 sc1
  s_add_u32 s33, s33, 262144
  s_add_u32 s34, s34, 262144
  s_add_u32 s36, s36, 262144
  ds_read_b128 v[56:59], v5 offset:16384
  ds_read_b128 v[60:63], v5 offset:17408
  s_waitcnt lgkmcnt(8)
  v_mfma_f32_16x16x32_bf16 v[124:127], v[32:35], v[88:91], v[124:127]
  v_add_f32_dpp v104, v104, v104 row_ror:8 row_mask:0xf bank_mask:0xf
  v_add_f32_dpp v105, v105, v105 row_ror:8 row_mask:0xf bank_mask:0xf
  v_add_f32_dpp v106, v106, v106 row_ror:8 row_mask:0xf bank_mask:0xf
  s_waitcnt lgkmcnt(6)
  v_mfma_f32_16x16x32_bf16 v[124:127], v[36:39], v[92:95], v[124:127]
  v_add_f32_dpp v107, v107, v107 row_ror:8 row_mask:0xf bank_mask:0xf
  v_add_f32_dpp v108, v108, v108 row_ror:8 row_mask:0xf bank_mask:0xf
  v_add_f32_dpp v109, v109, v109 row_ror:8 row_mask:0xf bank_mask:0xf
  s_waitcnt lgkmcnt(4)
  v_mfma_f32_16x16x32_bf16 v[124:127], v[40:43], v[96:99], v[124:127]
  v_add_f32_dpp v110, v110, v110 row_ror:8 row_mask:0xf bank_mask:0xf
  v_add_f32_dpp v111, v111, v111 row_ror:8 row_mask:0xf bank_mask:0xf
  v_max3_f32 v120, v104, v105, v106
  s_waitcnt lgkmcnt(2)
  v_mfma_f32_16x16x32_bf16 v[124:127], v[44:47], v[100:103], v[124:127]
  v_max3_f32 v120, v120, v107, v108
  v_max3_f32 v121, v109, v110, v111
  v_max_f32 v120, v120, v121
  v_mov_b32 v121, v120
  ds_read_b128 v[64:67], v5 offset:18432
  ds_read_b128 v[68:71], v5 offset:19456
  v_permlane32_swap_b32 v120, v121
  v_max_f32 v120, v120, v121
  v_add_f32_dpp v124, v124, v124 row_ror:8 row_mask:0xf bank_mask:0xf
  v_add_f32_dpp v125, v125, v125 row_ror:8 row_mask:0xf bank_mask:0xf
  v_add_f32_dpp v126, v126, v126 row_ror:8 row_mask:0xf bank_mask:0xf
  v_add_f32_dpp v127, v127, v127 row_ror:8 row_mask:0xf bank_mask:0xf
  v_max3_f32 v120, v120, v124, v125
  v_max3_f32 v120, v120, v126, v127
  v_mov_b32 v121, v120
  ds_read_b128 v[72:75], v5 offset:20480
  ds_read_b128 v[76:79], v5 offset:21504
  v_permlane16_swap_b32 v120, v121
  v_max_f32 v120, v120, v121
  v_mul_f32 v120, s40, v120
  v_pk_fma_f32 v[104:105], v[104:105], s[40:41], v[120:121] op_sel_hi:[1,1,0] neg_lo:[0,0,1] neg_hi:[0,0,1]
  v_pk_fma_f32 v[106:107], v[106:107], s[40:41], v[120:121] op_sel_hi:[1,1,0] neg_lo:[0,0,1] neg_hi:[0,0,1]
  v_pk_fma_f32 v[108:109], v[108:109], s[40:41], v[120:121] op_sel_hi:[1,1,0] neg_lo:[0,0,1] neg_hi:[0,0,1]
  v_pk_fma_f32 v[110:111], v[110:111], s[40:41], v[120:121] op_sel_hi:[1,1,0] neg_lo:[0,0,1] neg_hi:[0,0,1]
  v_exp_f32 v104, v104
  ds_read_b128 v[80:83], v5 offset:22528
  v_exp_f32 v105, v105
  ds_read_b128 v[84:87], v5 offset:23552
  v_exp_f32 v106, v106
  v_cvt_pk_bf16_f32 v32, v104, v105
  v_exp_f32 v107, v107
  ds_read_b128 v[40:43], v5 offset:24576
  v_exp_f32 v108, v108
  v_cvt_pk_bf16_f32 v33, v106, v107
  v_exp_f32 v109, v109
  ds_read_b128 v[44:47], v5 offset:25600
  v_exp_f32 v110, v110
  v_cvt_pk_bf16_f32 v34, v108, v109
  v_exp_f32 v111, v111
  ds_read_b128 v[88:91], v5 offset:26624
  ds_read_b128 v[92:95], v5 offset:27648
  v_pk_fma_f32 v[124:125], v[124:125], s[40:41], v[120:121] op_sel_hi:[1,1,0] neg_lo:[0,0,1] neg_hi:[0,0,1]
  v_cvt_pk_bf16_f32 v35, v110, v111
  v_pk_fma_f32 v[126:127], v[126:127], s[40:41], v[120:121] op_sel_hi:[1,1,0] neg_lo:[0,0,1] neg_hi:[0,0,1]
  v_exp_f32 v124, v124
  v_mfma_f32_16x16x32_bf16 v[96:99], v[48:51], v[32:35], 0
  v_exp_f32 v125, v125
  v_exp_f32 v126, v126
  v_mfma_f32_16x16x32_bf16 v[100:103], v[52:55], v[32:35], 0
  v_exp_f32 v127, v127
  v_cvt_pk_bf16_f32 v36, v124, v125
  v_mfma_f32_16x16x16_bf16 v[48:51], v[12:13], v[32:33], 0
  v_cvt_pk_bf16_f32 v37, v126, v127
  s_waitcnt vmcnt(6)
  v_and_b32 v121, 1, v118
  v_mfma_f32_16x16x16_bf16 v[48:51], v[12:13], v[34:35], v[48:51]
  v_cmp_ne_u32 vcc, 1, v121
  s_cbranch_vccnz .vs_255
.vc_256:
  v_permlane32_swap_b32 v112, v118
  v_permlane32_swap_b32 v113, v119
  v_mfma_f32_16x16x16_bf16 v[48:51], v[14:15], v[36:37], v[48:51]
  v_mov_b64 v[104:105], 0
  v_mfma_f32_16x16x16_bf16 v[96:99], v[112:113], v[36:37], v[96:99]
  v_mov_b64 v[106:107], 0
  v_mfma_f32_16x16x16_bf16 v[100:103], v[118:119], v[36:37], v[100:103]
  v_mov_b64 v[108:109], 0
  v_mov_b64 v[110:111], 0
  v_mov_b64 v[120:121], 0
  v_mov_b64 v[122:123], 0
  v_mov_b64 v[124:125], 0
  v_rcp_f32 v48, v48
  v_mov_b64 v[126:127], 0
  v_pk_mul_f32 v[96:97], v[96:97], v[48:49] op_sel_hi:[1,0]
  v_pk_mul_f32 v[98:99], v[98:99], v[48:49] op_sel_hi:[1,0]
  v_pk_mul_f32 v[100:101], v[100:101], v[48:49] op_sel_hi:[1,0]
  v_pk_mul_f32 v[102:103], v[102:103], v[48:49] op_sel_hi:[1,0]
  v_cvt_pk_bf16_f32 v52, v96, v97
  v_cvt_pk_bf16_f32 v53, v98, v99
  v_cvt_pk_bf16_f32 v54, v100, v101
  v_cvt_pk_bf16_f32 v55, v102, v103
  ds_write_b128 v0, v[52:55] offset:9216
  s_waitcnt lgkmcnt(11)
  v_smfmac_f32_16x16x64_bf16 v[104:107], v[52:55], v[56:63], v9
  s_waitcnt lgkmcnt(9)
  v_smfmac_f32_16x16x64_bf16 v[108:111], v[52:55], v[64:71], v9
  s_waitcnt lgkmcnt(7)
  v_smfmac_f32_16x16x64_bf16 v[120:123], v[52:55], v[72:79], v9
  s_waitcnt lgkmcnt(0)
  s_barrier
  ds_read_b128 v[96:99], v1 offset:9216
  v_smfmac_f32_16x16x64_bf16 v[124:127], v[52:55], v[80:87], v9
  ds_read_b128 v[100:103], v2 offset:9216
  ds_read_b128 v[32:35], v3 offset:9216
  ds_read_b128 v[56:59], v5 offset:28672
  ds_read_b128 v[60:63], v5 offset:29696
  ds_read_b128 v[64:67], v5 offset:30720
  ds_read_b128 v[68:71], v5 offset:31744
  s_waitcnt lgkmcnt(6)
  v_smfmac_f32_16x16x64_bf16 v[104:107], v[96:99], v[192:199], v9
  v_smfmac_f32_16x16x64_bf16 v[108:111], v[96:99], v[200:207], v9
  s_waitcnt lgkmcnt(5)
  v_smfmac_f32_16x16x64_bf16 v[104:107], v[100:103], v[224:231], v9
  v_smfmac_f32_16x16x64_bf16 v[108:111], v[100:103], v[232:239], v9
  s_waitcnt lgkmcnt(4)
  v_smfmac_f32_16x16x64_bf16 v[104:107], v[32:35], v[40:47], v9
  v_smfmac_f32_16x16x64_bf16 v[108:111], v[32:35], v[88:95], v9
  v_smfmac_f32_16x16x64_bf16 v[120:123], v[96:99], v[208:215], v9
  v_smfmac_f32_16x16x64_bf16 v[124:127], v[96:99], v[216:223], v9
  v_cvt_pk_bf16_f32 v104, v104, v105
  v_cvt_pk_bf16_f32 v105, v106, v107
  v_smfmac_f32_16x16x64_bf16 v[120:123], v[100:103], v[240:247], v9
  v_cvt_pk_bf16_f32 v106, v108, v109
  v_cvt_pk_bf16_f32 v107, v110, v111
  v_smfmac_f32_16x16x64_bf16 v[124:127], v[100:103], v[248:255], v9
  v_permlane16_swap_b32 v104, v106
  v_permlane16_swap_b32 v105, v107
  s_waitcnt lgkmcnt(2)
  v_smfmac_f32_16x16x64_bf16 v[120:123], v[32:35], v[56:63], v9
  v_and_b32 v104, -2, v104
  buffer_store_dwordx4 v[104:107], v6, s[4:7], s29 offen sc1
  s_waitcnt lgkmcnt(0)
  v_smfmac_f32_16x16x64_bf16 v[124:127], v[32:35], v[64:71], v9
  s_nop 3
  v_cvt_pk_bf16_f32 v120, v120, v121
  v_cvt_pk_bf16_f32 v121, v122, v123
  s_nop 1
  v_cvt_pk_bf16_f32 v122, v124, v125
  v_cvt_pk_bf16_f32 v123, v126, v127
  s_nop 0
  v_permlane16_swap_b32 v120, v122
  v_permlane16_swap_b32 v121, v123
  v_and_b32 v120, -2, v120
  buffer_store_dwordx4 v[120:123], v6, s[4:7], s30 offen sc1
  v_and_b32 v52, 16, v5
  v_mov_b32 v53, 0x3f80
  v_lshlrev_b32 v52, v52, v53
  s_mov_b32 vcc_lo, 0x30003
  s_mov_b32 vcc_hi, 0x30003
  v_cndmask_b32 v48, 0, v52, vcc
  s_mov_b32 vcc_lo, 0x300030
  s_mov_b32 vcc_hi, 0x300030
  v_cndmask_b32 v49, 0, v52, vcc
  s_mov_b32 vcc_lo, 0x3000300
  s_mov_b32 vcc_hi, 0x3000300
  v_cndmask_b32 v50, 0, v52, vcc
  s_mov_b32 vcc_lo, 0x30003000
  s_mov_b32 vcc_hi, 0x30003000
  v_cndmask_b32 v51, 0, v52, vcc
  v_mov_b32 v52, -1
  s_waitcnt vmcnt(0)
  buffer_load_dwordx4 v[64:67], v7, s[4:7], s31 offen offset:0 sc1
  buffer_load_dwordx4 v[68:71], v7, s[4:7], s32 offen offset:0 sc1
  s_waitcnt vmcnt(0)
.pl_258:
  v_bitop3_b32 v60, v64, v68, 1 bitop3:0xa8
  v_cmp_ne_u32 vcc, 0, v60
  s_cbranch_vccnz .pr_259
  v_mfma_f32_16x16x32_bf16 v[56:59], v[48:51], v[64:67], 0
  v_mfma_f32_16x16x32_bf16 v[56:59], v[48:51], v[68:71], v[56:59]
  s_nop 7
  v_add_f32_dpp v60, v56, v56 row_ror:8 row_mask:0xf bank_mask:0x3
  v_add_f32_dpp v60, v57, v57 row_ror:8 row_mask:0xf bank_mask:0xc
  s_nop 1
  v_add_f32_dpp v60, v60, v60 row_shl:4 row_mask:0xf bank_mask:0xf
  s_nop 1
  v_mov_b32_dpp v61, v60 quad_perm:[1,1,3,3] row_mask:0xf bank_mask:0xf
  v_cvt_pk_bf16_f32 v62, v60, v61
  v_min_u32 v62, -2, v62
  buffer_store_dword v62, v8, s[4:7], s24 offen offset:0 sc1
  buffer_store_dword v52, v8, s[4:7], s23 offen offset:0 sc1
  s_add_u32 s19, s19, 1
  s_cmp_eq_u32 s19, 63
  s_cbranch_scc1 .clast_222
  ds_write_b128 v0, v[16:19] offset:16384
  ds_write_b128 v0, v[20:23] offset:17408
  v_mov_b64 v[104:105], 0
  v_mov_b64 v[106:107], 0
  v_mov_b64 v[108:109], 0
  v_mov_b64 v[110:111], 0
  v_mov_b64 v[112:113], 0
  v_mov_b64 v[114:115], 0
  v_xor_b32 v116, 512, v0
  v_xor_b32 v117, 512, v1
  v_xor_b32 v118, 512, v2
  v_xor_b32 v119, 512, v3
  s_waitcnt vmcnt(0)
  buffer_load_dwordx4 v[32:35], v0, s[4:7], s22 offen offset:0 sc1
  buffer_load_dwordx4 v[36:39], v0, s[4:7], s22 offen offset:1024 sc1
  s_waitcnt vmcnt(0)
.ml_260:
  v_max3_u32 v120, v32, v33, v34
  v_max3_u32 v121, v35, v36, v37
  v_max3_u32 v120, v120, v38, v39
  v_max_u32 v120, v120, v121
  v_cmp_eq_u32 vcc, -1, v120
  s_cbranch_vccnz .mr_261
  ds_write_b128 v0, v[32:35]
  ds_write_b128 v0, v[36:39] offset:1024
  v_smfmac_f32_16x16x64_bf16 v[104:107], v[32:35], a[0:7], v9
  ds_read_b128 v[48:51], v116
  ds_read_b128 v[52:55], v116 offset:1024
  v_smfmac_f32_16x16x64_bf16 v[104:107], v[36:39], a[16:23], v9
  v_smfmac_f32_16x16x64_bf16 v[108:111], v[32:35], a[128:135], v9
  s_waitcnt lgkmcnt(2)
  s_barrier
  ds_read_b128 v[56:59], v1 offset:0
  ds_read_b128 v[60:63], v117 offset:0
  v_smfmac_f32_16x16x64_bf16 v[108:111], v[36:39], a[144:151], v9
  ds_read_b128 v[64:67], v1 offset:1024
  ds_read_b128 v[68:71], v117 offset:1024
  s_waitcnt lgkmcnt(5)
  v_smfmac_f32_16x16x64_bf16 v[104:107], v[48:51], a[8:15], v9
  ds_read_b128 v[72:75], v2 offset:0
  ds_read_b128 v[76:79], v118 offset:0
  s_waitcnt lgkmcnt(6)
  v_smfmac_f32_16x16x64_bf16 v[104:107], v[52:55], a[24:31], v9
  ds_read_b128 v[80:83], v2 offset:1024
  ds_read_b128 v[84:87], v118 offset:1024
  v_smfmac_f32_16x16x64_bf16 v[108:111], v[48:51], a[136:143], v9
  ds_read_b128 v[88:91], v3 offset:0
  ds_read_b128 v[92:95], v119 offset:0
  v_smfmac_f32_16x16x64_bf16 v[108:111], v[52:55], a[152:159], v9
  ds_read_b128 v[96:99], v3 offset:1024
  ds_read_b128 v[100:103], v119 offset:1024
  v_smfmac_f32_16x16x64_bf16 v[112:115], v[32:35], v[128:135], v9
  v_smfmac_f32_16x16x64_bf16 v[112:115], v[36:39], v[144:151], v9
  s_waitcnt lgkmcnt(11)
  v_smfmac_f32_16x16x64_bf16 v[104:107], v[56:59], a[32:39], v9
  s_waitcnt lgkmcnt(10)
  v_smfmac_f32_16x16x64_bf16 v[104:107], v[60:63], a[40:47], v9
  s_waitcnt lgkmcnt(9)
  v_smfmac_f32_16x16x64_bf16 v[104:107], v[64:67], a[48:55], v9
  v_mov_b32 v124, 1
  v_mov_b32 v125, s19
  s_waitcnt lgkmcnt(8)
  v_smfmac_f32_16x16x64_bf16 v[104:107], v[68:71], a[56:63], v9
  s_mov_b32 exec_lo, 0x01010101
  s_mov_b32 exec_hi, 0x01010101
  buffer_store_dword v124, v0, s[4:7], s27 offen offset:0 sc1
  s_mov_b64 exec, -1
  s_waitcnt lgkmcnt(7)
  v_smfmac_f32_16x16x64_bf16 v[104:107], v[72:75], a[64:71], v9
  s_mov_b32 exec_lo, 0x01010101
  s_mov_b32 exec_hi, 0x01010101
  buffer_store_dword v124, v0, s[4:7], s27 offen offset:1024 sc1
  s_mov_b64 exec, -1
  s_waitcnt lgkmcnt(6)
  v_smfmac_f32_16x16x64_bf16 v[104:107], v[76:79], a[72:79], v9
  s_mov_b64 exec, 1
  buffer_store_dword v125, off, s[4:7], s37 sc1
  s_mov_b64 exec, -1
  s_waitcnt lgkmcnt(5)
  v_smfmac_f32_16x16x64_bf16 v[104:107], v[80:83], a[80:87], v9
  s_waitcnt lgkmcnt(4)
  v_smfmac_f32_16x16x64_bf16 v[104:107], v[84:87], a[88:95], v9
  s_waitcnt lgkmcnt(3)
  v_smfmac_f32_16x16x64_bf16 v[104:107], v[88:91], a[96:103], v9
  s_waitcnt lgkmcnt(2)
  v_smfmac_f32_16x16x64_bf16 v[104:107], v[92:95], a[104:111], v9
  s_waitcnt lgkmcnt(1)
  v_smfmac_f32_16x16x64_bf16 v[104:107], v[96:99], a[112:119], v9
  s_waitcnt lgkmcnt(0)
  v_smfmac_f32_16x16x64_bf16 v[104:107], v[100:103], a[120:127], v9
  v_smfmac_f32_16x16x64_bf16 v[108:111], v[56:59], a[160:167], v9
  v_smfmac_f32_16x16x64_bf16 v[108:111], v[60:63], a[168:175], v9
  v_cvt_pk_bf16_f32 v104, v104, v105
  v_cvt_pk_bf16_f32 v105, v106, v107
  v_or_b32 v104, 1, v104
  buffer_store_dwordx2 v[104:105], v4, s[4:7], s26 offen offset:0 sc1
  ds_write_b64 v4, v[104:105] offset:24576
  v_smfmac_f32_16x16x64_bf16 v[108:111], v[64:67], a[176:183], v9
  v_smfmac_f32_16x16x64_bf16 v[108:111], v[68:71], a[184:191], v9
  v_smfmac_f32_16x16x64_bf16 v[108:111], v[72:75], a[192:199], v9
  ds_read_b128 v[40:43], v5 offset:0
  ds_read_b128 v[44:47], v5 offset:1024
  v_smfmac_f32_16x16x64_bf16 v[108:111], v[76:79], a[200:207], v9
  ds_read_b128 v[120:123], v5 offset:2048
  ds_read_b128 v[124:127], v5 offset:3072
  v_smfmac_f32_16x16x64_bf16 v[108:111], v[80:83], a[208:215], v9
  v_smfmac_f32_16x16x64_bf16 v[108:111], v[84:87], a[216:223], v9
  v_and_b32 v116, -6145, v0
  s_lshl_b32 s43, s18, 11
  v_add_u32 v117, s43, v11
  v_smfmac_f32_16x16x64_bf16 v[108:111], v[88:91], a[224:231], v9
  s_waitcnt vmcnt(4)
  ds_read_b128 v[32:35], v5 offset:4096
  ds_read_b128 v[36:39], v5 offset:5120
  v_smfmac_f32_16x16x64_bf16 v[108:111], v[92:95], a[232:239], v9
  v_smfmac_f32_16x16x64_bf16 v[108:111], v[96:99], a[240:247], v9
  v_smfmac_f32_16x16x64_bf16 v[108:111], v[100:103], a[248:255], v9
  v_smfmac_f32_16x16x64_bf16 v[112:115], v[48:51], v[136:143], v9
  v_smfmac_f32_16x16x64_bf16 v[112:115], v[52:55], v[152:159], v9
  v_cvt_pk_bf16_f32 v108, v108, v109
  v_cvt_pk_bf16_f32 v109, v110, v111
  v_or_b32 v108, 1, v108
  buffer_store_dwordx2 v[108:109], v4, s[4:7], s26 offen offset:512 sc1
  ds_write_b64 v4, v[108:109] offset:8192
  ds_read_b128 v[48:51], v5 offset:6144
  ds_read_b128 v[52:55], v5 offset:7168
  s_waitcnt lgkmcnt(7)
  v_smfmac_f32_16x16x64_bf16 v[112:115], v[72:75], v[40:47], v9
  ds_read_b128 v[40:43], v5 offset:8192
  ds_read_b128 v[44:47], v5 offset:9216
  s_waitcnt lgkmcnt(7)
  v_smfmac_f32_16x16x64_bf16 v[112:115], v[76:79], v[120:127], v9
  ds_read_b128 v[120:123], v5 offset:10240
  ds_read_b128 v[124:127], v5 offset:11264
  s_waitcnt lgkmcnt(7)
  v_smfmac_f32_16x16x64_bf16 v[112:115], v[80:83], v[32:39], v9
  ds_read_b128 v[32:35], v5 offset:12288
  ds_read_b128 v[36:39], v5 offset:13312
  v_smfmac_f32_16x16x64_bf16 v[112:115], v[56:59], v[160:167], v9
  v_smfmac_f32_16x16x64_bf16 v[112:115], v[60:63], v[168:175], v9
  buffer_load_dwordx2 v[104:105], v4, s[4:7], s28 offen offset:0 sc1
  s_waitcnt lgkmcnt(6)
  v_smfmac_f32_16x16x64_bf16 v[112:115], v[84:87], v[48:55], v9
  ds_read_b128 v[48:51], v5 offset:14336
  ds_read_b128 v[52:55], v5 offset:15360
  v_smfmac_f32_16x16x64_bf16 v[112:115], v[64:67], v[176:183], v9
  v_smfmac_f32_16x16x64_bf16 v[112:115], v[68:71], v[184:191], v9
  s_waitcnt lgkmcnt(6)
  v_smfmac_f32_16x16x64_bf16 v[112:115], v[88:91], v[40:47], v9
  ds_read_b128 v[56:59], v116 offset:16384
  ds_read_b128 v[60:63], v116 offset:17408
  s_waitcnt lgkmcnt(6)
  v_smfmac_f32_16x16x64_bf16 v[112:115], v[92:95], v[120:127], v9
  ds_read_b128 v[64:67], v116 offset:18432
  ds_read_b128 v[68:71], v116 offset:19456
  s_waitcnt lgkmcnt(6)
  v_smfmac_f32_16x16x64_bf16 v[112:115], v[96:99], v[32:39], v9
  ds_read_b128 v[72:75], v116 offset:20480
  ds_read_b128 v[76:79], v116 offset:21504
  s_waitcnt lgkmcnt(6)
  v_smfmac_f32_16x16x64_bf16 v[112:115], v[100:103], v[48:55], v9
  ds_read_b128 v[80:83], v116 offset:22528
  ds_read_b128 v[84:87], v116 offset:23552
  ds_read_b64_tr_b16 v[120:121], v117 offset:0
  ds_read_b64_tr_b16 v[122:123], v117 offset:32
  s_barrier
  s_waitcnt vmcnt(4)
  s_nop 1
  v_cvt_pk_bf16_f32 v112, v112, v113
  v_cvt_pk_bf16_f32 v113, v114, v115
  v_or_b32 v112, 1, v112
  buffer_store_dwordx2 v[112:113], v4, s[4:7], s26 offen offset:1024 sc1
  ds_read_b64_tr_b16 v[32:33], v11 offset:0
  ds_read_b64_tr_b16 v[34:35], v11 offset:32
  ds_read_b64_tr_b16 v[36:37], v11 offset:2048
  ds_read_b64_tr_b16 v[38:39], v11 offset:2080
  ds_read_b64_tr_b16 v[40:41], v11 offset:4096
  ds_read_b64_tr_b16 v[42:43], v11 offset:4128
  ds_read_b64_tr_b16 v[44:45], v11 offset:6144
  ds_read_b64_tr_b16 v[46:47], v11 offset:6176
  v_mov_b64 v[48:49], v[24:25]
  v_mov_b64 v[50:51], v[26:27]
  v_mov_b64 v[52:53], v[28:29]
  v_mov_b64 v[54:55], v[30:31]
  s_add_u32 s43, s19, 1
  s_lshr_b32 s43, s43, 2
  s_waitcnt vmcnt(2)
  buffer_load_dwordx2 v[20:21], v4, s[4:7], s28 offen offset:512 sc1
  s_waitcnt vmcnt(2)
  v_and_b32 v114, 1, v104
  v_cmp_ne_u32 vcc, 1, v114
  s_cbranch_vccnz .kx_262
.kok_263:
  ds_write_b64 v4, v[104:105] offset:25120
  s_waitcnt lgkmcnt(0)
  s_barrier
  ds_read_b64_tr_b16 v[88:89], v10 offset:0
  ds_read_b64_tr_b16 v[90:91], v10 offset:32
  ds_read_b64_tr_b16 v[92:93], v10 offset:2048
  ds_read_b64_tr_b16 v[94:95], v10 offset:2080
  ds_read_b64_tr_b16 v[96:97], v10 offset:4096
  ds_read_b64_tr_b16 v[98:99], v10 offset:4128
  ds_read_b64_tr_b16 v[100:101], v10 offset:6144
  ds_read_b64_tr_b16 v[102:103], v10 offset:6176
  s_waitcnt lgkmcnt(6)
  v_mfma_f32_16x16x32_bf16 v[124:127], v[32:35], v[88:91], 0
  s_waitcnt lgkmcnt(4)
  v_mfma_f32_16x16x32_bf16 v[124:127], v[36:39], v[92:95], v[124:127]
  s_waitcnt lgkmcnt(2)
  v_mfma_f32_16x16x32_bf16 v[124:127], v[40:43], v[96:99], v[124:127]
  s_waitcnt lgkmcnt(0)
  v_mfma_f32_16x16x32_bf16 v[124:127], v[44:47], v[100:103], v[124:127]
  buffer_load_dwordx2 v[118:119], v4, s[4:7], s28 offen offset:1024 sc1
  s_waitcnt vmcnt(1)
  v_and_b32 v114, 1, v20
  v_cmp_ne_u32 vcc, 1, v114
  s_cbranch_vccnz .kx_264
.kok_265:
  ds_write_b64 v4, v[20:21] offset:8704
  v_mfma_f32_16x16x32_bf16 v[104:107], v[56:59], v[88:91], 0
  buffer_store_dwordx2 v[112:113], v4, s[4:7], s36 offen offset:1024 sc1
  v_mfma_f32_16x16x32_bf16 v[108:111], v[60:63], v[88:91], 0
  s_mov_b64 exec, s[12:13]
  buffer_store_dwordx4 v[120:123], v0, s[4:7], s36 offen sc1
  s_mov_b64 exec, -1
  v_mfma_f32_16x16x32_bf16 v[104:107], v[64:67], v[92:95], v[104:107]
  v_mfma_f32_16x16x32_bf16 v[108:111], v[68:71], v[92:95], v[108:111]
  s_waitcnt lgkmcnt(0)
  s_barrier
  ds_read_b64_tr_b16 v[32:33], v11 offset:512
  ds_read_b64_tr_b16 v[34:35], v11 offset:544
  ds_read_b64_tr_b16 v[36:37], v11 offset:2560
  ds_read_b64_tr_b16 v[38:39], v11 offset:2592
  ds_read_b64_tr_b16 v[40:41], v11 offset:4608
  ds_read_b64_tr_b16 v[42:43], v11 offset:4640
  ds_read_b64_tr_b16 v[44:45], v11 offset:6656
  ds_read_b64_tr_b16 v[46:47], v11 offset:6688
  s_cmp_lt_u32 s43, s38
  s_cbranch_scc1 .kvok_267
  s_cmp_lg_u32 s18, 0
  s_cbranch_scc1 .kvo_269
  v_bfe_u32 v120, v5, 4, 4
  v_lshlrev_b32 v120, 7, v120
  s_mov_b32 s42, 123731968
.kvw_266:
  buffer_load_dword v121, v120, s[4:7], s42 offen sc1
  s_waitcnt vmcnt(0)
  v_cmp_gt_u32 vcc, 32, v121
  s_or_b32 s38, vcc_lo, 65536
  s_ff1_i32_b32 s38, s38
  s_cmp_lt_u32 s43, s38
  s_cbranch_scc1 .kvg_268
  s_sleep 4
  s_sub_u32 s20, s20, 1
  s_cbranch_scc0 .kvw_266
  s_mov_b32 s38, 0
.kvg_268:
  v_mov_b32 v120, 163792
  v_mov_b32 v121, s38
  ds_write_b32 v120, v121
.kvo_269:
  s_waitcnt vmcnt(0) lgkmcnt(0)
  s_barrier
  v_mov_b32 v120, 163792
  ds_read_b32 v121, v120
  s_waitcnt lgkmcnt(0)
  v_readfirstlane_b32 s38, v121
  s_cmp_eq_u32 s38, 0
  s_cbranch_scc1 .cabort
.kvok_267:
  v_mfma_f32_16x16x32_bf16 v[104:107], v[72:75], v[96:99], v[104:107]
  buffer_load_dwordx4 v[16:19], v0, s[4:7], s33 offen offset:0 sc1
  v_mfma_f32_16x16x32_bf16 v[108:111], v[76:79], v[96:99], v[108:111]
  buffer_load_dwordx4 v[20:23], v0, s[4:7], s33 offen offset:1024 sc1
  v_mfma_f32_16x16x32_bf16 v[104:107], v[80:83], v[100:103], v[104:107]
  buffer_load_dwordx4 v[24:27], v0, s[4:7], s34 offen offset:0 sc1
  v_mfma_f32_16x16x32_bf16 v[108:111], v[84:87], v[100:103], v[108:111]
  buffer_load_dwordx4 v[28:31], v0, s[4:7], s34 offen offset:1024 sc1
  s_add_u32 s33, s33, 262144
  s_add_u32 s34, s34, 262144
  s_add_u32 s36, s36, 262144
  ds_read_b128 v[56:59], v5 offset:16384
  ds_read_b128 v[60:63], v5 offset:17408
  s_waitcnt lgkmcnt(8)
  v_mfma_f32_16x16x32_bf16 v[124:127], v[32:35], v[88:91], v[124:127]
  v_add_f32_dpp v104, v104, v104 row_ror:8 row_mask:0xf bank_mask:0xf
  v_add_f32_dpp v105, v105, v105 row_ror:8 row_mask:0xf bank_mask:0xf
  v_add_f32_dpp v106, v106, v106 row_ror:8 row_mask:0xf bank_mask:0xf
  s_waitcnt lgkmcnt(6)
  v_mfma_f32_16x16x32_bf16 v[124:127], v[36:39], v[92:95], v[124:127]
  v_add_f32_dpp v107, v107, v107 row_ror:8 row_mask:0xf bank_mask:0xf
  v_add_f32_dpp v108, v108, v108 row_ror:8 row_mask:0xf bank_mask:0xf
  v_add_f32_dpp v109, v109, v109 row_ror:8 row_mask:0xf bank_mask:0xf
  s_waitcnt lgkmcnt(4)
  v_mfma_f32_16x16x32_bf16 v[124:127], v[40:43], v[96:99], v[124:127]
  v_add_f32_dpp v110, v110, v110 row_ror:8 row_mask:0xf bank_mask:0xf
  v_add_f32_dpp v111, v111, v111 row_ror:8 row_mask:0xf bank_mask:0xf
  v_max3_f32 v120, v104, v105, v106
  s_waitcnt lgkmcnt(2)
  v_mfma_f32_16x16x32_bf16 v[124:127], v[44:47], v[100:103], v[124:127]
  v_max3_f32 v120, v120, v107, v108
  v_max3_f32 v121, v109, v110, v111
  v_max_f32 v120, v120, v121
  v_mov_b32 v121, v120
  ds_read_b128 v[64:67], v5 offset:18432
  ds_read_b128 v[68:71], v5 offset:19456
  v_permlane32_swap_b32 v120, v121
  v_max_f32 v120, v120, v121
  v_add_f32_dpp v124, v124, v124 row_ror:8 row_mask:0xf bank_mask:0xf
  v_add_f32_dpp v125, v125, v125 row_ror:8 row_mask:0xf bank_mask:0xf
  v_add_f32_dpp v126, v126, v126 row_ror:8 row_mask:0xf bank_mask:0xf
  v_add_f32_dpp v127, v127, v127 row_ror:8 row_mask:0xf bank_mask:0xf
  v_max3_f32 v120, v120, v124, v125
  v_max3_f32 v120, v120, v126, v127
  v_mov_b32 v121, v120
  ds_read_b128 v[72:75], v5 offset:20480
  ds_read_b128 v[76:79], v5 offset:21504
  v_permlane16_swap_b32 v120, v121
  v_max_f32 v120, v120, v121
  v_mul_f32 v120, s40, v120
  v_pk_fma_f32 v[104:105], v[104:105], s[40:41], v[120:121] op_sel_hi:[1,1,0] neg_lo:[0,0,1] neg_hi:[0,0,1]
  v_pk_fma_f32 v[106:107], v[106:107], s[40:41], v[120:121] op_sel_hi:[1,1,0] neg_lo:[0,0,1] neg_hi:[0,0,1]
  v_pk_fma_f32 v[108:109], v[108:109], s[40:41], v[120:121] op_sel_hi:[1,1,0] neg_lo:[0,0,1] neg_hi:[0,0,1]
  v_pk_fma_f32 v[110:111], v[110:111], s[40:41], v[120:121] op_sel_hi:[1,1,0] neg_lo:[0,0,1] neg_hi:[0,0,1]
  v_exp_f32 v104, v104
  ds_read_b128 v[80:83], v5 offset:22528
  v_exp_f32 v105, v105
  ds_read_b128 v[84:87], v5 offset:23552
  v_exp_f32 v106, v106
  v_cvt_pk_bf16_f32 v32, v104, v105
  v_exp_f32 v107, v107
  ds_read_b128 v[40:43], v5 offset:24576
  v_exp_f32 v108, v108
  v_cvt_pk_bf16_f32 v33, v106, v107
  v_exp_f32 v109, v109
  ds_read_b128 v[44:47], v5 offset:25600
  v_exp_f32 v110, v110
  v_cvt_pk_bf16_f32 v34, v108, v109
  v_exp_f32 v111, v111
  ds_read_b128 v[88:91], v5 offset:26624
  ds_read_b128 v[92:95], v5 offset:27648
  v_pk_fma_f32 v[124:125], v[124:125], s[40:41], v[120:121] op_sel_hi:[1,1,0] neg_lo:[0,0,1] neg_hi:[0,0,1]
  v_cvt_pk_bf16_f32 v35, v110, v111
  v_pk_fma_f32 v[126:127], v[126:127], s[40:41], v[120:121] op_sel_hi:[1,1,0] neg_lo:[0,0,1] neg_hi:[0,0,1]
  v_exp_f32 v124, v124
  v_mfma_f32_16x16x32_bf16 v[96:99], v[48:51], v[32:35], 0
  v_exp_f32 v125, v125
  v_exp_f32 v126, v126
  v_mfma_f32_16x16x32_bf16 v[100:103], v[52:55], v[32:35], 0
  v_exp_f32 v127, v127
  v_cvt_pk_bf16_f32 v36, v124, v125
  v_mfma_f32_16x16x16_bf16 v[48:51], v[12:13], v[32:33], 0
  v_cvt_pk_bf16_f32 v37, v126, v127
  s_waitcnt vmcnt(6)
  v_and_b32 v121, 1, v118
  v_mfma_f32_16x16x16_bf16 v[48:51], v[12:13], v[34:35], v[48:51]
  v_cmp_ne_u32 vcc, 1, v121
  s_cbranch_vccnz .vs_270
.vc_271:
  v_permlane32_swap_b32 v112, v118
  v_permlane32_swap_b32 v113, v119
  v_mfma_f32_16x16x16_bf16 v[48:51], v[14:15], v[36:37], v[48:51]
  v_mov_b64 v[104:105], 0
  v_mfma_f32_16x16x16_bf16 v[96:99], v[112:113], v[36:37], v[96:99]
  v_mov_b64 v[106:107], 0
  v_mfma_f32_16x16x16_bf16 v[100:103], v[118:119], v[36:37], v[100:103]
  v_mov_b64 v[108:109], 0
  v_mov_b64 v[110:111], 0
  v_mov_b64 v[120:121], 0
  v_mov_b64 v[122:123], 0
  v_mov_b64 v[124:125], 0
  v_rcp_f32 v48, v48
  v_mov_b64 v[126:127], 0
  v_pk_mul_f32 v[96:97], v[96:97], v[48:49] op_sel_hi:[1,0]
  v_pk_mul_f32 v[98:99], v[98:99], v[48:49] op_sel_hi:[1,0]
  v_pk_mul_f32 v[100:101], v[100:101], v[48:49] op_sel_hi:[1,0]
  v_pk_mul_f32 v[102:103], v[102:103], v[48:49] op_sel_hi:[1,0]
  v_cvt_pk_bf16_f32 v52, v96, v97
  v_cvt_pk_bf16_f32 v53, v98, v99
  v_cvt_pk_bf16_f32 v54, v100, v101
  v_cvt_pk_bf16_f32 v55, v102, v103
  ds_write_b128 v0, v[52:55] offset:9216
  s_waitcnt lgkmcnt(11)
  v_smfmac_f32_16x16x64_bf16 v[104:107], v[52:55], v[56:63], v9
  s_waitcnt lgkmcnt(9)
  v_smfmac_f32_16x16x64_bf16 v[108:111], v[52:55], v[64:71], v9
  s_waitcnt lgkmcnt(7)
  v_smfmac_f32_16x16x64_bf16 v[120:123], v[52:55], v[72:79], v9
  s_waitcnt lgkmcnt(0)
  s_barrier
  ds_read_b128 v[96:99], v1 offset:9216
  v_smfmac_f32_16x16x64_bf16 v[124:127], v[52:55], v[80:87], v9
  ds_read_b128 v[100:103], v2 offset:9216
  ds_read_b128 v[32:35], v3 offset:9216
  ds_read_b128 v[56:59], v5 offset:28672
  ds_read_b128 v[60:63], v5 offset:29696
  ds_read_b128 v[64:67], v5 offset:30720
  ds_read_b128 v[68:71], v5 offset:31744
  s_waitcnt lgkmcnt(6)
  v_smfmac_f32_16x16x64_bf16 v[104:107], v[96:99], v[192:199], v9
  v_smfmac_f32_16x16x64_bf16 v[108:111], v[96:99], v[200:207], v9
  s_waitcnt lgkmcnt(5)
  v_smfmac_f32_16x16x64_bf16 v[104:107], v[100:103], v[224:231], v9
  v_smfmac_f32_16x16x64_bf16 v[108:111], v[100:103], v[232:239], v9
  s_waitcnt lgkmcnt(4)
  v_smfmac_f32_16x16x64_bf16 v[104:107], v[32:35], v[40:47], v9
  v_smfmac_f32_16x16x64_bf16 v[108:111], v[32:35], v[88:95], v9
  v_smfmac_f32_16x16x64_bf16 v[120:123], v[96:99], v[208:215], v9
  v_smfmac_f32_16x16x64_bf16 v[124:127], v[96:99], v[216:223], v9
  v_cvt_pk_bf16_f32 v104, v104, v105
  v_cvt_pk_bf16_f32 v105, v106, v107
  v_smfmac_f32_16x16x64_bf16 v[120:123], v[100:103], v[240:247], v9
  v_cvt_pk_bf16_f32 v106, v108, v109
  v_cvt_pk_bf16_f32 v107, v110, v111
  v_smfmac_f32_16x16x64_bf16 v[124:127], v[100:103], v[248:255], v9
  v_permlane16_swap_b32 v104, v106
  v_permlane16_swap_b32 v105, v107
  s_waitcnt lgkmcnt(2)
  v_smfmac_f32_16x16x64_bf16 v[120:123], v[32:35], v[56:63], v9
  v_or_b32 v104, 1, v104
  buffer_store_dwordx4 v[104:107], v6, s[4:7], s29 offen sc1
  s_waitcnt lgkmcnt(0)
  v_smfmac_f32_16x16x64_bf16 v[124:127], v[32:35], v[64:71], v9
  s_nop 3
  v_cvt_pk_bf16_f32 v120, v120, v121
  v_cvt_pk_bf16_f32 v121, v122, v123
  s_nop 1
  v_cvt_pk_bf16_f32 v122, v124, v125
  v_cvt_pk_bf16_f32 v123, v126, v127
  s_nop 0
  v_permlane16_swap_b32 v120, v122
  v_permlane16_swap_b32 v121, v123
  v_or_b32 v120, 1, v120
  buffer_store_dwordx4 v[120:123], v6, s[4:7], s30 offen sc1
  v_and_b32 v52, 16, v5
  v_mov_b32 v53, 0x3f80
  v_lshlrev_b32 v52, v52, v53
  s_mov_b32 vcc_lo, 0x30003
  s_mov_b32 vcc_hi, 0x30003
  v_cndmask_b32 v48, 0, v52, vcc
  s_mov_b32 vcc_lo, 0x300030
  s_mov_b32 vcc_hi, 0x300030
  v_cndmask_b32 v49, 0, v52, vcc
  s_mov_b32 vcc_lo, 0x3000300
  s_mov_b32 vcc_hi, 0x3000300
  v_cndmask_b32 v50, 0, v52, vcc
  s_mov_b32 vcc_lo, 0x30003000
  s_mov_b32 vcc_hi, 0x30003000
  v_cndmask_b32 v51, 0, v52, vcc
  v_mov_b32 v52, -1
  s_waitcnt vmcnt(0)
  buffer_load_dwordx4 v[64:67], v7, s[4:7], s31 offen offset:0 sc1
  buffer_load_dwordx4 v[68:71], v7, s[4:7], s32 offen offset:0 sc1
  s_waitcnt vmcnt(0)
.pl_273:
  v_bitop3_b32 v60, v64, v68, 1 bitop3:0x80
  v_cmp_ne_u32 vcc, 1, v60
  s_cbranch_vccnz .pr_274
  v_mfma_f32_16x16x32_bf16 v[56:59], v[48:51], v[64:67], 0
  v_mfma_f32_16x16x32_bf16 v[56:59], v[48:51], v[68:71], v[56:59]
  s_nop 7
  v_add_f32_dpp v60, v56, v56 row_ror:8 row_mask:0xf bank_mask:0x3
  v_add_f32_dpp v60, v57, v57 row_ror:8 row_mask:0xf bank_mask:0xc
  s_nop 1
  v_add_f32_dpp v60, v60, v60 row_shl:4 row_mask:0xf bank_mask:0xf
  s_nop 1
  v_mov_b32_dpp v61, v60 quad_perm:[1,1,3,3] row_mask:0xf bank_mask:0xf
  v_cvt_pk_bf16_f32 v62, v60, v61
  v_min_u32 v62, -2, v62
  buffer_store_dword v62, v8, s[4:7], s23 offen offset:0 sc1
  buffer_store_dword v52, v8, s[4:7], s24 offen offset:0 sc1
  s_add_u32 s19, s19, 1
  s_branch .ctop_220
.clast_222:
  ds_write_b128 v0, v[16:19] offset:16384
  ds_write_b128 v0, v[20:23] offset:17408
  v_mov_b64 v[104:105], 0
  v_mov_b64 v[106:107], 0
  v_mov_b64 v[108:109], 0
  v_mov_b64 v[110:111], 0
  v_mov_b64 v[112:113], 0
  v_mov_b64 v[114:115], 0
  v_xor_b32 v116, 512, v0
  v_xor_b32 v117, 512, v1
  v_xor_b32 v118, 512, v2
  v_xor_b32 v119, 512, v3
  s_waitcnt vmcnt(0)
  buffer_load_dwordx4 v[32:35], v0, s[4:7], s22 offen offset:0 sc1
  buffer_load_dwordx4 v[36:39], v0, s[4:7], s22 offen offset:1024 sc1
  s_waitcnt vmcnt(0)
.ml_275:
  v_max3_u32 v120, v32, v33, v34
  v_max3_u32 v121, v35, v36, v37
  v_max3_u32 v120, v120, v38, v39
  v_max_u32 v120, v120, v121
  v_cmp_eq_u32 vcc, -1, v120
  s_cbranch_vccnz .mr_276
  ds_write_b128 v0, v[32:35]
  ds_write_b128 v0, v[36:39] offset:1024
  ds_read_b128 v[48:51], v116
  ds_read_b128 v[52:55], v116 offset:1024
  v_smfmac_f32_16x16x64_bf16 v[108:111], v[32:35], a[128:135], v9
  s_waitcnt lgkmcnt(2)
  s_barrier
  ds_read_b128 v[56:59], v1 offset:0
  ds_read_b128 v[60:63], v117 offset:0
  v_smfmac_f32_16x16x64_bf16 v[108:111], v[36:39], a[144:151], v9
  ds_read_b128 v[64:67], v1 offset:1024
  ds_read_b128 v[68:71], v117 offset:1024
  s_waitcnt lgkmcnt(5)
  v_smfmac_f32_16x16x64_bf16 v[108:111], v[48:51], a[136:143], v9
  ds_read_b128 v[72:75], v2 offset:0
  ds_read_b128 v[76:79], v118 offset:0
  s_waitcnt lgkmcnt(6)
  v_smfmac_f32_16x16x64_bf16 v[108:111], v[52:55], a[152:159], v9
  ds_read_b128 v[80:83], v2 offset:1024
  ds_read_b128 v[84:87], v118 offset:1024
  v_smfmac_f32_16x16x64_bf16 v[112:115], v[32:35], v[128:135], v9
  ds_read_b128 v[88:91], v3 offset:0
  ds_read_b128 v[92:95], v119 offset:0
  v_smfmac_f32_16x16x64_bf16 v[112:115], v[36:39], v[144:151], v9
  ds_read_b128 v[96:99], v3 offset:1024
  ds_read_b128 v[100:103], v119 offset:1024
  v_mov_b32 v124, 1
  v_mov_b32 v125, s19
  s_mov_b64 exec, 1
  buffer_store_dword v125, off, s[4:7], s37 sc1
  s_mov_b64 exec, -1
  s_waitcnt lgkmcnt(11)
  v_smfmac_f32_16x16x64_bf16 v[108:111], v[56:59], a[160:167], v9
  s_waitcnt lgkmcnt(10)
  v_smfmac_f32_16x16x64_bf16 v[108:111], v[60:63], a[168:175], v9
  s_waitcnt lgkmcnt(9)
  v_smfmac_f32_16x16x64_bf16 v[108:111], v[64:67], a[176:183], v9
  s_waitcnt lgkmcnt(8)
  v_smfmac_f32_16x16x64_bf16 v[108:111], v[68:71], a[184:191], v9
  s_waitcnt lgkmcnt(7)
  v_smfmac_f32_16x16x64_bf16 v[108:111], v[72:75], a[192:199], v9
  ds_read_b128 v[40:43], v5 offset:0
  ds_read_b128 v[44:47], v5 offset:1024
  s_waitcnt lgkmcnt(8)
  v_smfmac_f32_16x16x64_bf16 v[108:111], v[76:79], a[200:207], v9
  ds_read_b128 v[120:123], v5 offset:2048
  ds_read_b128 v[124:127], v5 offset:3072
  s_waitcnt lgkmcnt(9)
  v_smfmac_f32_16x16x64_bf16 v[108:111], v[80:83], a[208:215], v9
  s_waitcnt lgkmcnt(8)
  v_smfmac_f32_16x16x64_bf16 v[108:111], v[84:87], a[216:223], v9
  v_and_b32 v116, -6145, v0
  s_lshl_b32 s43, s18, 11
  v_add_u32 v117, s43, v11
  s_waitcnt lgkmcnt(7)
  v_smfmac_f32_16x16x64_bf16 v[108:111], v[88:91], a[224:231], v9
  s_waitcnt vmcnt(1)
  ds_read_b128 v[32:35], v5 offset:4096
  ds_read_b128 v[36:39], v5 offset:5120
  s_waitcnt lgkmcnt(8)
  v_smfmac_f32_16x16x64_bf16 v[108:111], v[92:95], a[232:239], v9
  s_waitcnt lgkmcnt(7)
  v_smfmac_f32_16x16x64_bf16 v[108:111], v[96:99], a[240:247], v9
  s_waitcnt lgkmcnt(6)
  v_smfmac_f32_16x16x64_bf16 v[108:111], v[100:103], a[248:255], v9
  v_smfmac_f32_16x16x64_bf16 v[112:115], v[48:51], v[136:143], v9
  v_smfmac_f32_16x16x64_bf16 v[112:115], v[52:55], v[152:159], v9
  v_cvt_pk_bf16_f32 v108, v108, v109
  v_cvt_pk_bf16_f32 v109, v110, v111
  ds_write_b64 v4, v[108:109] offset:8192
  ds_read_b128 v[48:51], v5 offset:6144
  ds_read_b128 v[52:55], v5 offset:7168
  s_waitcnt lgkmcnt(7)
  v_smfmac_f32_16x16x64_bf16 v[112:115], v[72:75], v[40:47], v9
  ds_read_b128 v[40:43], v5 offset:8192
  ds_read_b128 v[44:47], v5 offset:9216
  s_waitcnt lgkmcnt(7)
  v_smfmac_f32_16x16x64_bf16 v[112:115], v[76:79], v[120:127], v9
  ds_read_b128 v[120:123], v5 offset:10240
  ds_read_b128 v[124:127], v5 offset:11264
  s_waitcnt lgkmcnt(7)
  v_smfmac_f32_16x16x64_bf16 v[112:115], v[80:83], v[32:39], v9
  ds_read_b128 v[32:35], v5 offset:12288
  ds_read_b128 v[36:39], v5 offset:13312
  v_smfmac_f32_16x16x64_bf16 v[112:115], v[56:59], v[160:167], v9
  v_smfmac_f32_16x16x64_bf16 v[112:115], v[60:63], v[168:175], v9
  s_waitcnt lgkmcnt(6)
  v_smfmac_f32_16x16x64_bf16 v[112:115], v[84:87], v[48:55], v9
  ds_read_b128 v[48:51], v5 offset:14336
  ds_read_b128 v[52:55], v5 offset:15360
  v_smfmac_f32_16x16x64_bf16 v[112:115], v[64:67], v[176:183], v9
  v_smfmac_f32_16x16x64_bf16 v[112:115], v[68:71], v[184:191], v9
  s_waitcnt lgkmcnt(6)
  v_smfmac_f32_16x16x64_bf16 v[112:115], v[88:91], v[40:47], v9
  s_waitcnt lgkmcnt(4)
  v_smfmac_f32_16x16x64_bf16 v[112:115], v[92:95], v[120:127], v9
  s_waitcnt lgkmcnt(2)
  v_smfmac_f32_16x16x64_bf16 v[112:115], v[96:99], v[32:39], v9
  s_waitcnt lgkmcnt(0)
  v_smfmac_f32_16x16x64_bf16 v[112:115], v[100:103], v[48:55], v9
  ds_read_b64_tr_b16 v[120:121], v117 offset:0
  ds_read_b64_tr_b16 v[122:123], v117 offset:32
  s_nop 5
  v_cvt_pk_bf16_f32 v112, v112, v113
  v_cvt_pk_bf16_f32 v113, v114, v115
  buffer_store_dwordx2 v[112:113], v4, s[4:7], s36 offen offset:1024 sc1
  s_waitcnt lgkmcnt(0)
  s_mov_b64 exec, s[12:13]
  buffer_store_dwordx4 v[120:123], v0, s[4:7], s36 offen sc1
  s_mov_b64 exec, -1
  s_waitcnt vmcnt(0)
  s_barrier
  v_mov_b32 v32, 64
  buffer_store_dword v32, off, s[4:7], s37 sc1
  s_branch .cdone
.mr_228:
  s_mov_b64 exec, vcc
  buffer_load_dwordx4 v[32:35], v0, s[4:7], s21 offen offset:0 sc1
  buffer_load_dwordx4 v[36:39], v0, s[4:7], s21 offen offset:1024 sc1
  s_mov_b64 exec, -1
  s_sub_u32 s20, s20, 1
  s_cbranch_scc1 .cabort
  s_waitcnt vmcnt(2)
  s_branch .ml_227
.cent_221:
  s_waitcnt vmcnt(0)
  v_min_u32 v32, -2, v32
  v_min_u32 v33, -2, v33
  v_min_u32 v34, -2, v34
  v_min_u32 v35, -2, v35
  v_min_u32 v36, -2, v36
  v_min_u32 v37, -2, v37
  v_min_u32 v38, -2, v38
  v_min_u32 v39, -2, v39
  ds_write_b128 v0, v[16:19] offset:16384
  ds_write_b128 v0, v[20:23] offset:17408
  v_mov_b64 v[104:105], 0
  v_mov_b64 v[106:107], 0
  v_mov_b64 v[108:109], 0
  v_mov_b64 v[110:111], 0
  v_mov_b64 v[112:113], 0
  v_mov_b64 v[114:115], 0
  v_xor_b32 v116, 512, v0
  v_xor_b32 v117, 512, v1
  v_xor_b32 v118, 512, v2
  v_xor_b32 v119, 512, v3
  v_mov_b32 v124, 1
  v_mov_b32 v125, 0
  s_branch .ml_227
.kx_229:
  buffer_load_dwordx2 v[24:25], v4, s[4:7], s27 offen offset:0 sc1
  s_nop 15
  buffer_load_dwordx2 v[28:29], v4, s[4:7], s27 offen offset:0 sc1
.kxl_277:
  s_waitcnt vmcnt(1)
  v_mov_b64 v[104:105], v[24:25]
  v_and_b32 v114, 1, v104
  v_cmp_ne_u32 vcc, 0, v114
  s_cbranch_vccz .kxk_278
  buffer_load_dwordx2 v[24:25], v4, s[4:7], s27 offen offset:0 sc1
  s_waitcnt vmcnt(1)
  v_mov_b64 v[104:105], v[28:29]
  v_and_b32 v114, 1, v104
  v_cmp_ne_u32 vcc, 0, v114
  s_cbranch_vccz .kxk_278
  buffer_load_dwordx2 v[28:29], v4, s[4:7], s27 offen offset:0 sc1
  s_sub_u32 s20, s20, 1
  s_cbranch_scc0 .kxl_277
  s_branch .cabort
.kxk_278:
  buffer_load_dwordx2 v[20:21], v4, s[4:7], s27 offen offset:512 sc1
  s_branch .kok_230
.kx_231:
  buffer_load_dwordx2 v[24:25], v4, s[4:7], s27 offen offset:512 sc1
  s_nop 15
  buffer_load_dwordx2 v[28:29], v4, s[4:7], s27 offen offset:512 sc1
.kxl_279:
  s_waitcnt vmcnt(1)
  v_mov_b64 v[20:21], v[24:25]
  v_and_b32 v114, 1, v20
  v_cmp_ne_u32 vcc, 0, v114
  s_cbranch_vccz .kok_232
  buffer_load_dwordx2 v[24:25], v4, s[4:7], s27 offen offset:512 sc1
  s_waitcnt vmcnt(1)
  v_mov_b64 v[20:21], v[28:29]
  v_and_b32 v114, 1, v20
  v_cmp_ne_u32 vcc, 0, v114
  s_cbranch_vccz .kok_232
  buffer_load_dwordx2 v[28:29], v4, s[4:7], s27 offen offset:512 sc1
  s_sub_u32 s20, s20, 1
  s_cbranch_scc0 .kxl_279
  s_branch .cabort
.vs_233:
  buffer_load_dwordx2 v[118:119], v4, s[4:7], s27 offen offset:1024 sc1
  s_waitcnt vmcnt(0)
  v_and_b32 v121, 1, v118
  v_cmp_ne_u32 vcc, 0, v121
  s_cbranch_vccz .vc_234
  s_sub_u32 s20, s20, 1
  s_cbranch_scc0 .vs_233
  s_branch .cabort
.pr_237:
  s_mov_b64 exec, vcc
  buffer_load_dwordx4 v[64:67], v7, s[4:7], s31 offen offset:0 sc1
  buffer_load_dwordx4 v[68:71], v7, s[4:7], s32 offen offset:0 sc1
  s_mov_b64 exec, -1
  s_sub_u32 s20, s20, 1
  s_cbranch_scc1 .cabort
  s_waitcnt vmcnt(2)
  s_branch .pl_236
.mr_239:
  s_mov_b64 exec, vcc
  buffer_load_dwordx4 v[32:35], v0, s[4:7], s22 offen offset:0 sc1
  buffer_load_dwordx4 v[36:39], v0, s[4:7], s22 offen offset:1024 sc1
  s_mov_b64 exec, -1
  s_sub_u32 s20, s20, 1
  s_cbranch_scc1 .cabort
  s_waitcnt vmcnt(2)
  s_branch .ml_238
.kx_240:
  buffer_load_dwordx2 v[24:25], v4, s[4:7], s28 offen offset:0 sc1
  s_nop 15
  buffer_load_dwordx2 v[28:29], v4, s[4:7], s28 offen offset:0 sc1
.kxl_280:
  s_waitcnt vmcnt(1)
  v_mov_b64 v[104:105], v[24:25]
  v_and_b32 v114, 1, v104
  v_cmp_ne_u32 vcc, 0, v114
  s_cbranch_vccz .kxk_281
  buffer_load_dwordx2 v[24:25], v4, s[4:7], s28 offen offset:0 sc1
  s_waitcnt vmcnt(1)
  v_mov_b64 v[104:105], v[28:29]
  v_and_b32 v114, 1, v104
  v_cmp_ne_u32 vcc, 0, v114
  s_cbranch_vccz .kxk_281
  buffer_load_dwordx2 v[28:29], v4, s[4:7], s28 offen offset:0 sc1
  s_sub_u32 s20, s20, 1
  s_cbranch_scc0 .kxl_280
  s_branch .cabort
.kxk_281:
  buffer_load_dwordx2 v[20:21], v4, s[4:7], s28 offen offset:512 sc1
  s_branch .kok_241
.kx_242:
  buffer_load_dwordx2 v[24:25], v4, s[4:7], s28 offen offset:512 sc1
  s_nop 15
  buffer_load_dwordx2 v[28:29], v4, s[4:7], s28 offen offset:512 sc1
.kxl_282:
  s_waitcnt vmcnt(1)
  v_mov_b64 v[20:21], v[24:25]
  v_and_b32 v114, 1, v20
  v_cmp_ne_u32 vcc, 0, v114
  s_cbranch_vccz .kok_243
  buffer_load_dwordx2 v[24:25], v4, s[4:7], s28 offen offset:512 sc1
  s_waitcnt vmcnt(1)
  v_mov_b64 v[20:21], v[28:29]
  v_and_b32 v114, 1, v20
  v_cmp_ne_u32 vcc, 0, v114
  s_cbranch_vccz .kok_243
  buffer_load_dwordx2 v[28:29], v4, s[4:7], s28 offen offset:512 sc1
  s_sub_u32 s20, s20, 1
  s_cbranch_scc0 .kxl_282
  s_branch .cabort
.vs_244:
  buffer_load_dwordx2 v[118:119], v4, s[4:7], s28 offen offset:1024 sc1
  s_waitcnt vmcnt(0)
  v_and_b32 v121, 1, v118
  v_cmp_ne_u32 vcc, 0, v121
  s_cbranch_vccz .vc_245
  s_sub_u32 s20, s20, 1
  s_cbranch_scc0 .vs_244
  s_branch .cabort
.pr_248:
  s_mov_b64 exec, vcc
  buffer_load_dwordx4 v[64:67], v7, s[4:7], s31 offen offset:0 sc1
  buffer_load_dwordx4 v[68:71], v7, s[4:7], s32 offen offset:0 sc1
  s_mov_b64 exec, -1
  s_sub_u32 s20, s20, 1
  s_cbranch_scc1 .cabort
  s_waitcnt vmcnt(2)
  s_branch .pl_247
.mr_250:
  s_mov_b64 exec, vcc
  buffer_load_dwordx4 v[32:35], v0, s[4:7], s21 offen offset:0 sc1
  buffer_load_dwordx4 v[36:39], v0, s[4:7], s21 offen offset:1024 sc1
  s_mov_b64 exec, -1
  s_sub_u32 s20, s20, 1
  s_cbranch_scc1 .cabort
  s_waitcnt vmcnt(2)
  s_branch .ml_249
.kx_251:
  buffer_load_dwordx2 v[24:25], v4, s[4:7], s27 offen offset:0 sc1
  s_nop 15
  buffer_load_dwordx2 v[28:29], v4, s[4:7], s27 offen offset:0 sc1
.kxl_283:
  s_waitcnt vmcnt(1)
  v_mov_b64 v[104:105], v[24:25]
  v_and_b32 v114, 1, v104
  v_cmp_ne_u32 vcc, 1, v114
  s_cbranch_vccz .kxk_284
  buffer_load_dwordx2 v[24:25], v4, s[4:7], s27 offen offset:0 sc1
  s_waitcnt vmcnt(1)
  v_mov_b64 v[104:105], v[28:29]
  v_and_b32 v114, 1, v104
  v_cmp_ne_u32 vcc, 1, v114
  s_cbranch_vccz .kxk_284
  buffer_load_dwordx2 v[28:29], v4, s[4:7], s27 offen offset:0 sc1
  s_sub_u32 s20, s20, 1
  s_cbranch_scc0 .kxl_283
  s_branch .cabort
.kxk_284:
  buffer_load_dwordx2 v[20:21], v4, s[4:7], s27 offen offset:512 sc1
  s_branch .kok_252
.kx_253:
  buffer_load_dwordx2 v[24:25], v4, s[4:7], s27 offen offset:512 sc1
  s_nop 15
  buffer_load_dwordx2 v[28:29], v4, s[4:7], s27 offen offset:512 sc1
.kxl_285:
  s_waitcnt vmcnt(1)
  v_mov_b64 v[20:21], v[24:25]
  v_and_b32 v114, 1, v20
  v_cmp_ne_u32 vcc, 1, v114
  s_cbranch_vccz .kok_254
  buffer_load_dwordx2 v[24:25], v4, s[4:7], s27 offen offset:512 sc1
  s_waitcnt vmcnt(1)
  v_mov_b64 v[20:21], v[28:29]
  v_and_b32 v114, 1, v20
  v_cmp_ne_u32 vcc, 1, v114
  s_cbranch_vccz .kok_254
  buffer_load_dwordx2 v[28:29], v4, s[4:7], s27 offen offset:512 sc1
  s_sub_u32 s20, s20, 1
  s_cbranch_scc0 .kxl_285
  s_branch .cabort
.vs_255:
  buffer_load_dwordx2 v[118:119], v4, s[4:7], s27 offen offset:1024 sc1
  s_waitcnt vmcnt(0)
  v_and_b32 v121, 1, v118
  v_cmp_ne_u32 vcc, 1, v121
  s_cbranch_vccz .vc_256
  s_sub_u32 s20, s20, 1
  s_cbranch_scc0 .vs_255
  s_branch .cabort
.pr_259:
  s_mov_b64 exec, vcc
  buffer_load_dwordx4 v[64:67], v7, s[4:7], s31 offen offset:0 sc1
  buffer_load_dwordx4 v[68:71], v7, s[4:7], s32 offen offset:0 sc1
  s_mov_b64 exec, -1
  s_sub_u32 s20, s20, 1
  s_cbranch_scc1 .cabort
  s_waitcnt vmcnt(2)
  s_branch .pl_258
.mr_261:
  s_mov_b64 exec, vcc
  buffer_load_dwordx4 v[32:35], v0, s[4:7], s22 offen offset:0 sc1
  buffer_load_dwordx4 v[36:39], v0, s[4:7], s22 offen offset:1024 sc1
  s_mov_b64 exec, -1
  s_sub_u32 s20, s20, 1
  s_cbranch_scc1 .cabort
  s_waitcnt vmcnt(2)
  s_branch .ml_260
.kx_262:
  buffer_load_dwordx2 v[24:25], v4, s[4:7], s28 offen offset:0 sc1
  s_nop 15
  buffer_load_dwordx2 v[28:29], v4, s[4:7], s28 offen offset:0 sc1
.kxl_286:
  s_waitcnt vmcnt(1)
  v_mov_b64 v[104:105], v[24:25]
  v_and_b32 v114, 1, v104
  v_cmp_ne_u32 vcc, 1, v114
  s_cbranch_vccz .kxk_287
  buffer_load_dwordx2 v[24:25], v4, s[4:7], s28 offen offset:0 sc1
  s_waitcnt vmcnt(1)
  v_mov_b64 v[104:105], v[28:29]
  v_and_b32 v114, 1, v104
  v_cmp_ne_u32 vcc, 1, v114
  s_cbranch_vccz .kxk_287
  buffer_load_dwordx2 v[28:29], v4, s[4:7], s28 offen offset:0 sc1
  s_sub_u32 s20, s20, 1
  s_cbranch_scc0 .kxl_286
  s_branch .cabort
.kxk_287:
  buffer_load_dwordx2 v[20:21], v4, s[4:7], s28 offen offset:512 sc1
  s_branch .kok_263
.kx_264:
  buffer_load_dwordx2 v[24:25], v4, s[4:7], s28 offen offset:512 sc1
  s_nop 15
  buffer_load_dwordx2 v[28:29], v4, s[4:7], s28 offen offset:512 sc1
.kxl_288:
  s_waitcnt vmcnt(1)
  v_mov_b64 v[20:21], v[24:25]
  v_and_b32 v114, 1, v20
  v_cmp_ne_u32 vcc, 1, v114
  s_cbranch_vccz .kok_265
  buffer_load_dwordx2 v[24:25], v4, s[4:7], s28 offen offset:512 sc1
  s_waitcnt vmcnt(1)
  v_mov_b64 v[20:21], v[28:29]
  v_and_b32 v114, 1, v20
  v_cmp_ne_u32 vcc, 1, v114
  s_cbranch_vccz .kok_265
  buffer_load_dwordx2 v[28:29], v4, s[4:7], s28 offen offset:512 sc1
  s_sub_u32 s20, s20, 1
  s_cbranch_scc0 .kxl_288
  s_branch .cabort
.vs_270:
  buffer_load_dwordx2 v[118:119], v4, s[4:7], s28 offen offset:1024 sc1
  s_waitcnt vmcnt(0)
  v_and_b32 v121, 1, v118
  v_cmp_ne_u32 vcc, 1, v121
  s_cbranch_vccz .vc_271
  s_sub_u32 s20, s20, 1
  s_cbranch_scc0 .vs_270
  s_branch .cabort
.pr_274:
  s_mov_b64 exec, vcc
  buffer_load_dwordx4 v[64:67], v7, s[4:7], s31 offen offset:0 sc1
  buffer_load_dwordx4 v[68:71], v7, s[4:7], s32 offen offset:0 sc1
  s_mov_b64 exec, -1
  s_sub_u32 s20, s20, 1
  s_cbranch_scc1 .cabort
  s_waitcnt vmcnt(2)
  s_branch .pl_273
.mr_276:
  s_mov_b64 exec, vcc
  buffer_load_dwordx4 v[32:35], v0, s[4:7], s22 offen offset:0 sc1
  buffer_load_dwordx4 v[36:39], v0, s[4:7], s22 offen offset:1024 sc1
  s_mov_b64 exec, -1
  s_sub_u32 s20, s20, 1
  s_cbranch_scc1 .cabort
  s_waitcnt vmcnt(2)
  s_branch .ml_275
.cdone:
  s_cmp_eq_u32 s46, -1
  s_cbranch_scc1 .next
  s_branch .decode
.cabort:
  s_mov_b64 exec, -1
  v_mov_b32 v120, 0xdead
  v_mov_b32 v121, 0
  buffer_store_dword v120, v121, s[8:11], 0 offen offset:28 sc1
  s_waitcnt vmcnt(0)
  s_endpgm
.section .rodata,"a"
.p2align 6
.amdhsa_kernel gated_mix__memory_aug_recurrent_mem_tr__swiglu_ffn__prompt_kernel
  .amdhsa_next_free_vgpr 512
  .amdhsa_next_free_sgpr 102
  .amdhsa_accum_offset 256
  .amdhsa_group_segment_fixed_size 0
  .amdhsa_kernarg_size 120
  .amdhsa_user_sgpr_count 2
  .amdhsa_user_sgpr_kernarg_segment_ptr 1
  .amdhsa_system_sgpr_workgroup_id_x 1
.end_amdhsa_kernel
```
